```python
import torch

def _softmax(x, axis=-1):
    return torch.softmax(x, dim=axis)
def _gelu(x):
    return torch.nn.functional.gelu(x, approximate="tanh")
def _silu(x):
    return torch.nn.functional.silu(x)
def _sigmoid(x):
    return torch.sigmoid(x)
def _layernorm(x, axis=-1, eps=1e-5):
    m = x.mean(dim=axis, keepdim=True)
    v = x.var(dim=axis, keepdim=True, unbiased=False)
    return (x - m) / torch.sqrt(v + eps)
def _scatter_add(tgt, idx, src, axis=0):
    return tgt.clone().index_add_(axis, idx, src)
def _segment_sum(src, seg, n):
    out = torch.zeros((n,) + src.shape[1:], dtype=src.dtype)
    return out.index_add_(0, seg, src)
def _pad(x, pw):
    flat = tuple(v for pair in reversed(pw) for v in pair)
    return torch.nn.functional.pad(x, flat)

kernel_name = 'parallel_sum__spectral_gfnet__dense_activation_gelu__prompt'

def setup_inputs():

    _w = (lambda a: (lambda t: t.to(torch.bfloat16) if t.is_floating_point() else t)(torch.as_tensor(a)))
    def _A_setup():
        B, S, D = 1, 2048, 1024
        Df = D // 2 + 1
        return {
            "x": _w((lambda *s: torch.randn(*s, dtype=torch.bfloat16) * 0.05)(B, S, D)),
            "w_r": _w((lambda *s: torch.randn(*s, dtype=torch.bfloat16) * 0.4)(S, Df) * 0.02),
            "w_i": _w((lambda *s: torch.randn(*s, dtype=torch.bfloat16) * 0.4)(S, Df) * 0.02),
        }
    _A_in = _A_setup()

    def _B_setup():
        B, S, D, F = 1, 2048, 1024, 3584
        return {
            "x": _w((lambda *s: torch.randn(*s, dtype=torch.bfloat16) * 0.05)(B, S, D)),
            "w1": _w((lambda *s: torch.randn(*s, dtype=torch.bfloat16) * 0.4)(D, F) * (D ** -0.5)),
            "b1": _w((lambda *s: torch.randn(*s, dtype=torch.bfloat16) * 12.8)(F) * 0.01),
            "w2": _w((lambda *s: torch.randn(*s, dtype=torch.bfloat16) * 0.1)(F, D) * (F ** -0.5)),
            "b2": _w((lambda *s: torch.randn(*s, dtype=torch.bfloat16) * 1.6)(D) * 0.01),
        }
    _B_in = _B_setup()

    return {
        "A_x": _A_in["x"],
        "A_w_r": _A_in["w_r"],
        "A_w_i": _A_in["w_i"],
        "B_x": _B_in["x"],
        "B_w1": _B_in["w1"],
        "B_b1": _B_in["b1"],
        "B_w2": _B_in["w2"],
        "B_b2": _B_in["b2"],
    }

def reference(A_x, A_w_r, A_w_i, B_x, B_w1, B_b1, B_w2, B_b2):
    def _A_ref(x, w_r, w_i):
        B, S, D = x.shape
        X = (lambda x, axes=(-2,-1): torch.fft.rfft2(x.float(), dim=axes))(x, axes=(-2, -1))
        W = w_r + 1j * w_i
        X = X * W
        y = (lambda x, s, axes=(-2,-1): torch.fft.irfft2(x, s=s, dim=axes).to(torch.bfloat16))(X, (S, D), axes=(-2, -1))
        return y

    def _B_ref(x, w1, b1, w2, b2):
        h = torch.einsum("bsd,df->bsf", x, w1) + b1
        h = _gelu(h)
        return torch.einsum("bsf,fd->bsd", h, w2) + b2

    x = A_x
    xn = _layernorm(x, axis=-1)
    return x + _A_ref(xn, A_w_r, A_w_i) + _B_ref(xn, B_w1, B_b1, B_w2, B_b2)
```

```asm
; @launch grid=(256,1,1) block=(256,1,1) lds=163840
.amdgcn_target "amdgcn-amd-amdhsa--gfx950"
.text
.globl parallel_sum__spectral_gfnet__dense_activation_gelu__prompt_kernel
.p2align 8
.type parallel_sum__spectral_gfnet__dense_activation_gelu__prompt_kernel,@function
parallel_sum__spectral_gfnet__dense_activation_gelu__prompt_kernel:
s_load_dwordx2 s[16:17], s[0:1], 0
s_load_dwordx2 s[24:25], s[0:1], 80
s_load_dwordx8 s[8:15], s[0:1], 32
s_load_dwordx2 s[32:33], s[0:1], 64
s_load_dwordx4 s[4:7], s[0:1], 8
s_cmp_ge_u32 s2, 256
s_cbranch_scc1 L_end
s_mov_b32 s3, 0x20000
v_lshrrev_b32 v1, 6, v0
s_nop 0
v_readfirstlane_b32 s36, v1
v_and_b32 v0, 63, v0
s_bfe_u32 s45, s2, 0x10001
s_bfe_u32 s46, s2, 0x20003
s_lshl1_add_u32 s37, s46, s45
s_bfe_u32 s45, s2, 0x10002
s_mul_i32 s45, s45, 3
s_and_b32 s46, s2, 1
s_xor_b32 s38, s45, s46
s_lshr_b32 s39, s2, 5
s_lshl_b32 s47, s36, 12
s_lshl_b32 s48, s36, 13
v_lshlrev_b32 v20, 4, v0
s_getpc_b64 s[66:67]
L_pc:
s_lshr_b32 s45, s2, 3
s_lshl2_add_u32 s45, s45, s36
s_lshl_b32 s45, s45, 7
v_lshl_add_u32 v55, v0, 14, s45
v_min_u32 v55, L_code_end-L_pc-4, v55
s_mov_b64 exec, 127
global_load_dword v55, v55, s[66:67]
s_mov_b64 exec, -1
s_mov_b32 s18, 0x400000
s_mov_b32 s19, 0x20000
s_mov_b32 s26, 0x10000000
s_mov_b32 s27, 0x20000
s_mov_b32 s34, 0x400000
s_mov_b32 s35, 0x20000
s_lshr_b32 s54, s2, 3
s_and_b32 s55, s2, 7
s_lshl_b32 s55, s55, 2
s_add_u32 s55, s55, s36
s_lshl_b32 s55, s55, 5
s_add_u32 s56, s55, s54
s_add_u32 m0, s47, 131072
s_lshl_b32 s55, s56, 11
s_add_u32 s57, s55, 2095104
s_waitcnt lgkmcnt(0)
buffer_load_dwordx4 v20, s[16:19], s55 offen offset:0 lds
buffer_load_dwordx4 v20, s[16:19], s55 offen offset:1024 lds
buffer_load_dwordx4 v20, s[16:19], s57 offen offset:2048 lds
buffer_load_dwordx4 v20, s[16:19], s57 offen offset:3072 lds
s_load_dword s53, s[24:25], 0
s_cmp_ge_u32 s2, 224
s_cbranch_scc1 L_noearly
s_lshl_b32 s40, s38, 1
s_add_u32 s40, s40, 2
v_lshrrev_b32 v1, 3, v0
v_lshrrev_b32 v36, 4, v0
v_and_b32 v37, 7, v0
v_xor_b32 v37, v37, v36
v_lshlrev_b32 v1, 11, v1
v_lshl_add_u32 v2, v37, 4, v1
v_xor_b32_e64 v3, 64, v2
v_add_u32 v3, 15360, v3
v_add_u32 v4, 30720, v2
v_add_u32 v5, 30720, v3
v_lshrrev_b32 v36, 4, v0
v_lshlrev_b32 v37, 1, v36
v_and_b32 v38, 15, v0
v_xor_b32 v37, v37, v38
v_mul_u32_u24 v36, 7168, v36
v_lshl_add_u32 v6, v37, 4, v36
v_xor_b32 v9, 128, v6
v_add_u32 v7, 27648, v6
v_add_u32 v8, 55296, v9
v_add_u32 v9, 82944, v9
s_lshl_b32 s41, s37, 19
s_add_u32 s45, s36, s40
s_and_b32 s45, s45, 7
s_lshl_b32 s45, s45, 16
s_add_u32 s42, s41, s45
s_lshr_b32 s51, s2, 3
s_add_u32 s51, s51, s39
s_and_b32 s51, s51, 3
s_lshl_b32 s51, s51, 1
s_and_b32 s89, s37, 1
s_mul_i32 s45, s38, 7
s_add_u32 s45, s45, s39
s_lshl_b32 s44, s45, 8
s_mul_i32 s45, s36, 114688
s_add_u32 s43, s45, s44
s_mov_b32 s20, s8
s_mov_b32 s21, s9
s_mov_b32 s22, 0x700000
s_mov_b32 s23, 0x20000
s_add_u32 m0, s47, 0x0
s_add_u32 s52, s51, 0
s_and_b32 s52, s52, 7
s_lshl_b32 s49, s52, 7
s_add_u32 s49, s49, s42
buffer_load_dwordx4 v2, s[16:19], s49 offen offset:0 lds
buffer_load_dwordx4 v3, s[16:19], s49 offen offset:1024 lds
buffer_load_dwordx4 v4, s[16:19], s49 offen offset:2048 lds
buffer_load_dwordx4 v5, s[16:19], s49 offen offset:3072 lds
s_add_u32 m0, s47, 0x4000
s_mul_i32 s50, s52, 458752
s_add_u32 s50, s50, s43
buffer_load_dwordx4 v6, s[20:23], s50 offen offset:0 lds
buffer_load_dwordx4 v7, s[20:23], s50 offen offset:1024 lds
s_branch L_early2
s_nop 0
L_noearly:
s_mov_b32 s84, s4
s_mov_b32 s85, s5
s_mov_b32 s86, 0x201000
s_mov_b32 s87, 0x20000
s_lshl_b32 s41, s38, 3
s_bfe_u32 s40, s2, 0x20003
s_lshl_b32 s40, s40, 1
s_add_u32 s41, s41, s40
s_and_b32 s40, s37, 1
s_add_u32 s41, s41, s40
v_lshrrev_b32 v40, 2, v0
v_mul_u32_u24 v40, 2052, v40
v_lshrrev_b32 v41, 4, v0
v_xor_b32 v41, v41, v0
v_and_b32 v41, 3, v41
v_lshl_add_u32 v40, v41, 4, v40
v_add_u32 v41, 31808, v40
v_add_u32 v42, 63616, v40
v_add_u32 v43, 95424, v40
s_and_b32 s40, s41, 1
s_mul_i32 s40, s40, 1028
s_lshr_b32 s51, s41, 1
s_lshl_b32 s51, s51, 6
s_add_u32 s40, s40, s51
s_mul_i32 s51, s36, 262656
s_add_u32 s40, s40, s51
s_bfe_u32 s51, s2, 0x10003
s_lshl_b32 s42, s51, 15
s_add_u32 s42, s42, s48
s_mul_i32 s51, s51, 1050624
s_add_u32 s43, s40, s51
s_sub_u32 s52, s40, s51
s_xor_b32 m0, s42, 0
s_add_u32 s51, s43, 0
buffer_load_dwordx4 v40, s[84:87], s51 offen offset:0 lds
buffer_load_dwordx4 v41, s[84:87], s51 offen offset:1024 lds
buffer_load_dwordx4 v42, s[84:87], s51 offen offset:2048 lds
L_early2:
v_and_b32 v248, 31, v0
v_cvt_f32_u32 v248, v248
v_lshrrev_b32 v249, 5, v0
v_cvt_f32_u32 v249, v249
v_mul_f32 v250, 0x3d000000, v248
v_mul_f32_e64 v251, v250, v249
v_mul_f32 v251, 0x41000000, v251
v_mov_b32_e64 v240, v251
v_fmamk_f32 v241, v250, 0x3f800000, v251
v_cos_f32 v242, v240
v_cos_f32 v243, v241
v_sin_f32 v244, v240
v_sin_f32 v245, v241
v_cvt_pk_bf16_f32 v64, v242, v243
v_cvt_pk_bf16_f32 v72, -v244, -v245
v_fmamk_f32 v240, v250, 0x40000000, v251
v_fmamk_f32 v241, v250, 0x40400000, v251
v_cos_f32 v242, v240
v_cos_f32 v243, v241
v_sin_f32 v244, v240
v_sin_f32 v245, v241
v_cvt_pk_bf16_f32 v65, v242, v243
v_cvt_pk_bf16_f32 v73, -v244, -v245
v_fmamk_f32 v240, v250, 0x40800000, v251
v_fmamk_f32 v241, v250, 0x40a00000, v251
v_cos_f32 v242, v240
v_cos_f32 v243, v241
v_sin_f32 v244, v240
v_sin_f32 v245, v241
v_cvt_pk_bf16_f32 v66, v242, v243
v_cvt_pk_bf16_f32 v74, -v244, -v245
v_fmamk_f32 v240, v250, 0x40c00000, v251
v_fmamk_f32 v241, v250, 0x40e00000, v251
v_cos_f32 v242, v240
v_cos_f32 v243, v241
v_sin_f32 v244, v240
v_sin_f32 v245, v241
v_cvt_pk_bf16_f32 v67, v242, v243
v_cvt_pk_bf16_f32 v75, -v244, -v245
v_fmamk_f32 v240, v250, 0x41800000, v251
v_fmamk_f32 v241, v250, 0x41880000, v251
v_cos_f32 v242, v240
v_cos_f32 v243, v241
v_sin_f32 v244, v240
v_sin_f32 v245, v241
v_cvt_pk_bf16_f32 v68, v242, v243
v_cvt_pk_bf16_f32 v76, -v244, -v245
v_fmamk_f32 v240, v250, 0x41900000, v251
v_fmamk_f32 v241, v250, 0x41980000, v251
v_cos_f32 v242, v240
v_cos_f32 v243, v241
v_sin_f32 v244, v240
v_sin_f32 v245, v241
v_cvt_pk_bf16_f32 v69, v242, v243
v_cvt_pk_bf16_f32 v77, -v244, -v245
v_fmamk_f32 v240, v250, 0x41a00000, v251
v_fmamk_f32 v241, v250, 0x41a80000, v251
v_cos_f32 v242, v240
v_cos_f32 v243, v241
v_sin_f32 v244, v240
v_sin_f32 v245, v241
v_cvt_pk_bf16_f32 v70, v242, v243
v_cvt_pk_bf16_f32 v78, -v244, -v245
v_fmamk_f32 v240, v250, 0x41b00000, v251
v_fmamk_f32 v241, v250, 0x41b80000, v251
v_cos_f32 v242, v240
v_cos_f32 v243, v241
v_sin_f32 v244, v240
v_sin_f32 v245, v241
v_cvt_pk_bf16_f32 v71, v242, v243
v_cvt_pk_bf16_f32 v79, -v244, -v245
v_bfe_u32 v240, v0, 2, 2
v_lshrrev_b32_e64 v241, 5, v0
v_lshl_add_u32 v240, v241, 3, v240
v_lshlrev_b32_e64 v240, 6, v240
v_bfe_u32 v241, v0, 4, 1
v_lshl_add_u32 v240, v241, 5, v240
v_and_b32_e64 v241, 3, v0
v_lshl_add_u32 v240, v241, 3, v240
s_add_u32 s57, s47, 131072
v_add_u32_e64 v62, s57, v240
v_mov_b32 v253, 0x3f803f80
v_mul_f32 v250, 0x3a800000, v248
v_mul_f32 v251, v250, v249
v_mul_f32 v251, 4.0, v251
v_mov_b32 v240, v251
v_cos_f32 v80, v240
v_sin_f32_e64 v96, v240
v_fmamk_f32 v241, v250, 0x3f800000, v251
v_cos_f32 v81, v241
v_sin_f32 v97, v241
v_fmamk_f32 v240, v250, 0x40000000, v251
v_cos_f32 v82, v240
v_sin_f32 v98, v240
v_fmamk_f32 v241, v250, 0x40400000, v251
v_cos_f32 v83, v241
v_sin_f32 v99, v241
v_fmamk_f32 v240, v250, 0x41000000, v251
v_cos_f32 v84, v240
v_sin_f32 v100, v240
v_and_b32 v49, 3, v0
v_lshl_add_u32 v49, s2, 2, v49
v_mul_u32_u24 v51, 2052, v49
s_mov_b64 exec, 15
global_load_dword v50, v51, s[4:5] offset:1024
global_load_dword v51, v51, s[6:7] offset:1024
s_mov_b64 exec, -1
s_lshr_b32 s45, s2, 3
s_lshl_b32 s45, s45, 2
s_add_u32 s45, s45, s36
s_mul_i32 s61, s45, -8208
s_add_u32 s61, s61, 1050624
s_mul_i32 s45, s45, 16416
s_and_b32 s46, s37, 1
s_mul_i32 s46, s46, 1028
s_add_u32 s45, s45, s46
s_lshl_b32 s46, s38, 8
s_add_u32 s45, s45, s46
v_and_b32_e64 v53, 3, v0
v_bfe_u32 v54, v0, 2, 3
v_mul_u32_u24 v54, 2052, v54
v_lshlrev_b32_e64 v53, 7, v53
v_min_u32 v53, 252, v53
v_add3_u32 v54, v53, v54, s45
v_add_u32_e64 v52, s61, v54
v_fmamk_f32 v241, v250, 0x41100000, v251
v_cos_f32 v85, v241
v_sin_f32 v101, v241
v_fmamk_f32 v240, v250, 0x41200000, v251
v_cos_f32 v86, v240
v_sin_f32 v102, v240
v_fmamk_f32 v241, v250, 0x41300000, v251
v_cos_f32 v87, v241
v_sin_f32 v103, v241
v_fmamk_f32 v240, v250, 0x41800000, v251
v_cos_f32 v88, v240
v_sin_f32 v104, v240
v_fmamk_f32 v241, v250, 0x41880000, v251
v_cos_f32 v89, v241
v_sin_f32 v105, v241
v_fmamk_f32 v240, v250, 0x41900000, v251
v_cos_f32 v90, v240
v_sin_f32 v106, v240
v_fmamk_f32 v241, v250, 0x41980000, v251
v_cos_f32 v91, v241
v_sin_f32 v107, v241
v_fmamk_f32 v240, v250, 0x41c00000, v251
v_cos_f32 v92, v240
v_sin_f32 v108, v240
v_fmamk_f32 v241, v250, 0x41c80000, v251
v_cos_f32 v93, v241
v_sin_f32 v109, v241
v_fmamk_f32 v240, v250, 0x41d00000, v251
v_cos_f32 v94, v240
v_sin_f32 v110, v240
v_fmamk_f32 v241, v250, 0x41d80000, v251
v_cos_f32 v95, v241
v_sin_f32 v111, v241
v_bfe_u32 v250, v0, 1, 4
v_cvt_f32_u32_e64 v250, v250
v_mul_f32 v250, 0x3d000000, v250
v_and_b32 v252, 1, v0
v_cvt_f32_u32 v252, v252
v_mul_f32 v251, v250, v249
v_mul_f32 v251, 4.0, v251
v_fmac_f32 v251, 0x3e800000, v252
v_mov_b32 v240, v251
v_cos_f32 v241, v240
v_sin_f32 v242, v240
s_nop 0
v_cvt_pk_bf16_f32 v112, v241, v242
v_fmamk_f32 v243, v250, 0x3f800000, v251
v_cos_f32_e64 v244, v243
v_sin_f32 v245, v243
s_nop 0
v_cvt_pk_bf16_f32 v113, v244, v245
v_fmamk_f32 v240, v250, 0x40000000, v251
v_cos_f32_e64 v241, v240
v_sin_f32 v242, v240
s_nop 0
v_cvt_pk_bf16_f32 v114, v241, v242
v_fmamk_f32 v243, v250, 0x40400000, v251
v_cos_f32_e64 v244, v243
v_sin_f32 v245, v243
s_nop 0
v_cvt_pk_bf16_f32 v115, v244, v245
v_fmamk_f32 v240, v250, 0x41000000, v251
v_cos_f32_e64 v241, v240
v_sin_f32 v242, v240
s_nop 0
v_cvt_pk_bf16_f32 v116, v241, v242
v_fmamk_f32 v243, v250, 0x41100000, v251
v_cos_f32_e64 v244, v243
v_sin_f32 v245, v243
s_nop 0
v_cvt_pk_bf16_f32 v117, v244, v245
v_fmamk_f32 v240, v250, 0x41200000, v251
v_cos_f32_e64 v241, v240
v_sin_f32 v242, v240
s_nop 0
v_cvt_pk_bf16_f32 v118, v241, v242
v_fmamk_f32 v243, v250, 0x41300000, v251
v_cos_f32_e64 v244, v243
v_sin_f32 v245, v243
s_nop 0
v_cvt_pk_bf16_f32 v119, v244, v245
v_fmamk_f32 v240, v250, 0x41800000, v251
v_cos_f32_e64 v241, v240
v_sin_f32 v242, v240
s_nop 0
v_cvt_pk_bf16_f32 v120, v241, v242
v_fmamk_f32 v243, v250, 0x41880000, v251
v_cos_f32_e64 v244, v243
v_sin_f32 v245, v243
s_nop 0
v_cvt_pk_bf16_f32 v121, v244, v245
v_fmamk_f32 v240, v250, 0x41900000, v251
v_cos_f32_e64 v241, v240
v_sin_f32 v242, v240
s_nop 0
v_cvt_pk_bf16_f32 v122, v241, v242
v_fmamk_f32 v243, v250, 0x41980000, v251
v_cos_f32_e64 v244, v243
v_sin_f32 v245, v243
s_nop 0
v_cvt_pk_bf16_f32 v123, v244, v245
v_fmamk_f32 v240, v250, 0x41c00000, v251
v_cos_f32_e64 v241, v240
v_sin_f32 v242, v240
s_nop 0
v_cvt_pk_bf16_f32 v124, v241, v242
v_fmamk_f32 v243, v250, 0x41c80000, v251
v_cos_f32_e64 v244, v243
v_sin_f32 v245, v243
s_nop 0
v_cvt_pk_bf16_f32 v125, v244, v245
v_fmamk_f32 v240, v250, 0x41d00000, v251
v_cos_f32_e64 v241, v240
v_sin_f32 v242, v240
s_nop 0
v_cvt_pk_bf16_f32 v126, v241, v242
v_fmamk_f32 v243, v250, 0x41d80000, v251
v_cos_f32 v244, v243
v_sin_f32 v245, v243
s_nop 0
v_cvt_pk_bf16_f32 v127, v244, v245
s_lshl_b32 s55, s36, 2
s_add_u32 s55, s55, 147456
v_lshrrev_b32 v61, 5, v0
v_lshlrev_b32 v61, 11, v61
v_add_u32_e64 v61, s55, v61
s_bfe_u32 s55, s2, 0x30003
v_add_u32_e64 v240, -1, v0
v_bfe_u32 v241, v0, 1, 2
v_bfe_u32 v60, v0, 3, 2
v_and_b32_e64 v59, 1, v0
v_lshl_add_u32 v59, v60, 1, v59
v_lshl_add_u32 v59, v241, 3, v59
v_xor_b32_e64 v59, s55, v59
v_lshl_add_u32 v59, v59, 4, v61
v_bfe_u32 v241, v240, 1, 2
v_bfe_u32 v60, v240, 3, 2
v_and_b32_e64 v240, 1, v240
v_lshl_add_u32 v240, v60, 1, v240
v_lshl_add_u32 v240, v241, 3, v240
v_xor_b32_e64 v240, s55, v240
v_lshl_add_u32 v240, v240, 4, v61
v_and_b32_e64 v241, 31, v0
v_cmp_eq_u32 vcc, 0, v241
v_add_u32 v241, -1024, v240
s_nop 0
v_cndmask_b32 v60, v240, v241, vcc
v_cmp_eq_u32 vcc, 0, v0
v_add_u32 v241, 16384, v60
s_nop 0
v_cndmask_b32 v61, v60, v241, vcc
v_fma_f32 v252, v252, -2.0, 1.0
s_waitcnt lgkmcnt(0)
s_and_b32 s53, s53, -16
s_add_u32 s53, s53, 0x9e3779b0
s_cmp_ge_u32 s2, 224
s_cbranch_scc1 L_fft
s_mov_b32 s28, s10
s_mov_b32 s29, s11
s_mov_b32 s30, 0x1c00
s_mov_b32 s31, 0x20000
v_and_b32 v37, 15, v0
v_bfe_u32 v38, v0, 1, 3
v_lshrrev_b32 v39, 4, v0
v_xor_b32 v38, v38, v39
v_lshlrev_b32_e64 v38, 4, v38
v_lshl_add_u32 v10, v37, 7, v38
v_xor_b32_e64 v11, 64, v10
v_add_u32 v12, 0x10000, v10
v_add_u32 v13, 0x10000, v11
v_bfe_u32 v40, v0, 2, 2
v_lshl_add_u32 v41, v39, 3, v40
v_bfe_u32 v42, v0, 2, 3
s_lshl_b32 s46, s36, 1
v_xor_b32 v42, s46, v42
v_and_b32_e64 v43, 3, v0
v_lshl_add_u32 v42, v42, 2, v43
v_lshlrev_b32_e64 v42, 3, v42
v_lshl_add_u32 v17, v41, 8, v42
v_add_u32 v16, 0x4000, v17
v_add_u32 v18, 0x14000, v17
v_xor_b32 v17, 32, v16
v_xor_b32 v19, 32, v18
v_lshlrev_b32_e64 v22, 5, v37
v_add_u32 v22, 131072, v22
buffer_load_dwordx4 v8, s[20:23], s50 offen offset:2048 lds
v_cmp_eq_u32 vcc, 0, v37
v_mov_b32 v44, 0x3f803f80
s_nop 0
v_cndmask_b32 v24, 0, v44, vcc
v_cndmask_b32 v25, 0, v44, vcc
v_cndmask_b32 v26, 0, v44, vcc
v_cndmask_b32 v27, 0, v44, vcc
v_lshlrev_b32 v37, 1, v37
s_lshl_b32 s46, s36, 6
s_add_u32 s45, s44, s46
buffer_load_ushort v32, v37, s[28:31], s45 offen offset:0
buffer_load_ushort v33, v37, s[28:31], s45 offen offset:32
s_waitcnt vmcnt(11)
ds_read_b64_tr_b16 v[128:129], v62 offset:0
ds_read_b64_tr_b16 v[130:131], v62 offset:256
ds_read_b64_tr_b16 v[132:133], v62 offset:1024
ds_read_b64_tr_b16 v[134:135], v62 offset:1280
ds_read_b64_tr_b16 v[136:137], v62 offset:2048
ds_read_b64_tr_b16 v[138:139], v62 offset:2304
ds_read_b64_tr_b16 v[140:141], v62 offset:3072
ds_read_b64_tr_b16 v[142:143], v62 offset:3328
s_waitcnt lgkmcnt(7)
v_dot2_f32_bf16 v240, v128, v253, 0
v_dot2_f32_bf16 v241, v128, v128, 0
v_dot2_f32_bf16 v240, v129, v253, v240
v_dot2_f32_bf16 v241, v129, v129, v241
s_waitcnt lgkmcnt(6)
v_dot2_f32_bf16 v240, v130, v253, v240
buffer_load_dwordx4 v9, s[20:23], s50 offen offset:3072 lds
v_dot2_f32_bf16 v241, v130, v130, v241
v_dot2_f32_bf16 v240, v131, v253, v240
v_dot2_f32_bf16 v241, v131, v131, v241
s_waitcnt lgkmcnt(5)
v_dot2_f32_bf16 v240, v132, v253, v240
v_dot2_f32_bf16 v241, v132, v132, v241
v_dot2_f32_bf16 v240, v133, v253, v240
v_dot2_f32_bf16 v241, v133, v133, v241
s_waitcnt lgkmcnt(4)
v_dot2_f32_bf16 v240, v134, v253, v240
v_dot2_f32_bf16 v241, v134, v134, v241
v_dot2_f32_bf16 v240, v135, v253, v240
v_dot2_f32_bf16 v241, v135, v135, v241
s_waitcnt lgkmcnt(3)
v_dot2_f32_bf16 v243, v136, v253, 0
v_dot2_f32_bf16 v244, v136, v136, 0
v_dot2_f32_bf16 v243, v137, v253, v243
v_dot2_f32_bf16 v244, v137, v137, v244
s_waitcnt lgkmcnt(2)
v_dot2_f32_bf16 v243, v138, v253, v243
v_dot2_f32_bf16 v244, v138, v138, v244
v_dot2_f32_bf16 v243, v139, v253, v243
v_dot2_f32_bf16 v244, v139, v139, v244
s_waitcnt lgkmcnt(1)
v_dot2_f32_bf16 v243, v140, v253, v243
v_dot2_f32_bf16 v244, v140, v140, v244
v_dot2_f32_bf16 v243, v141, v253, v243
v_dot2_f32_bf16 v244, v141, v141, v244
s_waitcnt lgkmcnt(0)
v_dot2_f32_bf16 v243, v142, v253, v243
s_add_u32 m0, s47, 0x8000
s_add_u32 s52, s51, 1
s_and_b32 s52, s52, 7
s_lshl_b32 s49, s52, 7
s_add_u32 s49, s49, s42
buffer_load_dwordx4 v2, s[16:19], s49 offen offset:0 lds
v_dot2_f32_bf16 v244, v142, v142, v244
v_dot2_f32_bf16 v243, v143, v253, v243
v_dot2_f32_bf16 v244, v143, v143, v244
v_mfma_f32_32x32x16_bf16 v[144:159], v[128:131], v[64:67], 0
v_mul_f32 v242, v240, v252
v_mul_f32 v245, v243, v252
v_add_f32_dpp v240, v240, v240 row_shr:1 row_mask:0xf bank_mask:0xf bound_ctrl:0
v_add_f32_dpp v241, v241, v241 row_shr:1 row_mask:0xf bank_mask:0xf bound_ctrl:0
v_add_f32_dpp v242, v242, v242 row_shr:1 row_mask:0xf bank_mask:0xf bound_ctrl:0
v_add_f32_dpp v243, v243, v243 row_shr:1 row_mask:0xf bank_mask:0xf bound_ctrl:0
v_mfma_f32_32x32x16_bf16 v[160:175], v[128:131], v[72:75], 0
buffer_load_dwordx4 v3, s[16:19], s49 offen offset:1024 lds
v_add_f32_dpp v244, v244, v244 row_shr:1 row_mask:0xf bank_mask:0xf bound_ctrl:0
v_add_f32_dpp v245, v245, v245 row_shr:1 row_mask:0xf bank_mask:0xf bound_ctrl:0
v_add_f32_dpp v240, v240, v240 row_shr:2 row_mask:0xf bank_mask:0xf bound_ctrl:0
v_add_f32_dpp v241, v241, v241 row_shr:2 row_mask:0xf bank_mask:0xf bound_ctrl:0
v_add_f32_dpp v242, v242, v242 row_shr:2 row_mask:0xf bank_mask:0xf bound_ctrl:0
v_add_f32_dpp v243, v243, v243 row_shr:2 row_mask:0xf bank_mask:0xf bound_ctrl:0
v_mfma_f32_32x32x16_bf16 v[144:159], v[132:135], v[68:71], v[144:159]
v_add_f32_dpp v244, v244, v244 row_shr:2 row_mask:0xf bank_mask:0xf bound_ctrl:0
v_add_f32_dpp v245, v245, v245 row_shr:2 row_mask:0xf bank_mask:0xf bound_ctrl:0
v_add_f32_dpp v240, v240, v240 row_shr:4 row_mask:0xf bank_mask:0xf bound_ctrl:0
v_add_f32_dpp v241, v241, v241 row_shr:4 row_mask:0xf bank_mask:0xf bound_ctrl:0
v_add_f32_dpp v242, v242, v242 row_shr:4 row_mask:0xf bank_mask:0xf bound_ctrl:0
v_add_f32_dpp v243, v243, v243 row_shr:4 row_mask:0xf bank_mask:0xf bound_ctrl:0
v_mfma_f32_32x32x16_bf16 v[160:175], v[132:135], v[76:79], v[160:175]
buffer_load_dwordx4 v4, s[16:19], s49 offen offset:2048 lds
v_add_f32_dpp v244, v244, v244 row_shr:4 row_mask:0xf bank_mask:0xf bound_ctrl:0
v_add_f32_dpp v245, v245, v245 row_shr:4 row_mask:0xf bank_mask:0xf bound_ctrl:0
v_add_f32_dpp v240, v240, v240 row_shr:8 row_mask:0xf bank_mask:0xf bound_ctrl:0
v_add_f32_dpp v241, v241, v241 row_shr:8 row_mask:0xf bank_mask:0xf bound_ctrl:0
v_add_f32_dpp v242, v242, v242 row_shr:8 row_mask:0xf bank_mask:0xf bound_ctrl:0
v_add_f32_dpp v243, v243, v243 row_shr:8 row_mask:0xf bank_mask:0xf bound_ctrl:0
v_mfma_f32_32x32x16_bf16 v[176:191], v[136:139], v[64:67], 0
v_add_f32_dpp v244, v244, v244 row_shr:8 row_mask:0xf bank_mask:0xf bound_ctrl:0
v_add_f32_dpp v245, v245, v245 row_shr:8 row_mask:0xf bank_mask:0xf bound_ctrl:0
v_add_f32_dpp v240, v240, v240 row_bcast:15 row_mask:0xa bank_mask:0xf
v_add_f32_dpp v241, v241, v241 row_bcast:15 row_mask:0xa bank_mask:0xf
v_add_f32_dpp v242, v242, v242 row_bcast:15 row_mask:0xa bank_mask:0xf
v_add_f32_dpp v243, v243, v243 row_bcast:15 row_mask:0xa bank_mask:0xf
v_mfma_f32_32x32x16_bf16 v[192:207], v[136:139], v[72:75], 0
buffer_load_dwordx4 v5, s[16:19], s49 offen offset:3072 lds
v_add_f32_dpp v244, v244, v244 row_bcast:15 row_mask:0xa bank_mask:0xf
v_add_f32_dpp v245, v245, v245 row_bcast:15 row_mask:0xa bank_mask:0xf
v_add_f32_dpp v240, v240, v240 row_bcast:31 row_mask:0xc bank_mask:0xf
v_add_f32_dpp v241, v241, v241 row_bcast:31 row_mask:0xc bank_mask:0xf
v_add_f32_dpp v242, v242, v242 row_bcast:31 row_mask:0xc bank_mask:0xf
v_add_f32_dpp v243, v243, v243 row_bcast:31 row_mask:0xc bank_mask:0xf
v_mfma_f32_32x32x16_bf16 v[176:191], v[140:143], v[68:71], v[176:191]
v_add_f32_dpp v244, v244, v244 row_bcast:31 row_mask:0xc bank_mask:0xf
v_add_f32_dpp v245, v245, v245 row_bcast:31 row_mask:0xc bank_mask:0xf
v_readlane_b32 s58, v240, 63
v_readlane_b32 s59, v241, 63
v_readlane_b32 s60, v242, 63
v_readlane_b32 s61, v243, 63
v_mfma_f32_32x32x16_bf16 v[192:207], v[140:143], v[76:79], v[192:207]
s_add_u32 m0, s47, 0xc000
s_mul_i32 s50, s52, 458752
s_add_u32 s50, s50, s43
buffer_load_dwordx4 v6, s[20:23], s50 offen offset:0 lds
v_readlane_b32 s62, v244, 63
v_readlane_b32 s63, v245, 63
v_cmp_gt_f32 vcc, 0, v252
v_mov_b32 v240, s58
v_mov_b32 v241, s61
v_mov_b32_e64 v242, s59
v_mov_b32 v243, s62
v_cndmask_b32 v240, v240, v241, vcc
v_cndmask_b32 v242, v242, v243, vcc
v_cmp_eq_f32 vcc, 0, v248
v_mov_b32 v244, 0xbd000000
v_mul_f32 v240, 0xba800000, v240
v_mul_f32 v242, 0x3a800000, v242
v_cndmask_b32 v244, 0, v244, vcc
v_fma_f32 v242, -v240, v240, v242
v_mul_f32 v246, s61, v244
v_max_f32 v242, 0, v242
v_mul_f32 v244, s58, v244
v_add_f32 v242, 0x3727c5ac, v242
v_rsq_f32_e64 v243, v242
v_pk_mul_f32 v[248:249], v[144:145], v[96:97]
v_pk_fma_f32 v[144:145], v[144:145], v[80:81], v[244:245] op_sel_hi:[1,1,0]
v_pk_fma_f32 v[144:145], v[160:161], v[96:97], v[144:145]
buffer_load_dwordx4 v7, s[20:23], s50 offen offset:1024 lds
v_pk_fma_f32 v[160:161], v[160:161], v[80:81], v[248:249] neg_lo:[0,0,1] neg_hi:[0,0,1]
v_pk_mul_f32 v[250:251], v[146:147], v[98:99]
v_pk_fma_f32 v[146:147], v[146:147], v[82:83], v[244:245] op_sel_hi:[1,1,0]
v_pk_fma_f32 v[146:147], v[162:163], v[98:99], v[146:147]
v_pk_fma_f32 v[162:163], v[162:163], v[82:83], v[250:251] neg_lo:[0,0,1] neg_hi:[0,0,1]
v_pk_mul_f32 v[248:249], v[148:149], v[100:101]
v_pk_fma_f32 v[148:149], v[148:149], v[84:85], v[244:245] op_sel_hi:[1,1,0]
v_pk_fma_f32 v[148:149], v[164:165], v[100:101], v[148:149]
v_pk_fma_f32 v[164:165], v[164:165], v[84:85], v[248:249] neg_lo:[0,0,1] neg_hi:[0,0,1]
v_pk_mul_f32 v[250:251], v[150:151], v[102:103]
v_pk_fma_f32 v[150:151], v[150:151], v[86:87], v[244:245] op_sel_hi:[1,1,0]
v_pk_fma_f32 v[150:151], v[166:167], v[102:103], v[150:151]
v_pk_fma_f32 v[166:167], v[166:167], v[86:87], v[250:251] neg_lo:[0,0,1] neg_hi:[0,0,1]
v_pk_mul_f32 v[248:249], v[152:153], v[104:105]
v_pk_fma_f32 v[152:153], v[152:153], v[88:89], v[244:245] op_sel_hi:[1,1,0]
v_pk_fma_f32 v[152:153], v[168:169], v[104:105], v[152:153]
v_pk_fma_f32 v[168:169], v[168:169], v[88:89], v[248:249] neg_lo:[0,0,1] neg_hi:[0,0,1]
v_pk_mul_f32 v[250:251], v[154:155], v[106:107]
v_pk_fma_f32 v[154:155], v[154:155], v[90:91], v[244:245] op_sel_hi:[1,1,0]
v_pk_fma_f32 v[154:155], v[170:171], v[106:107], v[154:155]
v_pk_fma_f32 v[170:171], v[170:171], v[90:91], v[250:251] neg_lo:[0,0,1] neg_hi:[0,0,1]
v_pk_mul_f32 v[248:249], v[156:157], v[108:109]
v_pk_fma_f32 v[156:157], v[156:157], v[92:93], v[244:245] op_sel_hi:[1,1,0]
v_pk_fma_f32 v[156:157], v[172:173], v[108:109], v[156:157]
buffer_load_dwordx4 v8, s[20:23], s50 offen offset:2048 lds
v_pk_fma_f32 v[172:173], v[172:173], v[92:93], v[248:249] neg_lo:[0,0,1] neg_hi:[0,0,1]
v_pk_mul_f32 v[250:251], v[158:159], v[110:111]
v_pk_fma_f32 v[158:159], v[158:159], v[94:95], v[244:245] op_sel_hi:[1,1,0]
v_pk_fma_f32 v[158:159], v[174:175], v[110:111], v[158:159]
v_pk_fma_f32 v[174:175], v[174:175], v[94:95], v[250:251] neg_lo:[0,0,1] neg_hi:[0,0,1]
v_cvt_pk_bf16_f32 v208, v144, v160
v_cvt_pk_bf16_f32 v209, v145, v161
v_cvt_pk_bf16_f32 v210, v146, v162
v_cvt_pk_bf16_f32 v211, v147, v163
v_cvt_pk_bf16_f32 v212, v148, v164
v_cvt_pk_bf16_f32 v213, v149, v165
v_cvt_pk_bf16_f32 v214, v150, v166
v_cvt_pk_bf16_f32 v215, v151, v167
v_cvt_pk_bf16_f32 v216, v152, v168
v_cvt_pk_bf16_f32 v217, v153, v169
v_cvt_pk_bf16_f32 v218, v154, v170
v_cvt_pk_bf16_f32 v219, v155, v171
v_cvt_pk_bf16_f32 v220, v156, v172
v_cvt_pk_bf16_f32 v221, v157, v173
v_cvt_pk_bf16_f32 v222, v158, v174
v_cvt_pk_bf16_f32 v223, v159, v175
v_pk_mul_f32 v[248:249], v[176:177], v[96:97]
v_pk_fma_f32 v[176:177], v[176:177], v[80:81], v[246:247] op_sel_hi:[1,1,0]
v_pk_fma_f32 v[176:177], v[192:193], v[96:97], v[176:177]
buffer_load_dwordx4 v9, s[20:23], s50 offen offset:3072 lds
v_pk_fma_f32 v[192:193], v[192:193], v[80:81], v[248:249] neg_lo:[0,0,1] neg_hi:[0,0,1]
v_pk_mul_f32 v[250:251], v[178:179], v[98:99]
v_pk_fma_f32 v[178:179], v[178:179], v[82:83], v[246:247] op_sel_hi:[1,1,0]
v_pk_fma_f32 v[178:179], v[194:195], v[98:99], v[178:179]
v_pk_fma_f32 v[194:195], v[194:195], v[82:83], v[250:251] neg_lo:[0,0,1] neg_hi:[0,0,1]
v_pk_mul_f32 v[248:249], v[180:181], v[100:101]
v_pk_fma_f32 v[180:181], v[180:181], v[84:85], v[246:247] op_sel_hi:[1,1,0]
v_pk_fma_f32 v[180:181], v[196:197], v[100:101], v[180:181]
v_pk_fma_f32 v[196:197], v[196:197], v[84:85], v[248:249] neg_lo:[0,0,1] neg_hi:[0,0,1]
v_pk_mul_f32 v[250:251], v[182:183], v[102:103]
v_pk_fma_f32 v[182:183], v[182:183], v[86:87], v[246:247] op_sel_hi:[1,1,0]
v_pk_fma_f32 v[182:183], v[198:199], v[102:103], v[182:183]
v_pk_fma_f32 v[198:199], v[198:199], v[86:87], v[250:251] neg_lo:[0,0,1] neg_hi:[0,0,1]
v_pk_mul_f32 v[248:249], v[184:185], v[104:105]
v_pk_fma_f32 v[184:185], v[184:185], v[88:89], v[246:247] op_sel_hi:[1,1,0]
v_pk_fma_f32 v[184:185], v[200:201], v[104:105], v[184:185]
v_pk_fma_f32 v[200:201], v[200:201], v[88:89], v[248:249] neg_lo:[0,0,1] neg_hi:[0,0,1]
v_pk_mul_f32 v[250:251], v[186:187], v[106:107]
v_pk_fma_f32 v[186:187], v[186:187], v[90:91], v[246:247] op_sel_hi:[1,1,0]
v_pk_fma_f32 v[186:187], v[202:203], v[106:107], v[186:187]
v_pk_fma_f32 v[202:203], v[202:203], v[90:91], v[250:251] neg_lo:[0,0,1] neg_hi:[0,0,1]
v_pk_mul_f32 v[248:249], v[188:189], v[108:109]
v_pk_fma_f32 v[188:189], v[188:189], v[92:93], v[246:247] op_sel_hi:[1,1,0]
v_pk_fma_f32 v[188:189], v[204:205], v[108:109], v[188:189]
v_pk_fma_f32 v[204:205], v[204:205], v[92:93], v[248:249] neg_lo:[0,0,1] neg_hi:[0,0,1]
v_pk_mul_f32 v[250:251], v[190:191], v[110:111]
v_pk_fma_f32 v[190:191], v[190:191], v[94:95], v[246:247] op_sel_hi:[1,1,0]
v_pk_fma_f32 v[190:191], v[206:207], v[110:111], v[190:191]
v_pk_fma_f32 v[206:207], v[206:207], v[94:95], v[250:251] neg_lo:[0,0,1] neg_hi:[0,0,1]
v_cvt_pk_bf16_f32 v224, v176, v192
v_cvt_pk_bf16_f32 v225, v177, v193
v_cvt_pk_bf16_f32 v226, v178, v194
v_cvt_pk_bf16_f32 v227, v179, v195
v_cvt_pk_bf16_f32 v228, v180, v196
v_cvt_pk_bf16_f32 v229, v181, v197
v_cvt_pk_bf16_f32 v230, v182, v198
v_cvt_pk_bf16_f32 v231, v183, v199
v_cvt_pk_bf16_f32 v232, v184, v200
v_cvt_pk_bf16_f32 v233, v185, v201
v_cvt_pk_bf16_f32 v234, v186, v202
v_cvt_pk_bf16_f32 v235, v187, v203
v_cvt_pk_bf16_f32 v236, v188, v204
v_cvt_pk_bf16_f32 v237, v189, v205
v_cvt_pk_bf16_f32 v238, v190, v206
v_cvt_pk_bf16_f32 v239, v191, v207
v_mfma_f32_32x32x16_bf16 v[144:159], v[112:115], v[208:211], 0
v_readlane_b32 s64, v243, 0
v_readlane_b32 s65, v243, 1
v_mul_f32_e64 v70, v242, v243
v_cvt_pk_bf16_f32 v65, v240, v240
v_cvt_pk_bf16_f32 v64, v70, v70
v_mfma_f32_32x32x16_bf16 v[160:175], v[112:115], v[224:227], 0
v_and_b32 v67, 0xffff0000, v65
v_and_b32 v66, 0xffff0000, v64
v_sub_f32 v67, v240, v67
v_sub_f32 v68, v70, v66
v_mul_f32 v69, 0xc0135761, v243
v_mfma_f32_32x32x16_bf16 v[144:159], v[116:119], v[212:215], v[144:159]
v_cvt_pk_bf16_f32 v64, v66, v68
v_cvt_pk_bf16_f32 v66, v67, v67
s_and_b32 s55, s53, 0xbfffbfff
v_mov_b32 v67, s55
v_mul_f32 v68, v243, v243
v_mfma_f32_32x32x16_bf16 v[160:175], v[116:119], v[228:231], v[160:175]
v_mov_b32 v71, s55
v_mul_f32 v68, v68, v69
v_lshlrev_b32 v72, 15, v0
v_mul_f32 v68, 0x3d372713, v68
s_lshl_b32 s55, s56, 5
v_mfma_f32_32x32x16_bf16 v[144:159], v[120:123], v[216:219], v[144:159]
s_add_u32 s55, s55, 65536
v_mov_b32 v240, s64
v_mov_b32 v242, s65
s_add_u32 s57, s47, 147456
v_add_u32_e64 v248, s57, v20
v_mfma_f32_32x32x16_bf16 v[160:175], v[120:123], v[232:235], v[160:175]
v_lshrrev_b32 v249, 5, v0
v_and_b32 v250, 31, v0
v_lshlrev_b32 v250, 4, v250
v_lshl_add_u32 v62, v249, 17, v250
s_lshl_b32 s57, s36, 20
v_mfma_f32_32x32x16_bf16 v[144:159], v[124:127], v[220:223], v[144:159]
s_lshl_b32 s54, s2, 9
s_add_u32 s57, s57, s54
s_add_u32 s57, s57, 2097152
s_lshl_b32 s54, s36, 28
s_waitcnt vmcnt(13)
v_and_b32 v50, 0xffff, v50
v_mfma_f32_32x32x16_bf16 v[160:175], v[124:127], v[236:239], v[160:175]
s_add_u32 s54, s54, 4096
s_waitcnt vmcnt(12)
v_lshl_or_b32 v50, v51, 16, v50
v_lshl_add_u32 v49, v49, 2, s54
s_mov_b64 exec, 15
buffer_store_dword v50, v49, s[24:27], 0 offen sc1
s_mov_b64 exec, 3
buffer_store_dwordx4 v[64:67], v72, s[24:27], s55 offen sc1
buffer_store_dwordx4 v[68:71], v72, s[24:27], s55 offen offset:16 sc1
s_mov_b64 exec, -1
v_writelane_b32 v144, s60, 0
v_writelane_b32 v145, 0, 0
v_writelane_b32 v160, s63, 0
v_writelane_b32 v161, 0, 0
v_pk_mul_f32 v[160:161], v[160:161], v[242:243] op_sel_hi:[1,0]
v_pk_mul_f32 v[162:163], v[162:163], v[242:243] op_sel_hi:[1,0]
v_pk_fma_f32 v[176:177], v[144:145], v[240:241], v[160:161] op_sel_hi:[1,0,1] neg_lo:[0,0,1] neg_hi:[0,0,1]
v_pk_fma_f32 v[178:179], v[146:147], v[240:241], v[162:163] op_sel_hi:[1,0,1] neg_lo:[0,0,1] neg_hi:[0,0,1]
v_pk_fma_f32 v[144:145], v[144:145], v[240:241], v[160:161] op_sel_hi:[1,0,1]
v_pk_fma_f32 v[146:147], v[146:147], v[240:241], v[162:163] op_sel_hi:[1,0,1]
v_cvt_pk_bf16_f32 v216, v176, v177
v_cvt_pk_bf16_f32 v217, v178, v179
v_cvt_pk_bf16_f32 v208, v144, v145
v_cvt_pk_bf16_f32 v209, v146, v147
ds_write_b32 v61, v216 offset:512
ds_write_b32 v60, v217 offset:1536
ds_write2st64_b32 v59, v208, v209 offset0:0 offset1:4
v_pk_mul_f32 v[164:165], v[164:165], v[242:243] op_sel_hi:[1,0]
v_pk_mul_f32 v[166:167], v[166:167], v[242:243] op_sel_hi:[1,0]
v_pk_fma_f32 v[180:181], v[148:149], v[240:241], v[164:165] op_sel_hi:[1,0,1] neg_lo:[0,0,1] neg_hi:[0,0,1]
v_pk_fma_f32 v[182:183], v[150:151], v[240:241], v[166:167] op_sel_hi:[1,0,1] neg_lo:[0,0,1] neg_hi:[0,0,1]
v_pk_fma_f32 v[148:149], v[148:149], v[240:241], v[164:165] op_sel_hi:[1,0,1]
v_pk_fma_f32 v[150:151], v[150:151], v[240:241], v[166:167] op_sel_hi:[1,0,1]
v_cvt_pk_bf16_f32 v218, v180, v181
v_cvt_pk_bf16_f32 v219, v182, v183
v_cvt_pk_bf16_f32 v210, v148, v149
v_cvt_pk_bf16_f32 v211, v150, v151
ds_write_b32 v60, v218 offset:4608
ds_write_b32 v60, v219 offset:5632
ds_write2st64_b32 v59, v210, v211 offset0:16 offset1:20
v_pk_mul_f32 v[168:169], v[168:169], v[242:243] op_sel_hi:[1,0]
v_pk_mul_f32 v[170:171], v[170:171], v[242:243] op_sel_hi:[1,0]
v_pk_fma_f32 v[184:185], v[152:153], v[240:241], v[168:169] op_sel_hi:[1,0,1] neg_lo:[0,0,1] neg_hi:[0,0,1]
v_pk_fma_f32 v[186:187], v[154:155], v[240:241], v[170:171] op_sel_hi:[1,0,1] neg_lo:[0,0,1] neg_hi:[0,0,1]
v_pk_fma_f32 v[152:153], v[152:153], v[240:241], v[168:169] op_sel_hi:[1,0,1]
v_pk_fma_f32 v[154:155], v[154:155], v[240:241], v[170:171] op_sel_hi:[1,0,1]
v_cvt_pk_bf16_f32 v220, v184, v185
v_cvt_pk_bf16_f32 v221, v186, v187
v_cvt_pk_bf16_f32 v212, v152, v153
v_cvt_pk_bf16_f32 v213, v154, v155
ds_write_b32 v60, v220 offset:8704
ds_write_b32 v60, v221 offset:9728
ds_write2st64_b32 v59, v212, v213 offset0:32 offset1:36
v_pk_mul_f32 v[172:173], v[172:173], v[242:243] op_sel_hi:[1,0]
v_pk_mul_f32 v[174:175], v[174:175], v[242:243] op_sel_hi:[1,0]
v_pk_fma_f32 v[188:189], v[156:157], v[240:241], v[172:173] op_sel_hi:[1,0,1] neg_lo:[0,0,1] neg_hi:[0,0,1]
v_pk_fma_f32 v[190:191], v[158:159], v[240:241], v[174:175] op_sel_hi:[1,0,1] neg_lo:[0,0,1] neg_hi:[0,0,1]
v_pk_fma_f32 v[156:157], v[156:157], v[240:241], v[172:173] op_sel_hi:[1,0,1]
v_pk_fma_f32 v[158:159], v[158:159], v[240:241], v[174:175] op_sel_hi:[1,0,1]
v_cvt_pk_bf16_f32 v222, v188, v189
v_cvt_pk_bf16_f32 v223, v190, v191
v_cvt_pk_bf16_f32 v214, v156, v157
v_cvt_pk_bf16_f32 v215, v158, v159
ds_write_b32 v60, v222 offset:12800
ds_write_b32 v60, v223 offset:13824
ds_write2st64_b32 v59, v214, v215 offset0:48 offset1:52
s_and_b32 s54, s2, 7
s_lshl_b32 s54, s54, 5
s_lshr_b32 s55, s2, 3
s_add_u32 s54, s54, s55
s_lshl_b32 s54, s54, 7
s_lshl_b32 s55, s36, 15
s_add_u32 s54, s54, s55
s_add_u32 s64, s54, 131072
s_waitcnt lgkmcnt(0)
s_barrier
ds_read_b128 v[144:147], v248 offset:0
ds_read_b128 v[148:151], v248 offset:1024
ds_read_b128 v[152:155], v248 offset:2048
ds_read_b128 v[156:159], v248 offset:3072
s_waitcnt lgkmcnt(3)
buffer_store_dwordx4 v[144:147], v62, s[24:27], s57 offen sc1
s_add_u32 s57, s57, 0x40000
s_waitcnt lgkmcnt(2)
buffer_store_dwordx4 v[148:151], v62, s[24:27], s57 offen sc1
s_add_u32 s57, s57, 0x40000
s_waitcnt lgkmcnt(1)
buffer_store_dwordx4 v[152:155], v62, s[24:27], s57 offen sc1
s_add_u32 s57, s57, 0x40000
s_waitcnt lgkmcnt(0)
buffer_store_dwordx4 v[156:159], v62, s[24:27], s57 offen sc1
s_waitcnt vmcnt(15)
s_barrier
ds_read_b64_tr_b16 a[0:1], v16 offset:0
ds_read_b64_tr_b16 a[2:3], v16 offset:1024
ds_read_b64_tr_b16 a[4:5], v17 offset:0
ds_read_b64_tr_b16 a[6:7], v17 offset:1024
ds_read_b128 v[64:67], v10 offset:0
ds_read_b128 v[68:71], v10 offset:2048
ds_read_b128 v[72:75], v10 offset:4096
ds_read_b128 v[76:79], v10 offset:6144
ds_read_b128 v[80:83], v10 offset:8192
ds_read_b128 v[84:87], v10 offset:10240
ds_read_b128 v[88:91], v10 offset:12288
ds_read_b128 v[92:95], v10 offset:14336
s_waitcnt lgkmcnt(7)
v_mfma_f32_16x16x32_bf16 v[128:131], a[0:3], v[64:67], 0
ds_read_b64_tr_b16 a[8:9], v16 offset:8192
ds_read_b64_tr_b16 a[10:11], v16 offset:9216
s_add_u32 m0, s47, 0x10000
v_mfma_f32_16x16x32_bf16 v[132:135], a[4:7], v[64:67], 0
ds_read_b64_tr_b16 a[12:13], v17 offset:8192
s_waitcnt lgkmcnt(9)
v_mfma_f32_16x16x32_bf16 v[140:143], a[4:7], v[68:71], 0
ds_read_b64_tr_b16 a[14:15], v17 offset:9216
s_add_u32 s52, s51, 2
s_and_b32 s52, s52, 7
v_mfma_f32_16x16x32_bf16 v[136:139], a[0:3], v[68:71], 0
ds_read_b128 v[96:99], v11 offset:0
s_lshl_b32 s49, s52, 7
s_waitcnt lgkmcnt(10)
v_mfma_f32_16x16x32_bf16 v[144:147], a[0:3], v[72:75], 0
ds_read_b128 v[100:103], v11 offset:2048
s_add_u32 s49, s49, s42
v_mov_b32 v56, s53
v_mfma_f32_16x16x32_bf16 v[148:151], a[4:7], v[72:75], 0
buffer_load_dwordx4 v2, s[16:19], s49 offen offset:0 lds
s_waitcnt lgkmcnt(6)
v_mfma_f32_16x16x32_bf16 v[156:159], a[4:7], v[76:79], 0
buffer_load_dwordx4 v3, s[16:19], s49 offen offset:1024 lds
ds_read_b128 v[104:107], v11 offset:4096
v_mfma_f32_16x16x32_bf16 v[152:155], a[0:3], v[76:79], 0
ds_read_b128 v[108:111], v11 offset:6144
v_lshrrev_b32 v57, 5, v0
v_lshlrev_b32 v57, 28, v57
v_mfma_f32_16x16x32_bf16 v[160:163], a[0:3], v[80:83], 0
buffer_load_dwordx4 v4, s[16:19], s49 offen offset:2048 lds
ds_read_b128 v[64:67], v11 offset:8192
v_mfma_f32_16x16x32_bf16 v[164:167], a[4:7], v[80:83], 0
v_add_lshl_u32 v57, v57, v0, 2
s_lshl_b32 s45, s37, 2
v_mfma_f32_16x16x32_bf16 v[172:175], a[4:7], v[84:87], 0
buffer_load_dwordx4 v5, s[16:19], s49 offen offset:3072 lds
ds_read_b128 v[68:71], v11 offset:10240
v_mfma_f32_16x16x32_bf16 v[168:171], a[0:3], v[84:87], 0
s_add_u32 m0, s47, 0x14000
s_mul_i32 s50, s52, 458752
s_add_u32 s50, s50, s43
v_mfma_f32_16x16x32_bf16 v[176:179], a[0:3], v[88:91], 0
buffer_load_dwordx4 v6, s[20:23], s50 offen offset:0 lds
ds_read_b128 v[72:75], v11 offset:12288
v_mfma_f32_16x16x32_bf16 v[180:183], a[4:7], v[88:91], 0
s_add_u32 s45, s45, s38
s_lshl_b32 s59, s45, 15
s_add_u32 s59, s59, 524288
v_mfma_f32_16x16x32_bf16 v[188:191], a[4:7], v[92:95], 0
buffer_load_dwordx4 v7, s[20:23], s50 offen offset:1024 lds
ds_read_b128 v[76:79], v11 offset:14336
v_mfma_f32_16x16x32_bf16 v[184:187], a[0:3], v[92:95], 0
s_mul_i32 s55, s45, 458752
s_add_u32 s55, s55, 31457280
s_lshl_b32 s45, s39, 2
v_mfma_f32_16x16x32_bf16 v[28:31], v[24:27], a[0:3], 0
buffer_load_dwordx4 v8, s[20:23], s50 offen offset:2048 lds
s_add_u32 s45, s45, s36
v_mfma_f32_16x16x32_bf16 v[116:119], v[24:27], a[4:7], 0
s_lshl_b32 s46, s45, 11
s_waitcnt lgkmcnt(2)
v_mfma_f32_16x16x32_bf16 v[128:131], a[8:11], v[96:99], v[128:131]
buffer_load_dwordx4 v9, s[20:23], s50 offen offset:3072 lds
s_add_u32 m0, s47, 0x18000
v_mfma_f32_16x16x32_bf16 v[132:135], a[12:15], v[96:99], v[132:135]
s_add_u32 s52, s51, 3
s_and_b32 s52, s52, 7
s_lshl_b32 s49, s52, 7
v_mfma_f32_16x16x32_bf16 v[140:143], a[12:15], v[100:103], v[140:143]
s_add_u32 s49, s49, s42
s_add_u32 s44, s55, s46
s_lshl_b32 s45, s45, 10
v_mfma_f32_16x16x32_bf16 v[136:139], a[8:11], v[100:103], v[136:139]
buffer_load_dwordx4 v2, s[16:19], s49 offen offset:0 lds
s_add_u32 s63, s59, s45
v_mfma_f32_16x16x32_bf16 v[144:147], a[8:11], v[104:107], v[144:147]
buffer_load_dwordx4 v3, s[16:19], s49 offen offset:1024 lds
v_mfma_f32_16x16x32_bf16 v[148:151], a[12:15], v[104:107], v[148:151]
v_mfma_f32_16x16x32_bf16 v[156:159], a[12:15], v[108:111], v[156:159]
s_waitcnt vmcnt(17) lgkmcnt(0)
s_barrier
v_mfma_f32_16x16x32_bf16 v[152:155], a[8:11], v[108:111], v[152:155]
ds_read_b64_tr_b16 a[16:17], v16 offset:32768
ds_read_b64_tr_b16 a[18:19], v16 offset:33792
v_mfma_f32_16x16x32_bf16 v[160:163], a[8:11], v[64:67], v[160:163]
buffer_load_dwordx4 v4, s[16:19], s49 offen offset:2048 lds
ds_read_b64_tr_b16 a[20:21], v17 offset:32768
v_mfma_f32_16x16x32_bf16 v[164:167], a[12:15], v[64:67], v[164:167]
ds_read_b64_tr_b16 a[22:23], v17 offset:33792
v_mfma_f32_16x16x32_bf16 v[172:175], a[12:15], v[68:71], v[172:175]
buffer_load_dwordx4 v5, s[16:19], s49 offen offset:3072 lds
ds_read_b128 v[80:83], v10 offset:32768
v_mfma_f32_16x16x32_bf16 v[168:171], a[8:11], v[68:71], v[168:171]
ds_read_b128 v[84:87], v10 offset:34816
s_add_u32 m0, s47, 0x1c000
s_mul_i32 s50, s52, 458752
v_mfma_f32_16x16x32_bf16 v[176:179], a[8:11], v[72:75], v[176:179]
ds_read_b128 v[88:91], v10 offset:36864
s_add_u32 s50, s50, s43
v_mfma_f32_16x16x32_bf16 v[180:183], a[12:15], v[72:75], v[180:183]
buffer_load_dwordx4 v6, s[20:23], s50 offen offset:0 lds
ds_read_b128 v[92:95], v10 offset:38912
v_mfma_f32_16x16x32_bf16 v[188:191], a[12:15], v[76:79], v[188:191]
buffer_load_dwordx4 v7, s[20:23], s50 offen offset:1024 lds
ds_read_b128 v[96:99], v10 offset:40960
v_mfma_f32_16x16x32_bf16 v[184:187], a[8:11], v[76:79], v[184:187]
ds_read_b128 v[100:103], v10 offset:43008
v_mfma_f32_16x16x32_bf16 v[28:31], v[24:27], a[8:11], v[28:31]
buffer_load_dwordx4 v8, s[20:23], s50 offen offset:2048 lds
ds_read_b128 v[104:107], v10 offset:45056
v_mfma_f32_16x16x32_bf16 v[116:119], v[24:27], a[12:15], v[116:119]
ds_read_b128 v[108:111], v10 offset:47104
s_waitcnt lgkmcnt(6)
v_mfma_f32_16x16x32_bf16 v[128:131], a[16:19], v[80:83], v[128:131]
buffer_load_dwordx4 v9, s[20:23], s50 offen offset:3072 lds
ds_read_b64_tr_b16 a[24:25], v16 offset:40960
v_mfma_f32_16x16x32_bf16 v[132:135], a[20:23], v[80:83], v[132:135]
ds_read_b64_tr_b16 a[26:27], v16 offset:41984
ds_read_b64_tr_b16 a[28:29], v17 offset:40960
s_add_u32 m0, s47, 0x0
v_mfma_f32_16x16x32_bf16 v[140:143], a[20:23], v[84:87], v[140:143]
ds_read_b64_tr_b16 a[30:31], v17 offset:41984
s_add_u32 s52, s51, 4
s_and_b32 s52, s52, 7
v_mfma_f32_16x16x32_bf16 v[136:139], a[16:19], v[84:87], v[136:139]
ds_read_b128 v[64:67], v11 offset:32768
s_lshl_b32 s49, s52, 7
s_waitcnt lgkmcnt(7)
v_mfma_f32_16x16x32_bf16 v[144:147], a[16:19], v[88:91], v[144:147]
ds_read_b128 v[68:71], v11 offset:34816
s_add_u32 s49, s49, s42
v_mfma_f32_16x16x32_bf16 v[148:151], a[20:23], v[88:91], v[148:151]
buffer_load_dwordx4 v2, s[16:19], s49 offen offset:0 lds
v_mfma_f32_16x16x32_bf16 v[156:159], a[20:23], v[92:95], v[156:159]
buffer_load_dwordx4 v3, s[16:19], s49 offen offset:1024 lds
ds_read_b128 v[72:75], v11 offset:36864
v_mfma_f32_16x16x32_bf16 v[152:155], a[16:19], v[92:95], v[152:155]
ds_read_b128 v[76:79], v11 offset:38912
v_mfma_f32_16x16x32_bf16 v[160:163], a[16:19], v[96:99], v[160:163]
buffer_load_dwordx4 v4, s[16:19], s49 offen offset:2048 lds
ds_read_b128 v[80:83], v11 offset:40960
v_mfma_f32_16x16x32_bf16 v[164:167], a[20:23], v[96:99], v[164:167]
v_mfma_f32_16x16x32_bf16 v[172:175], a[20:23], v[100:103], v[172:175]
buffer_load_dwordx4 v5, s[16:19], s49 offen offset:3072 lds
ds_read_b128 v[84:87], v11 offset:43008
v_mfma_f32_16x16x32_bf16 v[168:171], a[16:19], v[100:103], v[168:171]
s_add_u32 m0, s47, 0x4000
s_mul_i32 s50, s52, 458752
s_waitcnt lgkmcnt(4)
v_mfma_f32_16x16x32_bf16 v[176:179], a[16:19], v[104:107], v[176:179]
ds_read_b128 v[88:91], v11 offset:45056
s_add_u32 s50, s50, s43
v_mfma_f32_16x16x32_bf16 v[180:183], a[20:23], v[104:107], v[180:183]
buffer_load_dwordx4 v6, s[20:23], s50 offen offset:0 lds
v_mfma_f32_16x16x32_bf16 v[188:191], a[20:23], v[108:111], v[188:191]
buffer_load_dwordx4 v7, s[20:23], s50 offen offset:1024 lds
ds_read_b128 v[92:95], v11 offset:47104
v_mfma_f32_16x16x32_bf16 v[184:187], a[16:19], v[108:111], v[184:187]
v_mfma_f32_16x16x32_bf16 v[28:31], v[24:27], a[16:19], v[28:31]
v_mfma_f32_16x16x32_bf16 v[116:119], v[24:27], a[20:23], v[116:119]
v_mfma_f32_16x16x32_bf16 v[128:131], a[24:27], v[64:67], v[128:131]
buffer_load_dwordx4 v8, s[20:23], s50 offen offset:2048 lds
v_mfma_f32_16x16x32_bf16 v[132:135], a[28:31], v[64:67], v[132:135]
v_mfma_f32_16x16x32_bf16 v[140:143], a[28:31], v[68:71], v[140:143]
v_mfma_f32_16x16x32_bf16 v[136:139], a[24:27], v[68:71], v[136:139]
s_waitcnt lgkmcnt(0)
v_mfma_f32_16x16x32_bf16 v[144:147], a[24:27], v[72:75], v[144:147]
buffer_load_dwordx4 v9, s[20:23], s50 offen offset:3072 lds
s_add_u32 m0, s47, 0x8000
v_mfma_f32_16x16x32_bf16 v[148:151], a[28:31], v[72:75], v[148:151]
s_add_u32 s52, s51, 5
s_and_b32 s52, s52, 7
s_lshl_b32 s49, s52, 7
v_mfma_f32_16x16x32_bf16 v[156:159], a[28:31], v[76:79], v[156:159]
s_waitcnt vmcnt(16)
s_barrier
v_mfma_f32_16x16x32_bf16 v[152:155], a[24:27], v[76:79], v[152:155]
ds_read_b64_tr_b16 a[32:33], v18 offset:0
ds_read_b64_tr_b16 a[34:35], v18 offset:1024
s_add_u32 s49, s49, s42
v_mfma_f32_16x16x32_bf16 v[160:163], a[24:27], v[80:83], v[160:163]
buffer_load_dwordx4 v2, s[16:19], s49 offen offset:0 lds
ds_read_b64_tr_b16 a[36:37], v19 offset:0
v_mfma_f32_16x16x32_bf16 v[164:167], a[28:31], v[80:83], v[164:167]
ds_read_b64_tr_b16 a[38:39], v19 offset:1024
v_mfma_f32_16x16x32_bf16 v[172:175], a[28:31], v[84:87], v[172:175]
ds_read_b128 v[96:99], v12 offset:0
v_mfma_f32_16x16x32_bf16 v[168:171], a[24:27], v[84:87], v[168:171]
buffer_store_dword v56, v57, s[24:27], s64 offen offset:0 sc1
ds_read_b128 v[100:103], v12 offset:2048
v_mfma_f32_16x16x32_bf16 v[176:179], a[24:27], v[88:91], v[176:179]
buffer_load_dwordx4 v3, s[16:19], s49 offen offset:1024 lds
v_mfma_f32_16x16x32_bf16 v[180:183], a[28:31], v[88:91], v[180:183]
ds_read_b128 v[104:107], v12 offset:4096
s_add_u32 s45, s38, 1
s_and_b32 s45, s45, 3
v_mfma_f32_16x16x32_bf16 v[188:191], a[28:31], v[92:95], v[188:191]
ds_read_b128 v[108:111], v12 offset:6144
s_lshl_b32 s45, s45, 1
s_and_b32 s46, s37, 1
v_mfma_f32_16x16x32_bf16 v[184:187], a[24:27], v[92:95], v[184:187]
ds_read_b128 v[64:67], v12 offset:8192
s_or_b32 s45, s45, s46
s_andn2_b32 s46, s2, 7
v_mfma_f32_16x16x32_bf16 v[28:31], v[24:27], a[24:27], v[28:31]
buffer_load_dwordx4 v4, s[16:19], s49 offen offset:2048 lds
ds_read_b128 v[68:71], v12 offset:10240
v_mfma_f32_16x16x32_bf16 v[116:119], v[24:27], a[28:31], v[116:119]
ds_read_b128 v[72:75], v12 offset:12288
s_or_b32 s45, s45, s46
s_waitcnt lgkmcnt(5)
v_mfma_f32_16x16x32_bf16 v[128:131], a[32:35], v[96:99], v[128:131]
ds_read_b128 v[76:79], v12 offset:14336
s_mov_b64 exec, 0x7777
global_load_dword v52, v52, s[4:5]
s_mov_b64 exec, -1
v_mfma_f32_16x16x32_bf16 v[132:135], a[36:39], v[96:99], v[132:135]
ds_read_b64_tr_b16 a[40:41], v18 offset:8192
ds_read_b64_tr_b16 a[42:43], v18 offset:9216
v_mfma_f32_16x16x32_bf16 v[140:143], a[36:39], v[100:103], v[140:143]
buffer_load_dwordx4 v5, s[16:19], s49 offen offset:3072 lds
v_mfma_f32_16x16x32_bf16 v[136:139], a[32:35], v[100:103], v[136:139]
ds_read_b64_tr_b16 a[44:45], v19 offset:8192
s_waitcnt lgkmcnt(6)
v_mfma_f32_16x16x32_bf16 v[144:147], a[32:35], v[104:107], v[144:147]
ds_read_b64_tr_b16 a[46:47], v19 offset:9216
s_add_u32 m0, s47, 0xc000
v_mfma_f32_16x16x32_bf16 v[148:151], a[36:39], v[104:107], v[148:151]
ds_read_b128 v[80:83], v13 offset:0
s_mul_i32 s50, s52, 458752
v_mfma_f32_16x16x32_bf16 v[156:159], a[36:39], v[108:111], v[156:159]
ds_read_b128 v[84:87], v13 offset:2048
s_add_u32 s50, s50, s43
s_lshl2_add_u32 s45, s45, s36
v_mfma_f32_16x16x32_bf16 v[152:155], a[32:35], v[108:111], v[152:155]
buffer_load_dwordx4 v6, s[20:23], s50 offen offset:0 lds
ds_read_b128 v[88:91], v13 offset:4096
v_mfma_f32_16x16x32_bf16 v[160:163], a[32:35], v[64:67], v[160:163]
ds_read_b128 v[92:95], v13 offset:6144
s_mul_i32 s46, s45, 15360
s_add_u32 s68, s46, 14680064
v_mfma_f32_16x16x32_bf16 v[164:167], a[36:39], v[64:67], v[164:167]
ds_read_b128 v[96:99], v13 offset:8192
s_waitcnt lgkmcnt(6)
v_mfma_f32_16x16x32_bf16 v[172:175], a[36:39], v[68:71], v[172:175]
buffer_load_dwordx4 v7, s[20:23], s50 offen offset:1024 lds
ds_read_b128 v[100:103], v13 offset:10240
v_mfma_f32_16x16x32_bf16 v[168:171], a[32:35], v[68:71], v[168:171]
s_add_u32 s45, s38, 2
s_and_b32 s45, s45, 3
s_lshl_b32 s45, s45, 1
v_mfma_f32_16x16x32_bf16 v[176:179], a[32:35], v[72:75], v[176:179]
ds_read_b128 v[104:107], v13 offset:12288
s_and_b32 s46, s37, 1
s_or_b32 s45, s45, s46
v_mfma_f32_16x16x32_bf16 v[180:183], a[36:39], v[72:75], v[180:183]
s_andn2_b32 s46, s2, 7
s_or_b32 s45, s45, s46
s_lshl2_add_u32 s45, s45, s36
v_mfma_f32_16x16x32_bf16 v[188:191], a[36:39], v[76:79], v[188:191]
buffer_load_dwordx4 v8, s[20:23], s50 offen offset:2048 lds
ds_read_b128 v[108:111], v13 offset:14336
v_mfma_f32_16x16x32_bf16 v[184:187], a[32:35], v[76:79], v[184:187]
s_mul_i32 s46, s45, 15360
s_add_u32 s69, s46, 14685184
s_add_u32 s45, s38, 3
v_mfma_f32_16x16x32_bf16 v[28:31], v[24:27], a[32:35], v[28:31]
s_and_b32 s45, s45, 3
s_lshl_b32 s45, s45, 1
s_and_b32 s46, s37, 1
v_mfma_f32_16x16x32_bf16 v[116:119], v[24:27], a[36:39], v[116:119]
s_or_b32 s45, s45, s46
s_waitcnt lgkmcnt(2)
v_mfma_f32_16x16x32_bf16 v[128:131], a[40:43], v[80:83], v[128:131]
buffer_load_dwordx4 v9, s[20:23], s50 offen offset:3072 lds
s_add_u32 m0, s47, 0x10000
v_mfma_f32_16x16x32_bf16 v[132:135], a[44:47], v[80:83], v[132:135]
s_add_u32 s52, s51, 6
s_and_b32 s52, s52, 7
s_lshl_b32 s49, s52, 7
v_mfma_f32_16x16x32_bf16 v[140:143], a[44:47], v[84:87], v[140:143]
s_add_u32 s49, s49, s42
s_andn2_b32 s46, s2, 7
s_or_b32 s45, s45, s46
v_mfma_f32_16x16x32_bf16 v[136:139], a[40:43], v[84:87], v[136:139]
s_lshl2_add_u32 s45, s45, s36
s_mul_i32 s46, s45, 15360
s_add_u32 s70, s46, 14690304
v_mfma_f32_16x16x32_bf16 v[144:147], a[40:43], v[88:91], v[144:147]
s_add_u32 s45, s38, 4
s_and_b32 s45, s45, 3
s_lshl_b32 s45, s45, 1
v_mfma_f32_16x16x32_bf16 v[148:151], a[44:47], v[88:91], v[148:151]
s_and_b32 s46, s37, 1
s_or_b32 s45, s45, s46
s_andn2_b32 s46, s2, 7
v_mfma_f32_16x16x32_bf16 v[156:159], a[44:47], v[92:95], v[156:159]
s_waitcnt vmcnt(18) lgkmcnt(0)
s_barrier
v_mfma_f32_16x16x32_bf16 v[152:155], a[40:43], v[92:95], v[152:155]
ds_read_b64_tr_b16 a[48:49], v18 offset:32768
ds_read_b64_tr_b16 a[50:51], v18 offset:33792
v_mfma_f32_16x16x32_bf16 v[160:163], a[40:43], v[96:99], v[160:163]
buffer_load_dwordx4 v2, s[16:19], s49 offen offset:0 lds
ds_read_b64_tr_b16 a[52:53], v19 offset:32768
v_mfma_f32_16x16x32_bf16 v[164:167], a[44:47], v[96:99], v[164:167]
ds_read_b64_tr_b16 a[54:55], v19 offset:33792
s_or_b32 s45, s45, s46
s_lshl2_add_u32 s45, s45, s36
v_mfma_f32_16x16x32_bf16 v[172:175], a[44:47], v[100:103], v[172:175]
ds_read_b128 v[64:67], v12 offset:32768
s_mul_i32 s46, s45, 15360
s_add_u32 s71, s46, 14680064
v_mfma_f32_16x16x32_bf16 v[168:171], a[40:43], v[100:103], v[168:171]
ds_read_b128 v[68:71], v12 offset:34816
s_lshl2_add_u32 s45, s37, s38
s_lshl_b32 s45, s45, 17
v_mfma_f32_16x16x32_bf16 v[176:179], a[40:43], v[104:107], v[176:179]
buffer_load_dwordx4 v3, s[16:19], s49 offen offset:1024 lds
ds_read_b128 v[72:75], v12 offset:36864
v_mfma_f32_16x16x32_bf16 v[180:183], a[44:47], v[104:107], v[180:183]
ds_read_b128 v[76:79], v12 offset:38912
s_lshl2_add_u32 s46, s39, s36
s_lshl_b32 s78, s46, 6
v_mfma_f32_16x16x32_bf16 v[188:191], a[44:47], v[108:111], v[188:191]
ds_read_b128 v[80:83], v12 offset:40960
s_lshl_b32 s46, s39, 6
s_add_u32 s76, s45, s78
v_mfma_f32_16x16x32_bf16 v[184:187], a[40:43], v[108:111], v[184:187]
ds_read_b128 v[84:87], v12 offset:43008
s_andn2_b32 s74, s76, 0xc0
v_mfma_f32_16x16x32_bf16 v[28:31], v[24:27], a[40:43], v[28:31]
buffer_load_dwordx4 v4, s[16:19], s49 offen offset:2048 lds
ds_read_b128 v[88:91], v12 offset:45056
v_mfma_f32_16x16x32_bf16 v[116:119], v[24:27], a[44:47], v[116:119]
ds_read_b128 v[92:95], v12 offset:47104
s_bfe_u32 s77, s45, 0x30012
s_waitcnt lgkmcnt(6)
v_mfma_f32_16x16x32_bf16 v[128:131], a[48:51], v[64:67], v[128:131]
ds_read_b64_tr_b16 a[56:57], v18 offset:40960
ds_read_b64_tr_b16 a[58:59], v18 offset:41984
s_lshl3_add_u32 s46, s77, s39
v_mfma_f32_16x16x32_bf16 v[132:135], a[52:55], v[64:67], v[132:135]
ds_read_b64_tr_b16 a[60:61], v19 offset:40960
ds_read_b64_tr_b16 a[62:63], v19 offset:41984
s_lshl_b32 s46, s46, 6
v_mfma_f32_16x16x32_bf16 v[140:143], a[52:55], v[68:71], v[140:143]
buffer_load_dwordx4 v5, s[16:19], s49 offen offset:3072 lds
ds_read_b128 v[96:99], v13 offset:32768
v_mfma_f32_16x16x32_bf16 v[136:139], a[48:51], v[68:71], v[136:139]
ds_read_b128 v[100:103], v13 offset:34816
s_add_u32 m0, s47, 0x14000
s_waitcnt lgkmcnt(8)
v_mfma_f32_16x16x32_bf16 v[144:147], a[48:51], v[72:75], v[144:147]
ds_read_b128 v[104:107], v13 offset:36864
s_mul_i32 s50, s52, 458752
s_add_u32 s50, s50, s43
v_mfma_f32_16x16x32_bf16 v[148:151], a[52:55], v[72:75], v[148:151]
s_lshr_b32 s77, s37, 2
s_lshl_b32 s77, s77, 19
v_mfma_f32_16x16x32_bf16 v[156:159], a[52:55], v[76:79], v[156:159]
buffer_load_dwordx4 v6, s[20:23], s50 offen offset:0 lds
ds_read_b128 v[108:111], v13 offset:38912
v_mfma_f32_16x16x32_bf16 v[152:155], a[48:51], v[76:79], v[152:155]
s_add_u32 s46, s46, s77
s_and_b32 s77, s38, 1
s_lshl_b32 s77, s77, 21
v_mfma_f32_16x16x32_bf16 v[160:163], a[48:51], v[80:83], v[160:163]
ds_read_b128 v[64:67], v13 offset:40960
s_add_u32 s46, s46, s77
s_add_u32 s77, s46, 2097152
v_mfma_f32_16x16x32_bf16 v[164:167], a[52:55], v[80:83], v[164:167]
s_lshr_b32 s45, s45, 4
s_and_b32 s45, s45, 0x1e000
s_add_u32 s79, s45, 262144
v_mfma_f32_16x16x32_bf16 v[172:175], a[52:55], v[84:87], v[172:175]
buffer_load_dwordx4 v7, s[20:23], s50 offen offset:1024 lds
ds_read_b128 v[68:71], v13 offset:43008
v_mfma_f32_16x16x32_bf16 v[168:171], a[48:51], v[84:87], v[168:171]
s_lshr_b32 s45, s2, 6
s_lshl2_add_u32 s45, s45, s36
s_waitcnt lgkmcnt(3)
v_mfma_f32_16x16x32_bf16 v[176:179], a[48:51], v[88:91], v[176:179]
ds_read_b128 v[72:75], v13 offset:45056
s_lshl_b32 s45, s45, 12
s_add_u32 s80, s45, 393600
v_mfma_f32_16x16x32_bf16 v[180:183], a[52:55], v[88:91], v[180:183]
s_lshl_b32 s45, s36, 20
s_lshl_b32 s46, s2, 9
v_mfma_f32_16x16x32_bf16 v[188:191], a[52:55], v[92:95], v[188:191]
buffer_load_dwordx4 v8, s[20:23], s50 offen offset:2048 lds
ds_read_b128 v[76:79], v13 offset:47104
v_mfma_f32_16x16x32_bf16 v[184:187], a[48:51], v[92:95], v[184:187]
s_add_u32 s45, s45, s46
s_add_u32 s81, s45, 2097152
s_and_b32 s45, s2, 7
v_mfma_f32_16x16x32_bf16 v[28:31], v[24:27], a[48:51], v[28:31]
s_lshl2_add_u32 s45, s45, s36
s_lshl_b32 s45, s45, 5
s_lshr_b32 s46, s2, 3
v_mfma_f32_16x16x32_bf16 v[116:119], v[24:27], a[52:55], v[116:119]
s_add_u32 s45, s45, s46
s_mov_b32 s82, s81
s_lshl_b32 s46, s45, 7
v_mfma_f32_16x16x32_bf16 v[128:131], a[56:59], v[96:99], v[128:131]
buffer_load_dwordx4 v9, s[20:23], s50 offen offset:3072 lds
s_add_u32 m0, s47, 0x18000
v_mfma_f32_16x16x32_bf16 v[132:135], a[60:63], v[96:99], v[132:135]
s_add_u32 s52, s51, 7
s_and_b32 s52, s52, 7
s_lshl_b32 s49, s52, 7
v_mfma_f32_16x16x32_bf16 v[140:143], a[60:63], v[100:103], v[140:143]
s_add_u32 s49, s49, s42
s_mov_b64 exec, 0x77777777
global_load_dword v53, v54, s[6:7]
s_mov_b64 exec, -1
v_mfma_f32_16x16x32_bf16 v[136:139], a[56:59], v[100:103], v[136:139]
s_add_u32 s83, s46, 262144
v_and_b32_e64 v192, 0x13, v0
v_mfma_f32_16x16x32_bf16 v[144:147], a[56:59], v[104:107], v[144:147]
v_bfe_u32 v193, v0, 2, 1
v_lshl_add_u32 v192, v193, 3, v192
v_mfma_f32_16x16x32_bf16 v[148:151], a[60:63], v[104:107], v[148:151]
v_bfe_u32 v193, v0, 3, 1
s_waitcnt lgkmcnt(0)
v_mfma_f32_16x16x32_bf16 v[156:159], a[60:63], v[108:111], v[156:159]
s_waitcnt vmcnt(19)
s_barrier
v_mfma_f32_16x16x32_bf16 v[152:155], a[56:59], v[108:111], v[152:155]
ds_read_b64_tr_b16 a[64:65], v16 offset:0
ds_read_b64_tr_b16 a[66:67], v16 offset:1024
v_mfma_f32_16x16x32_bf16 v[160:163], a[56:59], v[64:67], v[160:163]
buffer_load_dwordx4 v2, s[16:19], s49 offen offset:0 lds
ds_read_b64_tr_b16 a[68:69], v17 offset:0
v_mfma_f32_16x16x32_bf16 v[164:167], a[60:63], v[64:67], v[164:167]
ds_read_b64_tr_b16 a[70:71], v17 offset:1024
v_lshl_add_u32 v192, v193, 2, v192
v_cvt_f32_u32_e64 v192, v192
v_mfma_f32_16x16x32_bf16 v[172:175], a[60:63], v[68:71], v[172:175]
ds_read_b128 v[80:83], v10 offset:0
v_lshrrev_b32_e64 v193, 5, v0
v_lshl_add_u32 v193, s36, 1, v193
v_mfma_f32_16x16x32_bf16 v[168:171], a[56:59], v[68:71], v[168:171]
ds_read_b128 v[84:87], v10 offset:2048
v_cvt_f32_u32_e64 v193, v193
v_mfma_f32_16x16x32_bf16 v[176:179], a[56:59], v[72:75], v[176:179]
buffer_load_dwordx4 v3, s[16:19], s49 offen offset:1024 lds
ds_read_b128 v[88:91], v10 offset:4096
v_mfma_f32_16x16x32_bf16 v[180:183], a[60:63], v[72:75], v[180:183]
ds_read_b128 v[92:95], v10 offset:6144
s_lshl_b32 s45, s36, 10
s_add_u32 s45, s45, 147456
v_mfma_f32_16x16x32_bf16 v[188:191], a[60:63], v[76:79], v[188:191]
ds_read_b128 v[96:99], v10 offset:8192
v_add_u32 v199, s45, v20
v_mul_f32 v194, 0x3a800000, v192
v_mfma_f32_16x16x32_bf16 v[184:187], a[56:59], v[76:79], v[184:187]
ds_read_b128 v[100:103], v10 offset:10240
v_mul_f32_e64 v195, v194, v193
v_mul_f32 v195, 4.0, v195
v_mfma_f32_16x16x32_bf16 v[28:31], v[24:27], a[56:59], v[28:31]
buffer_load_dwordx4 v4, s[16:19], s49 offen offset:2048 lds
ds_read_b128 v[104:107], v10 offset:12288
v_mfma_f32_16x16x32_bf16 v[116:119], v[24:27], a[60:63], v[116:119]
ds_read_b128 v[108:111], v10 offset:14336
s_waitcnt lgkmcnt(6)
v_mfma_f32_16x16x32_bf16 v[128:131], a[64:67], v[80:83], v[128:131]
ds_read_b64_tr_b16 a[72:73], v16 offset:8192
ds_read_b64_tr_b16 a[74:75], v16 offset:9216
v_mfma_f32_16x16x32_bf16 v[132:135], a[68:71], v[80:83], v[132:135]
ds_read_b64_tr_b16 a[76:77], v17 offset:8192
ds_read_b64_tr_b16 a[78:79], v17 offset:9216
v_mfma_f32_16x16x32_bf16 v[140:143], a[68:71], v[84:87], v[140:143]
buffer_load_dwordx4 v5, s[16:19], s49 offen offset:3072 lds
ds_read_b128 v[64:67], v11 offset:0
v_mfma_f32_16x16x32_bf16 v[136:139], a[64:67], v[84:87], v[136:139]
ds_read_b128 v[68:71], v11 offset:2048
s_add_u32 m0, s47, 0x1c000
s_waitcnt lgkmcnt(8)
v_mfma_f32_16x16x32_bf16 v[144:147], a[64:67], v[88:91], v[144:147]
ds_read_b128 v[72:75], v11 offset:4096
s_mul_i32 s50, s52, 458752
s_add_u32 s50, s50, s43
v_mfma_f32_16x16x32_bf16 v[148:151], a[68:71], v[88:91], v[148:151]
v_cos_f32_e64 v200, v195
v_mfma_f32_16x16x32_bf16 v[156:159], a[68:71], v[92:95], v[156:159]
buffer_load_dwordx4 v6, s[20:23], s50 offen offset:0 lds
ds_read_b128 v[76:79], v11 offset:6144
v_mfma_f32_16x16x32_bf16 v[152:155], a[64:67], v[92:95], v[152:155]
v_sin_f32 v204, v195
v_add_f32 v195, v195, v194
v_mfma_f32_16x16x32_bf16 v[160:163], a[64:67], v[96:99], v[160:163]
ds_read_b128 v[80:83], v11 offset:8192
v_cos_f32_e64 v201, v195
v_mfma_f32_16x16x32_bf16 v[164:167], a[68:71], v[96:99], v[164:167]
v_sin_f32_e64 v205, v195
v_mfma_f32_16x16x32_bf16 v[172:175], a[68:71], v[100:103], v[172:175]
buffer_load_dwordx4 v7, s[20:23], s50 offen offset:1024 lds
ds_read_b128 v[84:87], v11 offset:10240
v_mfma_f32_16x16x32_bf16 v[168:171], a[64:67], v[100:103], v[168:171]
v_add_f32 v195, v195, v194
s_waitcnt lgkmcnt(3)
v_mfma_f32_16x16x32_bf16 v[176:179], a[64:67], v[104:107], v[176:179]
ds_read_b128 v[88:91], v11 offset:12288
v_cos_f32_e64 v202, v195
v_mfma_f32_16x16x32_bf16 v[180:183], a[68:71], v[104:107], v[180:183]
v_sin_f32 v206, v195
v_add_f32 v195, v195, v194
v_mfma_f32_16x16x32_bf16 v[188:191], a[68:71], v[108:111], v[188:191]
buffer_load_dwordx4 v8, s[20:23], s50 offen offset:2048 lds
ds_read_b128 v[92:95], v11 offset:14336
v_mfma_f32_16x16x32_bf16 v[184:187], a[64:67], v[108:111], v[184:187]
v_cos_f32_e64 v203, v195
v_mfma_f32_16x16x32_bf16 v[28:31], v[24:27], a[64:67], v[28:31]
v_sin_f32 v207, v195
v_and_b32 v194, 31, v0
v_mfma_f32_16x16x32_bf16 v[116:119], v[24:27], a[68:71], v[116:119]
ds_write_b128 v199, v[200:203]
v_mfma_f32_16x16x32_bf16 v[128:131], a[72:75], v[64:67], v[128:131]
buffer_load_dwordx4 v9, s[20:23], s50 offen offset:3072 lds
v_mfma_f32_16x16x32_bf16 v[132:135], a[76:79], v[64:67], v[132:135]
s_xor_b32 s51, s51, s89
s_add_u32 m0, s47, 0x0
v_mfma_f32_16x16x32_bf16 v[140:143], a[76:79], v[68:71], v[140:143]
s_add_u32 s52, s51, 8
s_and_b32 s52, s52, 7
s_or_b32 s52, s52, 8
v_mfma_f32_16x16x32_bf16 v[136:139], a[72:75], v[68:71], v[136:139]
s_lshl_b32 s49, s52, 7
s_add_u32 s49, s49, s42
v_cvt_f32_u32 v194, v194
v_mfma_f32_16x16x32_bf16 v[144:147], a[72:75], v[72:75], v[144:147]
v_mul_f32 v194, 0x3d000000, v194
ds_write_b128 v199, v[204:207] offset:4096
v_mfma_f32_16x16x32_bf16 v[148:151], a[76:79], v[72:75], v[148:151]
v_mul_f32 v195, v194, v193
s_waitcnt lgkmcnt(2)
v_mfma_f32_16x16x32_bf16 v[156:159], a[76:79], v[76:79], v[156:159]
s_waitcnt vmcnt(17) lgkmcnt(0)
s_barrier
v_mfma_f32_16x16x32_bf16 v[152:155], a[72:75], v[76:79], v[152:155]
ds_read_b64_tr_b16 a[80:81], v16 offset:32768
ds_read_b64_tr_b16 a[82:83], v16 offset:33792
v_mfma_f32_16x16x32_bf16 v[160:163], a[72:75], v[80:83], v[160:163]
buffer_load_dwordx4 v2, s[16:19], s49 offen offset:0 lds
ds_read_b64_tr_b16 a[84:85], v17 offset:32768
v_mfma_f32_16x16x32_bf16 v[164:167], a[76:79], v[80:83], v[164:167]
ds_read_b64_tr_b16 a[86:87], v17 offset:33792
v_mul_f32_e64 v195, 4.0, v195
v_mfma_f32_16x16x32_bf16 v[172:175], a[76:79], v[84:87], v[172:175]
ds_read_b128 v[96:99], v10 offset:32768
v_cos_f32_e64 v196, v195
v_mfma_f32_16x16x32_bf16 v[168:171], a[72:75], v[84:87], v[168:171]
ds_read_b128 v[100:103], v10 offset:34816
v_sin_f32_e64 v197, v195
v_mfma_f32_16x16x32_bf16 v[176:179], a[72:75], v[88:91], v[176:179]
buffer_load_dwordx4 v3, s[16:19], s49 offen offset:1024 lds
ds_read_b128 v[104:107], v10 offset:36864
v_mfma_f32_16x16x32_bf16 v[180:183], a[76:79], v[88:91], v[180:183]
ds_read_b128 v[108:111], v10 offset:38912
s_nop 0
v_cvt_pk_bf16_f32 v208, v196, -v197
v_mfma_f32_16x16x32_bf16 v[188:191], a[76:79], v[92:95], v[188:191]
ds_read_b128 v[64:67], v10 offset:40960
v_add_f32_e64 v195, v195, v194
v_mfma_f32_16x16x32_bf16 v[184:187], a[72:75], v[92:95], v[184:187]
ds_read_b128 v[68:71], v10 offset:43008
v_mfma_f32_16x16x32_bf16 v[28:31], v[24:27], a[72:75], v[28:31]
buffer_load_dwordx4 v4, s[16:19], s49 offen offset:2048 lds
ds_read_b128 v[72:75], v10 offset:45056
v_mfma_f32_16x16x32_bf16 v[116:119], v[24:27], a[76:79], v[116:119]
ds_read_b128 v[76:79], v10 offset:47104
s_waitcnt lgkmcnt(6)
v_mfma_f32_16x16x32_bf16 v[128:131], a[80:83], v[96:99], v[128:131]
ds_read_b64_tr_b16 a[88:89], v16 offset:40960
ds_read_b64_tr_b16 a[90:91], v16 offset:41984
v_mfma_f32_16x16x32_bf16 v[132:135], a[84:87], v[96:99], v[132:135]
ds_read_b64_tr_b16 a[92:93], v17 offset:40960
ds_read_b64_tr_b16 a[94:95], v17 offset:41984
v_mfma_f32_16x16x32_bf16 v[140:143], a[84:87], v[100:103], v[140:143]
buffer_load_dwordx4 v5, s[16:19], s49 offen offset:3072 lds
ds_read_b128 v[80:83], v11 offset:32768
v_mfma_f32_16x16x32_bf16 v[136:139], a[80:83], v[100:103], v[136:139]
ds_read_b128 v[84:87], v11 offset:34816
s_add_u32 m0, s47, 0x4000
s_waitcnt lgkmcnt(8)
v_mfma_f32_16x16x32_bf16 v[144:147], a[80:83], v[104:107], v[144:147]
ds_read_b128 v[88:91], v11 offset:36864
s_mul_i32 s50, s52, 458752
s_add_u32 s50, s50, s43
v_mfma_f32_16x16x32_bf16 v[148:151], a[84:87], v[104:107], v[148:151]
v_cos_f32_e64 v196, v195
v_mfma_f32_16x16x32_bf16 v[156:159], a[84:87], v[108:111], v[156:159]
buffer_load_dwordx4 v6, s[20:23], s50 offen offset:0 lds
ds_read_b128 v[92:95], v11 offset:38912
v_mfma_f32_16x16x32_bf16 v[152:155], a[80:83], v[108:111], v[152:155]
v_sin_f32 v197, v195
s_nop 0
v_mfma_f32_16x16x32_bf16 v[160:163], a[80:83], v[64:67], v[160:163]
ds_read_b128 v[96:99], v11 offset:40960
v_cvt_pk_bf16_f32 v209, v196, -v197
v_add_f32_e64 v195, v195, v194
v_mfma_f32_16x16x32_bf16 v[164:167], a[84:87], v[64:67], v[164:167]
v_cos_f32_e64 v196, v195
v_mfma_f32_16x16x32_bf16 v[172:175], a[84:87], v[68:71], v[172:175]
buffer_load_dwordx4 v7, s[20:23], s50 offen offset:1024 lds
ds_read_b128 v[100:103], v11 offset:43008
v_mfma_f32_16x16x32_bf16 v[168:171], a[80:83], v[68:71], v[168:171]
v_sin_f32 v197, v195
s_waitcnt lgkmcnt(3)
v_mfma_f32_16x16x32_bf16 v[176:179], a[80:83], v[72:75], v[176:179]
ds_read_b128 v[104:107], v11 offset:45056
s_nop 0
v_cvt_pk_bf16_f32 v210, v196, -v197
v_mfma_f32_16x16x32_bf16 v[180:183], a[84:87], v[72:75], v[180:183]
v_add_f32 v195, v195, v194
v_mfma_f32_16x16x32_bf16 v[188:191], a[84:87], v[76:79], v[188:191]
buffer_load_dwordx4 v8, s[20:23], s50 offen offset:2048 lds
ds_read_b128 v[108:111], v11 offset:47104
v_mfma_f32_16x16x32_bf16 v[184:187], a[80:83], v[76:79], v[184:187]
v_cos_f32_e64 v196, v195
v_mfma_f32_16x16x32_bf16 v[28:31], v[24:27], a[80:83], v[28:31]
v_sin_f32_e64 v197, v195
v_mul_f32 v194, 0x3d000000, v192
v_mfma_f32_16x16x32_bf16 v[116:119], v[24:27], a[84:87], v[116:119]
v_cvt_pk_bf16_f32 v211, v196, -v197
v_mul_f32 v195, v194, v193
v_mfma_f32_16x16x32_bf16 v[128:131], a[88:91], v[80:83], v[128:131]
buffer_load_dwordx4 v9, s[20:23], s50 offen offset:3072 lds
s_add_u32 m0, s47, 0x8000
v_mfma_f32_16x16x32_bf16 v[132:135], a[92:95], v[80:83], v[132:135]
s_add_u32 s52, s51, 9
s_and_b32 s52, s52, 7
s_or_b32 s52, s52, 8
v_mfma_f32_16x16x32_bf16 v[140:143], a[92:95], v[84:87], v[140:143]
s_lshl_b32 s49, s52, 7
s_add_u32 s49, s49, s42
v_mfma_f32_16x16x32_bf16 v[136:139], a[88:91], v[84:87], v[136:139]
ds_write_b128 v199, v[208:211] offset:8192
v_mfma_f32_16x16x32_bf16 v[144:147], a[88:91], v[88:91], v[144:147]
v_add_f32 v195, v195, v195
s_lshr_b32 s45, s36, 1
v_mfma_f32_16x16x32_bf16 v[148:151], a[92:95], v[88:91], v[148:151]
s_lshl_b32 s45, s45, 10
s_waitcnt lgkmcnt(1)
v_mfma_f32_16x16x32_bf16 v[156:159], a[92:95], v[92:95], v[156:159]
s_waitcnt vmcnt(17) lgkmcnt(0)
s_barrier
v_mfma_f32_16x16x32_bf16 v[152:155], a[88:91], v[92:95], v[152:155]
ds_read_b64_tr_b16 a[96:97], v18 offset:0
ds_read_b64_tr_b16 a[98:99], v18 offset:1024
s_and_b32 s46, s36, 1
v_mfma_f32_16x16x32_bf16 v[160:163], a[88:91], v[96:99], v[160:163]
buffer_load_dwordx4 v2, s[16:19], s49 offen offset:0 lds
ds_read_b64_tr_b16 a[100:101], v19 offset:0
v_mfma_f32_16x16x32_bf16 v[164:167], a[92:95], v[96:99], v[164:167]
ds_read_b64_tr_b16 a[102:103], v19 offset:1024
s_lshl3_add_u32 s45, s46, s45
s_add_u32 s45, s45, 147456
v_mfma_f32_16x16x32_bf16 v[172:175], a[92:95], v[100:103], v[172:175]
ds_read_b128 v[64:67], v12 offset:0
v_cos_f32_e64 v196, v195
v_mfma_f32_16x16x32_bf16 v[168:171], a[88:91], v[100:103], v[168:171]
ds_read_b128 v[68:71], v12 offset:2048
v_mfma_f32_16x16x32_bf16 v[176:179], a[88:91], v[104:107], v[176:179]
buffer_load_dwordx4 v3, s[16:19], s49 offen offset:1024 lds
ds_read_b128 v[72:75], v12 offset:4096
v_mfma_f32_16x16x32_bf16 v[180:183], a[92:95], v[104:107], v[180:183]
ds_read_b128 v[76:79], v12 offset:6144
v_sin_f32_e64 v197, v195
v_mfma_f32_16x16x32_bf16 v[188:191], a[92:95], v[108:111], v[188:191]
ds_read_b128 v[80:83], v12 offset:8192
v_add_u32_e64 v198, s45, v20
v_cvt_pk_bf16_f32 v212, v196, -v197
v_mfma_f32_16x16x32_bf16 v[184:187], a[88:91], v[108:111], v[184:187]
ds_read_b128 v[84:87], v12 offset:10240
v_cvt_pk_bf16_f32 v214, v197, v196
v_add_f32 v195, v195, v194
v_mfma_f32_16x16x32_bf16 v[28:31], v[24:27], a[88:91], v[28:31]
buffer_load_dwordx4 v4, s[16:19], s49 offen offset:2048 lds
ds_read_b128 v[88:91], v12 offset:12288
v_mfma_f32_16x16x32_bf16 v[116:119], v[24:27], a[92:95], v[116:119]
ds_read_b128 v[92:95], v12 offset:14336
s_waitcnt lgkmcnt(6)
v_mfma_f32_16x16x32_bf16 v[128:131], a[96:99], v[64:67], v[128:131]
ds_read_b64_tr_b16 a[104:105], v18 offset:8192
ds_read_b64_tr_b16 a[106:107], v18 offset:9216
v_mfma_f32_16x16x32_bf16 v[132:135], a[100:103], v[64:67], v[132:135]
ds_read_b64_tr_b16 a[108:109], v19 offset:8192
ds_read_b64_tr_b16 a[110:111], v19 offset:9216
v_mfma_f32_16x16x32_bf16 v[140:143], a[100:103], v[68:71], v[140:143]
buffer_load_dwordx4 v5, s[16:19], s49 offen offset:3072 lds
ds_read_b128 v[96:99], v13 offset:0
v_mfma_f32_16x16x32_bf16 v[136:139], a[96:99], v[68:71], v[136:139]
ds_read_b128 v[100:103], v13 offset:2048
s_add_u32 m0, s47, 0xc000
s_waitcnt lgkmcnt(8)
v_mfma_f32_16x16x32_bf16 v[144:147], a[96:99], v[72:75], v[144:147]
ds_read_b128 v[104:107], v13 offset:4096
s_mul_i32 s50, s52, 458752
s_add_u32 s50, s50, s43
v_mfma_f32_16x16x32_bf16 v[148:151], a[100:103], v[72:75], v[148:151]
v_cos_f32_e64 v196, v195
v_mfma_f32_16x16x32_bf16 v[156:159], a[100:103], v[76:79], v[156:159]
buffer_load_dwordx4 v6, s[20:23], s50 offen offset:0 lds
ds_read_b128 v[108:111], v13 offset:6144
v_mfma_f32_16x16x32_bf16 v[152:155], a[96:99], v[76:79], v[152:155]
v_sin_f32 v197, v195
v_add_u32 v198, s45, v20
v_mfma_f32_16x16x32_bf16 v[160:163], a[96:99], v[80:83], v[160:163]
ds_read_b128 v[64:67], v13 offset:8192
v_cvt_pk_bf16_f32 v213, v196, -v197
v_cvt_pk_bf16_f32 v215, v197, v196
v_mfma_f32_16x16x32_bf16 v[164:167], a[100:103], v[80:83], v[164:167]
ds_write_b64 v198, v[212:213] offset:12288
v_mfma_f32_16x16x32_bf16 v[172:175], a[100:103], v[84:87], v[172:175]
buffer_load_dwordx4 v7, s[20:23], s50 offen offset:1024 lds
ds_read_b128 v[68:71], v13 offset:10240
v_mfma_f32_16x16x32_bf16 v[168:171], a[96:99], v[84:87], v[168:171]
ds_write_b64 v198, v[214:215] offset:14336
s_waitcnt lgkmcnt(5)
v_mfma_f32_16x16x32_bf16 v[176:179], a[96:99], v[88:91], v[176:179]
ds_read_b128 v[72:75], v13 offset:12288
s_mov_b32 s84, s12
s_mov_b32 s85, s13
v_mfma_f32_16x16x32_bf16 v[180:183], a[100:103], v[88:91], v[180:183]
s_mov_b32 s86, 0x700000
s_mov_b32 s87, 0x20000
s_mov_b32 s28, s14
v_mfma_f32_16x16x32_bf16 v[188:191], a[100:103], v[92:95], v[188:191]
buffer_load_dwordx4 v8, s[20:23], s50 offen offset:2048 lds
ds_read_b128 v[76:79], v13 offset:14336
v_mfma_f32_16x16x32_bf16 v[184:187], a[96:99], v[92:95], v[184:187]
s_mov_b32 s29, s15
s_mov_b32 s30, 0x800
s_mov_b32 s31, 0x20000
v_mfma_f32_16x16x32_bf16 v[28:31], v[24:27], a[96:99], v[28:31]
s_mul_i32 s46, s38, 1835008
s_lshl_b32 s45, s36, 15
s_add_u32 s46, s46, s45
v_mfma_f32_16x16x32_bf16 v[116:119], v[24:27], a[100:103], v[116:119]
s_lshl_b32 s45, s39, 8
s_add_u32 s46, s46, s45
v_mfma_f32_16x16x32_bf16 v[128:131], a[104:107], v[96:99], v[128:131]
buffer_load_dwordx4 v9, s[20:23], s50 offen offset:3072 lds
s_add_u32 m0, s47, 0x10000
v_mfma_f32_16x16x32_bf16 v[132:135], a[108:111], v[96:99], v[132:135]
s_add_u32 s52, s51, 10
s_and_b32 s52, s52, 7
s_or_b32 s52, s52, 8
v_mfma_f32_16x16x32_bf16 v[140:143], a[108:111], v[100:103], v[140:143]
s_lshl_b32 s49, s52, 7
s_add_u32 s49, s49, s42
v_lshrrev_b32_e64 v44, 4, v0
v_mfma_f32_16x16x32_bf16 v[136:139], a[104:107], v[100:103], v[136:139]
v_lshlrev_b32 v45, 1, v44
v_and_b32 v46, 15, v0
v_xor_b32_e64 v45, v45, v46
v_mfma_f32_16x16x32_bf16 v[144:147], a[104:107], v[104:107], v[144:147]
v_mul_u32_u24 v44, 2048, v44
v_lshl_add_u32 v122, v45, 4, v44
v_add_u32 v122, s46, v122
v_mfma_f32_16x16x32_bf16 v[148:151], a[108:111], v[104:107], v[148:151]
v_xor_b32 v125, 128, v122
v_add_u32 v123, 7168, v125
s_waitcnt lgkmcnt(0)
v_mfma_f32_16x16x32_bf16 v[156:159], a[108:111], v[108:111], v[156:159]
s_waitcnt vmcnt(16)
s_barrier
v_mfma_f32_16x16x32_bf16 v[152:155], a[104:107], v[108:111], v[152:155]
ds_read_b64_tr_b16 a[112:113], v18 offset:32768
ds_read_b64_tr_b16 a[114:115], v18 offset:33792
v_mfma_f32_16x16x32_bf16 v[160:163], a[104:107], v[64:67], v[160:163]
buffer_load_dwordx4 v2, s[16:19], s49 offen offset:0 lds
ds_read_b64_tr_b16 a[116:117], v19 offset:32768
v_mfma_f32_16x16x32_bf16 v[164:167], a[108:111], v[64:67], v[164:167]
ds_read_b64_tr_b16 a[118:119], v19 offset:33792
v_add_u32 v124, 14336, v122
v_add_u32 v125, 21504, v125
v_mfma_f32_16x16x32_bf16 v[172:175], a[108:111], v[68:71], v[172:175]
ds_read_b128 v[80:83], v12 offset:32768
v_bfe_u32 v44, v0, 2, 3
s_lshl_b32 s45, s36, 1
v_mfma_f32_16x16x32_bf16 v[168:171], a[104:107], v[68:71], v[168:171]
ds_read_b128 v[84:87], v12 offset:34816
v_xor_b32 v44, s45, v44
v_and_b32_e64 v46, 1, v0
v_mfma_f32_16x16x32_bf16 v[176:179], a[104:107], v[72:75], v[176:179]
buffer_load_dwordx4 v3, s[16:19], s49 offen offset:1024 lds
ds_read_b128 v[88:91], v12 offset:36864
v_mfma_f32_16x16x32_bf16 v[180:183], a[108:111], v[72:75], v[180:183]
ds_read_b128 v[92:95], v12 offset:38912
v_lshl_add_u32 v44, v44, 1, v46
v_bfe_u32 v46, v0, 1, 1
v_mfma_f32_16x16x32_bf16 v[188:191], a[108:111], v[76:79], v[188:191]
ds_read_b128 v[96:99], v12 offset:40960
v_lshl_add_u32 v44, v44, 1, v46
v_lshrrev_b32_e64 v45, 2, v0
v_mfma_f32_16x16x32_bf16 v[184:187], a[104:107], v[76:79], v[184:187]
ds_read_b128 v[100:103], v12 offset:43008
v_lshlrev_b32_e64 v44, 3, v44
v_mfma_f32_16x16x32_bf16 v[28:31], v[24:27], a[104:107], v[28:31]
buffer_load_dwordx4 v4, s[16:19], s49 offen offset:2048 lds
ds_read_b128 v[104:107], v12 offset:45056
v_mfma_f32_16x16x32_bf16 v[116:119], v[24:27], a[108:111], v[116:119]
ds_read_b128 v[108:111], v12 offset:47104
v_lshl_add_u32 v120, v45, 8, v44
s_waitcnt lgkmcnt(6)
v_mfma_f32_16x16x32_bf16 v[128:131], a[112:115], v[80:83], v[128:131]
ds_read_b64_tr_b16 a[120:121], v18 offset:40960
ds_read_b64_tr_b16 a[122:123], v18 offset:41984
v_add_u32 v21, 0x10000, v20
v_mfma_f32_16x16x32_bf16 v[132:135], a[116:119], v[80:83], v[132:135]
ds_read_b64_tr_b16 a[124:125], v19 offset:40960
ds_read_b64_tr_b16 a[126:127], v19 offset:41984
s_bfe_u32 s54, s2, 0x20003
v_mfma_f32_16x16x32_bf16 v[140:143], a[116:119], v[84:87], v[140:143]
buffer_load_dwordx4 v5, s[16:19], s49 offen offset:3072 lds
ds_read_b128 v[64:67], v13 offset:32768
v_mfma_f32_16x16x32_bf16 v[136:139], a[112:115], v[84:87], v[136:139]
ds_read_b128 v[68:71], v13 offset:34816
s_add_u32 m0, s47, 0x14000
s_waitcnt lgkmcnt(8)
v_mfma_f32_16x16x32_bf16 v[144:147], a[112:115], v[88:91], v[144:147]
ds_read_b128 v[72:75], v13 offset:36864
s_mul_i32 s50, s52, 458752
s_add_u32 s50, s50, s43
v_mfma_f32_16x16x32_bf16 v[148:151], a[116:119], v[88:91], v[148:151]
s_lshl1_add_u32 s54, s54, s39
s_and_b32 s45, s37, 1
v_mfma_f32_16x16x32_bf16 v[156:159], a[116:119], v[92:95], v[156:159]
buffer_load_dwordx4 v6, s[20:23], s50 offen offset:0 lds
ds_read_b128 v[76:79], v13 offset:38912
v_mfma_f32_16x16x32_bf16 v[152:155], a[112:115], v[92:95], v[152:155]
s_add_u32 s54, s54, s45
s_sub_u32 s45, s54, 7
s_min_u32 s54, s54, s45
v_mfma_f32_16x16x32_bf16 v[160:163], a[112:115], v[96:99], v[160:163]
ds_read_b128 v[80:83], v13 offset:40960
s_lshl_b32 s4, s54, 18
s_lshl_b32 s45, s54, 3
v_mfma_f32_16x16x32_bf16 v[164:167], a[116:119], v[96:99], v[164:167]
s_mul_i32 s46, s36, 6
s_add_u32 s46, s46, s45
s_add_u32 s56, s46, 32
v_mfma_f32_16x16x32_bf16 v[172:175], a[116:119], v[100:103], v[172:175]
buffer_load_dwordx4 v7, s[20:23], s50 offen offset:1024 lds
ds_read_b128 v[84:87], v13 offset:43008
v_mfma_f32_16x16x32_bf16 v[168:171], a[112:115], v[100:103], v[168:171]
s_sub_u32 s60, s56, 56
s_min_u32 s56, s56, s60
s_waitcnt lgkmcnt(3)
v_mfma_f32_16x16x32_bf16 v[176:179], a[112:115], v[104:107], v[176:179]
ds_read_b128 v[88:91], v13 offset:45056
s_lshl_b32 s56, s56, 10
s_add_u32 s56, s56, s55
v_mfma_f32_16x16x32_bf16 v[180:183], a[116:119], v[104:107], v[180:183]
s_add_u32 s57, s46, 34
s_sub_u32 s60, s57, 56
v_mfma_f32_16x16x32_bf16 v[188:191], a[116:119], v[108:111], v[188:191]
buffer_load_dwordx4 v8, s[20:23], s50 offen offset:2048 lds
ds_read_b128 v[92:95], v13 offset:47104
v_mfma_f32_16x16x32_bf16 v[184:187], a[112:115], v[108:111], v[184:187]
s_min_u32 s57, s57, s60
s_lshl_b32 s57, s57, 10
s_add_u32 s57, s57, s55
v_mfma_f32_16x16x32_bf16 v[28:31], v[24:27], a[112:115], v[28:31]
s_sub_u32 s57, s57, 2048
s_add_u32 s58, s46, 36
s_sub_u32 s60, s58, 56
v_mfma_f32_16x16x32_bf16 v[116:119], v[24:27], a[116:119], v[116:119]
s_min_u32 s58, s58, s60
s_lshl_b32 s58, s58, 10
s_add_u32 s58, s58, s55
v_mfma_f32_16x16x32_bf16 v[128:131], a[120:123], v[64:67], v[128:131]
buffer_load_dwordx4 v9, s[20:23], s50 offen offset:3072 lds
s_add_u32 m0, s47, 0x18000
v_mfma_f32_16x16x32_bf16 v[132:135], a[124:127], v[64:67], v[132:135]
s_add_u32 s52, s51, 11
s_and_b32 s52, s52, 7
s_or_b32 s52, s52, 8
v_mfma_f32_16x16x32_bf16 v[140:143], a[124:127], v[68:71], v[140:143]
s_lshl_b32 s49, s52, 7
s_add_u32 s49, s49, s42
s_add_u32 s46, s54, s36
v_mfma_f32_16x16x32_bf16 v[136:139], a[120:123], v[68:71], v[136:139]
s_sub_u32 s60, s46, 7
s_min_u32 s46, s46, s60
v_mfma_f32_16x16x32_bf16 v[144:147], a[120:123], v[72:75], v[144:147]
s_lshl_b32 s46, s46, 13
s_add_u32 s55, s55, s46
s_mul_i32 s5, s36, 6144
v_mfma_f32_16x16x32_bf16 v[148:151], a[124:127], v[72:75], v[148:151]
v_min_u32 v1, 6, v0
v_lshl_add_u32 v1, v1, 2, s36
s_waitcnt lgkmcnt(0)
v_mfma_f32_16x16x32_bf16 v[156:159], a[124:127], v[76:79], v[156:159]
s_waitcnt vmcnt(16)
s_barrier
v_mfma_f32_16x16x32_bf16 v[152:155], a[120:123], v[76:79], v[152:155]
ds_read_b64_tr_b16 a[128:129], v16 offset:0
ds_read_b64_tr_b16 a[130:131], v16 offset:1024
v_lshlrev_b32 v1, 10, v1
v_mfma_f32_16x16x32_bf16 v[160:163], a[120:123], v[80:83], v[160:163]
buffer_load_dwordx4 v2, s[16:19], s49 offen offset:0 lds
ds_read_b64_tr_b16 a[132:133], v17 offset:0
v_mfma_f32_16x16x32_bf16 v[164:167], a[124:127], v[80:83], v[164:167]
ds_read_b64_tr_b16 a[134:135], v17 offset:1024
s_lshl_b32 s62, s36, 1
s_add_u32 s62, s62, s40
v_mfma_f32_16x16x32_bf16 v[172:175], a[124:127], v[84:87], v[172:175]
ds_read_b128 v[96:99], v10 offset:0
s_and_b32 s62, s62, 7
s_lshl3_add_u32 s62, s37, s62
v_mfma_f32_16x16x32_bf16 v[168:171], a[120:123], v[84:87], v[168:171]
ds_read_b128 v[100:103], v10 offset:2048
s_lshl_b32 s62, s62, 10
v_mfma_f32_16x16x32_bf16 v[176:179], a[120:123], v[88:91], v[176:179]
buffer_load_dwordx4 v3, s[16:19], s49 offen offset:1024 lds
ds_read_b128 v[104:107], v10 offset:4096
v_mfma_f32_16x16x32_bf16 v[180:183], a[124:127], v[88:91], v[180:183]
ds_read_b128 v[108:111], v10 offset:6144
s_add_u32 s62, s62, 65536
s_and_b32 s61, s53, 0xbfffbfff
v_mfma_f32_16x16x32_bf16 v[188:191], a[124:127], v[92:95], v[188:191]
ds_read_b128 v[64:67], v10 offset:8192
v_lshl_add_u32 v242, s36, 11, v20
v_add_u32 v242, 131084, v242
v_mfma_f32_16x16x32_bf16 v[184:187], a[120:123], v[92:95], v[184:187]
ds_read_b128 v[68:71], v10 offset:10240
s_lshr_b32 s88, s2, 3
s_lshl2_add_u32 s88, s88, s36
v_mfma_f32_16x16x32_bf16 v[28:31], v[24:27], a[120:123], v[28:31]
buffer_load_dwordx4 v4, s[16:19], s49 offen offset:2048 lds
ds_read_b128 v[72:75], v10 offset:12288
v_mfma_f32_16x16x32_bf16 v[116:119], v[24:27], a[124:127], v[116:119]
ds_read_b128 v[76:79], v10 offset:14336
s_lshl_b32 s88, s88, 14
s_waitcnt lgkmcnt(6)
v_mfma_f32_16x16x32_bf16 v[128:131], a[128:131], v[96:99], v[128:131]
ds_read_b64_tr_b16 a[136:137], v16 offset:8192
ds_read_b64_tr_b16 a[138:139], v16 offset:9216
s_mul_i32 s90, s38, 1835008
v_mfma_f32_16x16x32_bf16 v[132:135], a[132:135], v[96:99], v[132:135]
ds_read_b64_tr_b16 a[140:141], v17 offset:8192
ds_read_b64_tr_b16 a[142:143], v17 offset:9216
v_mfma_f32_16x16x32_bf16 v[140:143], a[132:135], v[100:103], v[140:143]
buffer_load_dwordx4 v5, s[16:19], s49 offen offset:3072 lds
ds_read_b128 v[80:83], v11 offset:0
v_mfma_f32_16x16x32_bf16 v[136:139], a[128:131], v[100:103], v[136:139]
ds_read_b128 v[84:87], v11 offset:2048
s_add_u32 m0, s47, 0x1c000
s_waitcnt lgkmcnt(8)
v_mfma_f32_16x16x32_bf16 v[144:147], a[128:131], v[104:107], v[144:147]
ds_read_b128 v[88:91], v11 offset:4096
s_mul_i32 s50, s52, 458752
s_add_u32 s50, s50, s43
v_mfma_f32_16x16x32_bf16 v[148:151], a[132:135], v[104:107], v[148:151]
s_add_u32 s88, s88, s90
v_and_b32 v126, 1, v0
v_lshlrev_b32_e64 v126, 2, v126
v_mfma_f32_16x16x32_bf16 v[156:159], a[132:135], v[108:111], v[156:159]
buffer_load_dwordx4 v6, s[20:23], s50 offen offset:0 lds
ds_read_b128 v[92:95], v11 offset:6144
v_mfma_f32_16x16x32_bf16 v[152:155], a[128:131], v[108:111], v[152:155]
s_mov_b32 s90, 0xb3fe
v_bfe_u32 v126, s90, v126, 4
v_bfe_u32 v121, v0, 2, 3
v_mfma_f32_16x16x32_bf16 v[160:163], a[128:131], v[64:67], v[160:163]
ds_read_b128 v[96:99], v11 offset:8192
v_lshl_add_u32 v121, v121, 4, v126
v_lshlrev_b32_e64 v121, 7, v121
v_mfma_f32_16x16x32_bf16 v[164:167], a[132:135], v[64:67], v[164:167]
v_lshrrev_b32_e64 v127, 1, v0
v_lshl_add_u32 v127, s36, 5, v127
v_mfma_f32_16x16x32_bf16 v[172:175], a[132:135], v[68:71], v[172:175]
buffer_load_dwordx4 v7, s[20:23], s50 offen offset:1024 lds
ds_read_b128 v[100:103], v11 offset:10240
v_mfma_f32_16x16x32_bf16 v[168:171], a[128:131], v[68:71], v[168:171]
v_and_b32 v14, 1, v0
v_lshl_add_u32 v127, v127, 4, v14
s_waitcnt lgkmcnt(3)
v_mfma_f32_16x16x32_bf16 v[176:179], a[128:131], v[72:75], v[176:179]
ds_read_b128 v[104:107], v11 offset:12288
v_lshl_add_u32 v127, s39, 1, v127
s_mul_i32 s91, s38, 1835008
v_mfma_f32_16x16x32_bf16 v[180:183], a[132:135], v[72:75], v[180:183]
v_lshl_add_u32 v127, v127, 7, s91
s_lshr_b32 s91, s2, 3
s_lshl_b32 s91, s91, 30
v_mfma_f32_16x16x32_bf16 v[188:191], a[132:135], v[76:79], v[188:191]
buffer_load_dwordx4 v8, s[20:23], s50 offen offset:2048 lds
ds_read_b128 v[108:111], v11 offset:14336
v_mfma_f32_16x16x32_bf16 v[184:187], a[128:131], v[76:79], v[184:187]
v_subrev_u32 v127, s91, v127
v_mfma_f32_16x16x32_bf16 v[28:31], v[24:27], a[128:131], v[28:31]
v_mfma_f32_16x16x32_bf16 v[116:119], v[24:27], a[132:135], v[116:119]
v_mfma_f32_16x16x32_bf16 v[128:131], a[136:139], v[80:83], v[128:131]
buffer_load_dwordx4 v9, s[20:23], s50 offen offset:3072 lds
s_add_u32 m0, s47, 0x0
v_mfma_f32_16x16x32_bf16 v[132:135], a[140:143], v[80:83], v[132:135]
s_add_u32 s52, s51, 12
s_and_b32 s52, s52, 7
s_or_b32 s52, s52, 8
v_mfma_f32_16x16x32_bf16 v[140:143], a[140:143], v[84:87], v[140:143]
s_lshl_b32 s49, s52, 7
s_add_u32 s49, s49, s42
v_mfma_f32_16x16x32_bf16 v[136:139], a[136:139], v[84:87], v[136:139]
v_mfma_f32_16x16x32_bf16 v[144:147], a[136:139], v[88:91], v[144:147]
v_mfma_f32_16x16x32_bf16 v[148:151], a[140:143], v[88:91], v[148:151]
s_waitcnt lgkmcnt(0)
v_mfma_f32_16x16x32_bf16 v[156:159], a[140:143], v[92:95], v[156:159]
s_waitcnt vmcnt(16)
s_barrier
v_mfma_f32_16x16x32_bf16 v[152:155], a[136:139], v[92:95], v[152:155]
ds_read_b64_tr_b16 a[144:145], v16 offset:32768
ds_read_b64_tr_b16 a[146:147], v16 offset:33792
v_mfma_f32_16x16x32_bf16 v[160:163], a[136:139], v[96:99], v[160:163]
buffer_load_dwordx4 v2, s[16:19], s49 offen offset:0 lds
ds_read_b64_tr_b16 a[148:149], v17 offset:32768
v_mfma_f32_16x16x32_bf16 v[164:167], a[140:143], v[96:99], v[164:167]
ds_read_b64_tr_b16 a[150:151], v17 offset:33792
v_mfma_f32_16x16x32_bf16 v[172:175], a[140:143], v[100:103], v[172:175]
ds_read_b128 v[64:67], v10 offset:32768
v_mfma_f32_16x16x32_bf16 v[168:171], a[136:139], v[100:103], v[168:171]
ds_read_b128 v[68:71], v10 offset:34816
v_mfma_f32_16x16x32_bf16 v[176:179], a[136:139], v[104:107], v[176:179]
buffer_load_dwordx4 v3, s[16:19], s49 offen offset:1024 lds
ds_read_b128 v[72:75], v10 offset:36864
v_mfma_f32_16x16x32_bf16 v[180:183], a[140:143], v[104:107], v[180:183]
ds_read_b128 v[76:79], v10 offset:38912
v_mfma_f32_16x16x32_bf16 v[188:191], a[140:143], v[108:111], v[188:191]
buffer_load_dword v14, v127, s[84:87], s4 offen
v_mfma_f32_16x16x32_bf16 v[184:187], a[136:139], v[108:111], v[184:187]
ds_read_b128 v[80:83], v10 offset:40960
v_add_u32_e64 v127, 0x40000000, v127
v_mfma_f32_16x16x32_bf16 v[28:31], v[24:27], a[136:139], v[28:31]
buffer_load_dwordx4 v4, s[16:19], s49 offen offset:2048 lds
v_mfma_f32_16x16x32_bf16 v[116:119], v[24:27], a[140:143], v[116:119]
ds_read_b128 v[84:87], v10 offset:43008
s_waitcnt lgkmcnt(4)
v_mfma_f32_16x16x32_bf16 v[128:131], a[144:147], v[64:67], v[128:131]
ds_read_b128 v[88:91], v10 offset:45056
v_mfma_f32_16x16x32_bf16 v[132:135], a[148:151], v[64:67], v[132:135]
ds_read_b128 v[92:95], v10 offset:47104
v_mfma_f32_16x16x32_bf16 v[140:143], a[148:151], v[68:71], v[140:143]
buffer_load_dwordx4 v5, s[16:19], s49 offen offset:3072 lds
ds_read_b64_tr_b16 a[152:153], v16 offset:40960
v_mfma_f32_16x16x32_bf16 v[136:139], a[144:147], v[68:71], v[136:139]
ds_read_b64_tr_b16 a[154:155], v16 offset:41984
s_waitcnt lgkmcnt(5)
v_mfma_f32_16x16x32_bf16 v[144:147], a[144:147], v[72:75], v[144:147]
ds_read_b64_tr_b16 a[156:157], v17 offset:40960
ds_read_b64_tr_b16 a[158:159], v17 offset:41984
v_mfma_f32_16x16x32_bf16 v[148:151], a[148:151], v[72:75], v[148:151]
ds_read_b128 v[96:99], v11 offset:32768
s_add_u32 m0, s47, 0x4000
v_mfma_f32_16x16x32_bf16 v[156:159], a[148:151], v[76:79], v[156:159]
ds_read_b128 v[100:103], v11 offset:34816
s_mul_i32 s50, s52, 458752
v_mfma_f32_16x16x32_bf16 v[152:155], a[144:147], v[76:79], v[152:155]
ds_read_b128 v[104:107], v11 offset:36864
s_add_u32 s50, s50, s43
v_mfma_f32_16x16x32_bf16 v[160:163], a[144:147], v[80:83], v[160:163]
buffer_load_dwordx4 v6, s[20:23], s50 offen offset:0 lds
v_mfma_f32_16x16x32_bf16 v[164:167], a[148:151], v[80:83], v[164:167]
ds_read_b128 v[108:111], v11 offset:38912
s_waitcnt lgkmcnt(6)
v_mfma_f32_16x16x32_bf16 v[172:175], a[148:151], v[84:87], v[172:175]
ds_read_b128 v[64:67], v11 offset:40960
v_mfma_f32_16x16x32_bf16 v[168:171], a[144:147], v[84:87], v[168:171]
ds_read_b128 v[68:71], v11 offset:43008
v_mfma_f32_16x16x32_bf16 v[176:179], a[144:147], v[88:91], v[176:179]
buffer_load_dwordx4 v7, s[20:23], s50 offen offset:1024 lds
v_mfma_f32_16x16x32_bf16 v[180:183], a[148:151], v[88:91], v[180:183]
ds_read_b128 v[72:75], v11 offset:45056
v_mfma_f32_16x16x32_bf16 v[188:191], a[148:151], v[92:95], v[188:191]
ds_read_b128 v[76:79], v11 offset:47104
v_mfma_f32_16x16x32_bf16 v[184:187], a[144:147], v[92:95], v[184:187]
v_mfma_f32_16x16x32_bf16 v[28:31], v[24:27], a[144:147], v[28:31]
buffer_load_dwordx4 v8, s[20:23], s50 offen offset:2048 lds
v_mfma_f32_16x16x32_bf16 v[116:119], v[24:27], a[148:151], v[116:119]
s_waitcnt lgkmcnt(2)
v_mfma_f32_16x16x32_bf16 v[128:131], a[152:155], v[96:99], v[128:131]
v_mfma_f32_16x16x32_bf16 v[132:135], a[156:159], v[96:99], v[132:135]
v_mfma_f32_16x16x32_bf16 v[140:143], a[156:159], v[100:103], v[140:143]
buffer_load_dwordx4 v9, s[20:23], s50 offen offset:3072 lds
v_mfma_f32_16x16x32_bf16 v[136:139], a[152:155], v[100:103], v[136:139]
s_add_u32 m0, s47, 0x8000
s_add_u32 s52, s51, 13
v_mfma_f32_16x16x32_bf16 v[144:147], a[152:155], v[104:107], v[144:147]
s_and_b32 s52, s52, 7
s_or_b32 s52, s52, 8
v_mfma_f32_16x16x32_bf16 v[148:151], a[156:159], v[104:107], v[148:151]
s_lshl_b32 s49, s52, 7
s_add_u32 s49, s49, s42
v_mfma_f32_16x16x32_bf16 v[156:159], a[156:159], v[108:111], v[156:159]
s_waitcnt vmcnt(17) lgkmcnt(0)
s_barrier
v_mfma_f32_16x16x32_bf16 v[152:155], a[152:155], v[108:111], v[152:155]
ds_read_b64_tr_b16 a[160:161], v18 offset:0
ds_read_b64_tr_b16 a[162:163], v18 offset:1024
v_mfma_f32_16x16x32_bf16 v[160:163], a[152:155], v[64:67], v[160:163]
buffer_load_dwordx4 v2, s[16:19], s49 offen offset:0 lds
ds_read_b64_tr_b16 a[164:165], v19 offset:0
v_mfma_f32_16x16x32_bf16 v[164:167], a[156:159], v[64:67], v[164:167]
ds_read_b64_tr_b16 a[166:167], v19 offset:1024
v_mfma_f32_16x16x32_bf16 v[172:175], a[156:159], v[68:71], v[172:175]
ds_read_b128 v[80:83], v12 offset:0
v_mfma_f32_16x16x32_bf16 v[168:171], a[152:155], v[68:71], v[168:171]
ds_read_b128 v[84:87], v12 offset:2048
v_mfma_f32_16x16x32_bf16 v[176:179], a[152:155], v[72:75], v[176:179]
buffer_load_dwordx4 v3, s[16:19], s49 offen offset:1024 lds
v_mfma_f32_16x16x32_bf16 v[180:183], a[156:159], v[72:75], v[180:183]
ds_read_b128 v[88:91], v12 offset:4096
v_mfma_f32_16x16x32_bf16 v[188:191], a[156:159], v[76:79], v[188:191]
ds_read_b128 v[92:95], v12 offset:6144
v_mfma_f32_16x16x32_bf16 v[184:187], a[152:155], v[76:79], v[184:187]
ds_read_b128 v[96:99], v12 offset:8192
v_mfma_f32_16x16x32_bf16 v[28:31], v[24:27], a[152:155], v[28:31]
buffer_load_dwordx4 v4, s[16:19], s49 offen offset:2048 lds
ds_read_b128 v[100:103], v12 offset:10240
v_mfma_f32_16x16x32_bf16 v[116:119], v[24:27], a[156:159], v[116:119]
ds_read_b128 v[104:107], v12 offset:12288
s_waitcnt lgkmcnt(5)
v_mfma_f32_16x16x32_bf16 v[128:131], a[160:163], v[80:83], v[128:131]
ds_read_b128 v[108:111], v12 offset:14336
v_mfma_f32_16x16x32_bf16 v[132:135], a[164:167], v[80:83], v[132:135]
ds_read_b64_tr_b16 a[168:169], v18 offset:8192
ds_read_b64_tr_b16 a[170:171], v18 offset:9216
v_mfma_f32_16x16x32_bf16 v[140:143], a[164:167], v[84:87], v[140:143]
buffer_load_dwordx4 v5, s[16:19], s49 offen offset:3072 lds
v_mfma_f32_16x16x32_bf16 v[136:139], a[160:163], v[84:87], v[136:139]
ds_read_b64_tr_b16 a[172:173], v19 offset:8192
s_waitcnt lgkmcnt(6)
v_mfma_f32_16x16x32_bf16 v[144:147], a[160:163], v[88:91], v[144:147]
ds_read_b64_tr_b16 a[174:175], v19 offset:9216
s_add_u32 m0, s47, 0xc000
v_mfma_f32_16x16x32_bf16 v[148:151], a[164:167], v[88:91], v[148:151]
ds_read_b128 v[64:67], v13 offset:0
s_mul_i32 s50, s52, 458752
v_mfma_f32_16x16x32_bf16 v[156:159], a[164:167], v[92:95], v[156:159]
ds_read_b128 v[68:71], v13 offset:2048
s_add_u32 s50, s50, s43
v_mfma_f32_16x16x32_bf16 v[152:155], a[160:163], v[92:95], v[152:155]
buffer_load_dwordx4 v6, s[20:23], s50 offen offset:0 lds
v_mfma_f32_16x16x32_bf16 v[160:163], a[160:163], v[96:99], v[160:163]
ds_read_b128 v[72:75], v13 offset:4096
v_mfma_f32_16x16x32_bf16 v[164:167], a[164:167], v[96:99], v[164:167]
ds_read_b128 v[76:79], v13 offset:6144
s_waitcnt lgkmcnt(5)
v_mfma_f32_16x16x32_bf16 v[172:175], a[164:167], v[100:103], v[172:175]
buffer_load_dwordx4 v7, s[20:23], s50 offen offset:1024 lds
v_mfma_f32_16x16x32_bf16 v[168:171], a[160:163], v[100:103], v[168:171]
ds_read_b128 v[80:83], v13 offset:8192
v_mfma_f32_16x16x32_bf16 v[176:179], a[160:163], v[104:107], v[176:179]
ds_read_b128 v[84:87], v13 offset:10240
v_mfma_f32_16x16x32_bf16 v[180:183], a[164:167], v[104:107], v[180:183]
ds_read_b128 v[88:91], v13 offset:12288
v_mfma_f32_16x16x32_bf16 v[188:191], a[164:167], v[108:111], v[188:191]
buffer_load_dwordx4 v8, s[20:23], s50 offen offset:2048 lds
ds_read_b128 v[92:95], v13 offset:14336
v_mfma_f32_16x16x32_bf16 v[184:187], a[160:163], v[108:111], v[184:187]
v_mfma_f32_16x16x32_bf16 v[28:31], v[24:27], a[160:163], v[28:31]
v_mfma_f32_16x16x32_bf16 v[116:119], v[24:27], a[164:167], v[116:119]
s_waitcnt lgkmcnt(3)
v_mfma_f32_16x16x32_bf16 v[128:131], a[168:171], v[64:67], v[128:131]
buffer_load_dwordx4 v9, s[20:23], s50 offen offset:3072 lds
v_mfma_f32_16x16x32_bf16 v[132:135], a[172:175], v[64:67], v[132:135]
s_add_u32 m0, s47, 0x10000
s_add_u32 s52, s51, 14
v_mfma_f32_16x16x32_bf16 v[140:143], a[172:175], v[68:71], v[140:143]
s_and_b32 s52, s52, 7
s_or_b32 s52, s52, 8
v_mfma_f32_16x16x32_bf16 v[136:139], a[168:171], v[68:71], v[136:139]
s_lshl_b32 s49, s52, 7
s_add_u32 s49, s49, s42
v_mfma_f32_16x16x32_bf16 v[144:147], a[168:171], v[72:75], v[144:147]
v_mfma_f32_16x16x32_bf16 v[148:151], a[172:175], v[72:75], v[148:151]
v_mfma_f32_16x16x32_bf16 v[156:159], a[172:175], v[76:79], v[156:159]
s_waitcnt vmcnt(17) lgkmcnt(0)
s_barrier
v_mfma_f32_16x16x32_bf16 v[152:155], a[168:171], v[76:79], v[152:155]
ds_read_b64_tr_b16 a[176:177], v18 offset:32768
ds_read_b64_tr_b16 a[178:179], v18 offset:33792
v_mfma_f32_16x16x32_bf16 v[160:163], a[168:171], v[80:83], v[160:163]
buffer_load_dwordx4 v2, s[16:19], s49 offen offset:0 lds
v_mfma_f32_16x16x32_bf16 v[164:167], a[172:175], v[80:83], v[164:167]
ds_read_b64_tr_b16 a[180:181], v19 offset:32768
ds_read_b64_tr_b16 a[182:183], v19 offset:33792
v_mfma_f32_16x16x32_bf16 v[172:175], a[172:175], v[84:87], v[172:175]
ds_read_b128 v[96:99], v12 offset:32768
v_mfma_f32_16x16x32_bf16 v[168:171], a[168:171], v[84:87], v[168:171]
ds_read_b128 v[100:103], v12 offset:34816
v_mfma_f32_16x16x32_bf16 v[176:179], a[168:171], v[88:91], v[176:179]
buffer_load_dwordx4 v3, s[16:19], s49 offen offset:1024 lds
ds_read_b128 v[104:107], v12 offset:36864
v_mfma_f32_16x16x32_bf16 v[180:183], a[172:175], v[88:91], v[180:183]
ds_read_b128 v[108:111], v12 offset:38912
v_mfma_f32_16x16x32_bf16 v[188:191], a[172:175], v[92:95], v[188:191]
buffer_load_dword v15, v127, s[84:87], s4 offen
v_mfma_f32_16x16x32_bf16 v[184:187], a[168:171], v[92:95], v[184:187]
ds_read_b128 v[64:67], v12 offset:40960
v_add_u32_e64 v127, 0x40000000, v127
v_mfma_f32_16x16x32_bf16 v[28:31], v[24:27], a[168:171], v[28:31]
buffer_load_dwordx4 v4, s[16:19], s49 offen offset:2048 lds
v_mfma_f32_16x16x32_bf16 v[116:119], v[24:27], a[172:175], v[116:119]
ds_read_b128 v[68:71], v12 offset:43008
s_waitcnt lgkmcnt(4)
v_mfma_f32_16x16x32_bf16 v[128:131], a[176:179], v[96:99], v[128:131]
ds_read_b128 v[72:75], v12 offset:45056
v_mfma_f32_16x16x32_bf16 v[132:135], a[180:183], v[96:99], v[132:135]
ds_read_b128 v[76:79], v12 offset:47104
v_mfma_f32_16x16x32_bf16 v[140:143], a[180:183], v[100:103], v[140:143]
buffer_load_dwordx4 v5, s[16:19], s49 offen offset:3072 lds
ds_read_b64_tr_b16 a[184:185], v18 offset:40960
v_mfma_f32_16x16x32_bf16 v[136:139], a[176:179], v[100:103], v[136:139]
ds_read_b64_tr_b16 a[186:187], v18 offset:41984
s_waitcnt lgkmcnt(5)
v_mfma_f32_16x16x32_bf16 v[144:147], a[176:179], v[104:107], v[144:147]
ds_read_b64_tr_b16 a[188:189], v19 offset:40960
ds_read_b64_tr_b16 a[190:191], v19 offset:41984
v_mfma_f32_16x16x32_bf16 v[148:151], a[180:183], v[104:107], v[148:151]
ds_read_b128 v[80:83], v13 offset:32768
s_add_u32 m0, s47, 0x14000
v_mfma_f32_16x16x32_bf16 v[156:159], a[180:183], v[108:111], v[156:159]
ds_read_b128 v[84:87], v13 offset:34816
s_mul_i32 s50, s52, 458752
v_mfma_f32_16x16x32_bf16 v[152:155], a[176:179], v[108:111], v[152:155]
ds_read_b128 v[88:91], v13 offset:36864
s_add_u32 s50, s50, s43
v_mfma_f32_16x16x32_bf16 v[160:163], a[176:179], v[64:67], v[160:163]
buffer_load_dwordx4 v6, s[20:23], s50 offen offset:0 lds
v_mfma_f32_16x16x32_bf16 v[164:167], a[180:183], v[64:67], v[164:167]
ds_read_b128 v[92:95], v13 offset:38912
s_waitcnt lgkmcnt(6)
v_mfma_f32_16x16x32_bf16 v[172:175], a[180:183], v[68:71], v[172:175]
ds_read_b128 v[96:99], v13 offset:40960
v_mfma_f32_16x16x32_bf16 v[168:171], a[176:179], v[68:71], v[168:171]
ds_read_b128 v[100:103], v13 offset:43008
v_mfma_f32_16x16x32_bf16 v[176:179], a[176:179], v[72:75], v[176:179]
buffer_load_dwordx4 v7, s[20:23], s50 offen offset:1024 lds
v_mfma_f32_16x16x32_bf16 v[180:183], a[180:183], v[72:75], v[180:183]
ds_read_b128 v[104:107], v13 offset:45056
v_mfma_f32_16x16x32_bf16 v[188:191], a[180:183], v[76:79], v[188:191]
ds_read_b128 v[108:111], v13 offset:47104
v_mfma_f32_16x16x32_bf16 v[184:187], a[176:179], v[76:79], v[184:187]
v_mfma_f32_16x16x32_bf16 v[28:31], v[24:27], a[176:179], v[28:31]
buffer_load_dwordx4 v8, s[20:23], s50 offen offset:2048 lds
v_mfma_f32_16x16x32_bf16 v[116:119], v[24:27], a[180:183], v[116:119]
s_waitcnt lgkmcnt(2)
v_mfma_f32_16x16x32_bf16 v[128:131], a[184:187], v[80:83], v[128:131]
v_mfma_f32_16x16x32_bf16 v[132:135], a[188:191], v[80:83], v[132:135]
v_mfma_f32_16x16x32_bf16 v[140:143], a[188:191], v[84:87], v[140:143]
buffer_load_dwordx4 v9, s[20:23], s50 offen offset:3072 lds
v_mfma_f32_16x16x32_bf16 v[136:139], a[184:187], v[84:87], v[136:139]
s_add_u32 m0, s47, 0x18000
s_add_u32 s52, s51, 15
v_mfma_f32_16x16x32_bf16 v[144:147], a[184:187], v[88:91], v[144:147]
s_and_b32 s52, s52, 7
s_or_b32 s52, s52, 8
v_mfma_f32_16x16x32_bf16 v[148:151], a[188:191], v[88:91], v[148:151]
s_lshl_b32 s49, s52, 7
s_add_u32 s49, s49, s42
v_mfma_f32_16x16x32_bf16 v[156:159], a[188:191], v[92:95], v[156:159]
s_waitcnt vmcnt(17) lgkmcnt(0)
s_barrier
v_mfma_f32_16x16x32_bf16 v[152:155], a[184:187], v[92:95], v[152:155]
ds_read_b64_tr_b16 a[192:193], v16 offset:0
ds_read_b64_tr_b16 a[194:195], v16 offset:1024
v_mfma_f32_16x16x32_bf16 v[160:163], a[184:187], v[96:99], v[160:163]
buffer_load_dwordx4 v2, s[16:19], s49 offen offset:0 lds
ds_read_b64_tr_b16 a[196:197], v17 offset:0
v_mfma_f32_16x16x32_bf16 v[164:167], a[188:191], v[96:99], v[164:167]
ds_read_b64_tr_b16 a[198:199], v17 offset:1024
v_mfma_f32_16x16x32_bf16 v[172:175], a[188:191], v[100:103], v[172:175]
ds_read_b128 v[64:67], v10 offset:0
v_mfma_f32_16x16x32_bf16 v[168:171], a[184:187], v[100:103], v[168:171]
ds_read_b128 v[68:71], v10 offset:2048
v_mfma_f32_16x16x32_bf16 v[176:179], a[184:187], v[104:107], v[176:179]
buffer_load_dwordx4 v3, s[16:19], s49 offen offset:1024 lds
v_mfma_f32_16x16x32_bf16 v[180:183], a[188:191], v[104:107], v[180:183]
ds_read_b128 v[72:75], v10 offset:4096
v_mfma_f32_16x16x32_bf16 v[188:191], a[188:191], v[108:111], v[188:191]
ds_read_b128 v[76:79], v10 offset:6144
v_mfma_f32_16x16x32_bf16 v[184:187], a[184:187], v[108:111], v[184:187]
ds_read_b128 v[80:83], v10 offset:8192
v_mfma_f32_16x16x32_bf16 v[28:31], v[24:27], a[184:187], v[28:31]
buffer_load_dwordx4 v4, s[16:19], s49 offen offset:2048 lds
ds_read_b128 v[84:87], v10 offset:10240
v_mfma_f32_16x16x32_bf16 v[116:119], v[24:27], a[188:191], v[116:119]
ds_read_b128 v[88:91], v10 offset:12288
s_waitcnt lgkmcnt(5)
v_mfma_f32_16x16x32_bf16 v[128:131], a[192:195], v[64:67], v[128:131]
ds_read_b128 v[92:95], v10 offset:14336
v_mfma_f32_16x16x32_bf16 v[132:135], a[196:199], v[64:67], v[132:135]
ds_read_b64_tr_b16 a[200:201], v16 offset:8192
ds_read_b64_tr_b16 a[202:203], v16 offset:9216
v_mfma_f32_16x16x32_bf16 v[140:143], a[196:199], v[68:71], v[140:143]
buffer_load_dwordx4 v5, s[16:19], s49 offen offset:3072 lds
v_mfma_f32_16x16x32_bf16 v[136:139], a[192:195], v[68:71], v[136:139]
ds_read_b64_tr_b16 a[204:205], v17 offset:8192
s_waitcnt lgkmcnt(6)
v_mfma_f32_16x16x32_bf16 v[144:147], a[192:195], v[72:75], v[144:147]
ds_read_b64_tr_b16 a[206:207], v17 offset:9216
s_add_u32 m0, s47, 0x1c000
v_mfma_f32_16x16x32_bf16 v[148:151], a[196:199], v[72:75], v[148:151]
ds_read_b128 v[96:99], v11 offset:0
s_mul_i32 s50, s52, 458752
v_mfma_f32_16x16x32_bf16 v[156:159], a[196:199], v[76:79], v[156:159]
ds_read_b128 v[100:103], v11 offset:2048
s_add_u32 s50, s50, s43
v_mfma_f32_16x16x32_bf16 v[152:155], a[192:195], v[76:79], v[152:155]
buffer_load_dwordx4 v6, s[20:23], s50 offen offset:0 lds
v_mfma_f32_16x16x32_bf16 v[160:163], a[192:195], v[80:83], v[160:163]
ds_read_b128 v[104:107], v11 offset:4096
v_mfma_f32_16x16x32_bf16 v[164:167], a[196:199], v[80:83], v[164:167]
ds_read_b128 v[108:111], v11 offset:6144
s_waitcnt lgkmcnt(5)
v_mfma_f32_16x16x32_bf16 v[172:175], a[196:199], v[84:87], v[172:175]
buffer_load_dwordx4 v7, s[20:23], s50 offen offset:1024 lds
v_mfma_f32_16x16x32_bf16 v[168:171], a[192:195], v[84:87], v[168:171]
ds_read_b128 v[64:67], v11 offset:8192
v_mfma_f32_16x16x32_bf16 v[176:179], a[192:195], v[88:91], v[176:179]
ds_read_b128 v[68:71], v11 offset:10240
v_mfma_f32_16x16x32_bf16 v[180:183], a[196:199], v[88:91], v[180:183]
ds_read_b128 v[72:75], v11 offset:12288
v_mfma_f32_16x16x32_bf16 v[188:191], a[196:199], v[92:95], v[188:191]
buffer_load_dwordx4 v8, s[20:23], s50 offen offset:2048 lds
ds_read_b128 v[76:79], v11 offset:14336
v_mfma_f32_16x16x32_bf16 v[184:187], a[192:195], v[92:95], v[184:187]
v_mfma_f32_16x16x32_bf16 v[28:31], v[24:27], a[192:195], v[28:31]
v_mfma_f32_16x16x32_bf16 v[116:119], v[24:27], a[196:199], v[116:119]
s_waitcnt lgkmcnt(3)
v_mfma_f32_16x16x32_bf16 v[128:131], a[200:203], v[96:99], v[128:131]
buffer_load_dwordx4 v9, s[20:23], s50 offen offset:3072 lds
v_mfma_f32_16x16x32_bf16 v[132:135], a[204:207], v[96:99], v[132:135]
s_lshl_b32 m0, s36, 11
s_add_u32 m0, m0, 131072
v_mfma_f32_16x16x32_bf16 v[140:143], a[204:207], v[100:103], v[140:143]
v_mfma_f32_16x16x32_bf16 v[136:139], a[200:203], v[100:103], v[136:139]
v_mfma_f32_16x16x32_bf16 v[144:147], a[200:203], v[104:107], v[144:147]
v_mfma_f32_16x16x32_bf16 v[148:151], a[204:207], v[104:107], v[148:151]
v_mfma_f32_16x16x32_bf16 v[156:159], a[204:207], v[108:111], v[156:159]
s_waitcnt vmcnt(17) lgkmcnt(0)
s_barrier
v_mfma_f32_16x16x32_bf16 v[152:155], a[200:203], v[108:111], v[152:155]
ds_read_b64_tr_b16 a[208:209], v16 offset:32768
ds_read_b64_tr_b16 a[210:211], v16 offset:33792
v_mfma_f32_16x16x32_bf16 v[160:163], a[200:203], v[64:67], v[160:163]
buffer_load_dwordx4 v20, s[24:27], s62 offen offset:0 sc1 lds
v_mfma_f32_16x16x32_bf16 v[164:167], a[204:207], v[64:67], v[164:167]
ds_read_b64_tr_b16 a[212:213], v17 offset:32768
ds_read_b64_tr_b16 a[214:215], v17 offset:33792
v_mfma_f32_16x16x32_bf16 v[172:175], a[204:207], v[68:71], v[172:175]
ds_read_b128 v[80:83], v10 offset:32768
v_mfma_f32_16x16x32_bf16 v[168:171], a[200:203], v[68:71], v[168:171]
ds_read_b128 v[84:87], v10 offset:34816
v_mfma_f32_16x16x32_bf16 v[176:179], a[200:203], v[72:75], v[176:179]
buffer_load_dwordx4 v20, s[24:27], s62 offen offset:1024 sc1 lds
ds_read_b128 v[88:91], v10 offset:36864
v_mfma_f32_16x16x32_bf16 v[180:183], a[204:207], v[72:75], v[180:183]
ds_read_b128 v[92:95], v10 offset:38912
s_xor_b32 s42, s42, 0x40000
v_mfma_f32_16x16x32_bf16 v[188:191], a[204:207], v[76:79], v[188:191]
buffer_load_dword v14, v127, s[84:87], s4 offen
v_mfma_f32_16x16x32_bf16 v[184:187], a[200:203], v[76:79], v[184:187]
ds_read_b128 v[96:99], v10 offset:40960
s_xor_b32 s51, s51, s89
v_mfma_f32_16x16x32_bf16 v[28:31], v[24:27], a[200:203], v[28:31]
ds_read_b128 v[100:103], v10 offset:43008
s_add_u32 m0, s47, 0x0
v_mfma_f32_16x16x32_bf16 v[116:119], v[24:27], a[204:207], v[116:119]
ds_read_b128 v[104:107], v10 offset:45056
s_waitcnt lgkmcnt(5)
v_mfma_f32_16x16x32_bf16 v[128:131], a[208:211], v[80:83], v[128:131]
ds_read_b128 v[108:111], v10 offset:47104
s_add_u32 s52, s51, 0
v_mfma_f32_16x16x32_bf16 v[132:135], a[212:215], v[80:83], v[132:135]
ds_read_b64_tr_b16 a[216:217], v16 offset:40960
ds_read_b64_tr_b16 a[218:219], v16 offset:41984
v_mfma_f32_16x16x32_bf16 v[140:143], a[212:215], v[84:87], v[140:143]
ds_read_b64_tr_b16 a[220:221], v17 offset:40960
ds_read_b64_tr_b16 a[222:223], v17 offset:41984
s_and_b32 s52, s52, 7
v_mfma_f32_16x16x32_bf16 v[136:139], a[208:211], v[84:87], v[136:139]
ds_read_b128 v[64:67], v11 offset:32768
s_waitcnt lgkmcnt(8)
v_mfma_f32_16x16x32_bf16 v[144:147], a[208:211], v[88:91], v[144:147]
ds_read_b128 v[68:71], v11 offset:34816
s_lshl_b32 s49, s52, 7
v_mfma_f32_16x16x32_bf16 v[148:151], a[212:215], v[88:91], v[148:151]
ds_read_b128 v[72:75], v11 offset:36864
s_add_u32 s49, s49, s42
v_mfma_f32_16x16x32_bf16 v[156:159], a[212:215], v[92:95], v[156:159]
buffer_load_dwordx4 v2, s[16:19], s49 offen offset:0 lds
v_mfma_f32_16x16x32_bf16 v[152:155], a[208:211], v[92:95], v[152:155]
ds_read_b128 v[76:79], v11 offset:38912
v_add_u32_e64 v127, 0x40000000, v127
v_mfma_f32_16x16x32_bf16 v[160:163], a[208:211], v[96:99], v[160:163]
ds_read_b128 v[80:83], v11 offset:40960
v_mfma_f32_16x16x32_bf16 v[164:167], a[212:215], v[96:99], v[164:167]
s_waitcnt lgkmcnt(4)
v_mfma_f32_16x16x32_bf16 v[172:175], a[212:215], v[100:103], v[172:175]
buffer_load_dwordx4 v3, s[16:19], s49 offen offset:1024 lds
ds_read_b128 v[84:87], v11 offset:43008
v_mfma_f32_16x16x32_bf16 v[168:171], a[208:211], v[100:103], v[168:171]
v_mfma_f32_16x16x32_bf16 v[176:179], a[208:211], v[104:107], v[176:179]
ds_read_b128 v[88:91], v11 offset:45056
v_mfma_f32_16x16x32_bf16 v[180:183], a[212:215], v[104:107], v[180:183]
v_mfma_f32_16x16x32_bf16 v[188:191], a[212:215], v[108:111], v[188:191]
buffer_load_dwordx4 v4, s[16:19], s49 offen offset:2048 lds
v_mfma_f32_16x16x32_bf16 v[184:187], a[208:211], v[108:111], v[184:187]
ds_read_b128 v[92:95], v11 offset:47104
v_mfma_f32_16x16x32_bf16 v[28:31], v[24:27], a[208:211], v[28:31]
v_mfma_f32_16x16x32_bf16 v[116:119], v[24:27], a[212:215], v[116:119]
v_mfma_f32_16x16x32_bf16 v[128:131], a[216:219], v[64:67], v[128:131]
buffer_load_dwordx4 v5, s[16:19], s49 offen offset:3072 lds
s_add_u32 m0, s47, 0x8000
v_mfma_f32_16x16x32_bf16 v[132:135], a[220:223], v[64:67], v[132:135]
s_add_u32 s52, s51, 1
s_waitcnt lgkmcnt(1)
v_mfma_f32_16x16x32_bf16 v[140:143], a[220:223], v[68:71], v[140:143]
s_and_b32 s52, s52, 7
s_lshl_b32 s49, s52, 7
v_mfma_f32_16x16x32_bf16 v[136:139], a[216:219], v[68:71], v[136:139]
s_add_u32 s49, s49, s42
v_mfma_f32_16x16x32_bf16 v[144:147], a[216:219], v[72:75], v[144:147]
v_mfma_f32_16x16x32_bf16 v[148:151], a[220:223], v[72:75], v[148:151]
v_mfma_f32_16x16x32_bf16 v[156:159], a[220:223], v[76:79], v[156:159]
s_waitcnt vmcnt(15) lgkmcnt(0)
s_barrier
v_mfma_f32_16x16x32_bf16 v[152:155], a[216:219], v[76:79], v[152:155]
ds_read_b64_tr_b16 a[224:225], v18 offset:0
ds_read_b64_tr_b16 a[226:227], v18 offset:1024
v_mfma_f32_16x16x32_bf16 v[160:163], a[216:219], v[80:83], v[160:163]
buffer_load_dwordx4 v2, s[16:19], s49 offen offset:0 lds
ds_read_b64_tr_b16 a[228:229], v19 offset:0
v_mfma_f32_16x16x32_bf16 v[164:167], a[220:223], v[80:83], v[164:167]
ds_read_b64_tr_b16 a[230:231], v19 offset:1024
v_mfma_f32_16x16x32_bf16 v[172:175], a[220:223], v[84:87], v[172:175]
ds_read_b128 v[96:99], v12 offset:0
v_mfma_f32_16x16x32_bf16 v[168:171], a[216:219], v[84:87], v[168:171]
ds_read_b128 v[100:103], v12 offset:2048
v_mfma_f32_16x16x32_bf16 v[176:179], a[216:219], v[88:91], v[176:179]
buffer_load_dwordx4 v3, s[16:19], s49 offen offset:1024 lds
v_mfma_f32_16x16x32_bf16 v[180:183], a[220:223], v[88:91], v[180:183]
ds_read_b128 v[104:107], v12 offset:4096
v_mfma_f32_16x16x32_bf16 v[188:191], a[220:223], v[92:95], v[188:191]
ds_read_b128 v[108:111], v12 offset:6144
v_mfma_f32_16x16x32_bf16 v[184:187], a[216:219], v[92:95], v[184:187]
ds_read_b128 v[64:67], v12 offset:8192
v_mfma_f32_16x16x32_bf16 v[28:31], v[24:27], a[216:219], v[28:31]
buffer_load_dwordx4 v4, s[16:19], s49 offen offset:2048 lds
ds_read_b128 v[68:71], v12 offset:10240
v_mfma_f32_16x16x32_bf16 v[116:119], v[24:27], a[220:223], v[116:119]
ds_read_b128 v[72:75], v12 offset:12288
s_waitcnt lgkmcnt(5)
v_mfma_f32_16x16x32_bf16 v[128:131], a[224:227], v[96:99], v[128:131]
ds_read_b128 v[76:79], v12 offset:14336
v_mfma_f32_16x16x32_bf16 v[132:135], a[228:231], v[96:99], v[132:135]
ds_read_b64_tr_b16 a[232:233], v18 offset:8192
ds_read_b64_tr_b16 a[234:235], v18 offset:9216
v_mfma_f32_16x16x32_bf16 v[140:143], a[228:231], v[100:103], v[140:143]
buffer_load_dwordx4 v5, s[16:19], s49 offen offset:3072 lds
v_mfma_f32_16x16x32_bf16 v[136:139], a[224:227], v[100:103], v[136:139]
ds_read_b64_tr_b16 a[236:237], v19 offset:8192
s_waitcnt lgkmcnt(6)
v_mfma_f32_16x16x32_bf16 v[144:147], a[224:227], v[104:107], v[144:147]
ds_read_b64_tr_b16 a[238:239], v19 offset:9216
v_mfma_f32_16x16x32_bf16 v[148:151], a[228:231], v[104:107], v[148:151]
ds_read_b128 v[80:83], v13 offset:0
v_mfma_f32_16x16x32_bf16 v[156:159], a[228:231], v[108:111], v[156:159]
ds_read_b128 v[84:87], v13 offset:2048
v_mfma_f32_16x16x32_bf16 v[152:155], a[224:227], v[108:111], v[152:155]
ds_read_b128 v[88:91], v13 offset:4096
v_mfma_f32_16x16x32_bf16 v[160:163], a[224:227], v[64:67], v[160:163]
ds_read_b128 v[92:95], v13 offset:6144
v_mfma_f32_16x16x32_bf16 v[164:167], a[228:231], v[64:67], v[164:167]
ds_read_b128 v[96:99], v13 offset:8192
s_waitcnt lgkmcnt(6)
v_mfma_f32_16x16x32_bf16 v[172:175], a[228:231], v[68:71], v[172:175]
ds_read_b128 v[100:103], v13 offset:10240
v_mfma_f32_16x16x32_bf16 v[168:171], a[224:227], v[68:71], v[168:171]
v_mfma_f32_16x16x32_bf16 v[176:179], a[224:227], v[72:75], v[176:179]
ds_read_b128 v[104:107], v13 offset:12288
v_mfma_f32_16x16x32_bf16 v[180:183], a[228:231], v[72:75], v[180:183]
v_mfma_f32_16x16x32_bf16 v[188:191], a[228:231], v[76:79], v[188:191]
ds_read_b128 v[108:111], v13 offset:14336
s_add_u32 m0, s47, 0x10000
s_add_u32 s52, s51, 2
v_mfma_f32_16x16x32_bf16 v[184:187], a[224:227], v[76:79], v[184:187]
s_and_b32 s52, s52, 7
s_lshl_b32 s49, s52, 7
v_mfma_f32_16x16x32_bf16 v[28:31], v[24:27], a[224:227], v[28:31]
s_add_u32 s49, s49, s42
v_mfma_f32_16x16x32_bf16 v[116:119], v[24:27], a[228:231], v[116:119]
s_waitcnt lgkmcnt(2)
v_mfma_f32_16x16x32_bf16 v[128:131], a[232:235], v[80:83], v[128:131]
v_mfma_f32_16x16x32_bf16 v[132:135], a[236:239], v[80:83], v[132:135]
v_mfma_f32_16x16x32_bf16 v[140:143], a[236:239], v[84:87], v[140:143]
v_mfma_f32_16x16x32_bf16 v[136:139], a[232:235], v[84:87], v[136:139]
v_mfma_f32_16x16x32_bf16 v[144:147], a[232:235], v[88:91], v[144:147]
v_mfma_f32_16x16x32_bf16 v[148:151], a[236:239], v[88:91], v[148:151]
v_mfma_f32_16x16x32_bf16 v[156:159], a[236:239], v[92:95], v[156:159]
s_waitcnt vmcnt(9) lgkmcnt(0)
s_barrier
v_mfma_f32_16x16x32_bf16 v[152:155], a[232:235], v[92:95], v[152:155]
ds_read_b64_tr_b16 a[240:241], v18 offset:32768
ds_read_b64_tr_b16 a[242:243], v18 offset:33792
v_mfma_f32_16x16x32_bf16 v[160:163], a[232:235], v[96:99], v[160:163]
buffer_load_dwordx4 v2, s[16:19], s49 offen offset:0 lds
v_mfma_f32_16x16x32_bf16 v[164:167], a[236:239], v[96:99], v[164:167]
ds_read_b64_tr_b16 a[244:245], v19 offset:32768
ds_read_b64_tr_b16 a[246:247], v19 offset:33792
v_mfma_f32_16x16x32_bf16 v[172:175], a[236:239], v[100:103], v[172:175]
ds_read_b128 v[64:67], v12 offset:32768
ds_read2st64_b32 v[240:241], v242 offset0:0 offset1:4
v_mfma_f32_16x16x32_bf16 v[168:171], a[232:235], v[100:103], v[168:171]
ds_read_b128 v[68:71], v12 offset:34816
v_mfma_f32_16x16x32_bf16 v[176:179], a[232:235], v[104:107], v[176:179]
buffer_load_dwordx4 v3, s[16:19], s49 offen offset:1024 lds
ds_read_b128 v[72:75], v12 offset:36864
v_mfma_f32_16x16x32_bf16 v[180:183], a[236:239], v[104:107], v[180:183]
ds_read_b128 v[76:79], v12 offset:38912
v_mfma_f32_16x16x32_bf16 v[188:191], a[236:239], v[108:111], v[188:191]
buffer_load_dword v15, v127, s[84:87], s4 offen
v_mfma_f32_16x16x32_bf16 v[184:187], a[232:235], v[108:111], v[184:187]
ds_read_b128 v[80:83], v12 offset:40960
v_mfma_f32_16x16x32_bf16 v[28:31], v[24:27], a[232:235], v[28:31]
buffer_load_dwordx4 v4, s[16:19], s49 offen offset:2048 lds
v_mfma_f32_16x16x32_bf16 v[116:119], v[24:27], a[236:239], v[116:119]
ds_read_b128 v[84:87], v12 offset:43008
s_waitcnt lgkmcnt(4)
v_mfma_f32_16x16x32_bf16 v[128:131], a[240:243], v[64:67], v[128:131]
ds_read_b128 v[88:91], v12 offset:45056
v_xor_b32 v241, s61, v241
v_xor_b32_e64 v240, s61, v240
v_or_b32 v241, v241, v240
v_cmp_ne_u32 vcc, 0, v241
s_cbranch_vccnz L_spin0
L_back0:
v_mfma_f32_16x16x32_bf16 v[132:135], a[244:247], v[64:67], v[132:135]
ds_read_b128 v[92:95], v12 offset:47104
v_mfma_f32_16x16x32_bf16 v[140:143], a[244:247], v[68:71], v[140:143]
buffer_load_dwordx4 v5, s[16:19], s49 offen offset:3072 lds
v_mfma_f32_16x16x32_bf16 v[136:139], a[240:243], v[68:71], v[136:139]
ds_read_b64_tr_b16 a[248:249], v18 offset:40960
s_waitcnt lgkmcnt(4)
v_mfma_f32_16x16x32_bf16 v[144:147], a[240:243], v[72:75], v[144:147]
ds_read_b64_tr_b16 a[250:251], v18 offset:41984
ds_read_b64_tr_b16 a[252:253], v19 offset:40960
v_mfma_f32_16x16x32_bf16 v[148:151], a[244:247], v[72:75], v[148:151]
ds_read_b64_tr_b16 a[254:255], v19 offset:41984
s_add_u32 m0, s47, 0x14000
v_mfma_f32_16x16x32_bf16 v[156:159], a[244:247], v[76:79], v[156:159]
buffer_load_dwordx4 v122, s[84:87], s4 offen offset:0 lds
v_mfma_f32_16x16x32_bf16 v[152:155], a[240:243], v[76:79], v[152:155]
ds_read_b128 v[96:99], v13 offset:32768
v_mfma_f32_16x16x32_bf16 v[160:163], a[240:243], v[80:83], v[160:163]
ds_read_b128 v[100:103], v13 offset:34816
v_mfma_f32_16x16x32_bf16 v[164:167], a[244:247], v[80:83], v[164:167]
ds_read_b128 v[104:107], v13 offset:36864
s_waitcnt lgkmcnt(6)
v_mfma_f32_16x16x32_bf16 v[172:175], a[244:247], v[84:87], v[172:175]
buffer_load_dwordx4 v123, s[84:87], s4 offen offset:1024 lds
v_mfma_f32_16x16x32_bf16 v[168:171], a[240:243], v[84:87], v[168:171]
ds_read_b128 v[108:111], v13 offset:38912
v_mfma_f32_16x16x32_bf16 v[176:179], a[240:243], v[88:91], v[176:179]
ds_read_b128 v[64:67], v13 offset:40960
v_mfma_f32_16x16x32_bf16 v[180:183], a[244:247], v[88:91], v[180:183]
ds_read_b128 v[68:71], v13 offset:43008
v_mfma_f32_16x16x32_bf16 v[188:191], a[244:247], v[92:95], v[188:191]
buffer_load_dwordx4 v124, s[84:87], s4 offen offset:2048 lds
v_mfma_f32_16x16x32_bf16 v[184:187], a[240:243], v[92:95], v[184:187]
ds_read_b128 v[72:75], v13 offset:45056
v_mfma_f32_16x16x32_bf16 v[28:31], v[24:27], a[240:243], v[28:31]
ds_read_b128 v[76:79], v13 offset:47104
v_mfma_f32_16x16x32_bf16 v[116:119], v[24:27], a[244:247], v[116:119]
s_waitcnt lgkmcnt(4)
v_mfma_f32_16x16x32_bf16 v[128:131], a[248:251], v[96:99], v[128:131]
buffer_load_dwordx4 v125, s[84:87], s4 offen offset:3072 lds
v_mfma_f32_16x16x32_bf16 v[132:135], a[252:255], v[96:99], v[132:135]
s_add_u32 m0, s47, 0x18000
s_add_u32 s52, s51, 3
v_mfma_f32_16x16x32_bf16 v[140:143], a[252:255], v[100:103], v[140:143]
s_and_b32 s52, s52, 7
s_lshl_b32 s49, s52, 7
v_mfma_f32_16x16x32_bf16 v[136:139], a[248:251], v[100:103], v[136:139]
s_add_u32 s49, s49, s42
v_mfma_f32_16x16x32_bf16 v[144:147], a[248:251], v[104:107], v[144:147]
v_mfma_f32_16x16x32_bf16 v[148:151], a[252:255], v[104:107], v[148:151]
v_mfma_f32_16x16x32_bf16 v[156:159], a[252:255], v[108:111], v[156:159]
s_waitcnt vmcnt(13) lgkmcnt(0)
s_barrier
v_mfma_f32_16x16x32_bf16 v[152:155], a[248:251], v[108:111], v[152:155]
ds_read_b128 v[80:83], v10 offset:0
v_mfma_f32_16x16x32_bf16 v[160:163], a[248:251], v[64:67], v[160:163]
buffer_load_dwordx4 v2, s[16:19], s49 offen offset:0 lds
v_mfma_f32_16x16x32_bf16 v[164:167], a[252:255], v[64:67], v[164:167]
ds_read_b128 v[84:87], v10 offset:2048
v_mfma_f32_16x16x32_bf16 v[172:175], a[252:255], v[68:71], v[172:175]
ds_read_b128 v[88:91], v10 offset:4096
v_mfma_f32_16x16x32_bf16 v[168:171], a[248:251], v[68:71], v[168:171]
ds_read_b128 v[92:95], v10 offset:6144
v_mfma_f32_16x16x32_bf16 v[176:179], a[248:251], v[72:75], v[176:179]
buffer_load_dwordx4 v3, s[16:19], s49 offen offset:1024 lds
v_mfma_f32_16x16x32_bf16 v[180:183], a[252:255], v[72:75], v[180:183]
ds_read_b128 v[96:99], v10 offset:8192
v_mfma_f32_16x16x32_bf16 v[188:191], a[252:255], v[76:79], v[188:191]
ds_read_b128 v[100:103], v10 offset:10240
v_mfma_f32_16x16x32_bf16 v[184:187], a[248:251], v[76:79], v[184:187]
ds_read_b128 v[104:107], v10 offset:12288
v_mfma_f32_16x16x32_bf16 v[28:31], v[24:27], a[248:251], v[28:31]
buffer_load_dwordx4 v4, s[16:19], s49 offen offset:2048 lds
v_mfma_f32_16x16x32_bf16 v[116:119], v[24:27], a[252:255], v[116:119]
ds_read_b128 v[108:111], v10 offset:14336
s_waitcnt lgkmcnt(4)
v_mfma_f32_16x16x32_bf16 v[192:195], a[0:3], v[80:83], 0
ds_read_b128 v[64:67], v22 offset:0
v_mfma_f32_16x16x32_bf16 v[196:199], a[4:7], v[80:83], 0
ds_read_b128 v[68:71], v22 offset:512
v_mfma_f32_16x16x32_bf16 v[204:207], a[4:7], v[84:87], 0
buffer_load_dwordx4 v5, s[16:19], s49 offen offset:3072 lds
ds_read_b128 v[72:75], v22 offset:1024
v_cmp_gt_u32 s[66:67], 16, v0
v_mfma_f32_16x16x32_bf16 v[200:203], a[0:3], v[84:87], 0
v_cvt_pk_bf16_f32 v44, v116, v116
v_lshl_or_b32 v46, v33, 16, v33
s_add_u32 m0, s47, 0x1c000
s_add_u32 s4, s4, 0x20000
v_mfma_f32_16x16x32_bf16 v[208:211], a[0:3], v[88:91], 0
ds_read_b128 v[76:79], v22 offset:1536
v_and_b32 v44, 0xffff0000, v44
v_sub_f32 v45, v116, v44
v_cndmask_b32 v24, 0, v46, s[66:67]
v_mfma_f32_16x16x32_bf16 v[212:215], a[4:7], v[88:91], 0
ds_read_b128 v[112:115], v22 offset:16
v_mfma_f32_16x16x32_bf16 v[220:223], a[4:7], v[92:95], 0
buffer_load_dwordx4 v122, s[84:87], s4 offen offset:0 lds
ds_read_b128 v[80:83], v22 offset:2048
v_cvt_pk_bf16_f32 v25, v44, v45
v_mfma_f32_16x16x32_bf16 v[216:219], a[0:3], v[92:95], 0
v_cvt_pk_bf16_f32 v26, v44, v45
v_mov_b32 v27, 0
s_waitcnt lgkmcnt(4)
v_mfma_f32_16x16x32_bf16 v[224:227], a[0:3], v[96:99], 0
ds_read_b128 v[84:87], v22 offset:2560
v_cvt_pk_bf16_f32 v44, v28, v28
v_lshl_or_b32 v46, v32, 16, v32
v_and_b32 v44, 0xffff0000, v44
v_mfma_f32_16x16x32_bf16 v[228:231], a[4:7], v[96:99], 0
v_add_u32 v16, 0x4000, v120
v_add_u32 v18, 0x14000, v120
v_xor_b32 v17, 32, v16
v_xor_b32 v19, 32, v18
v_mfma_f32_16x16x32_bf16 v[236:239], a[4:7], v[100:103], 0
buffer_load_dwordx4 v123, s[84:87], s4 offen offset:1024 lds
ds_read_b128 v[88:91], v22 offset:3072
v_sub_f32_e64 v45, v28, v44
v_mfma_f32_16x16x32_bf16 v[232:235], a[0:3], v[100:103], 0
v_cndmask_b32 v32, 0, v46, s[66:67]
v_cvt_pk_bf16_f32 v33, v44, v45
v_mfma_f32_16x16x32_bf16 v[240:243], a[0:3], v[104:107], 0
ds_read_b128 v[92:95], v22 offset:3584
v_cvt_pk_bf16_f32 v34, v44, v45
v_mov_b32_e64 v35, 0
v_mfma_f32_16x16x32_bf16 v[244:247], a[4:7], v[104:107], 0
v_mfma_f32_16x16x32_bf16 v[252:255], a[4:7], v[108:111], 0
buffer_load_dwordx4 v124, s[84:87], s4 offen offset:2048 lds
ds_read_b128 v[96:99], v11 offset:0
v_mfma_f32_16x16x32_bf16 v[248:251], a[0:3], v[108:111], 0
v_mfma_f32_16x16x32_bf16 v[128:131], v[32:35], v[64:67], v[128:131]
ds_read_b128 v[100:103], v11 offset:2048
v_mfma_f32_16x16x32_bf16 v[132:135], v[24:27], v[64:67], v[132:135]
v_mfma_f32_16x16x32_bf16 v[140:143], v[24:27], v[68:71], v[140:143]
buffer_load_dwordx4 v125, s[84:87], s4 offen offset:3072 lds
ds_read_b128 v[104:107], v11 offset:4096
v_mfma_f32_16x16x32_bf16 v[136:139], v[32:35], v[68:71], v[136:139]
s_waitcnt lgkmcnt(3)
v_mfma_f32_16x16x32_bf16 v[144:147], v[32:35], v[72:75], v[144:147]
ds_read_b128 v[108:111], v11 offset:6144
v_mfma_f32_16x16x32_bf16 v[148:151], v[24:27], v[72:75], v[148:151]
v_mfma_f32_16x16x32_bf16 v[156:159], v[24:27], v[76:79], v[156:159]
ds_read_b128 v[64:67], v11 offset:8192
v_mfma_f32_16x16x32_bf16 v[152:155], v[32:35], v[76:79], v[152:155]
v_mfma_f32_16x16x32_bf16 v[160:163], v[32:35], v[80:83], v[160:163]
ds_read_b128 v[68:71], v11 offset:10240
ds_read_b128 v[116:119], v22 offset:528
v_mul_f32 v36, v128, v128
v_mul_f32_e64 v37, v129, v129
v_mfma_f32_16x16x32_bf16 v[164:167], v[24:27], v[80:83], v[164:167]
v_mul_f32 v38, v130, v130
v_mul_f32 v39, v131, v131
v_fma_f32 v36, v36, v112, v113
v_fma_f32 v37, v37, v112, v113
v_mfma_f32_16x16x32_bf16 v[172:175], v[24:27], v[84:87], v[172:175]
ds_read_b128 v[72:75], v11 offset:12288
v_fma_f32 v38, v38, v112, v113
v_fma_f32 v39, v39, v112, v113
v_mul_f32_e64 v36, v128, v36
v_mfma_f32_16x16x32_bf16 v[168:171], v[32:35], v[84:87], v[168:171]
v_mul_f32 v37, v129, v37
v_mul_f32 v38, v130, v38
v_mul_f32_e64 v39, v131, v39
v_mfma_f32_16x16x32_bf16 v[176:179], v[32:35], v[88:91], v[176:179]
ds_read_b128 v[76:79], v11 offset:14336
v_exp_f32_e64 v36, v36
v_mfma_f32_16x16x32_bf16 v[180:183], v[24:27], v[88:91], v[180:183]
v_exp_f32 v37, v37
v_exp_f32 v38, v38
v_mfma_f32_16x16x32_bf16 v[188:191], v[24:27], v[92:95], v[188:191]
ds_read_b128 v[80:83], v22 offset:4096
v_exp_f32_e64 v39, v39
v_fma_f32 v36, v36, v114, v114
v_mfma_f32_16x16x32_bf16 v[184:187], v[32:35], v[92:95], v[184:187]
v_fma_f32 v37, v37, v114, v114
v_fma_f32 v38, v38, v114, v114
v_fma_f32 v39, v39, v114, v114
s_waitcnt lgkmcnt(4)
v_mfma_f32_16x16x32_bf16 v[192:195], a[8:11], v[96:99], v[192:195]
ds_read_b128 v[84:87], v22 offset:4608
v_rcp_f32 v36, v36
v_mfma_f32_16x16x32_bf16 v[196:199], a[12:15], v[96:99], v[196:199]
v_rcp_f32 v37, v37
v_rcp_f32 v38, v38
v_mfma_f32_16x16x32_bf16 v[204:207], a[12:15], v[100:103], v[204:207]
ds_read_b128 v[88:91], v22 offset:5120
v_rcp_f32 v39, v39
v_mul_f32 v36, v128, v36
v_mfma_f32_16x16x32_bf16 v[200:203], a[8:11], v[100:103], v[200:203]
v_mul_f32 v37, v129, v37
v_mul_f32 v38, v130, v38
v_mul_f32_e64 v39, v131, v39
v_cvt_pk_bf16_f32 v48, v36, v37
v_mfma_f32_16x16x32_bf16 v[208:211], a[8:11], v[104:107], v[208:211]
ds_read_b128 v[92:95], v22 offset:5632
v_cvt_pk_bf16_f32 v49, v38, v39
v_mul_f32 v40, v132, v132
v_mul_f32 v41, v133, v133
v_mfma_f32_16x16x32_bf16 v[212:215], a[12:15], v[104:107], v[212:215]
v_mul_f32 v42, v134, v134
v_mul_f32 v43, v135, v135
v_fma_f32 v40, v40, v112, v113
v_fma_f32 v41, v41, v112, v113
v_mfma_f32_16x16x32_bf16 v[220:223], a[12:15], v[108:111], v[220:223]
ds_read_b128 v[96:99], v22 offset:6144
v_fma_f32 v42, v42, v112, v113
v_fma_f32 v43, v43, v112, v113
v_mul_f32_e64 v40, v132, v40
v_mfma_f32_16x16x32_bf16 v[216:219], a[8:11], v[108:111], v[216:219]
v_mul_f32 v41, v133, v41
v_mul_f32 v42, v134, v42
v_mul_f32_e64 v43, v135, v43
v_mfma_f32_16x16x32_bf16 v[224:227], a[8:11], v[64:67], v[224:227]
ds_read_b128 v[100:103], v22 offset:6656
v_exp_f32_e64 v40, v40
v_mfma_f32_16x16x32_bf16 v[228:231], a[12:15], v[64:67], v[228:231]
v_exp_f32 v41, v41
v_exp_f32 v42, v42
v_mfma_f32_16x16x32_bf16 v[236:239], a[12:15], v[68:71], v[236:239]
ds_read_b128 v[104:107], v22 offset:7168
s_add_u32 m0, s47, 0x0
s_add_u32 s52, s51, 4
s_and_b32 s52, s52, 7
v_mfma_f32_16x16x32_bf16 v[232:235], a[8:11], v[68:71], v[232:235]
s_lshl_b32 s49, s52, 7
s_add_u32 s49, s49, s42
s_waitcnt lgkmcnt(3)
v_mfma_f32_16x16x32_bf16 v[240:243], a[8:11], v[72:75], v[240:243]
ds_read_b128 v[108:111], v22 offset:7680
v_exp_f32_e64 v43, v43
v_fma_f32 v40, v40, v114, v114
v_mfma_f32_16x16x32_bf16 v[244:247], a[12:15], v[72:75], v[244:247]
v_fma_f32 v41, v41, v114, v114
v_fma_f32 v42, v42, v114, v114
v_fma_f32 v43, v43, v114, v114
v_mfma_f32_16x16x32_bf16 v[252:255], a[12:15], v[76:79], v[252:255]
v_rcp_f32 v40, v40
v_rcp_f32 v41, v41
v_mfma_f32_16x16x32_bf16 v[248:251], a[8:11], v[76:79], v[248:251]
v_rcp_f32 v42, v42
v_rcp_f32 v43, v43
v_mfma_f32_16x16x32_bf16 v[192:195], v[32:35], v[80:83], v[192:195]
v_mul_f32 v40, v132, v40
v_mul_f32 v41, v133, v41
v_mul_f32 v42, v134, v42
v_mul_f32 v43, v135, v43
v_mfma_f32_16x16x32_bf16 v[196:199], v[24:27], v[80:83], v[196:199]
v_cvt_pk_bf16_f32 v50, v40, v41
v_cvt_pk_bf16_f32 v51, v42, v43
ds_read_b128 v[112:115], v22 offset:1040
v_mul_f32_e64 v36, v136, v136
v_mfma_f32_16x16x32_bf16 v[204:207], v[24:27], v[84:87], v[204:207]
buffer_store_dwordx4 v[48:51], v20, s[24:27], s44 offen offset:0 sc1
v_mul_f32 v37, v137, v137
v_mul_f32 v38, v138, v138
v_mul_f32_e64 v39, v139, v139
v_mfma_f32_16x16x32_bf16 v[200:203], v[32:35], v[84:87], v[200:203]
v_fma_f32 v36, v36, v116, v117
v_fma_f32 v37, v37, v116, v117
v_fma_f32 v38, v38, v116, v117
v_fma_f32 v39, v39, v116, v117
v_mfma_f32_16x16x32_bf16 v[208:211], v[32:35], v[88:91], v[208:211]
s_waitcnt vmcnt(18) lgkmcnt(0)
s_barrier
v_mfma_f32_16x16x32_bf16 v[212:215], v[24:27], v[88:91], v[212:215]
ds_read_b128 v[64:67], v10 offset:32768
v_mul_f32 v36, v136, v36
v_mul_f32 v37, v137, v37
v_mul_f32_e64 v38, v138, v38
v_mfma_f32_16x16x32_bf16 v[220:223], v[24:27], v[92:95], v[220:223]
buffer_load_dwordx4 v2, s[16:19], s49 offen offset:0 lds
ds_read_b128 v[68:71], v10 offset:34816
v_mul_f32_e64 v39, v139, v39
v_mfma_f32_16x16x32_bf16 v[216:219], v[32:35], v[92:95], v[216:219]
ds_read_b128 v[72:75], v10 offset:36864
v_exp_f32_e64 v36, v36
v_mfma_f32_16x16x32_bf16 v[224:227], v[32:35], v[96:99], v[224:227]
ds_read_b128 v[76:79], v10 offset:38912
v_exp_f32_e64 v37, v37
v_mfma_f32_16x16x32_bf16 v[228:231], v[24:27], v[96:99], v[228:231]
ds_read_b128 v[80:83], v10 offset:40960
v_exp_f32_e64 v38, v38
v_mfma_f32_16x16x32_bf16 v[236:239], v[24:27], v[100:103], v[236:239]
buffer_load_dwordx4 v3, s[16:19], s49 offen offset:1024 lds
ds_read_b128 v[84:87], v10 offset:43008
v_mfma_f32_16x16x32_bf16 v[232:235], v[32:35], v[100:103], v[232:235]
ds_read_b128 v[88:91], v10 offset:45056
v_exp_f32_e64 v39, v39
v_fma_f32 v36, v36, v118, v118
v_mfma_f32_16x16x32_bf16 v[240:243], v[32:35], v[104:107], v[240:243]
ds_read_b128 v[92:95], v10 offset:47104
v_fma_f32 v37, v37, v118, v118
v_fma_f32 v38, v38, v118, v118
v_fma_f32 v39, v39, v118, v118
v_mfma_f32_16x16x32_bf16 v[244:247], v[24:27], v[104:107], v[244:247]
v_rcp_f32 v36, v36
v_rcp_f32 v37, v37
v_mfma_f32_16x16x32_bf16 v[252:255], v[24:27], v[108:111], v[252:255]
buffer_load_dwordx4 v4, s[16:19], s49 offen offset:2048 lds
ds_read_b128 v[96:99], v11 offset:32768
v_mfma_f32_16x16x32_bf16 v[248:251], v[32:35], v[108:111], v[248:251]
v_rcp_f32 v38, v38
s_waitcnt lgkmcnt(4)
v_mfma_f32_16x16x32_bf16 v[192:195], a[16:19], v[64:67], v[192:195]
ds_read_b128 v[100:103], v11 offset:34816
v_rcp_f32 v39, v39
v_mul_f32 v36, v136, v36
v_mfma_f32_16x16x32_bf16 v[196:199], a[20:23], v[64:67], v[196:199]
v_mul_f32 v37, v137, v37
v_mul_f32 v38, v138, v38
v_mul_f32_e64 v39, v139, v39
v_cvt_pk_bf16_f32 v52, v36, v37
v_mfma_f32_16x16x32_bf16 v[204:207], a[20:23], v[68:71], v[204:207]
buffer_load_dwordx4 v5, s[16:19], s49 offen offset:3072 lds
ds_read_b128 v[104:107], v11 offset:36864
s_add_u32 m0, s47, 0x4000
v_mfma_f32_16x16x32_bf16 v[200:203], a[16:19], v[68:71], v[200:203]
s_add_u32 s4, s4, 0x20000
s_sub_u32 s50, s4, 1835008
s_min_u32 s4, s4, s50
v_cvt_pk_bf16_f32 v53, v38, v39
v_mfma_f32_16x16x32_bf16 v[208:211], a[16:19], v[72:75], v[208:211]
ds_read_b128 v[108:111], v11 offset:38912
v_mul_f32 v40, v140, v140
v_mul_f32 v41, v141, v141
v_mul_f32 v42, v142, v142
v_mfma_f32_16x16x32_bf16 v[212:215], a[20:23], v[72:75], v[212:215]
v_mul_f32_e64 v43, v143, v143
v_fma_f32 v40, v40, v116, v117
v_fma_f32 v41, v41, v116, v117
v_fma_f32 v42, v42, v116, v117
v_mfma_f32_16x16x32_bf16 v[220:223], a[20:23], v[76:79], v[220:223]
buffer_load_dwordx4 v122, s[84:87], s4 offen offset:0 lds
ds_read_b128 v[64:67], v11 offset:40960
v_fma_f32 v43, v43, v116, v117
v_mfma_f32_16x16x32_bf16 v[216:219], a[16:19], v[76:79], v[216:219]
v_mul_f32 v40, v140, v40
v_mul_f32 v41, v141, v41
v_mul_f32 v42, v142, v42
v_mul_f32 v43, v143, v43
v_mfma_f32_16x16x32_bf16 v[224:227], a[16:19], v[80:83], v[224:227]
ds_read_b128 v[68:71], v11 offset:43008
v_exp_f32_e64 v40, v40
v_mfma_f32_16x16x32_bf16 v[228:231], a[20:23], v[80:83], v[228:231]
v_exp_f32 v41, v41
s_waitcnt lgkmcnt(3)
v_mfma_f32_16x16x32_bf16 v[236:239], a[20:23], v[84:87], v[236:239]
buffer_load_dwordx4 v123, s[84:87], s4 offen offset:1024 lds
ds_read_b128 v[72:75], v11 offset:45056
v_mfma_f32_16x16x32_bf16 v[232:235], a[16:19], v[84:87], v[232:235]
v_exp_f32 v42, v42
v_exp_f32 v43, v43
v_mfma_f32_16x16x32_bf16 v[240:243], a[16:19], v[88:91], v[240:243]
ds_read_b128 v[76:79], v11 offset:47104
v_fma_f32 v40, v40, v118, v118
v_fma_f32 v41, v41, v118, v118
v_fma_f32 v42, v42, v118, v118
v_mfma_f32_16x16x32_bf16 v[244:247], a[20:23], v[88:91], v[244:247]
v_fma_f32 v43, v43, v118, v118
v_rcp_f32_e64 v40, v40
v_mfma_f32_16x16x32_bf16 v[252:255], a[20:23], v[92:95], v[252:255]
buffer_load_dwordx4 v124, s[84:87], s4 offen offset:2048 lds
v_rcp_f32_e64 v41, v41
v_mfma_f32_16x16x32_bf16 v[248:251], a[16:19], v[92:95], v[248:251]
v_rcp_f32 v42, v42
v_rcp_f32 v43, v43
v_mfma_f32_16x16x32_bf16 v[192:195], a[24:27], v[96:99], v[192:195]
v_mul_f32 v40, v140, v40
v_mul_f32 v41, v141, v41
v_mul_f32 v42, v142, v42
v_mul_f32 v43, v143, v43
v_mfma_f32_16x16x32_bf16 v[196:199], a[28:31], v[96:99], v[196:199]
v_cvt_pk_bf16_f32 v54, v40, v41
v_cvt_pk_bf16_f32 v55, v42, v43
ds_read_b128 v[116:119], v22 offset:1552
v_mul_f32_e64 v36, v144, v144
v_mfma_f32_16x16x32_bf16 v[204:207], a[28:31], v[100:103], v[204:207]
buffer_load_dwordx4 v125, s[84:87], s4 offen offset:3072 lds
s_add_u32 m0, s47, 0x8000
s_add_u32 s52, s51, 5
v_mfma_f32_16x16x32_bf16 v[200:203], a[24:27], v[100:103], v[200:203]
s_and_b32 s52, s52, 7
s_lshl_b32 s49, s52, 7
s_add_u32 s49, s49, s42
v_mul_f32_e64 v37, v145, v145
v_mfma_f32_16x16x32_bf16 v[208:211], a[24:27], v[104:107], v[208:211]
s_waitcnt vmcnt(17) lgkmcnt(0)
s_barrier
v_mfma_f32_16x16x32_bf16 v[212:215], a[28:31], v[104:107], v[212:215]
ds_read_b64_tr_b16 a[0:1], v18 offset:0
ds_read_b64_tr_b16 a[2:3], v18 offset:4096
v_mul_f32 v38, v146, v146
v_mul_f32 v39, v147, v147
v_mfma_f32_16x16x32_bf16 v[220:223], a[28:31], v[108:111], v[220:223]
buffer_load_dwordx4 v2, s[16:19], s49 offen offset:0 lds
ds_read_b64_tr_b16 a[4:5], v19 offset:0
ds_read_b64_tr_b16 a[6:7], v19 offset:4096
v_mfma_f32_16x16x32_bf16 v[216:219], a[24:27], v[108:111], v[216:219]
ds_read_b128 v[80:83], v12 offset:0
v_fma_f32 v36, v36, v112, v113
v_fma_f32 v37, v37, v112, v113
v_fma_f32 v38, v38, v112, v113
v_mfma_f32_16x16x32_bf16 v[224:227], a[24:27], v[64:67], v[224:227]
buffer_store_dwordx4 v[52:55], v20, s[24:27], s44 offen offset:1024 sc1
ds_read_b128 v[84:87], v12 offset:2048
s_add_u32 s44, s44, 57344
v_fma_f32 v39, v39, v112, v113
v_mfma_f32_16x16x32_bf16 v[228:231], a[28:31], v[64:67], v[228:231]
ds_read_b128 v[88:91], v12 offset:4096
v_mul_f32 v36, v144, v36
v_mul_f32 v37, v145, v37
v_mul_f32_e64 v38, v146, v38
v_mfma_f32_16x16x32_bf16 v[236:239], a[28:31], v[68:71], v[236:239]
buffer_load_dwordx4 v3, s[16:19], s49 offen offset:1024 lds
ds_read_b128 v[92:95], v12 offset:6144
v_mul_f32_e64 v39, v147, v39
v_mfma_f32_16x16x32_bf16 v[232:235], a[24:27], v[68:71], v[232:235]
ds_read_b128 v[96:99], v12 offset:8192
v_exp_f32_e64 v36, v36
v_mfma_f32_16x16x32_bf16 v[240:243], a[24:27], v[72:75], v[240:243]
ds_read_b128 v[100:103], v12 offset:10240
v_exp_f32_e64 v37, v37
v_mfma_f32_16x16x32_bf16 v[244:247], a[28:31], v[72:75], v[244:247]
ds_read_b128 v[104:107], v12 offset:12288
v_exp_f32_e64 v38, v38
v_mfma_f32_16x16x32_bf16 v[252:255], a[28:31], v[76:79], v[252:255]
buffer_load_dwordx4 v4, s[16:19], s49 offen offset:2048 lds
ds_read_b128 v[108:111], v12 offset:14336
v_mfma_f32_16x16x32_bf16 v[248:251], a[24:27], v[76:79], v[248:251]
ds_read_b64_tr_b16 a[8:9], v18 offset:8192
ds_read_b64_tr_b16 a[10:11], v18 offset:12288
s_waitcnt lgkmcnt(7)
v_mfma_f32_16x16x32_bf16 v[192:195], a[32:35], v[80:83], v[192:195]
ds_read_b64_tr_b16 a[12:13], v19 offset:8192
ds_read_b64_tr_b16 a[14:15], v19 offset:12288
v_exp_f32 v39, v39
v_mfma_f32_16x16x32_bf16 v[196:199], a[36:39], v[80:83], v[196:199]
ds_read_b128 v[64:67], v13 offset:0
v_fma_f32 v36, v36, v114, v114
v_fma_f32 v37, v37, v114, v114
v_fma_f32 v38, v38, v114, v114
v_mfma_f32_16x16x32_bf16 v[204:207], a[36:39], v[84:87], v[204:207]
buffer_load_dwordx4 v5, s[16:19], s49 offen offset:3072 lds
ds_read_b128 v[68:71], v13 offset:2048
s_add_u32 m0, s47, 0xc000
v_mfma_f32_16x16x32_bf16 v[200:203], a[32:35], v[84:87], v[200:203]
ds_read_b128 v[72:75], v13 offset:4096
s_add_u32 s4, s4, 0x20000
v_fma_f32 v39, v39, v114, v114
v_mfma_f32_16x16x32_bf16 v[208:211], a[32:35], v[88:91], v[208:211]
ds_read_b128 v[76:79], v13 offset:6144
v_rcp_f32_e64 v36, v36
v_mfma_f32_16x16x32_bf16 v[212:215], a[36:39], v[88:91], v[212:215]
v_rcp_f32 v37, v37
s_waitcnt lgkmcnt(6)
v_mfma_f32_16x16x32_bf16 v[220:223], a[36:39], v[92:95], v[220:223]
buffer_load_dwordx4 v122, s[84:87], s4 offen offset:0 lds
ds_read_b128 v[80:83], v13 offset:8192
v_mfma_f32_16x16x32_bf16 v[216:219], a[32:35], v[92:95], v[216:219]
v_rcp_f32 v38, v38
v_rcp_f32 v39, v39
v_mfma_f32_16x16x32_bf16 v[224:227], a[32:35], v[96:99], v[224:227]
ds_read_b128 v[84:87], v13 offset:10240
v_mul_f32 v36, v144, v36
v_mul_f32 v37, v145, v37
v_mul_f32_e64 v38, v146, v38
v_mfma_f32_16x16x32_bf16 v[228:231], a[36:39], v[96:99], v[228:231]
v_mul_f32_e64 v39, v147, v39
v_cvt_pk_bf16_f32 v48, v36, v37
v_cvt_pk_bf16_f32 v49, v38, v39
v_mul_f32_e64 v40, v148, v148
v_mfma_f32_16x16x32_bf16 v[236:239], a[36:39], v[100:103], v[236:239]
buffer_load_dwordx4 v123, s[84:87], s4 offen offset:1024 lds
ds_read_b128 v[88:91], v13 offset:12288
v_mul_f32_e64 v41, v149, v149
v_mfma_f32_16x16x32_bf16 v[232:235], a[32:35], v[100:103], v[232:235]
v_mul_f32 v42, v150, v150
v_mul_f32 v43, v151, v151
v_fma_f32 v40, v40, v112, v113
v_fma_f32 v41, v41, v112, v113
v_mfma_f32_16x16x32_bf16 v[240:243], a[32:35], v[104:107], v[240:243]
ds_read_b128 v[92:95], v13 offset:14336
v_fma_f32 v42, v42, v112, v113
v_fma_f32 v43, v43, v112, v113
v_mul_f32_e64 v40, v148, v40
v_mfma_f32_16x16x32_bf16 v[244:247], a[36:39], v[104:107], v[244:247]
v_mul_f32 v41, v149, v41
v_mul_f32 v42, v150, v42
v_mul_f32_e64 v43, v151, v43
v_mfma_f32_16x16x32_bf16 v[252:255], a[36:39], v[108:111], v[252:255]
buffer_load_dwordx4 v124, s[84:87], s4 offen offset:2048 lds
v_exp_f32_e64 v40, v40
v_mfma_f32_16x16x32_bf16 v[248:251], a[32:35], v[108:111], v[248:251]
v_exp_f32 v41, v41
s_waitcnt lgkmcnt(2)
v_mfma_f32_16x16x32_bf16 v[192:195], a[40:43], v[64:67], v[192:195]
v_exp_f32 v42, v42
v_exp_f32 v43, v43
v_mfma_f32_16x16x32_bf16 v[196:199], a[44:47], v[64:67], v[196:199]
v_fma_f32 v40, v40, v114, v114
v_fma_f32 v41, v41, v114, v114
v_fma_f32 v42, v42, v114, v114
v_fma_f32 v43, v43, v114, v114
v_mfma_f32_16x16x32_bf16 v[204:207], a[44:47], v[68:71], v[204:207]
buffer_load_dwordx4 v125, s[84:87], s4 offen offset:3072 lds
s_add_u32 m0, s47, 0x10000
s_add_u32 s52, s51, 6
v_mfma_f32_16x16x32_bf16 v[200:203], a[40:43], v[68:71], v[200:203]
s_and_b32 s52, s52, 7
s_lshl_b32 s49, s52, 7
s_add_u32 s49, s49, s42
v_mfma_f32_16x16x32_bf16 v[208:211], a[40:43], v[72:75], v[208:211]
s_waitcnt vmcnt(18) lgkmcnt(0)
s_barrier
v_mfma_f32_16x16x32_bf16 v[212:215], a[44:47], v[72:75], v[212:215]
ds_read_b64_tr_b16 a[16:17], v18 offset:32768
ds_read_b64_tr_b16 a[18:19], v18 offset:36864
v_rcp_f32_e64 v40, v40
v_mfma_f32_16x16x32_bf16 v[220:223], a[44:47], v[76:79], v[220:223]
buffer_load_dwordx4 v2, s[16:19], s49 offen offset:0 lds
ds_read_b64_tr_b16 a[20:21], v19 offset:32768
ds_read_b64_tr_b16 a[22:23], v19 offset:36864
v_mfma_f32_16x16x32_bf16 v[216:219], a[40:43], v[76:79], v[216:219]
ds_read_b128 v[96:99], v12 offset:32768
v_rcp_f32_e64 v41, v41
v_mfma_f32_16x16x32_bf16 v[224:227], a[40:43], v[80:83], v[224:227]
ds_read_b128 v[100:103], v12 offset:34816
v_rcp_f32_e64 v42, v42
v_mfma_f32_16x16x32_bf16 v[228:231], a[44:47], v[80:83], v[228:231]
ds_read_b128 v[104:107], v12 offset:36864
v_rcp_f32 v43, v43
v_mul_f32 v40, v148, v40
v_mfma_f32_16x16x32_bf16 v[236:239], a[44:47], v[84:87], v[236:239]
buffer_load_dwordx4 v3, s[16:19], s49 offen offset:1024 lds
ds_read_b128 v[108:111], v12 offset:38912
v_mul_f32_e64 v41, v149, v41
v_mfma_f32_16x16x32_bf16 v[232:235], a[40:43], v[84:87], v[232:235]
ds_read_b128 v[64:67], v12 offset:40960
v_mul_f32 v42, v150, v42
v_mul_f32 v43, v151, v43
v_cvt_pk_bf16_f32 v50, v40, v41
v_mfma_f32_16x16x32_bf16 v[240:243], a[40:43], v[88:91], v[240:243]
ds_read_b128 v[68:71], v12 offset:43008
v_cvt_pk_bf16_f32 v51, v42, v43
ds_read_b128 v[112:115], v22 offset:2064
v_mul_f32_e64 v36, v152, v152
v_mfma_f32_16x16x32_bf16 v[244:247], a[44:47], v[88:91], v[244:247]
buffer_store_dwordx4 v[48:51], v20, s[24:27], s44 offen offset:0 sc1
ds_read_b128 v[72:75], v12 offset:45056
v_mul_f32 v37, v153, v153
v_mul_f32 v38, v154, v154
v_mfma_f32_16x16x32_bf16 v[252:255], a[44:47], v[92:95], v[252:255]
buffer_load_dwordx4 v4, s[16:19], s49 offen offset:2048 lds
ds_read_b128 v[76:79], v12 offset:47104
v_mul_f32 v39, v155, v155
v_mfma_f32_16x16x32_bf16 v[248:251], a[40:43], v[92:95], v[248:251]
ds_read_b64_tr_b16 a[24:25], v18 offset:40960
ds_read_b64_tr_b16 a[26:27], v18 offset:45056
v_fma_f32 v36, v36, v116, v117
s_waitcnt lgkmcnt(8)
v_mfma_f32_16x16x32_bf16 v[192:195], a[48:51], v[96:99], v[192:195]
ds_read_b64_tr_b16 a[28:29], v19 offset:40960
ds_read_b64_tr_b16 a[30:31], v19 offset:45056
v_fma_f32 v37, v37, v116, v117
v_fma_f32 v38, v38, v116, v117
v_mfma_f32_16x16x32_bf16 v[196:199], a[52:55], v[96:99], v[196:199]
ds_read_b128 v[80:83], v13 offset:32768
v_fma_f32 v39, v39, v116, v117
v_mul_f32 v36, v152, v36
v_mul_f32 v37, v153, v37
v_mfma_f32_16x16x32_bf16 v[204:207], a[52:55], v[100:103], v[204:207]
buffer_load_dwordx4 v5, s[16:19], s49 offen offset:3072 lds
ds_read_b128 v[84:87], v13 offset:34816
s_add_u32 m0, s47, 0x14000
v_mfma_f32_16x16x32_bf16 v[200:203], a[48:51], v[100:103], v[200:203]
ds_read_b128 v[88:91], v13 offset:36864
s_add_u32 s4, s4, 0x20000
s_sub_u32 s50, s4, 1835008
s_min_u32 s4, s4, s50
v_mfma_f32_16x16x32_bf16 v[208:211], a[48:51], v[104:107], v[208:211]
ds_read_b128 v[92:95], v13 offset:38912
v_mul_f32 v38, v154, v38
v_mul_f32_e64 v39, v155, v39
v_mfma_f32_16x16x32_bf16 v[212:215], a[52:55], v[104:107], v[212:215]
v_exp_f32 v36, v36
s_waitcnt lgkmcnt(6)
v_mfma_f32_16x16x32_bf16 v[220:223], a[52:55], v[108:111], v[220:223]
buffer_load_dwordx4 v122, s[84:87], s4 offen offset:0 lds
ds_read_b128 v[96:99], v13 offset:40960
v_mfma_f32_16x16x32_bf16 v[216:219], a[48:51], v[108:111], v[216:219]
v_exp_f32 v37, v37
v_exp_f32 v38, v38
v_mfma_f32_16x16x32_bf16 v[224:227], a[48:51], v[64:67], v[224:227]
ds_read_b128 v[100:103], v13 offset:43008
v_exp_f32_e64 v39, v39
v_fma_f32 v36, v36, v118, v118
v_mfma_f32_16x16x32_bf16 v[228:231], a[52:55], v[64:67], v[228:231]
v_fma_f32 v37, v37, v118, v118
v_fma_f32 v38, v38, v118, v118
v_fma_f32 v39, v39, v118, v118
v_mfma_f32_16x16x32_bf16 v[236:239], a[52:55], v[68:71], v[236:239]
buffer_load_dwordx4 v123, s[84:87], s4 offen offset:1024 lds
ds_read_b128 v[104:107], v13 offset:45056
v_mfma_f32_16x16x32_bf16 v[232:235], a[48:51], v[68:71], v[232:235]
v_rcp_f32 v36, v36
v_rcp_f32 v37, v37
v_mfma_f32_16x16x32_bf16 v[240:243], a[48:51], v[72:75], v[240:243]
ds_read_b128 v[108:111], v13 offset:47104
v_rcp_f32_e64 v38, v38
v_mfma_f32_16x16x32_bf16 v[244:247], a[52:55], v[72:75], v[244:247]
v_rcp_f32 v39, v39
v_mul_f32 v36, v152, v36
v_mul_f32_e64 v37, v153, v37
v_mfma_f32_16x16x32_bf16 v[252:255], a[52:55], v[76:79], v[252:255]
buffer_load_dwordx4 v124, s[84:87], s4 offen offset:2048 lds
v_mul_f32 v38, v154, v38
v_mul_f32 v39, v155, v39
v_mfma_f32_16x16x32_bf16 v[248:251], a[48:51], v[76:79], v[248:251]
v_cvt_pk_bf16_f32 v52, v36, v37
v_cvt_pk_bf16_f32 v53, v38, v39
v_mul_f32 v40, v156, v156
s_waitcnt lgkmcnt(2)
v_mfma_f32_16x16x32_bf16 v[192:195], a[56:59], v[80:83], v[192:195]
v_mul_f32 v41, v157, v157
v_mul_f32 v42, v158, v158
v_mul_f32_e64 v43, v159, v159
v_fma_f32 v40, v40, v116, v117
v_mfma_f32_16x16x32_bf16 v[196:199], a[60:63], v[80:83], v[196:199]
v_fma_f32 v41, v41, v116, v117
v_fma_f32 v42, v42, v116, v117
v_fma_f32 v43, v43, v116, v117
v_mul_f32_e64 v40, v156, v40
v_mfma_f32_16x16x32_bf16 v[204:207], a[60:63], v[84:87], v[204:207]
buffer_load_dwordx4 v125, s[84:87], s4 offen offset:3072 lds
s_add_u32 m0, s47, 0x18000
s_add_u32 s52, s51, 7
v_mfma_f32_16x16x32_bf16 v[200:203], a[56:59], v[84:87], v[200:203]
s_and_b32 s52, s52, 7
s_lshl_b32 s49, s52, 7
s_add_u32 s49, s49, s42
v_mul_f32_e64 v41, v157, v41
v_mfma_f32_16x16x32_bf16 v[208:211], a[56:59], v[88:91], v[208:211]
s_waitcnt vmcnt(18) lgkmcnt(0)
s_barrier
v_mfma_f32_16x16x32_bf16 v[212:215], a[60:63], v[88:91], v[212:215]
ds_read_b64_tr_b16 a[32:33], v16 offset:0
ds_read_b64_tr_b16 a[34:35], v16 offset:4096
v_mul_f32 v42, v158, v42
v_mul_f32 v43, v159, v43
v_mfma_f32_16x16x32_bf16 v[220:223], a[60:63], v[92:95], v[220:223]
buffer_load_dwordx4 v2, s[16:19], s49 offen offset:0 lds
ds_read_b64_tr_b16 a[36:37], v17 offset:0
ds_read_b64_tr_b16 a[38:39], v17 offset:4096
v_mfma_f32_16x16x32_bf16 v[216:219], a[56:59], v[92:95], v[216:219]
ds_read_b128 v[64:67], v10 offset:0
v_exp_f32_e64 v40, v40
v_mfma_f32_16x16x32_bf16 v[224:227], a[56:59], v[96:99], v[224:227]
ds_read_b128 v[68:71], v10 offset:2048
v_exp_f32_e64 v41, v41
v_mfma_f32_16x16x32_bf16 v[228:231], a[60:63], v[96:99], v[228:231]
ds_read_b128 v[72:75], v10 offset:4096
v_exp_f32_e64 v42, v42
v_mfma_f32_16x16x32_bf16 v[236:239], a[60:63], v[100:103], v[236:239]
buffer_load_dwordx4 v3, s[16:19], s49 offen offset:1024 lds
ds_read_b128 v[76:79], v10 offset:6144
v_mfma_f32_16x16x32_bf16 v[232:235], a[56:59], v[100:103], v[232:235]
ds_read_b128 v[80:83], v10 offset:8192
v_exp_f32_e64 v43, v43
v_fma_f32 v40, v40, v118, v118
v_mfma_f32_16x16x32_bf16 v[240:243], a[56:59], v[104:107], v[240:243]
ds_read_b128 v[84:87], v10 offset:10240
v_fma_f32 v41, v41, v118, v118
v_fma_f32 v42, v42, v118, v118
v_fma_f32 v43, v43, v118, v118
v_mfma_f32_16x16x32_bf16 v[244:247], a[60:63], v[104:107], v[244:247]
ds_read_b128 v[88:91], v10 offset:12288
v_rcp_f32_e64 v40, v40
v_mfma_f32_16x16x32_bf16 v[252:255], a[60:63], v[108:111], v[252:255]
buffer_load_dwordx4 v4, s[16:19], s49 offen offset:2048 lds
ds_read_b128 v[92:95], v10 offset:14336
v_mfma_f32_16x16x32_bf16 v[248:251], a[56:59], v[108:111], v[248:251]
ds_read_b64_tr_b16 a[40:41], v16 offset:8192
ds_read_b64_tr_b16 a[42:43], v16 offset:12288
s_waitcnt lgkmcnt(7)
v_mfma_f32_16x16x32_bf16 v[192:195], a[64:67], v[64:67], v[192:195]
ds_read_b64_tr_b16 a[44:45], v17 offset:8192
ds_read_b64_tr_b16 a[46:47], v17 offset:12288
v_rcp_f32 v41, v41
v_mfma_f32_16x16x32_bf16 v[196:199], a[68:71], v[64:67], v[196:199]
ds_read_b128 v[96:99], v11 offset:0
v_rcp_f32_e64 v42, v42
v_mfma_f32_16x16x32_bf16 v[204:207], a[68:71], v[68:71], v[204:207]
buffer_load_dwordx4 v5, s[16:19], s49 offen offset:3072 lds
ds_read_b128 v[100:103], v11 offset:2048
s_add_u32 m0, s47, 0x1c000
v_mfma_f32_16x16x32_bf16 v[200:203], a[64:67], v[68:71], v[200:203]
ds_read_b128 v[104:107], v11 offset:4096
s_add_u32 s4, s4, 0x20000
v_rcp_f32_e64 v43, v43
v_mfma_f32_16x16x32_bf16 v[208:211], a[64:67], v[72:75], v[208:211]
ds_read_b128 v[108:111], v11 offset:6144
v_mul_f32 v40, v156, v40
v_mul_f32 v41, v157, v41
v_mul_f32_e64 v42, v158, v42
v_mfma_f32_16x16x32_bf16 v[212:215], a[68:71], v[72:75], v[212:215]
v_mul_f32 v43, v159, v43
v_cvt_pk_bf16_f32 v54, v40, v41
v_cvt_pk_bf16_f32 v55, v42, v43
s_waitcnt lgkmcnt(6)
v_mfma_f32_16x16x32_bf16 v[220:223], a[68:71], v[76:79], v[220:223]
buffer_load_dwordx4 v122, s[84:87], s4 offen offset:0 lds
ds_read_b128 v[64:67], v11 offset:8192
ds_read_b128 v[116:119], v22 offset:2576
v_mfma_f32_16x16x32_bf16 v[216:219], a[64:67], v[76:79], v[216:219]
v_mul_f32 v36, v160, v160
v_mul_f32 v37, v161, v161
v_mul_f32 v38, v162, v162
v_mul_f32 v39, v163, v163
v_mfma_f32_16x16x32_bf16 v[224:227], a[64:67], v[80:83], v[224:227]
buffer_store_dwordx4 v[52:55], v20, s[24:27], s44 offen offset:1024 sc1
ds_read_b128 v[68:71], v11 offset:10240
s_add_u32 s44, s44, 57344
v_fma_f32 v36, v36, v112, v113
v_mfma_f32_16x16x32_bf16 v[228:231], a[68:71], v[80:83], v[228:231]
v_fma_f32 v37, v37, v112, v113
v_fma_f32 v38, v38, v112, v113
v_fma_f32 v39, v39, v112, v113
v_mul_f32_e64 v36, v160, v36
v_mfma_f32_16x16x32_bf16 v[236:239], a[68:71], v[84:87], v[236:239]
buffer_load_dwordx4 v123, s[84:87], s4 offen offset:1024 lds
ds_read_b128 v[72:75], v11 offset:12288
v_mul_f32_e64 v37, v161, v37
v_mfma_f32_16x16x32_bf16 v[232:235], a[64:67], v[84:87], v[232:235]
v_mul_f32 v38, v162, v38
v_mul_f32 v39, v163, v39
v_exp_f32_e64 v36, v36
v_mfma_f32_16x16x32_bf16 v[240:243], a[64:67], v[88:91], v[240:243]
ds_read_b128 v[76:79], v11 offset:14336
v_exp_f32_e64 v37, v37
v_mfma_f32_16x16x32_bf16 v[244:247], a[68:71], v[88:91], v[244:247]
v_exp_f32 v38, v38
v_exp_f32 v39, v39
v_mfma_f32_16x16x32_bf16 v[252:255], a[68:71], v[92:95], v[252:255]
buffer_load_dwordx4 v124, s[84:87], s4 offen offset:2048 lds
v_fma_f32 v36, v36, v114, v114
v_fma_f32 v37, v37, v114, v114
v_mfma_f32_16x16x32_bf16 v[248:251], a[64:67], v[92:95], v[248:251]
v_fma_f32 v38, v38, v114, v114
v_fma_f32 v39, v39, v114, v114
s_waitcnt lgkmcnt(2)
v_mfma_f32_16x16x32_bf16 v[192:195], a[72:75], v[96:99], v[192:195]
v_rcp_f32 v36, v36
v_rcp_f32_e64 v37, v37
v_mfma_f32_16x16x32_bf16 v[196:199], a[76:79], v[96:99], v[196:199]
v_rcp_f32 v38, v38
v_rcp_f32 v39, v39
v_mfma_f32_16x16x32_bf16 v[204:207], a[76:79], v[100:103], v[204:207]
buffer_load_dwordx4 v125, s[84:87], s4 offen offset:3072 lds
s_xor_b32 s51, s51, s89
s_add_u32 m0, s47, 0x0
v_mfma_f32_16x16x32_bf16 v[200:203], a[72:75], v[100:103], v[200:203]
s_add_u32 s52, s51, 8
s_and_b32 s52, s52, 7
s_or_b32 s52, s52, 8
s_lshl_b32 s49, s52, 7
v_mfma_f32_16x16x32_bf16 v[208:211], a[72:75], v[104:107], v[208:211]
s_waitcnt vmcnt(18) lgkmcnt(0)
s_barrier
v_mfma_f32_16x16x32_bf16 v[212:215], a[76:79], v[104:107], v[212:215]
ds_read_b64_tr_b16 a[48:49], v16 offset:32768
ds_read_b64_tr_b16 a[50:51], v16 offset:36864
s_add_u32 s49, s49, s42
v_mul_f32 v36, v160, v36
v_mfma_f32_16x16x32_bf16 v[220:223], a[76:79], v[108:111], v[220:223]
buffer_load_dwordx4 v2, s[16:19], s49 offen offset:0 lds
ds_read_b64_tr_b16 a[52:53], v17 offset:32768
ds_read_b64_tr_b16 a[54:55], v17 offset:36864
v_mfma_f32_16x16x32_bf16 v[216:219], a[72:75], v[108:111], v[216:219]
ds_read_b128 v[80:83], v10 offset:32768
v_mul_f32 v37, v161, v37
v_mul_f32 v38, v162, v38
v_mul_f32_e64 v39, v163, v39
v_mfma_f32_16x16x32_bf16 v[224:227], a[72:75], v[64:67], v[224:227]
ds_read_b128 v[84:87], v10 offset:34816
v_cvt_pk_bf16_f32 v48, v36, v37
v_cvt_pk_bf16_f32 v49, v38, v39
v_mul_f32_e64 v40, v164, v164
v_mfma_f32_16x16x32_bf16 v[228:231], a[76:79], v[64:67], v[228:231]
ds_read_b128 v[88:91], v10 offset:36864
v_mul_f32 v41, v165, v165
v_mul_f32 v42, v166, v166
v_mul_f32_e64 v43, v167, v167
v_mfma_f32_16x16x32_bf16 v[236:239], a[76:79], v[68:71], v[236:239]
buffer_load_dwordx4 v3, s[16:19], s49 offen offset:1024 lds
ds_read_b128 v[92:95], v10 offset:38912
v_fma_f32 v40, v40, v112, v113
v_mfma_f32_16x16x32_bf16 v[232:235], a[72:75], v[68:71], v[232:235]
ds_read_b128 v[96:99], v10 offset:40960
v_fma_f32 v41, v41, v112, v113
v_fma_f32 v42, v42, v112, v113
v_fma_f32 v43, v43, v112, v113
v_mfma_f32_16x16x32_bf16 v[240:243], a[72:75], v[72:75], v[240:243]
ds_read_b128 v[100:103], v10 offset:43008
v_mul_f32 v40, v164, v40
v_mul_f32 v41, v165, v41
v_mul_f32_e64 v42, v166, v42
v_mfma_f32_16x16x32_bf16 v[244:247], a[76:79], v[72:75], v[244:247]
ds_read_b128 v[104:107], v10 offset:45056
v_mul_f32 v43, v167, v43
v_exp_f32 v40, v40
v_mfma_f32_16x16x32_bf16 v[252:255], a[76:79], v[76:79], v[252:255]
buffer_load_dwordx4 v4, s[16:19], s49 offen offset:2048 lds
ds_read_b128 v[108:111], v10 offset:47104
v_mfma_f32_16x16x32_bf16 v[248:251], a[72:75], v[76:79], v[248:251]
ds_read_b64_tr_b16 a[56:57], v16 offset:40960
ds_read_b64_tr_b16 a[58:59], v16 offset:45056
s_waitcnt lgkmcnt(7)
v_mfma_f32_16x16x32_bf16 v[192:195], a[80:83], v[80:83], v[192:195]
ds_read_b64_tr_b16 a[60:61], v17 offset:40960
ds_read_b64_tr_b16 a[62:63], v17 offset:45056
v_exp_f32 v41, v41
v_mfma_f32_16x16x32_bf16 v[196:199], a[84:87], v[80:83], v[196:199]
ds_read_b128 v[64:67], v11 offset:32768
v_exp_f32_e64 v42, v42
v_mfma_f32_16x16x32_bf16 v[204:207], a[84:87], v[84:87], v[204:207]
buffer_load_dwordx4 v5, s[16:19], s49 offen offset:3072 lds
ds_read_b128 v[68:71], v11 offset:34816
s_add_u32 m0, s47, 0x4000
v_mfma_f32_16x16x32_bf16 v[200:203], a[80:83], v[84:87], v[200:203]
ds_read_b128 v[72:75], v11 offset:36864
s_add_u32 s4, s4, 0x20000
s_sub_u32 s50, s4, 1835008
s_min_u32 s4, s4, s50
v_mfma_f32_16x16x32_bf16 v[208:211], a[80:83], v[88:91], v[208:211]
ds_read_b128 v[76:79], v11 offset:38912
v_exp_f32 v43, v43
v_fma_f32 v40, v40, v114, v114
v_mfma_f32_16x16x32_bf16 v[212:215], a[84:87], v[88:91], v[212:215]
v_fma_f32 v41, v41, v114, v114
v_fma_f32 v42, v42, v114, v114
v_fma_f32 v43, v43, v114, v114
s_waitcnt lgkmcnt(6)
v_mfma_f32_16x16x32_bf16 v[220:223], a[84:87], v[92:95], v[220:223]
buffer_load_dwordx4 v122, s[84:87], s4 offen offset:0 lds
ds_read_b128 v[80:83], v11 offset:40960
v_mfma_f32_16x16x32_bf16 v[216:219], a[80:83], v[92:95], v[216:219]
v_rcp_f32 v40, v40
v_rcp_f32_e64 v41, v41
v_mfma_f32_16x16x32_bf16 v[224:227], a[80:83], v[96:99], v[224:227]
ds_read_b128 v[84:87], v11 offset:43008
v_rcp_f32_e64 v42, v42
v_mfma_f32_16x16x32_bf16 v[228:231], a[84:87], v[96:99], v[228:231]
v_rcp_f32 v43, v43
v_mul_f32 v40, v164, v40
v_mul_f32_e64 v41, v165, v41
v_mfma_f32_16x16x32_bf16 v[236:239], a[84:87], v[100:103], v[236:239]
buffer_load_dwordx4 v123, s[84:87], s4 offen offset:1024 lds
ds_read_b128 v[88:91], v11 offset:45056
v_mul_f32_e64 v42, v166, v42
v_mfma_f32_16x16x32_bf16 v[232:235], a[80:83], v[100:103], v[232:235]
v_mul_f32_e64 v43, v167, v43
v_cvt_pk_bf16_f32 v50, v40, v41
v_cvt_pk_bf16_f32 v51, v42, v43
ds_read_b128 v[112:115], v22 offset:3088
v_mfma_f32_16x16x32_bf16 v[240:243], a[80:83], v[104:107], v[240:243]
buffer_store_dwordx4 v[48:51], v20, s[24:27], s44 offen offset:0 sc1
ds_read_b128 v[92:95], v11 offset:47104
v_mul_f32 v36, v168, v168
v_mul_f32 v37, v169, v169
v_mfma_f32_16x16x32_bf16 v[244:247], a[84:87], v[104:107], v[244:247]
v_mul_f32 v38, v170, v170
v_mul_f32 v39, v171, v171
v_fma_f32 v36, v36, v116, v117
v_fma_f32 v37, v37, v116, v117
v_mfma_f32_16x16x32_bf16 v[252:255], a[84:87], v[108:111], v[252:255]
buffer_load_dwordx4 v124, s[84:87], s4 offen offset:2048 lds
v_fma_f32 v38, v38, v116, v117
v_fma_f32 v39, v39, v116, v117
v_mfma_f32_16x16x32_bf16 v[248:251], a[80:83], v[108:111], v[248:251]
v_mul_f32 v36, v168, v36
v_mul_f32 v37, v169, v37
v_mul_f32 v38, v170, v38
s_waitcnt lgkmcnt(3)
v_mfma_f32_16x16x32_bf16 v[192:195], a[88:91], v[64:67], v[192:195]
v_mul_f32 v39, v171, v39
v_exp_f32 v36, v36
v_mfma_f32_16x16x32_bf16 v[196:199], a[92:95], v[64:67], v[196:199]
v_exp_f32_e64 v37, v37
v_exp_f32 v38, v38
v_mfma_f32_16x16x32_bf16 v[204:207], a[92:95], v[68:71], v[204:207]
buffer_load_dwordx4 v125, s[84:87], s4 offen offset:3072 lds
s_add_u32 m0, s47, 0x8000
s_add_u32 s52, s51, 9
v_mfma_f32_16x16x32_bf16 v[200:203], a[88:91], v[68:71], v[200:203]
s_and_b32 s52, s52, 7
s_or_b32 s52, s52, 8
s_lshl_b32 s49, s52, 7
s_add_u32 s49, s49, s42
v_mfma_f32_16x16x32_bf16 v[208:211], a[88:91], v[72:75], v[208:211]
s_waitcnt vmcnt(18) lgkmcnt(0)
s_barrier
v_mfma_f32_16x16x32_bf16 v[212:215], a[92:95], v[72:75], v[212:215]
ds_read_b64_tr_b16 a[64:65], v18 offset:0
ds_read_b64_tr_b16 a[66:67], v18 offset:4096
v_exp_f32_e64 v39, v39
v_mfma_f32_16x16x32_bf16 v[220:223], a[92:95], v[76:79], v[220:223]
buffer_load_dwordx4 v2, s[16:19], s49 offen offset:0 lds
ds_read_b64_tr_b16 a[68:69], v19 offset:0
ds_read_b64_tr_b16 a[70:71], v19 offset:4096
v_mfma_f32_16x16x32_bf16 v[216:219], a[88:91], v[76:79], v[216:219]
ds_read_b128 v[96:99], v12 offset:0
v_fma_f32 v36, v36, v118, v118
v_fma_f32 v37, v37, v118, v118
v_fma_f32 v38, v38, v118, v118
v_mfma_f32_16x16x32_bf16 v[224:227], a[88:91], v[80:83], v[224:227]
ds_read_b128 v[100:103], v12 offset:2048
s_waitcnt vmcnt(13)
v_fma_f32 v39, v39, v118, v118
v_mfma_f32_16x16x32_bf16 v[228:231], a[92:95], v[80:83], v[228:231]
buffer_store_dword v56, v57, s[24:27], s63 offen offset:0 sc1
ds_read_b128 v[104:107], v12 offset:4096
v_mfma_f32_16x16x32_bf16 v[236:239], a[92:95], v[84:87], v[236:239]
buffer_load_dwordx4 v3, s[16:19], s49 offen offset:1024 lds
ds_read_b128 v[108:111], v12 offset:6144
v_mfma_f32_16x16x32_bf16 v[232:235], a[88:91], v[84:87], v[232:235]
ds_read_b128 v[64:67], v12 offset:8192
v_rcp_f32 v36, v36
v_mfma_f32_16x16x32_bf16 v[240:243], a[88:91], v[88:91], v[240:243]
ds_read_b128 v[68:71], v12 offset:10240
v_rcp_f32_e64 v37, v37
v_mfma_f32_16x16x32_bf16 v[244:247], a[92:95], v[88:91], v[244:247]
ds_read_b128 v[72:75], v12 offset:12288
v_rcp_f32_e64 v38, v38
v_mfma_f32_16x16x32_bf16 v[252:255], a[92:95], v[92:95], v[252:255]
buffer_load_dwordx4 v4, s[16:19], s49 offen offset:2048 lds
ds_read_b128 v[76:79], v12 offset:14336
v_mfma_f32_16x16x32_bf16 v[248:251], a[88:91], v[92:95], v[248:251]
ds_read_b64_tr_b16 a[72:73], v18 offset:8192
ds_read_b64_tr_b16 a[74:75], v18 offset:12288
s_waitcnt lgkmcnt(7)
v_mfma_f32_16x16x32_bf16 v[192:195], a[96:99], v[96:99], v[192:195]
ds_read_b64_tr_b16 a[76:77], v19 offset:8192
ds_read_b64_tr_b16 a[78:79], v19 offset:12288
v_rcp_f32 v39, v39
v_mfma_f32_16x16x32_bf16 v[196:199], a[100:103], v[96:99], v[196:199]
ds_read_b128 v[80:83], v13 offset:0
v_mul_f32 v36, v168, v36
v_mul_f32 v37, v169, v37
v_mul_f32_e64 v38, v170, v38
v_mfma_f32_16x16x32_bf16 v[204:207], a[100:103], v[100:103], v[204:207]
buffer_load_dwordx4 v5, s[16:19], s49 offen offset:3072 lds
ds_read_b128 v[84:87], v13 offset:2048
s_add_u32 m0, s47, 0xc000
v_mfma_f32_16x16x32_bf16 v[200:203], a[96:99], v[100:103], v[200:203]
ds_read_b128 v[88:91], v13 offset:4096
s_add_u32 s4, s4, 0x20000
v_mul_f32_e64 v39, v171, v39
v_cvt_pk_bf16_f32 v52, v36, v37
v_mfma_f32_16x16x32_bf16 v[208:211], a[96:99], v[104:107], v[208:211]
ds_read_b128 v[92:95], v13 offset:6144
v_cvt_pk_bf16_f32 v53, v38, v39
v_mul_f32 v40, v172, v172
v_mul_f32 v41, v173, v173
v_mfma_f32_16x16x32_bf16 v[212:215], a[100:103], v[104:107], v[212:215]
v_mul_f32_e64 v42, v174, v174
v_mul_f32 v43, v175, v175
v_fma_f32 v40, v40, v116, v117
s_waitcnt lgkmcnt(6)
v_mfma_f32_16x16x32_bf16 v[220:223], a[100:103], v[108:111], v[220:223]
buffer_load_dwordx4 v122, s[84:87], s4 offen offset:0 lds
ds_read_b128 v[96:99], v13 offset:8192
v_fma_f32 v41, v41, v116, v117
v_mfma_f32_16x16x32_bf16 v[216:219], a[96:99], v[108:111], v[216:219]
v_fma_f32 v42, v42, v116, v117
v_fma_f32 v43, v43, v116, v117
v_mul_f32 v40, v172, v40
v_mul_f32 v41, v173, v41
v_mfma_f32_16x16x32_bf16 v[224:227], a[96:99], v[64:67], v[224:227]
ds_read_b128 v[100:103], v13 offset:10240
v_mul_f32 v42, v174, v42
v_mul_f32 v43, v175, v43
v_mfma_f32_16x16x32_bf16 v[228:231], a[100:103], v[64:67], v[228:231]
v_exp_f32 v40, v40
v_exp_f32 v41, v41
v_mfma_f32_16x16x32_bf16 v[236:239], a[100:103], v[68:71], v[236:239]
buffer_load_dwordx4 v123, s[84:87], s4 offen offset:1024 lds
ds_read_b128 v[104:107], v13 offset:12288
v_mfma_f32_16x16x32_bf16 v[232:235], a[96:99], v[68:71], v[232:235]
v_exp_f32 v42, v42
v_exp_f32 v43, v43
v_mfma_f32_16x16x32_bf16 v[240:243], a[96:99], v[72:75], v[240:243]
ds_read_b128 v[108:111], v13 offset:14336
v_fma_f32 v40, v40, v118, v118
v_fma_f32 v41, v41, v118, v118
v_fma_f32 v42, v42, v118, v118
v_mfma_f32_16x16x32_bf16 v[244:247], a[100:103], v[72:75], v[244:247]
v_fma_f32 v43, v43, v118, v118
v_rcp_f32_e64 v40, v40
v_mfma_f32_16x16x32_bf16 v[252:255], a[100:103], v[76:79], v[252:255]
buffer_load_dwordx4 v124, s[84:87], s4 offen offset:2048 lds
v_rcp_f32_e64 v41, v41
v_mfma_f32_16x16x32_bf16 v[248:251], a[96:99], v[76:79], v[248:251]
v_rcp_f32 v42, v42
s_waitcnt lgkmcnt(2)
v_mfma_f32_16x16x32_bf16 v[192:195], a[104:107], v[80:83], v[192:195]
v_rcp_f32 v43, v43
v_mul_f32 v40, v172, v40
v_mul_f32_e64 v41, v173, v41
v_mfma_f32_16x16x32_bf16 v[196:199], a[108:111], v[80:83], v[196:199]
v_mul_f32_e64 v42, v174, v42
v_mul_f32 v43, v175, v43
v_cvt_pk_bf16_f32 v54, v40, v41
v_cvt_pk_bf16_f32 v55, v42, v43
v_mfma_f32_16x16x32_bf16 v[204:207], a[108:111], v[84:87], v[204:207]
buffer_load_dwordx4 v125, s[84:87], s4 offen offset:3072 lds
s_add_u32 m0, s47, 0x10000
s_add_u32 s52, s51, 10
v_mfma_f32_16x16x32_bf16 v[200:203], a[104:107], v[84:87], v[200:203]
s_and_b32 s52, s52, 7
s_or_b32 s52, s52, 8
s_lshl_b32 s49, s52, 7
s_add_u32 s49, s49, s42
v_mfma_f32_16x16x32_bf16 v[208:211], a[104:107], v[88:91], v[208:211]
s_waitcnt vmcnt(18) lgkmcnt(0)
s_barrier
v_mfma_f32_16x16x32_bf16 v[212:215], a[108:111], v[88:91], v[212:215]
ds_read_b64_tr_b16 a[80:81], v18 offset:32768
ds_read_b64_tr_b16 a[82:83], v18 offset:36864
ds_read_b128 v[116:119], v22 offset:3600
v_mul_f32_e64 v36, v176, v176
v_mfma_f32_16x16x32_bf16 v[220:223], a[108:111], v[92:95], v[220:223]
buffer_load_dwordx4 v2, s[16:19], s49 offen offset:0 lds
ds_read_b64_tr_b16 a[84:85], v19 offset:32768
ds_read_b64_tr_b16 a[86:87], v19 offset:36864
v_mfma_f32_16x16x32_bf16 v[216:219], a[104:107], v[92:95], v[216:219]
ds_read_b128 v[64:67], v12 offset:32768
v_mul_f32 v37, v177, v177
v_mul_f32 v38, v178, v178
v_mul_f32_e64 v39, v179, v179
v_mfma_f32_16x16x32_bf16 v[224:227], a[104:107], v[96:99], v[224:227]
buffer_store_dwordx4 v[52:55], v20, s[24:27], s44 offen offset:1024 sc1
ds_read_b128 v[68:71], v12 offset:34816
s_add_u32 s44, s44, 57344
v_fma_f32 v36, v36, v112, v113
v_mfma_f32_16x16x32_bf16 v[228:231], a[108:111], v[96:99], v[228:231]
ds_read_b128 v[72:75], v12 offset:36864
v_fma_f32 v37, v37, v112, v113
v_fma_f32 v38, v38, v112, v113
v_fma_f32 v39, v39, v112, v113
v_mfma_f32_16x16x32_bf16 v[236:239], a[108:111], v[100:103], v[236:239]
buffer_load_dwordx4 v3, s[16:19], s49 offen offset:1024 lds
ds_read_b128 v[76:79], v12 offset:38912
v_mul_f32_e64 v36, v176, v36
v_mfma_f32_16x16x32_bf16 v[232:235], a[104:107], v[100:103], v[232:235]
ds_read_b128 v[80:83], v12 offset:40960
v_mul_f32 v37, v177, v37
v_mul_f32 v38, v178, v38
v_mul_f32_e64 v39, v179, v39
v_mfma_f32_16x16x32_bf16 v[240:243], a[104:107], v[104:107], v[240:243]
ds_read_b128 v[84:87], v12 offset:43008
v_exp_f32_e64 v36, v36
v_mfma_f32_16x16x32_bf16 v[244:247], a[108:111], v[104:107], v[244:247]
ds_read_b128 v[88:91], v12 offset:45056
v_exp_f32_e64 v37, v37
v_mfma_f32_16x16x32_bf16 v[252:255], a[108:111], v[108:111], v[252:255]
buffer_load_dwordx4 v4, s[16:19], s49 offen offset:2048 lds
ds_read_b128 v[92:95], v12 offset:47104
v_mfma_f32_16x16x32_bf16 v[248:251], a[104:107], v[108:111], v[248:251]
ds_read_b64_tr_b16 a[88:89], v18 offset:40960
ds_read_b64_tr_b16 a[90:91], v18 offset:45056
s_waitcnt lgkmcnt(7)
v_mfma_f32_16x16x32_bf16 v[192:195], a[112:115], v[64:67], v[192:195]
ds_read_b64_tr_b16 a[92:93], v19 offset:40960
ds_read_b64_tr_b16 a[94:95], v19 offset:45056
v_exp_f32 v38, v38
v_mfma_f32_16x16x32_bf16 v[196:199], a[116:119], v[64:67], v[196:199]
ds_read_b128 v[96:99], v13 offset:32768
v_exp_f32_e64 v39, v39
v_fma_f32 v36, v36, v114, v114
v_mfma_f32_16x16x32_bf16 v[204:207], a[116:119], v[68:71], v[204:207]
buffer_load_dwordx4 v5, s[16:19], s49 offen offset:3072 lds
ds_read_b128 v[100:103], v13 offset:34816
s_add_u32 m0, s47, 0x14000
v_mfma_f32_16x16x32_bf16 v[200:203], a[112:115], v[68:71], v[200:203]
ds_read_b128 v[104:107], v13 offset:36864
s_add_u32 s4, s4, 0x20000
s_sub_u32 s50, s4, 1835008
s_min_u32 s4, s4, s50
v_mfma_f32_16x16x32_bf16 v[208:211], a[112:115], v[72:75], v[208:211]
ds_read_b128 v[108:111], v13 offset:38912
v_fma_f32 v37, v37, v114, v114
v_fma_f32 v38, v38, v114, v114
v_fma_f32 v39, v39, v114, v114
v_mfma_f32_16x16x32_bf16 v[212:215], a[116:119], v[72:75], v[212:215]
v_rcp_f32_e64 v36, v36
s_waitcnt lgkmcnt(6)
v_mfma_f32_16x16x32_bf16 v[220:223], a[116:119], v[76:79], v[220:223]
buffer_load_dwordx4 v122, s[84:87], s4 offen offset:0 lds
ds_read_b128 v[64:67], v13 offset:40960
v_mfma_f32_16x16x32_bf16 v[216:219], a[112:115], v[76:79], v[216:219]
v_rcp_f32 v37, v37
v_rcp_f32 v38, v38
v_mfma_f32_16x16x32_bf16 v[224:227], a[112:115], v[80:83], v[224:227]
ds_read_b128 v[68:71], v13 offset:43008
v_rcp_f32 v39, v39
v_mul_f32 v36, v176, v36
v_mfma_f32_16x16x32_bf16 v[228:231], a[116:119], v[80:83], v[228:231]
v_mul_f32 v37, v177, v37
v_mul_f32 v38, v178, v38
v_mul_f32_e64 v39, v179, v39
v_cvt_pk_bf16_f32 v48, v36, v37
v_mfma_f32_16x16x32_bf16 v[236:239], a[116:119], v[84:87], v[236:239]
buffer_load_dwordx4 v123, s[84:87], s4 offen offset:1024 lds
ds_read_b128 v[72:75], v13 offset:45056
v_cvt_pk_bf16_f32 v49, v38, v39
v_mfma_f32_16x16x32_bf16 v[232:235], a[112:115], v[84:87], v[232:235]
v_mul_f32 v40, v180, v180
v_mul_f32 v41, v181, v181
v_mul_f32 v42, v182, v182
v_mul_f32 v43, v183, v183
v_mfma_f32_16x16x32_bf16 v[240:243], a[112:115], v[88:91], v[240:243]
ds_read_b128 v[76:79], v13 offset:47104
v_fma_f32 v40, v40, v112, v113
v_fma_f32 v41, v41, v112, v113
v_fma_f32 v42, v42, v112, v113
v_mfma_f32_16x16x32_bf16 v[244:247], a[116:119], v[88:91], v[244:247]
v_fma_f32 v43, v43, v112, v113
v_mul_f32 v40, v180, v40
v_mul_f32 v41, v181, v41
v_mul_f32_e64 v42, v182, v42
v_mfma_f32_16x16x32_bf16 v[252:255], a[116:119], v[92:95], v[252:255]
buffer_load_dwordx4 v124, s[84:87], s4 offen offset:2048 lds
v_mul_f32_e64 v43, v183, v43
v_mfma_f32_16x16x32_bf16 v[248:251], a[112:115], v[92:95], v[248:251]
v_exp_f32 v40, v40
s_waitcnt lgkmcnt(2)
v_mfma_f32_16x16x32_bf16 v[192:195], a[120:123], v[96:99], v[192:195]
v_exp_f32 v41, v41
v_exp_f32 v42, v42
v_mfma_f32_16x16x32_bf16 v[196:199], a[124:127], v[96:99], v[196:199]
v_exp_f32 v43, v43
v_fma_f32 v40, v40, v114, v114
v_fma_f32 v41, v41, v114, v114
v_mfma_f32_16x16x32_bf16 v[204:207], a[124:127], v[100:103], v[204:207]
buffer_load_dwordx4 v125, s[84:87], s4 offen offset:3072 lds
s_add_u32 m0, s47, 0x18000
s_add_u32 s52, s51, 11
v_mfma_f32_16x16x32_bf16 v[200:203], a[120:123], v[100:103], v[200:203]
s_and_b32 s52, s52, 7
s_or_b32 s52, s52, 8
s_lshl_b32 s49, s52, 7
s_add_u32 s49, s49, s42
v_mfma_f32_16x16x32_bf16 v[208:211], a[120:123], v[104:107], v[208:211]
s_waitcnt vmcnt(18) lgkmcnt(0)
s_barrier
v_mfma_f32_16x16x32_bf16 v[212:215], a[124:127], v[104:107], v[212:215]
ds_read_b64_tr_b16 a[96:97], v16 offset:0
ds_read_b64_tr_b16 a[98:99], v16 offset:4096
v_fma_f32 v42, v42, v114, v114
v_fma_f32 v43, v43, v114, v114
v_mfma_f32_16x16x32_bf16 v[220:223], a[124:127], v[108:111], v[220:223]
buffer_load_dwordx4 v2, s[16:19], s49 offen offset:0 lds
ds_read_b64_tr_b16 a[100:101], v17 offset:0
ds_read_b64_tr_b16 a[102:103], v17 offset:4096
v_mfma_f32_16x16x32_bf16 v[216:219], a[120:123], v[108:111], v[216:219]
ds_read_b128 v[80:83], v10 offset:0
v_rcp_f32_e64 v40, v40
v_mfma_f32_16x16x32_bf16 v[224:227], a[120:123], v[64:67], v[224:227]
buffer_load_dword v126, v121, s[84:87], s88 offen
ds_read_b128 v[84:87], v10 offset:2048
v_mfma_f32_16x16x32_bf16 v[228:231], a[124:127], v[64:67], v[228:231]
ds_read_b128 v[88:91], v10 offset:4096
v_rcp_f32_e64 v41, v41
v_mfma_f32_16x16x32_bf16 v[236:239], a[124:127], v[68:71], v[236:239]
buffer_load_dwordx4 v3, s[16:19], s49 offen offset:1024 lds
ds_read_b128 v[92:95], v10 offset:6144
v_mfma_f32_16x16x32_bf16 v[232:235], a[120:123], v[68:71], v[232:235]
ds_read_b128 v[96:99], v10 offset:8192
v_rcp_f32_e64 v42, v42
v_mfma_f32_16x16x32_bf16 v[240:243], a[120:123], v[72:75], v[240:243]
ds_read_b128 v[100:103], v10 offset:10240
v_rcp_f32 v43, v43
v_mul_f32 v40, v180, v40
v_mfma_f32_16x16x32_bf16 v[244:247], a[124:127], v[72:75], v[244:247]
ds_read_b128 v[104:107], v10 offset:12288
v_mul_f32 v41, v181, v41
v_mul_f32 v42, v182, v42
v_mul_f32_e64 v43, v183, v43
v_mfma_f32_16x16x32_bf16 v[252:255], a[124:127], v[76:79], v[252:255]
buffer_load_dwordx4 v4, s[16:19], s49 offen offset:2048 lds
ds_read_b128 v[108:111], v10 offset:14336
v_cvt_pk_bf16_f32 v50, v40, v41
v_mfma_f32_16x16x32_bf16 v[248:251], a[120:123], v[76:79], v[248:251]
ds_read_b64_tr_b16 a[104:105], v16 offset:8192
ds_read_b64_tr_b16 a[106:107], v16 offset:12288
v_cvt_pk_bf16_f32 v51, v42, v43
s_waitcnt lgkmcnt(7)
v_mfma_f32_16x16x32_bf16 v[192:195], a[128:131], v[80:83], v[192:195]
buffer_store_dwordx4 v[48:51], v20, s[24:27], s44 offen offset:0 sc1
ds_read_b64_tr_b16 a[108:109], v17 offset:8192
ds_read_b64_tr_b16 a[110:111], v17 offset:12288
ds_read_b128 v[112:115], v22 offset:4112
v_mfma_f32_16x16x32_bf16 v[196:199], a[132:135], v[80:83], v[196:199]
ds_read_b128 v[64:67], v11 offset:0
v_mul_f32 v36, v184, v184
v_mul_f32 v37, v185, v185
v_mul_f32 v38, v186, v186
v_mfma_f32_16x16x32_bf16 v[204:207], a[132:135], v[84:87], v[204:207]
buffer_load_dwordx4 v5, s[16:19], s49 offen offset:3072 lds
ds_read_b128 v[68:71], v11 offset:2048
s_add_u32 m0, s47, 0x1c000
v_mfma_f32_16x16x32_bf16 v[200:203], a[128:131], v[84:87], v[200:203]
ds_read_b128 v[72:75], v11 offset:4096
s_add_u32 s4, s4, 0x20000
v_mul_f32_e64 v39, v187, v187
v_fma_f32 v36, v36, v116, v117
v_mfma_f32_16x16x32_bf16 v[208:211], a[128:131], v[88:91], v[208:211]
ds_read_b128 v[76:79], v11 offset:6144
v_fma_f32 v37, v37, v116, v117
v_fma_f32 v38, v38, v116, v117
v_fma_f32 v39, v39, v116, v117
v_mfma_f32_16x16x32_bf16 v[212:215], a[132:135], v[88:91], v[212:215]
v_mul_f32 v36, v184, v36
v_mul_f32 v37, v185, v37
v_mul_f32 v38, v186, v38
s_waitcnt lgkmcnt(7)
v_mfma_f32_16x16x32_bf16 v[220:223], a[132:135], v[92:95], v[220:223]
buffer_load_dwordx4 v122, s[84:87], s4 offen offset:0 lds
ds_read_b128 v[80:83], v11 offset:8192
v_mul_f32_e64 v39, v187, v39
v_mfma_f32_16x16x32_bf16 v[216:219], a[128:131], v[92:95], v[216:219]
v_exp_f32 v36, v36
v_exp_f32 v37, v37
v_mfma_f32_16x16x32_bf16 v[224:227], a[128:131], v[96:99], v[224:227]
ds_read_b128 v[84:87], v11 offset:10240
v_exp_f32_e64 v38, v38
v_mfma_f32_16x16x32_bf16 v[228:231], a[132:135], v[96:99], v[228:231]
v_exp_f32_e64 v39, v39
v_fma_f32 v36, v36, v118, v118
v_fma_f32 v37, v37, v118, v118
v_mfma_f32_16x16x32_bf16 v[236:239], a[132:135], v[100:103], v[236:239]
buffer_load_dwordx4 v123, s[84:87], s4 offen offset:1024 lds
ds_read_b128 v[88:91], v11 offset:12288
v_fma_f32 v38, v38, v118, v118
v_mfma_f32_16x16x32_bf16 v[232:235], a[128:131], v[100:103], v[232:235]
v_fma_f32 v39, v39, v118, v118
v_rcp_f32_e64 v36, v36
v_mfma_f32_16x16x32_bf16 v[240:243], a[128:131], v[104:107], v[240:243]
ds_read_b128 v[92:95], v11 offset:14336
v_rcp_f32_e64 v37, v37
v_mfma_f32_16x16x32_bf16 v[244:247], a[132:135], v[104:107], v[244:247]
v_rcp_f32 v38, v38
v_rcp_f32 v39, v39
v_mfma_f32_16x16x32_bf16 v[252:255], a[132:135], v[108:111], v[252:255]
buffer_load_dwordx4 v124, s[84:87], s4 offen offset:2048 lds
v_mul_f32 v36, v184, v36
v_mul_f32 v37, v185, v37
v_mfma_f32_16x16x32_bf16 v[248:251], a[128:131], v[108:111], v[248:251]
v_mul_f32_e64 v38, v186, v38
v_mul_f32 v39, v187, v39
v_cvt_pk_bf16_f32 v52, v36, v37
s_waitcnt lgkmcnt(2)
v_mfma_f32_16x16x32_bf16 v[192:195], a[136:139], v[64:67], v[192:195]
v_cvt_pk_bf16_f32 v53, v38, v39
v_mul_f32 v40, v188, v188
v_mul_f32 v41, v189, v189
v_mul_f32_e64 v42, v190, v190
v_mfma_f32_16x16x32_bf16 v[196:199], a[140:143], v[64:67], v[196:199]
v_mul_f32_e64 v43, v191, v191
v_fma_f32 v40, v40, v116, v117
v_fma_f32 v41, v41, v116, v117
v_fma_f32 v42, v42, v116, v117
v_mfma_f32_16x16x32_bf16 v[204:207], a[140:143], v[68:71], v[204:207]
buffer_load_dwordx4 v125, s[84:87], s4 offen offset:3072 lds
s_add_u32 m0, s47, 0x0
s_add_u32 s52, s51, 12
v_mfma_f32_16x16x32_bf16 v[200:203], a[136:139], v[68:71], v[200:203]
s_and_b32 s52, s52, 7
s_or_b32 s52, s52, 8
s_lshl_b32 s49, s52, 7
s_add_u32 s49, s49, s42
v_mfma_f32_16x16x32_bf16 v[208:211], a[136:139], v[72:75], v[208:211]
s_waitcnt vmcnt(19) lgkmcnt(0)
s_barrier
v_mfma_f32_16x16x32_bf16 v[212:215], a[140:143], v[72:75], v[212:215]
ds_read_b64_tr_b16 a[112:113], v16 offset:32768
ds_read_b64_tr_b16 a[114:115], v16 offset:36864
v_fma_f32 v43, v43, v116, v117
v_mul_f32_e64 v40, v188, v40
v_mfma_f32_16x16x32_bf16 v[220:223], a[140:143], v[76:79], v[220:223]
buffer_load_dwordx4 v2, s[16:19], s49 offen offset:0 lds
ds_read_b64_tr_b16 a[116:117], v17 offset:32768
ds_read_b64_tr_b16 a[118:119], v17 offset:36864
v_mfma_f32_16x16x32_bf16 v[216:219], a[136:139], v[76:79], v[216:219]
ds_read_b128 v[96:99], v10 offset:32768
v_mul_f32 v41, v189, v41
v_mul_f32 v42, v190, v42
v_mul_f32_e64 v43, v191, v43
v_mfma_f32_16x16x32_bf16 v[224:227], a[136:139], v[80:83], v[224:227]
ds_read_b128 v[100:103], v10 offset:34816
v_exp_f32_e64 v40, v40
v_mfma_f32_16x16x32_bf16 v[228:231], a[140:143], v[80:83], v[228:231]
ds_read_b128 v[104:107], v10 offset:36864
v_exp_f32_e64 v41, v41
v_mfma_f32_16x16x32_bf16 v[236:239], a[140:143], v[84:87], v[236:239]
buffer_load_dwordx4 v3, s[16:19], s49 offen offset:1024 lds
ds_read_b128 v[108:111], v10 offset:38912
v_mfma_f32_16x16x32_bf16 v[232:235], a[136:139], v[84:87], v[232:235]
ds_read_b128 v[64:67], v10 offset:40960
v_exp_f32_e64 v42, v42
v_mfma_f32_16x16x32_bf16 v[240:243], a[136:139], v[88:91], v[240:243]
ds_read_b128 v[68:71], v10 offset:43008
v_exp_f32_e64 v43, v43
v_fma_f32 v40, v40, v118, v118
v_mfma_f32_16x16x32_bf16 v[244:247], a[140:143], v[88:91], v[244:247]
ds_read_b128 v[72:75], v10 offset:45056
v_fma_f32 v41, v41, v118, v118
v_fma_f32 v42, v42, v118, v118
v_fma_f32 v43, v43, v118, v118
v_mfma_f32_16x16x32_bf16 v[252:255], a[140:143], v[92:95], v[252:255]
buffer_load_dwordx4 v4, s[16:19], s49 offen offset:2048 lds
ds_read_b128 v[76:79], v10 offset:47104
v_mfma_f32_16x16x32_bf16 v[248:251], a[136:139], v[92:95], v[248:251]
ds_read_b64_tr_b16 a[120:121], v16 offset:40960
ds_read_b64_tr_b16 a[122:123], v16 offset:45056
s_waitcnt lgkmcnt(7)
v_mfma_f32_16x16x32_bf16 v[192:195], a[144:147], v[96:99], v[192:195]
ds_read_b64_tr_b16 a[124:125], v17 offset:40960
ds_read_b64_tr_b16 a[126:127], v17 offset:45056
v_rcp_f32 v40, v40
v_mfma_f32_16x16x32_bf16 v[196:199], a[148:151], v[96:99], v[196:199]
ds_read_b128 v[80:83], v11 offset:32768
v_rcp_f32_e64 v41, v41
v_mfma_f32_16x16x32_bf16 v[204:207], a[148:151], v[100:103], v[204:207]
buffer_load_dwordx4 v5, s[16:19], s49 offen offset:3072 lds
ds_read_b128 v[84:87], v11 offset:34816
s_add_u32 m0, s47, 0x4000
v_mfma_f32_16x16x32_bf16 v[200:203], a[144:147], v[100:103], v[200:203]
ds_read_b128 v[88:91], v11 offset:36864
s_add_u32 s4, s4, 0x20000
s_sub_u32 s50, s4, 1835008
s_min_u32 s4, s4, s50
v_mfma_f32_16x16x32_bf16 v[208:211], a[144:147], v[104:107], v[208:211]
ds_read_b128 v[92:95], v11 offset:38912
v_rcp_f32 v42, v42
v_mfma_f32_16x16x32_bf16 v[212:215], a[148:151], v[104:107], v[212:215]
v_rcp_f32_e64 v43, v43
v_mul_f32 v40, v188, v40
s_waitcnt lgkmcnt(6)
v_mfma_f32_16x16x32_bf16 v[220:223], a[148:151], v[108:111], v[220:223]
buffer_load_dwordx4 v122, s[84:87], s4 offen offset:0 lds
ds_read_b128 v[96:99], v11 offset:40960
v_mul_f32_e64 v41, v189, v41
v_mfma_f32_16x16x32_bf16 v[216:219], a[144:147], v[108:111], v[216:219]
v_mul_f32 v42, v190, v42
v_mul_f32 v43, v191, v43
v_cvt_pk_bf16_f32 v54, v40, v41
v_cvt_pk_bf16_f32 v55, v42, v43
v_mfma_f32_16x16x32_bf16 v[224:227], a[144:147], v[64:67], v[224:227]
buffer_store_dwordx4 v[52:55], v20, s[24:27], s44 offen offset:1024 sc1
ds_read_b128 v[100:103], v11 offset:43008
s_add_u32 s44, s44, 57344
v_mfma_f32_16x16x32_bf16 v[228:231], a[148:151], v[64:67], v[228:231]
v_mfma_f32_16x16x32_bf16 v[236:239], a[148:151], v[68:71], v[236:239]
buffer_load_dwordx4 v123, s[84:87], s4 offen offset:1024 lds
ds_read_b128 v[104:107], v11 offset:45056
v_mfma_f32_16x16x32_bf16 v[232:235], a[144:147], v[68:71], v[232:235]
v_mfma_f32_16x16x32_bf16 v[240:243], a[144:147], v[72:75], v[240:243]
ds_read_b128 v[108:111], v11 offset:47104
v_mfma_f32_16x16x32_bf16 v[244:247], a[148:151], v[72:75], v[244:247]
v_mfma_f32_16x16x32_bf16 v[252:255], a[148:151], v[76:79], v[252:255]
buffer_load_dwordx4 v124, s[84:87], s4 offen offset:2048 lds
v_mfma_f32_16x16x32_bf16 v[248:251], a[144:147], v[76:79], v[248:251]
s_waitcnt lgkmcnt(2)
v_mfma_f32_16x16x32_bf16 v[192:195], a[152:155], v[80:83], v[192:195]
v_mfma_f32_16x16x32_bf16 v[196:199], a[156:159], v[80:83], v[196:199]
v_mfma_f32_16x16x32_bf16 v[204:207], a[156:159], v[84:87], v[204:207]
buffer_load_dwordx4 v125, s[84:87], s4 offen offset:3072 lds
s_add_u32 m0, s47, 0x8000
s_add_u32 s52, s51, 13
v_mfma_f32_16x16x32_bf16 v[200:203], a[152:155], v[84:87], v[200:203]
s_and_b32 s52, s52, 7
s_or_b32 s52, s52, 8
s_lshl_b32 s49, s52, 7
s_add_u32 s49, s49, s42
v_mfma_f32_16x16x32_bf16 v[208:211], a[152:155], v[88:91], v[208:211]
s_waitcnt vmcnt(19) lgkmcnt(0)
s_barrier
v_mfma_f32_16x16x32_bf16 v[212:215], a[156:159], v[88:91], v[212:215]
ds_read_b64_tr_b16 a[128:129], v18 offset:0
ds_read_b64_tr_b16 a[130:131], v18 offset:4096
v_mfma_f32_16x16x32_bf16 v[220:223], a[156:159], v[92:95], v[220:223]
buffer_load_dwordx4 v2, s[16:19], s49 offen offset:0 lds
ds_read_b64_tr_b16 a[132:133], v19 offset:0
ds_read_b64_tr_b16 a[134:135], v19 offset:4096
v_mfma_f32_16x16x32_bf16 v[216:219], a[152:155], v[92:95], v[216:219]
ds_read_b128 v[64:67], v12 offset:0
v_mfma_f32_16x16x32_bf16 v[224:227], a[152:155], v[96:99], v[224:227]
ds_read_b128 v[68:71], v12 offset:2048
v_mfma_f32_16x16x32_bf16 v[228:231], a[156:159], v[96:99], v[228:231]
ds_read_b128 v[72:75], v12 offset:4096
v_mfma_f32_16x16x32_bf16 v[236:239], a[156:159], v[100:103], v[236:239]
buffer_load_dwordx4 v3, s[16:19], s49 offen offset:1024 lds
ds_read_b128 v[76:79], v12 offset:6144
v_mfma_f32_16x16x32_bf16 v[232:235], a[152:155], v[100:103], v[232:235]
ds_read_b128 v[80:83], v12 offset:8192
v_mfma_f32_16x16x32_bf16 v[240:243], a[152:155], v[104:107], v[240:243]
ds_read_b128 v[84:87], v12 offset:10240
v_mfma_f32_16x16x32_bf16 v[244:247], a[156:159], v[104:107], v[244:247]
ds_read_b128 v[88:91], v12 offset:12288
v_mfma_f32_16x16x32_bf16 v[252:255], a[156:159], v[108:111], v[252:255]
buffer_load_dwordx4 v4, s[16:19], s49 offen offset:2048 lds
ds_read_b128 v[92:95], v12 offset:14336
v_mfma_f32_16x16x32_bf16 v[248:251], a[152:155], v[108:111], v[248:251]
ds_read_b64_tr_b16 a[136:137], v18 offset:8192
ds_read_b64_tr_b16 a[138:139], v18 offset:12288
s_waitcnt lgkmcnt(7)
v_mfma_f32_16x16x32_bf16 v[192:195], a[160:163], v[64:67], v[192:195]
ds_read_b64_tr_b16 a[140:141], v19 offset:8192
ds_read_b64_tr_b16 a[142:143], v19 offset:12288
v_mfma_f32_16x16x32_bf16 v[196:199], a[164:167], v[64:67], v[196:199]
ds_read_b128 v[96:99], v13 offset:0
v_mfma_f32_16x16x32_bf16 v[204:207], a[164:167], v[68:71], v[204:207]
buffer_load_dwordx4 v5, s[16:19], s49 offen offset:3072 lds
ds_read_b128 v[100:103], v13 offset:2048
s_add_u32 m0, s47, 0xc000
v_mfma_f32_16x16x32_bf16 v[200:203], a[160:163], v[68:71], v[200:203]
ds_read_b128 v[104:107], v13 offset:4096
s_add_u32 s4, s4, 0x20000
v_mfma_f32_16x16x32_bf16 v[208:211], a[160:163], v[72:75], v[208:211]
ds_read_b128 v[108:111], v13 offset:6144
v_mfma_f32_16x16x32_bf16 v[212:215], a[164:167], v[72:75], v[212:215]
s_waitcnt lgkmcnt(6)
v_mfma_f32_16x16x32_bf16 v[220:223], a[164:167], v[76:79], v[220:223]
buffer_load_dwordx4 v122, s[84:87], s4 offen offset:0 lds
ds_read_b128 v[64:67], v13 offset:8192
v_mfma_f32_16x16x32_bf16 v[216:219], a[160:163], v[76:79], v[216:219]
v_mfma_f32_16x16x32_bf16 v[224:227], a[160:163], v[80:83], v[224:227]
ds_read_b128 v[68:71], v13 offset:10240
v_mfma_f32_16x16x32_bf16 v[228:231], a[164:167], v[80:83], v[228:231]
v_mfma_f32_16x16x32_bf16 v[236:239], a[164:167], v[84:87], v[236:239]
buffer_load_dwordx4 v123, s[84:87], s4 offen offset:1024 lds
ds_read_b128 v[72:75], v13 offset:12288
v_mfma_f32_16x16x32_bf16 v[232:235], a[160:163], v[84:87], v[232:235]
v_mfma_f32_16x16x32_bf16 v[240:243], a[160:163], v[88:91], v[240:243]
ds_read_b128 v[76:79], v13 offset:14336
v_mfma_f32_16x16x32_bf16 v[244:247], a[164:167], v[88:91], v[244:247]
v_mfma_f32_16x16x32_bf16 v[252:255], a[164:167], v[92:95], v[252:255]
buffer_load_dwordx4 v124, s[84:87], s4 offen offset:2048 lds
v_mfma_f32_16x16x32_bf16 v[248:251], a[160:163], v[92:95], v[248:251]
s_waitcnt lgkmcnt(2)
v_mfma_f32_16x16x32_bf16 v[192:195], a[168:171], v[96:99], v[192:195]
v_mfma_f32_16x16x32_bf16 v[196:199], a[172:175], v[96:99], v[196:199]
v_mfma_f32_16x16x32_bf16 v[204:207], a[172:175], v[100:103], v[204:207]
buffer_load_dwordx4 v125, s[84:87], s4 offen offset:3072 lds
s_add_u32 m0, s47, 0x10000
s_add_u32 s52, s51, 14
v_mfma_f32_16x16x32_bf16 v[200:203], a[168:171], v[100:103], v[200:203]
s_and_b32 s52, s52, 7
s_or_b32 s52, s52, 8
s_lshl_b32 s49, s52, 7
s_add_u32 s49, s49, s42
v_mfma_f32_16x16x32_bf16 v[208:211], a[168:171], v[104:107], v[208:211]
s_waitcnt vmcnt(17) lgkmcnt(0)
s_barrier
v_mfma_f32_16x16x32_bf16 v[212:215], a[172:175], v[104:107], v[212:215]
ds_read_b64_tr_b16 a[144:145], v18 offset:32768
ds_read_b64_tr_b16 a[146:147], v18 offset:36864
v_mfma_f32_16x16x32_bf16 v[220:223], a[172:175], v[108:111], v[220:223]
buffer_load_dwordx4 v2, s[16:19], s49 offen offset:0 lds
ds_read_b64_tr_b16 a[148:149], v19 offset:32768
ds_read_b64_tr_b16 a[150:151], v19 offset:36864
v_mfma_f32_16x16x32_bf16 v[216:219], a[168:171], v[108:111], v[216:219]
ds_read_b128 v[80:83], v12 offset:32768
v_mfma_f32_16x16x32_bf16 v[224:227], a[168:171], v[64:67], v[224:227]
ds_read_b128 v[84:87], v12 offset:34816
s_waitcnt vmcnt(12)
v_mfma_f32_16x16x32_bf16 v[228:231], a[172:175], v[64:67], v[228:231]
buffer_store_dword v56, v57, s[24:27], s63 offen offset:128 sc1
ds_read_b128 v[88:91], v12 offset:36864
v_mfma_f32_16x16x32_bf16 v[236:239], a[172:175], v[68:71], v[236:239]
buffer_load_dwordx4 v3, s[16:19], s49 offen offset:1024 lds
ds_read_b128 v[92:95], v12 offset:38912
v_mfma_f32_16x16x32_bf16 v[232:235], a[168:171], v[68:71], v[232:235]
ds_read_b128 v[96:99], v12 offset:40960
v_mfma_f32_16x16x32_bf16 v[240:243], a[168:171], v[72:75], v[240:243]
ds_read_b128 v[100:103], v12 offset:43008
v_mfma_f32_16x16x32_bf16 v[244:247], a[172:175], v[72:75], v[244:247]
ds_read_b128 v[104:107], v12 offset:45056
v_mfma_f32_16x16x32_bf16 v[252:255], a[172:175], v[76:79], v[252:255]
buffer_load_dwordx4 v4, s[16:19], s49 offen offset:2048 lds
ds_read_b128 v[108:111], v12 offset:47104
v_mfma_f32_16x16x32_bf16 v[248:251], a[168:171], v[76:79], v[248:251]
ds_read_b64_tr_b16 a[152:153], v18 offset:40960
ds_read_b64_tr_b16 a[154:155], v18 offset:45056
s_waitcnt lgkmcnt(7)
v_mfma_f32_16x16x32_bf16 v[192:195], a[176:179], v[80:83], v[192:195]
ds_read_b64_tr_b16 a[156:157], v19 offset:40960
ds_read_b64_tr_b16 a[158:159], v19 offset:45056
v_mfma_f32_16x16x32_bf16 v[196:199], a[180:183], v[80:83], v[196:199]
ds_read_b128 v[64:67], v13 offset:32768
v_mfma_f32_16x16x32_bf16 v[204:207], a[180:183], v[84:87], v[204:207]
buffer_load_dwordx4 v5, s[16:19], s49 offen offset:3072 lds
ds_read_b128 v[68:71], v13 offset:34816
s_add_u32 m0, s47, 0x14000
v_mfma_f32_16x16x32_bf16 v[200:203], a[176:179], v[84:87], v[200:203]
ds_read_b128 v[72:75], v13 offset:36864
s_add_u32 s4, s4, 0x20000
s_sub_u32 s50, s4, 1835008
s_min_u32 s4, s4, s50
v_mfma_f32_16x16x32_bf16 v[208:211], a[176:179], v[88:91], v[208:211]
ds_read_b128 v[76:79], v13 offset:38912
v_mfma_f32_16x16x32_bf16 v[212:215], a[180:183], v[88:91], v[212:215]
s_waitcnt lgkmcnt(6)
v_mfma_f32_16x16x32_bf16 v[220:223], a[180:183], v[92:95], v[220:223]
buffer_load_dword v23, v1, s[24:27], s59 offen offset:0 sc1
ds_read_b128 v[80:83], v13 offset:40960
v_mfma_f32_16x16x32_bf16 v[216:219], a[176:179], v[92:95], v[216:219]
v_mfma_f32_16x16x32_bf16 v[224:227], a[176:179], v[96:99], v[224:227]
buffer_load_dwordx4 v122, s[84:87], s4 offen offset:0 lds
ds_read_b128 v[84:87], v13 offset:43008
v_mfma_f32_16x16x32_bf16 v[228:231], a[180:183], v[96:99], v[228:231]
v_mfma_f32_16x16x32_bf16 v[236:239], a[180:183], v[100:103], v[236:239]
buffer_load_dwordx4 v123, s[84:87], s4 offen offset:1024 lds
ds_read_b128 v[88:91], v13 offset:45056
v_mfma_f32_16x16x32_bf16 v[232:235], a[176:179], v[100:103], v[232:235]
v_mfma_f32_16x16x32_bf16 v[240:243], a[176:179], v[104:107], v[240:243]
ds_read_b128 v[92:95], v13 offset:47104
v_mfma_f32_16x16x32_bf16 v[244:247], a[180:183], v[104:107], v[244:247]
v_mfma_f32_16x16x32_bf16 v[252:255], a[180:183], v[108:111], v[252:255]
buffer_load_dwordx4 v124, s[84:87], s4 offen offset:2048 lds
v_mfma_f32_16x16x32_bf16 v[248:251], a[176:179], v[108:111], v[248:251]
s_waitcnt lgkmcnt(2)
v_mfma_f32_16x16x32_bf16 v[192:195], a[184:187], v[64:67], v[192:195]
v_mfma_f32_16x16x32_bf16 v[196:199], a[188:191], v[64:67], v[196:199]
v_mfma_f32_16x16x32_bf16 v[204:207], a[188:191], v[68:71], v[204:207]
buffer_load_dwordx4 v125, s[84:87], s4 offen offset:3072 lds
s_add_u32 m0, s47, 0x18000
s_add_u32 s52, s51, 15
v_mfma_f32_16x16x32_bf16 v[200:203], a[184:187], v[68:71], v[200:203]
s_and_b32 s52, s52, 7
s_or_b32 s52, s52, 8
s_lshl_b32 s49, s52, 7
s_add_u32 s49, s49, s42
v_mfma_f32_16x16x32_bf16 v[208:211], a[184:187], v[72:75], v[208:211]
s_waitcnt vmcnt(18) lgkmcnt(0)
s_barrier
v_mfma_f32_16x16x32_bf16 v[212:215], a[188:191], v[72:75], v[212:215]
ds_read_b64_tr_b16 a[160:161], v16 offset:0
ds_read_b64_tr_b16 a[162:163], v16 offset:4096
v_mfma_f32_16x16x32_bf16 v[220:223], a[188:191], v[76:79], v[220:223]
buffer_load_dwordx4 v2, s[16:19], s49 offen offset:0 lds
ds_read_b64_tr_b16 a[164:165], v17 offset:0
ds_read_b64_tr_b16 a[166:167], v17 offset:4096
v_mfma_f32_16x16x32_bf16 v[216:219], a[184:187], v[76:79], v[216:219]
ds_read_b128 v[96:99], v10 offset:0
v_mfma_f32_16x16x32_bf16 v[224:227], a[184:187], v[80:83], v[224:227]
ds_read_b128 v[100:103], v10 offset:2048
v_mfma_f32_16x16x32_bf16 v[228:231], a[188:191], v[80:83], v[228:231]
ds_read_b128 v[104:107], v10 offset:4096
v_mfma_f32_16x16x32_bf16 v[236:239], a[188:191], v[84:87], v[236:239]
buffer_load_dwordx4 v3, s[16:19], s49 offen offset:1024 lds
ds_read_b128 v[108:111], v10 offset:6144
v_mfma_f32_16x16x32_bf16 v[232:235], a[184:187], v[84:87], v[232:235]
ds_read_b128 v[64:67], v10 offset:8192
v_mfma_f32_16x16x32_bf16 v[240:243], a[184:187], v[88:91], v[240:243]
ds_read_b128 v[68:71], v10 offset:10240
v_mfma_f32_16x16x32_bf16 v[244:247], a[188:191], v[88:91], v[244:247]
ds_read_b128 v[72:75], v10 offset:12288
v_mfma_f32_16x16x32_bf16 v[252:255], a[188:191], v[92:95], v[252:255]
buffer_load_dwordx4 v4, s[16:19], s49 offen offset:2048 lds
ds_read_b128 v[76:79], v10 offset:14336
v_mfma_f32_16x16x32_bf16 v[248:251], a[184:187], v[92:95], v[248:251]
ds_read_b64_tr_b16 a[168:169], v16 offset:8192
ds_read_b64_tr_b16 a[170:171], v16 offset:12288
s_waitcnt lgkmcnt(7)
v_mfma_f32_16x16x32_bf16 v[192:195], a[192:195], v[96:99], v[192:195]
ds_read_b64_tr_b16 a[172:173], v17 offset:8192
ds_read_b64_tr_b16 a[174:175], v17 offset:12288
v_mfma_f32_16x16x32_bf16 v[196:199], a[196:199], v[96:99], v[196:199]
ds_read_b128 v[80:83], v11 offset:0
v_mfma_f32_16x16x32_bf16 v[204:207], a[196:199], v[100:103], v[204:207]
buffer_load_dwordx4 v5, s[16:19], s49 offen offset:3072 lds
ds_read_b128 v[84:87], v11 offset:2048
s_add_u32 m0, s47, 0x1c000
v_mfma_f32_16x16x32_bf16 v[200:203], a[192:195], v[100:103], v[200:203]
ds_read_b128 v[88:91], v11 offset:4096
s_add_u32 s4, s4, 0x20000
v_mfma_f32_16x16x32_bf16 v[208:211], a[192:195], v[104:107], v[208:211]
ds_read_b128 v[92:95], v11 offset:6144
v_mfma_f32_16x16x32_bf16 v[212:215], a[196:199], v[104:107], v[212:215]
s_waitcnt lgkmcnt(6)
v_mfma_f32_16x16x32_bf16 v[220:223], a[196:199], v[108:111], v[220:223]
buffer_load_dwordx4 v122, s[84:87], s4 offen offset:0 lds
ds_read_b128 v[96:99], v11 offset:8192
v_mfma_f32_16x16x32_bf16 v[216:219], a[192:195], v[108:111], v[216:219]
v_mfma_f32_16x16x32_bf16 v[224:227], a[192:195], v[64:67], v[224:227]
ds_read_b128 v[100:103], v11 offset:10240
v_mfma_f32_16x16x32_bf16 v[228:231], a[196:199], v[64:67], v[228:231]
v_mfma_f32_16x16x32_bf16 v[236:239], a[196:199], v[68:71], v[236:239]
buffer_load_dwordx4 v123, s[84:87], s4 offen offset:1024 lds
ds_read_b128 v[104:107], v11 offset:12288
v_mfma_f32_16x16x32_bf16 v[232:235], a[192:195], v[68:71], v[232:235]
v_mfma_f32_16x16x32_bf16 v[240:243], a[192:195], v[72:75], v[240:243]
ds_read_b128 v[108:111], v11 offset:14336
v_mfma_f32_16x16x32_bf16 v[244:247], a[196:199], v[72:75], v[244:247]
v_mfma_f32_16x16x32_bf16 v[252:255], a[196:199], v[76:79], v[252:255]
buffer_load_dwordx4 v124, s[84:87], s4 offen offset:2048 lds
v_mfma_f32_16x16x32_bf16 v[248:251], a[192:195], v[76:79], v[248:251]
s_waitcnt vmcnt(11)
v_cmp_ne_u32 vcc, s53, v23
s_cbranch_vccnz L_spin1
L_back1:
s_waitcnt lgkmcnt(2)
v_mfma_f32_16x16x32_bf16 v[192:195], a[200:203], v[80:83], v[192:195]
v_mfma_f32_16x16x32_bf16 v[196:199], a[204:207], v[80:83], v[196:199]
v_mfma_f32_16x16x32_bf16 v[204:207], a[204:207], v[84:87], v[204:207]
buffer_load_dwordx4 v125, s[84:87], s4 offen offset:3072 lds
s_add_u32 m0, s48, 0x0
s_add_u32 s49, s55, 0
v_mfma_f32_16x16x32_bf16 v[200:203], a[200:203], v[84:87], v[200:203]
v_mfma_f32_16x16x32_bf16 v[208:211], a[200:203], v[88:91], v[208:211]
s_waitcnt lgkmcnt(0)
s_barrier
v_mfma_f32_16x16x32_bf16 v[212:215], a[204:207], v[88:91], v[212:215]
ds_read_b64_tr_b16 a[176:177], v16 offset:32768
ds_read_b64_tr_b16 a[178:179], v16 offset:36864
v_mfma_f32_16x16x32_bf16 v[220:223], a[204:207], v[92:95], v[220:223]
buffer_load_dwordx4 v20, s[24:27], s49 offen offset:0 sc1 lds
ds_read_b64_tr_b16 a[180:181], v17 offset:32768
ds_read_b64_tr_b16 a[182:183], v17 offset:36864
v_mfma_f32_16x16x32_bf16 v[216:219], a[200:203], v[92:95], v[216:219]
ds_read_b128 v[64:67], v10 offset:32768
v_mfma_f32_16x16x32_bf16 v[224:227], a[200:203], v[96:99], v[224:227]
ds_read_b128 v[68:71], v10 offset:34816
v_mfma_f32_16x16x32_bf16 v[228:231], a[204:207], v[96:99], v[228:231]
ds_read_b128 v[72:75], v10 offset:36864
v_mfma_f32_16x16x32_bf16 v[236:239], a[204:207], v[100:103], v[236:239]
buffer_load_dwordx4 v20, s[24:27], s49 offen offset:1024 sc1 lds
ds_read_b128 v[76:79], v10 offset:38912
v_mfma_f32_16x16x32_bf16 v[232:235], a[200:203], v[100:103], v[232:235]
ds_read_b128 v[80:83], v10 offset:40960
v_mfma_f32_16x16x32_bf16 v[240:243], a[200:203], v[104:107], v[240:243]
ds_read_b128 v[84:87], v10 offset:43008
v_mfma_f32_16x16x32_bf16 v[244:247], a[204:207], v[104:107], v[244:247]
ds_read_b128 v[88:91], v10 offset:45056
v_mfma_f32_16x16x32_bf16 v[252:255], a[204:207], v[108:111], v[252:255]
buffer_load_dwordx4 v20, s[24:27], s49 offen offset:2048 sc1 lds
ds_read_b128 v[92:95], v10 offset:47104
v_mfma_f32_16x16x32_bf16 v[248:251], a[200:203], v[108:111], v[248:251]
ds_read_b64_tr_b16 a[184:185], v16 offset:40960
ds_read_b64_tr_b16 a[186:187], v16 offset:45056
s_waitcnt lgkmcnt(7)
v_mfma_f32_16x16x32_bf16 v[192:195], a[208:211], v[64:67], v[192:195]
ds_read_b64_tr_b16 a[188:189], v17 offset:40960
ds_read_b64_tr_b16 a[190:191], v17 offset:45056
v_mfma_f32_16x16x32_bf16 v[196:199], a[212:215], v[64:67], v[196:199]
ds_read_b128 v[96:99], v11 offset:32768
v_mfma_f32_16x16x32_bf16 v[204:207], a[212:215], v[68:71], v[204:207]
buffer_load_dwordx4 v20, s[24:27], s49 offen offset:3072 sc1 lds
ds_read_b128 v[100:103], v11 offset:34816
s_add_u32 m0, s48, 0x1000
v_mfma_f32_16x16x32_bf16 v[200:203], a[208:211], v[68:71], v[200:203]
ds_read_b128 v[104:107], v11 offset:36864
s_add_u32 s49, s55, 4096
v_mfma_f32_16x16x32_bf16 v[208:211], a[208:211], v[72:75], v[208:211]
ds_read_b128 v[108:111], v11 offset:38912
v_mfma_f32_16x16x32_bf16 v[212:215], a[212:215], v[72:75], v[212:215]
s_waitcnt lgkmcnt(6)
v_mfma_f32_16x16x32_bf16 v[220:223], a[212:215], v[76:79], v[220:223]
buffer_load_dwordx4 v20, s[24:27], s49 offen offset:0 sc1 lds
ds_read_b128 v[64:67], v11 offset:40960
v_mfma_f32_16x16x32_bf16 v[216:219], a[208:211], v[76:79], v[216:219]
v_mfma_f32_16x16x32_bf16 v[224:227], a[208:211], v[80:83], v[224:227]
ds_read_b128 v[68:71], v11 offset:43008
v_mfma_f32_16x16x32_bf16 v[228:231], a[212:215], v[80:83], v[228:231]
v_mfma_f32_16x16x32_bf16 v[236:239], a[212:215], v[84:87], v[236:239]
buffer_load_dwordx4 v20, s[24:27], s49 offen offset:1024 sc1 lds
ds_read_b128 v[72:75], v11 offset:45056
v_mfma_f32_16x16x32_bf16 v[232:235], a[208:211], v[84:87], v[232:235]
v_mfma_f32_16x16x32_bf16 v[240:243], a[208:211], v[88:91], v[240:243]
ds_read_b128 v[76:79], v11 offset:47104
v_mfma_f32_16x16x32_bf16 v[244:247], a[212:215], v[88:91], v[244:247]
v_mfma_f32_16x16x32_bf16 v[252:255], a[212:215], v[92:95], v[252:255]
buffer_load_dwordx4 v20, s[24:27], s49 offen offset:2048 sc1 lds
v_mfma_f32_16x16x32_bf16 v[248:251], a[208:211], v[92:95], v[248:251]
s_waitcnt lgkmcnt(2)
v_mfma_f32_16x16x32_bf16 v[192:195], a[216:219], v[96:99], v[192:195]
v_mfma_f32_16x16x32_bf16 v[196:199], a[220:223], v[96:99], v[196:199]
v_mfma_f32_16x16x32_bf16 v[204:207], a[220:223], v[100:103], v[204:207]
buffer_load_dwordx4 v20, s[24:27], s49 offen offset:3072 sc1 lds
s_add_u32 m0, s5, 0x8000
s_add_u32 s49, s56, 0
v_mfma_f32_16x16x32_bf16 v[200:203], a[216:219], v[100:103], v[200:203]
v_mfma_f32_16x16x32_bf16 v[208:211], a[216:219], v[104:107], v[208:211]
s_waitcnt vmcnt(16) lgkmcnt(0)
s_barrier
v_mfma_f32_16x16x32_bf16 v[212:215], a[220:223], v[104:107], v[212:215]
ds_read_b64_tr_b16 a[192:193], v18 offset:0
ds_read_b64_tr_b16 a[194:195], v18 offset:4096
v_mfma_f32_16x16x32_bf16 v[220:223], a[220:223], v[108:111], v[220:223]
buffer_load_dwordx4 v20, s[24:27], s49 offen offset:0 sc1 lds
ds_read_b64_tr_b16 a[196:197], v19 offset:0
ds_read_b64_tr_b16 a[198:199], v19 offset:4096
v_mfma_f32_16x16x32_bf16 v[216:219], a[216:219], v[108:111], v[216:219]
ds_read_b128 v[80:83], v12 offset:0
v_mfma_f32_16x16x32_bf16 v[224:227], a[216:219], v[64:67], v[224:227]
ds_read_b128 v[84:87], v12 offset:2048
v_mfma_f32_16x16x32_bf16 v[228:231], a[220:223], v[64:67], v[228:231]
ds_read_b128 v[88:91], v12 offset:4096
v_mfma_f32_16x16x32_bf16 v[236:239], a[220:223], v[68:71], v[236:239]
buffer_load_dwordx4 v20, s[24:27], s49 offen offset:1024 sc1 lds
ds_read_b128 v[92:95], v12 offset:6144
s_add_u32 s49, s57, 0
v_mfma_f32_16x16x32_bf16 v[232:235], a[216:219], v[68:71], v[232:235]
ds_read_b128 v[96:99], v12 offset:8192
v_mfma_f32_16x16x32_bf16 v[240:243], a[216:219], v[72:75], v[240:243]
ds_read_b128 v[100:103], v12 offset:10240
v_mfma_f32_16x16x32_bf16 v[244:247], a[220:223], v[72:75], v[244:247]
ds_read_b128 v[104:107], v12 offset:12288
v_mfma_f32_16x16x32_bf16 v[252:255], a[220:223], v[76:79], v[252:255]
buffer_load_dwordx4 v20, s[24:27], s49 offen offset:2048 sc1 lds
ds_read_b128 v[108:111], v12 offset:14336
v_mfma_f32_16x16x32_bf16 v[248:251], a[216:219], v[76:79], v[248:251]
ds_read_b64_tr_b16 a[200:201], v18 offset:8192
ds_read_b64_tr_b16 a[202:203], v18 offset:12288
s_waitcnt lgkmcnt(7)
v_mfma_f32_16x16x32_bf16 v[192:195], a[224:227], v[80:83], v[192:195]
ds_read_b64_tr_b16 a[204:205], v19 offset:8192
ds_read_b64_tr_b16 a[206:207], v19 offset:12288
v_mfma_f32_16x16x32_bf16 v[196:199], a[228:231], v[80:83], v[196:199]
ds_read_b128 v[64:67], v13 offset:0
v_mfma_f32_16x16x32_bf16 v[204:207], a[228:231], v[84:87], v[204:207]
buffer_load_dwordx4 v20, s[24:27], s49 offen offset:3072 sc1 lds
ds_read_b128 v[68:71], v13 offset:2048
s_add_u32 m0, s5, 0x9000
v_mfma_f32_16x16x32_bf16 v[200:203], a[224:227], v[84:87], v[200:203]
ds_read_b128 v[72:75], v13 offset:4096
s_add_u32 s49, s58, 0
v_mfma_f32_16x16x32_bf16 v[208:211], a[224:227], v[88:91], v[208:211]
ds_read_b128 v[76:79], v13 offset:6144
v_mfma_f32_16x16x32_bf16 v[212:215], a[228:231], v[88:91], v[212:215]
s_waitcnt lgkmcnt(6)
v_mfma_f32_16x16x32_bf16 v[220:223], a[228:231], v[92:95], v[220:223]
buffer_load_dwordx4 v20, s[24:27], s49 offen offset:0 sc1 lds
ds_read_b128 v[80:83], v13 offset:8192
v_mfma_f32_16x16x32_bf16 v[216:219], a[224:227], v[92:95], v[216:219]
v_mfma_f32_16x16x32_bf16 v[224:227], a[224:227], v[96:99], v[224:227]
ds_read_b128 v[84:87], v13 offset:10240
v_mfma_f32_16x16x32_bf16 v[228:231], a[228:231], v[96:99], v[228:231]
v_mfma_f32_16x16x32_bf16 v[236:239], a[228:231], v[100:103], v[236:239]
buffer_load_dwordx4 v20, s[24:27], s49 offen offset:1024 sc1 lds
ds_read_b128 v[88:91], v13 offset:12288
s_add_u32 m0, s48, 0x10000
v_mfma_f32_16x16x32_bf16 v[232:235], a[224:227], v[100:103], v[232:235]
s_add_u32 s49, s55, 57344
v_mfma_f32_16x16x32_bf16 v[240:243], a[224:227], v[104:107], v[240:243]
ds_read_b128 v[92:95], v13 offset:14336
v_mfma_f32_16x16x32_bf16 v[244:247], a[228:231], v[104:107], v[244:247]
v_mfma_f32_16x16x32_bf16 v[252:255], a[228:231], v[108:111], v[252:255]
v_mfma_f32_16x16x32_bf16 v[248:251], a[224:227], v[108:111], v[248:251]
s_waitcnt lgkmcnt(2)
v_mfma_f32_16x16x32_bf16 v[192:195], a[232:235], v[64:67], v[192:195]
v_mfma_f32_16x16x32_bf16 v[196:199], a[236:239], v[64:67], v[196:199]
v_mfma_f32_16x16x32_bf16 v[204:207], a[236:239], v[68:71], v[204:207]
v_mfma_f32_16x16x32_bf16 v[200:203], a[232:235], v[68:71], v[200:203]
v_mfma_f32_16x16x32_bf16 v[208:211], a[232:235], v[72:75], v[208:211]
s_waitcnt vmcnt(14) lgkmcnt(0)
s_barrier
v_mfma_f32_16x16x32_bf16 v[212:215], a[236:239], v[72:75], v[212:215]
ds_read_b64_tr_b16 a[208:209], v18 offset:32768
ds_read_b64_tr_b16 a[210:211], v18 offset:36864
v_mfma_f32_16x16x32_bf16 v[220:223], a[236:239], v[76:79], v[220:223]
buffer_load_dwordx4 v20, s[24:27], s49 offen offset:0 sc1 lds
ds_read_b64_tr_b16 a[212:213], v19 offset:32768
ds_read_b64_tr_b16 a[214:215], v19 offset:36864
v_mfma_f32_16x16x32_bf16 v[216:219], a[232:235], v[76:79], v[216:219]
ds_read_b128 v[96:99], v12 offset:32768
v_mfma_f32_16x16x32_bf16 v[224:227], a[232:235], v[80:83], v[224:227]
ds_read_b128 v[100:103], v12 offset:34816
v_mfma_f32_16x16x32_bf16 v[228:231], a[236:239], v[80:83], v[228:231]
ds_read_b128 v[104:107], v12 offset:36864
v_mfma_f32_16x16x32_bf16 v[236:239], a[236:239], v[84:87], v[236:239]
buffer_load_dwordx4 v20, s[24:27], s49 offen offset:1024 sc1 lds
ds_read_b128 v[108:111], v12 offset:38912
v_mfma_f32_16x16x32_bf16 v[232:235], a[232:235], v[84:87], v[232:235]
ds_read_b128 v[64:67], v12 offset:40960
v_mfma_f32_16x16x32_bf16 v[240:243], a[232:235], v[88:91], v[240:243]
ds_read_b128 v[68:71], v12 offset:43008
v_mfma_f32_16x16x32_bf16 v[244:247], a[236:239], v[88:91], v[244:247]
ds_read_b128 v[72:75], v12 offset:45056
v_mfma_f32_16x16x32_bf16 v[252:255], a[236:239], v[92:95], v[252:255]
buffer_load_dwordx4 v20, s[24:27], s49 offen offset:2048 sc1 lds
ds_read_b128 v[76:79], v12 offset:47104
v_mfma_f32_16x16x32_bf16 v[248:251], a[232:235], v[92:95], v[248:251]
ds_read_b64_tr_b16 a[216:217], v18 offset:40960
ds_read_b64_tr_b16 a[218:219], v18 offset:45056
s_waitcnt lgkmcnt(7)
v_mfma_f32_16x16x32_bf16 v[192:195], a[240:243], v[96:99], v[192:195]
ds_read_b64_tr_b16 a[220:221], v19 offset:40960
ds_read_b64_tr_b16 a[222:223], v19 offset:45056
v_mfma_f32_16x16x32_bf16 v[196:199], a[244:247], v[96:99], v[196:199]
ds_read_b128 v[80:83], v13 offset:32768
v_mfma_f32_16x16x32_bf16 v[204:207], a[244:247], v[100:103], v[204:207]
buffer_load_dwordx4 v20, s[24:27], s49 offen offset:3072 sc1 lds
ds_read_b128 v[84:87], v13 offset:34816
s_add_u32 m0, s48, 0x11000
v_mfma_f32_16x16x32_bf16 v[200:203], a[240:243], v[100:103], v[200:203]
ds_read_b128 v[88:91], v13 offset:36864
s_add_u32 s49, s55, 61440
v_mfma_f32_16x16x32_bf16 v[208:211], a[240:243], v[104:107], v[208:211]
ds_read_b128 v[92:95], v13 offset:38912
v_mfma_f32_16x16x32_bf16 v[212:215], a[244:247], v[104:107], v[212:215]
s_waitcnt lgkmcnt(6)
v_mfma_f32_16x16x32_bf16 v[220:223], a[244:247], v[108:111], v[220:223]
buffer_load_dwordx4 v20, s[24:27], s49 offen offset:0 sc1 lds
ds_read_b128 v[96:99], v13 offset:40960
v_mfma_f32_16x16x32_bf16 v[216:219], a[240:243], v[108:111], v[216:219]
v_mfma_f32_16x16x32_bf16 v[224:227], a[240:243], v[64:67], v[224:227]
ds_read_b128 v[100:103], v13 offset:43008
v_mfma_f32_16x16x32_bf16 v[228:231], a[244:247], v[64:67], v[228:231]
v_mfma_f32_16x16x32_bf16 v[236:239], a[244:247], v[68:71], v[236:239]
buffer_load_dwordx4 v20, s[24:27], s49 offen offset:1024 sc1 lds
ds_read_b128 v[104:107], v13 offset:45056
v_mfma_f32_16x16x32_bf16 v[232:235], a[240:243], v[68:71], v[232:235]
v_mfma_f32_16x16x32_bf16 v[240:243], a[240:243], v[72:75], v[240:243]
ds_read_b128 v[108:111], v13 offset:47104
v_mfma_f32_16x16x32_bf16 v[244:247], a[244:247], v[72:75], v[244:247]
v_mfma_f32_16x16x32_bf16 v[252:255], a[244:247], v[76:79], v[252:255]
buffer_load_dwordx4 v20, s[24:27], s49 offen offset:2048 sc1 lds
v_mfma_f32_16x16x32_bf16 v[248:251], a[240:243], v[76:79], v[248:251]
s_waitcnt lgkmcnt(2)
v_mfma_f32_16x16x32_bf16 v[192:195], a[248:251], v[80:83], v[192:195]
v_mfma_f32_16x16x32_bf16 v[196:199], a[252:255], v[80:83], v[196:199]
v_mfma_f32_16x16x32_bf16 v[204:207], a[252:255], v[84:87], v[204:207]
buffer_load_dwordx4 v20, s[24:27], s49 offen offset:3072 sc1 lds
s_add_u32 m0, s5, 0x18000
s_add_u32 s49, s56, 57344
v_mfma_f32_16x16x32_bf16 v[200:203], a[248:251], v[84:87], v[200:203]
v_mfma_f32_16x16x32_bf16 v[208:211], a[248:251], v[88:91], v[208:211]
s_waitcnt vmcnt(14) lgkmcnt(0)
s_barrier
v_mfma_f32_16x16x32_bf16 v[212:215], a[252:255], v[88:91], v[212:215]
ds_read_b128 v[64:67], v20 offset:0
v_mfma_f32_16x16x32_bf16 v[220:223], a[252:255], v[92:95], v[220:223]
buffer_load_dwordx4 v20, s[24:27], s49 offen offset:0 sc1 lds
ds_read_b128 v[68:71], v20 offset:1024
v_mfma_f32_16x16x32_bf16 v[216:219], a[248:251], v[92:95], v[216:219]
ds_read_b128 v[72:75], v20 offset:2048
v_mfma_f32_16x16x32_bf16 v[224:227], a[248:251], v[96:99], v[224:227]
ds_read_b128 v[76:79], v20 offset:3072
ds_read_b128 v[116:119], v22 offset:4624
v_mul_f32 v36, v192, v192
v_mul_f32 v37, v193, v193
v_mfma_f32_16x16x32_bf16 v[228:231], a[252:255], v[96:99], v[228:231]
ds_read_b128 v[80:83], v20 offset:4096
v_mul_f32 v38, v194, v194
v_mul_f32 v39, v195, v195
v_fma_f32 v36, v36, v112, v113
v_mfma_f32_16x16x32_bf16 v[236:239], a[252:255], v[100:103], v[236:239]
buffer_load_dwordx4 v20, s[24:27], s49 offen offset:1024 sc1 lds
ds_read_b128 v[84:87], v20 offset:5120
s_add_u32 s49, s57, 57344
v_mfma_f32_16x16x32_bf16 v[232:235], a[248:251], v[100:103], v[232:235]
ds_read_b128 v[88:91], v20 offset:6144
v_fma_f32 v37, v37, v112, v113
v_fma_f32 v38, v38, v112, v113
v_fma_f32 v39, v39, v112, v113
v_mfma_f32_16x16x32_bf16 v[240:243], a[248:251], v[104:107], v[240:243]
ds_read_b128 v[92:95], v20 offset:7168
v_mul_f32 v36, v192, v36
v_mul_f32 v37, v193, v37
v_mul_f32_e64 v38, v194, v38
v_mfma_f32_16x16x32_bf16 v[244:247], a[252:255], v[104:107], v[244:247]
v_mul_f32 v39, v195, v39
v_exp_f32 v36, v36
v_mfma_f32_16x16x32_bf16 v[252:255], a[252:255], v[108:111], v[252:255]
buffer_load_dwordx4 v20, s[24:27], s49 offen offset:2048 sc1 lds
ds_read_b128 v[96:99], v20 offset:8192
v_mfma_f32_16x16x32_bf16 v[248:251], a[248:251], v[108:111], v[248:251]
v_exp_f32 v37, v37
s_waitcnt lgkmcnt(4)
v_mfma_f32_16x16x32_bf16 v[128:131], a[0:3], v[64:67], 0
ds_read_b128 v[100:103], v20 offset:9216
v_exp_f32_e64 v38, v38
v_mfma_f32_16x16x32_bf16 v[132:135], a[4:7], v[64:67], 0
v_exp_f32_e64 v39, v39
v_fma_f32 v36, v36, v114, v114
v_mfma_f32_16x16x32_bf16 v[140:143], a[4:7], v[68:71], 0
ds_read_b128 v[104:107], v20 offset:10240
v_add_u32 v2, 147456, v20
ds_read_b128 a[240:243], v2 offset:8192
ds_read_b128 a[244:247], v2 offset:9216
v_mfma_f32_16x16x32_bf16 v[136:139], a[0:3], v[68:71], 0
ds_read_b128 a[248:251], v2 offset:10240
ds_read_b128 a[252:255], v2 offset:11264
ds_read_b128 a[224:227], v2 offset:12288
ds_read_b128 a[228:231], v2 offset:13312
v_mfma_f32_16x16x32_bf16 v[128:131], a[8:11], v[72:75], v[128:131]
ds_read_b128 v[108:111], v20 offset:11264
ds_read_b128 a[232:235], v2 offset:14336
ds_read_b128 a[236:239], v2 offset:15360
ds_read_b128 v[160:163], v2 offset:0
v_mfma_f32_16x16x32_bf16 v[132:135], a[12:15], v[72:75], v[132:135]
ds_read_b128 v[164:167], v2 offset:1024
ds_read_b128 v[168:171], v2 offset:2048
ds_read_b128 v[172:175], v2 offset:3072
v_mfma_f32_16x16x32_bf16 v[140:143], a[12:15], v[76:79], v[140:143]
buffer_load_dwordx4 v20, s[24:27], s49 offen offset:3072 sc1 lds
ds_read_b128 v[64:67], v20 offset:12288
s_add_u32 m0, s5, 0x19000
v_mfma_f32_16x16x32_bf16 v[136:139], a[8:11], v[76:79], v[136:139]
s_add_u32 s49, s58, 57344
ds_read_b128 v[176:179], v2 offset:4096
ds_read_b128 v[180:183], v2 offset:5120
ds_read_b128 v[184:187], v2 offset:6144
v_mfma_f32_16x16x32_bf16 v[128:131], a[16:19], v[80:83], v[128:131]
ds_read_b128 v[68:71], v20 offset:13312
ds_read_b128 v[188:191], v2 offset:7168
v_min_u32 v4, 7, v0
v_lshlrev_b32 v4, 9, v4
v_mfma_f32_16x16x32_bf16 v[132:135], a[20:23], v[80:83], v[132:135]
v_fma_f32 v37, v37, v114, v114
v_fma_f32 v38, v38, v114, v114
s_waitcnt lgkmcnt(15)
v_mfma_f32_16x16x32_bf16 v[140:143], a[20:23], v[84:87], v[140:143]
ds_read_b128 v[72:75], v20 offset:14336
v_fma_f32 v39, v39, v114, v114
v_rcp_f32 v36, v36
v_mfma_f32_16x16x32_bf16 v[136:139], a[16:19], v[84:87], v[136:139]
v_rcp_f32 v37, v37
v_rcp_f32 v38, v38
v_mfma_f32_16x16x32_bf16 v[128:131], a[24:27], v[88:91], v[128:131]
ds_read_b128 v[76:79], v20 offset:15360
v_rcp_f32 v39, v39
v_mul_f32 v36, v192, v36
v_mfma_f32_16x16x32_bf16 v[132:135], a[28:31], v[88:91], v[132:135]
v_mul_f32 v37, v193, v37
v_mul_f32 v38, v194, v38
v_mul_f32_e64 v39, v195, v39
v_mfma_f32_16x16x32_bf16 v[140:143], a[28:31], v[92:95], v[140:143]
buffer_load_dwordx4 v20, s[24:27], s49 offen offset:0 sc1 lds
ds_read_b128 v[80:83], v20 offset:16384
v_cvt_pk_bf16_f32 v48, v36, v37
v_mfma_f32_16x16x32_bf16 v[136:139], a[24:27], v[92:95], v[136:139]
v_cvt_pk_bf16_f32 v49, v38, v39
v_mul_f32 v40, v196, v196
v_mul_f32 v41, v197, v197
v_mul_f32_e64 v42, v198, v198
v_mfma_f32_16x16x32_bf16 v[128:131], a[32:35], v[96:99], v[128:131]
ds_read_b128 v[84:87], v20 offset:17408
v_mul_f32_e64 v43, v199, v199
v_fma_f32 v40, v40, v112, v113
v_fma_f32 v41, v41, v112, v113
v_mfma_f32_16x16x32_bf16 v[132:135], a[36:39], v[96:99], v[132:135]
v_fma_f32 v42, v42, v112, v113
v_fma_f32 v43, v43, v112, v113
v_mul_f32_e64 v40, v196, v40
v_mfma_f32_16x16x32_bf16 v[140:143], a[36:39], v[100:103], v[140:143]
ds_read_b128 v[88:91], v20 offset:18432
v_mul_f32 v41, v197, v41
v_mul_f32 v42, v198, v42
v_mul_f32_e64 v43, v199, v43
v_mfma_f32_16x16x32_bf16 v[136:139], a[32:35], v[100:103], v[136:139]
v_exp_f32 v40, v40
v_exp_f32 v41, v41
v_mfma_f32_16x16x32_bf16 v[128:131], a[40:43], v[104:107], v[128:131]
ds_read_b128 v[92:95], v20 offset:19456
v_exp_f32_e64 v42, v42
v_mfma_f32_16x16x32_bf16 v[132:135], a[44:47], v[104:107], v[132:135]
v_exp_f32 v43, v43
s_waitcnt lgkmcnt(3)
v_mfma_f32_16x16x32_bf16 v[140:143], a[44:47], v[108:111], v[140:143]
buffer_load_dwordx4 v20, s[24:27], s49 offen offset:1024 sc1 lds
ds_read_b128 v[96:99], v20 offset:20480
v_fma_f32 v40, v40, v114, v114
v_mfma_f32_16x16x32_bf16 v[136:139], a[40:43], v[108:111], v[136:139]
v_fma_f32 v41, v41, v114, v114
v_fma_f32 v42, v42, v114, v114
v_fma_f32 v43, v43, v114, v114
v_mfma_f32_16x16x32_bf16 v[128:131], a[48:51], v[64:67], v[128:131]
ds_read_b128 v[100:103], v20 offset:21504
v_rcp_f32_e64 v40, v40
v_mfma_f32_16x16x32_bf16 v[132:135], a[52:55], v[64:67], v[132:135]
v_rcp_f32_e64 v41, v41
v_mfma_f32_16x16x32_bf16 v[140:143], a[52:55], v[68:71], v[140:143]
ds_read_b128 v[104:107], v20 offset:22528
v_rcp_f32_e64 v42, v42
v_mfma_f32_16x16x32_bf16 v[136:139], a[48:51], v[68:71], v[136:139]
v_rcp_f32 v43, v43
v_mul_f32 v40, v196, v40
v_mul_f32_e64 v41, v197, v41
v_mfma_f32_16x16x32_bf16 v[128:131], a[56:59], v[72:75], v[128:131]
ds_read_b128 v[108:111], v20 offset:23552
v_mul_f32 v42, v198, v42
v_mul_f32 v43, v199, v43
v_cvt_pk_bf16_f32 v50, v40, v41
v_mfma_f32_16x16x32_bf16 v[132:135], a[60:63], v[72:75], v[132:135]
v_cvt_pk_bf16_f32 v51, v42, v43
ds_read_b128 v[112:115], v22 offset:5136
v_mul_f32_e64 v36, v200, v200
v_mfma_f32_16x16x32_bf16 v[140:143], a[60:63], v[76:79], v[140:143]
buffer_store_dwordx4 v[48:51], v20, s[24:27], s44 offen offset:0 sc1
ds_read_b128 v[64:67], v20 offset:24576
v_mul_f32 v37, v201, v201
v_mul_f32 v38, v202, v202
v_mfma_f32_16x16x32_bf16 v[136:139], a[56:59], v[76:79], v[136:139]
v_mul_f32_e64 v39, v203, v203
v_fma_f32 v36, v36, v116, v117
v_fma_f32 v37, v37, v116, v117
v_fma_f32 v38, v38, v116, v117
v_mfma_f32_16x16x32_bf16 v[128:131], a[64:67], v[80:83], v[128:131]
ds_read_b128 v[68:71], v20 offset:25600
v_fma_f32 v39, v39, v116, v117
v_mul_f32 v36, v200, v36
v_mul_f32 v37, v201, v37
v_mfma_f32_16x16x32_bf16 v[132:135], a[68:71], v[80:83], v[132:135]
v_mul_f32_e64 v38, v202, v38
v_mul_f32 v39, v203, v39
s_waitcnt lgkmcnt(4)
v_mfma_f32_16x16x32_bf16 v[140:143], a[68:71], v[84:87], v[140:143]
ds_read_b128 v[72:75], v20 offset:26624
v_exp_f32_e64 v36, v36
v_mfma_f32_16x16x32_bf16 v[136:139], a[64:67], v[84:87], v[136:139]
v_exp_f32 v37, v37
v_exp_f32 v38, v38
v_mfma_f32_16x16x32_bf16 v[128:131], a[72:75], v[88:91], v[128:131]
ds_read_b128 v[76:79], v20 offset:27648
v_exp_f32_e64 v39, v39
v_fma_f32 v36, v36, v118, v118
v_mfma_f32_16x16x32_bf16 v[132:135], a[76:79], v[88:91], v[132:135]
v_fma_f32 v37, v37, v118, v118
v_fma_f32 v38, v38, v118, v118
v_fma_f32 v39, v39, v118, v118
v_mfma_f32_16x16x32_bf16 v[140:143], a[76:79], v[92:95], v[140:143]
ds_read_b128 v[80:83], v20 offset:28672
v_rcp_f32_e64 v36, v36
v_mfma_f32_16x16x32_bf16 v[136:139], a[72:75], v[92:95], v[136:139]
v_rcp_f32 v37, v37
v_rcp_f32 v38, v38
v_mfma_f32_16x16x32_bf16 v[128:131], a[80:83], v[96:99], v[128:131]
ds_read_b128 v[84:87], v20 offset:29696
v_rcp_f32 v39, v39
v_mul_f32 v36, v200, v36
v_mfma_f32_16x16x32_bf16 v[132:135], a[84:87], v[96:99], v[132:135]
v_mul_f32 v37, v201, v37
v_mul_f32 v38, v202, v38
v_mul_f32_e64 v39, v203, v39
v_mfma_f32_16x16x32_bf16 v[140:143], a[84:87], v[100:103], v[140:143]
ds_read_b128 v[88:91], v20 offset:30720
v_cvt_pk_bf16_f32 v52, v36, v37
v_cvt_pk_bf16_f32 v53, v38, v39
v_mul_f32_e64 v40, v204, v204
v_mfma_f32_16x16x32_bf16 v[136:139], a[80:83], v[100:103], v[136:139]
v_mul_f32 v41, v205, v205
v_mul_f32 v42, v206, v206
v_mul_f32_e64 v43, v207, v207
v_fma_f32 v40, v40, v116, v117
v_mfma_f32_16x16x32_bf16 v[128:131], a[88:91], v[104:107], v[128:131]
ds_read_b128 v[92:95], v20 offset:31744
v_fma_f32 v41, v41, v116, v117
v_fma_f32 v42, v42, v116, v117
v_fma_f32 v43, v43, v116, v117
v_mfma_f32_16x16x32_bf16 v[132:135], a[92:95], v[104:107], v[132:135]
v_mul_f32_e64 v40, v204, v40
v_mul_f32 v41, v205, v41
s_waitcnt lgkmcnt(3)
v_mfma_f32_16x16x32_bf16 v[140:143], a[92:95], v[108:111], v[140:143]
v_mul_f32 v42, v206, v42
v_mul_f32 v43, v207, v43
v_exp_f32_e64 v40, v40
v_mfma_f32_16x16x32_bf16 v[136:139], a[88:91], v[108:111], v[136:139]
v_exp_f32 v41, v41
v_exp_f32 v42, v42
v_mfma_f32_16x16x32_bf16 v[128:131], a[96:99], v[64:67], v[128:131]
v_exp_f32_e64 v43, v43
v_fma_f32 v40, v40, v118, v118
v_fma_f32 v41, v41, v118, v118
v_mfma_f32_16x16x32_bf16 v[132:135], a[100:103], v[64:67], v[132:135]
v_fma_f32 v42, v42, v118, v118
v_fma_f32 v43, v43, v118, v118
v_mfma_f32_16x16x32_bf16 v[140:143], a[100:103], v[68:71], v[140:143]
s_waitcnt vmcnt(15) lgkmcnt(0)
s_barrier
ds_read_b128 v[96:99], v20 offset:32768
v_mfma_f32_16x16x32_bf16 v[136:139], a[96:99], v[68:71], v[136:139]
ds_read_b128 v[100:103], v20 offset:33792
v_rcp_f32_e64 v40, v40
v_mfma_f32_16x16x32_bf16 v[128:131], a[104:107], v[72:75], v[128:131]
buffer_load_dword v23, v1, s[24:27], s59 offen offset:128 sc1
ds_read_b128 v[104:107], v20 offset:34816
v_mfma_f32_16x16x32_bf16 v[132:135], a[108:111], v[72:75], v[132:135]
ds_read_b128 v[108:111], v20 offset:35840
v_rcp_f32_e64 v41, v41
v_mfma_f32_16x16x32_bf16 v[140:143], a[108:111], v[76:79], v[140:143]
ds_read_b128 v[64:67], v20 offset:36864
v_rcp_f32_e64 v42, v42
v_mfma_f32_16x16x32_bf16 v[136:139], a[104:107], v[76:79], v[136:139]
v_rcp_f32 v43, v43
v_mul_f32 v40, v204, v40
v_mul_f32_e64 v41, v205, v41
v_mfma_f32_16x16x32_bf16 v[128:131], a[112:115], v[80:83], v[128:131]
ds_read_b128 v[68:71], v20 offset:37888
v_mul_f32 v42, v206, v42
v_mul_f32 v43, v207, v43
v_cvt_pk_bf16_f32 v54, v40, v41
v_mfma_f32_16x16x32_bf16 v[132:135], a[116:119], v[80:83], v[132:135]
v_cvt_pk_bf16_f32 v55, v42, v43
ds_read_b128 v[116:119], v22 offset:5648
v_mul_f32_e64 v36, v208, v208
v_mfma_f32_16x16x32_bf16 v[140:143], a[116:119], v[84:87], v[140:143]
buffer_store_dwordx4 v[52:55], v20, s[24:27], s44 offen offset:1024 sc1
ds_read_b128 v[72:75], v20 offset:38912
s_add_u32 s44, s44, 57344
v_mul_f32_e64 v37, v209, v209
v_mfma_f32_16x16x32_bf16 v[136:139], a[112:115], v[84:87], v[136:139]
v_mul_f32 v38, v210, v210
v_mul_f32 v39, v211, v211
v_fma_f32 v36, v36, v112, v113
v_fma_f32 v37, v37, v112, v113
v_mfma_f32_16x16x32_bf16 v[128:131], a[120:123], v[88:91], v[128:131]
ds_read_b128 v[76:79], v20 offset:39936
v_lshlrev_b32 v63, 3, v0
v_mov_b32 v9, v56
s_mov_b32 s72, 0xffff
v_mfma_f32_16x16x32_bf16 v[132:135], a[124:127], v[88:91], v[132:135]
v_fma_f32 v38, v38, v112, v113
v_fma_f32 v39, v39, v112, v113
v_mul_f32_e64 v36, v208, v36
v_mfma_f32_16x16x32_bf16 v[140:143], a[124:127], v[92:95], v[140:143]
ds_read_b128 v[80:83], v20 offset:40960
v_mul_f32 v37, v209, v37
v_mul_f32 v38, v210, v38
v_mul_f32_e64 v39, v211, v39
v_mfma_f32_16x16x32_bf16 v[136:139], a[120:123], v[92:95], v[136:139]
v_exp_f32 v36, v36
s_waitcnt lgkmcnt(4)
v_mfma_f32_16x16x32_bf16 v[128:131], a[128:131], v[96:99], v[128:131]
ds_read_b128 v[84:87], v20 offset:41984
v_exp_f32_e64 v37, v37
v_mfma_f32_16x16x32_bf16 v[132:135], a[132:135], v[96:99], v[132:135]
v_exp_f32_e64 v38, v38
v_mfma_f32_16x16x32_bf16 v[140:143], a[132:135], v[100:103], v[140:143]
ds_read_b128 v[88:91], v20 offset:43008
v_exp_f32_e64 v39, v39
v_fma_f32 v36, v36, v114, v114
v_mfma_f32_16x16x32_bf16 v[136:139], a[128:131], v[100:103], v[136:139]
v_fma_f32 v37, v37, v114, v114
v_fma_f32 v38, v38, v114, v114
v_fma_f32 v39, v39, v114, v114
v_mfma_f32_16x16x32_bf16 v[128:131], a[136:139], v[104:107], v[128:131]
ds_read_b128 v[92:95], v20 offset:44032
v_rcp_f32_e64 v36, v36
v_mfma_f32_16x16x32_bf16 v[132:135], a[140:143], v[104:107], v[132:135]
v_rcp_f32_e64 v37, v37
v_mfma_f32_16x16x32_bf16 v[140:143], a[140:143], v[108:111], v[140:143]
ds_read_b128 v[96:99], v20 offset:45056
v_rcp_f32_e64 v38, v38
v_mfma_f32_16x16x32_bf16 v[136:139], a[136:139], v[108:111], v[136:139]
v_rcp_f32 v39, v39
v_mul_f32 v36, v208, v36
v_mul_f32_e64 v37, v209, v37
v_mfma_f32_16x16x32_bf16 v[128:131], a[144:147], v[64:67], v[128:131]
ds_read_b128 v[100:103], v20 offset:46080
v_mul_f32 v38, v210, v38
v_mul_f32 v39, v211, v39
v_cvt_pk_bf16_f32 v48, v36, v37
v_mfma_f32_16x16x32_bf16 v[132:135], a[148:151], v[64:67], v[132:135]
v_cvt_pk_bf16_f32 v49, v38, v39
v_mul_f32 v40, v212, v212
v_mul_f32 v41, v213, v213
v_mfma_f32_16x16x32_bf16 v[140:143], a[148:151], v[68:71], v[140:143]
ds_read_b128 v[104:107], v20 offset:47104
v_mul_f32 v42, v214, v214
v_mul_f32 v43, v215, v215
v_fma_f32 v40, v40, v112, v113
v_mfma_f32_16x16x32_bf16 v[136:139], a[144:147], v[68:71], v[136:139]
v_fma_f32 v41, v41, v112, v113
v_fma_f32 v42, v42, v112, v113
v_fma_f32 v43, v43, v112, v113
s_waitcnt lgkmcnt(3)
v_mfma_f32_16x16x32_bf16 v[128:131], a[152:155], v[72:75], v[128:131]
ds_read_b128 v[108:111], v20 offset:48128
v_mul_f32 v40, v212, v40
v_mul_f32 v41, v213, v41
v_mul_f32 v42, v214, v42
v_mfma_f32_16x16x32_bf16 v[132:135], a[156:159], v[72:75], v[132:135]
v_mul_f32 v43, v215, v43
v_exp_f32 v40, v40
v_mfma_f32_16x16x32_bf16 v[140:143], a[156:159], v[76:79], v[140:143]
ds_read_b128 v[64:67], v20 offset:49152
v_exp_f32_e64 v41, v41
v_mfma_f32_16x16x32_bf16 v[136:139], a[152:155], v[76:79], v[136:139]
v_exp_f32 v42, v42
v_exp_f32 v43, v43
v_mfma_f32_16x16x32_bf16 v[128:131], a[160:163], v[80:83], v[128:131]
ds_read_b128 v[68:71], v20 offset:50176
v_fma_f32 v40, v40, v114, v114
v_fma_f32 v41, v41, v114, v114
v_fma_f32 v42, v42, v114, v114
v_mfma_f32_16x16x32_bf16 v[132:135], a[164:167], v[80:83], v[132:135]
v_fma_f32 v43, v43, v114, v114
v_rcp_f32_e64 v40, v40
v_mfma_f32_16x16x32_bf16 v[140:143], a[164:167], v[84:87], v[140:143]
ds_read_b128 v[72:75], v20 offset:51200
v_rcp_f32_e64 v41, v41
v_mfma_f32_16x16x32_bf16 v[136:139], a[160:163], v[84:87], v[136:139]
v_rcp_f32 v42, v42
v_rcp_f32 v43, v43
v_mfma_f32_16x16x32_bf16 v[128:131], a[168:171], v[88:91], v[128:131]
ds_read_b128 v[76:79], v20 offset:52224
v_mul_f32 v40, v212, v40
v_mul_f32 v41, v213, v41
v_mul_f32_e64 v42, v214, v42
v_mfma_f32_16x16x32_bf16 v[132:135], a[172:175], v[88:91], v[132:135]
v_mul_f32_e64 v43, v215, v43
v_cvt_pk_bf16_f32 v50, v40, v41
v_cvt_pk_bf16_f32 v51, v42, v43
v_mfma_f32_16x16x32_bf16 v[140:143], a[172:175], v[92:95], v[140:143]
buffer_store_dwordx4 v[48:51], v20, s[24:27], s44 offen offset:0 sc1
ds_read_b128 v[80:83], v20 offset:53248
ds_read_b128 v[112:115], v22 offset:6160
v_mul_f32_e64 v36, v216, v216
v_mfma_f32_16x16x32_bf16 v[136:139], a[168:171], v[92:95], v[136:139]
v_mul_f32 v37, v217, v217
v_mul_f32 v38, v218, v218
v_mul_f32_e64 v39, v219, v219
s_waitcnt lgkmcnt(4)
v_mfma_f32_16x16x32_bf16 v[128:131], a[176:179], v[96:99], v[128:131]
ds_read_b128 v[84:87], v20 offset:54272
s_add_u32 m0, s48, 0x0
s_add_u32 s49, s55, 114688
v_fma_f32 v36, v36, v116, v117
v_mfma_f32_16x16x32_bf16 v[132:135], a[180:183], v[96:99], v[132:135]
v_fma_f32 v37, v37, v116, v117
v_fma_f32 v38, v38, v116, v117
v_fma_f32 v39, v39, v116, v117
v_mfma_f32_16x16x32_bf16 v[140:143], a[180:183], v[100:103], v[140:143]
ds_read_b128 v[88:91], v20 offset:55296
v_mul_f32 v36, v216, v36
v_mul_f32 v37, v217, v37
v_mul_f32_e64 v38, v218, v38
v_mfma_f32_16x16x32_bf16 v[136:139], a[176:179], v[100:103], v[136:139]
v_mul_f32 v39, v219, v39
v_exp_f32 v36, v36
v_mfma_f32_16x16x32_bf16 v[128:131], a[184:187], v[104:107], v[128:131]
ds_read_b128 v[92:95], v20 offset:56320
s_waitcnt vmcnt(2)
v_cmp_ne_u32 vcc, s53, v23
s_cbranch_vccnz L_spin2
L_back2:
v_mfma_f32_16x16x32_bf16 v[132:135], a[188:191], v[104:107], v[132:135]
v_exp_f32 v37, v37
v_mfma_f32_16x16x32_bf16 v[140:143], a[188:191], v[108:111], v[140:143]
v_exp_f32_e64 v38, v38
v_mfma_f32_16x16x32_bf16 v[136:139], a[184:187], v[108:111], v[136:139]
v_exp_f32_e64 v39, v39
v_fma_f32 v36, v36, v118, v118
v_fma_f32 v37, v37, v118, v118
v_mfma_f32_16x16x32_bf16 v[128:131], a[192:195], v[64:67], v[128:131]
v_fma_f32 v38, v38, v118, v118
v_fma_f32 v39, v39, v118, v118
v_rcp_f32_e64 v36, v36
v_mfma_f32_16x16x32_bf16 v[132:135], a[196:199], v[64:67], v[132:135]
v_rcp_f32_e64 v37, v37
v_mfma_f32_16x16x32_bf16 v[140:143], a[196:199], v[68:71], v[140:143]
s_waitcnt lgkmcnt(0)
s_barrier
ds_read_b128 v[96:99], v21 offset:0
v_mfma_f32_16x16x32_bf16 v[136:139], a[192:195], v[68:71], v[136:139]
ds_read_b128 v[100:103], v21 offset:1024
v_rcp_f32_e64 v38, v38
v_mfma_f32_16x16x32_bf16 v[128:131], a[200:203], v[72:75], v[128:131]
buffer_load_dwordx4 v20, s[24:27], s49 offen offset:0 sc1 lds
ds_read_b128 v[104:107], v21 offset:2048
v_mfma_f32_16x16x32_bf16 v[132:135], a[204:207], v[72:75], v[132:135]
ds_read_b128 v[108:111], v21 offset:3072
v_rcp_f32_e64 v39, v39
v_mfma_f32_16x16x32_bf16 v[140:143], a[204:207], v[76:79], v[140:143]
ds_read_b128 v[64:67], v21 offset:4096
v_mul_f32 v36, v216, v36
v_mul_f32 v37, v217, v37
v_mul_f32_e64 v38, v218, v38
v_mfma_f32_16x16x32_bf16 v[136:139], a[200:203], v[76:79], v[136:139]
v_mul_f32_e64 v39, v219, v39
v_cvt_pk_bf16_f32 v52, v36, v37
v_cvt_pk_bf16_f32 v53, v38, v39
v_mul_f32_e64 v40, v220, v220
v_mfma_f32_16x16x32_bf16 v[128:131], a[208:211], v[80:83], v[128:131]
buffer_load_dwordx4 v20, s[24:27], s49 offen offset:1024 sc1 lds
ds_read_b128 v[68:71], v21 offset:5120
v_mul_f32_e64 v41, v221, v221
v_mfma_f32_16x16x32_bf16 v[132:135], a[212:215], v[80:83], v[132:135]
v_mul_f32 v42, v222, v222
v_mul_f32 v43, v223, v223
v_fma_f32 v40, v40, v116, v117
v_mfma_f32_16x16x32_bf16 v[140:143], a[212:215], v[84:87], v[140:143]
ds_read_b128 v[72:75], v21 offset:6144
v_fma_f32 v41, v41, v116, v117
v_fma_f32 v42, v42, v116, v117
v_fma_f32 v43, v43, v116, v117
v_mfma_f32_16x16x32_bf16 v[136:139], a[208:211], v[84:87], v[136:139]
v_mul_f32 v40, v220, v40
v_mul_f32 v41, v221, v41
v_mul_f32 v42, v222, v42
v_mul_f32 v43, v223, v43
v_mfma_f32_16x16x32_bf16 v[128:131], a[216:219], v[88:91], v[128:131]
buffer_load_dwordx4 v20, s[24:27], s49 offen offset:2048 sc1 lds
ds_read_b128 v[76:79], v21 offset:7168
v_mfma_f32_16x16x32_bf16 v[132:135], a[220:223], v[88:91], v[132:135]
v_exp_f32_e64 v40, v40
v_mfma_f32_16x16x32_bf16 v[140:143], a[220:223], v[92:95], v[140:143]
ds_read_b128 v[80:83], v21 offset:8192
v_exp_f32_e64 v41, v41
v_mfma_f32_16x16x32_bf16 v[136:139], a[216:219], v[92:95], v[136:139]
v_exp_f32 v42, v42
s_waitcnt lgkmcnt(3)
v_mfma_f32_16x16x32_bf16 v[144:147], a[0:3], v[96:99], 0
buffer_load_dwordx4 v20, s[24:27], s49 offen offset:3072 sc1 lds
ds_read_b128 v[84:87], v21 offset:9216
s_add_u32 m0, s48, 0x1000
v_mfma_f32_16x16x32_bf16 v[148:151], a[4:7], v[96:99], 0
s_add_u32 s49, s55, 118784
v_exp_f32_e64 v43, v43
v_mfma_f32_16x16x32_bf16 v[156:159], a[4:7], v[100:103], 0
ds_read_b128 v[88:91], v21 offset:10240
v_fma_f32 v40, v40, v118, v118
v_fma_f32 v41, v41, v118, v118
v_fma_f32 v42, v42, v118, v118
v_mfma_f32_16x16x32_bf16 v[152:155], a[0:3], v[100:103], 0
v_fma_f32 v43, v43, v118, v118
v_rcp_f32_e64 v40, v40
v_mfma_f32_16x16x32_bf16 v[144:147], a[8:11], v[104:107], v[144:147]
buffer_load_dwordx4 v20, s[24:27], s49 offen offset:0 sc1 lds
ds_read_b128 v[92:95], v21 offset:11264
v_cvt_pk_bf16_f32 v10, v128, v129
v_mfma_f32_16x16x32_bf16 v[148:151], a[12:15], v[104:107], v[148:151]
v_cvt_pk_bf16_f32 v11, v130, v131
v_cvt_pk_bf16_f32 v12, v132, v133
v_cvt_pk_bf16_f32 v13, v134, v135
v_mfma_f32_16x16x32_bf16 v[156:159], a[12:15], v[108:111], v[156:159]
ds_read_b128 v[96:99], v21 offset:12288
v_cvt_pk_bf16_f32 v14, v136, v137
v_cvt_pk_bf16_f32 v15, v138, v139
v_cvt_pk_bf16_f32 v16, v140, v141
v_mfma_f32_16x16x32_bf16 v[152:155], a[8:11], v[108:111], v[152:155]
v_cvt_pk_bf16_f32 v17, v142, v143
v_cvt_pk_bf16_f32 v6, v135, v143
v_bfi_b32 v13, s72, v13, v56
v_bfi_b32 v17, s72, v17, v56
v_mfma_f32_16x16x32_bf16 v[144:147], a[16:19], v[64:67], v[144:147]
buffer_load_dwordx4 v20, s[24:27], s49 offen offset:1024 sc1 lds
ds_read_b128 v[100:103], v21 offset:13312
v_mfma_f32_16x16x32_bf16 v[148:151], a[20:23], v[64:67], v[148:151]
v_rcp_f32_e64 v41, v41
v_mfma_f32_16x16x32_bf16 v[156:159], a[20:23], v[68:71], v[156:159]
buffer_store_dwordx4 v[10:13], v20, s[24:27], s68 offen offset:0 sc1
ds_read_b128 v[104:107], v21 offset:14336
v_rcp_f32_e64 v42, v42
v_mfma_f32_16x16x32_bf16 v[152:155], a[16:19], v[68:71], v[152:155]
v_rcp_f32_e64 v43, v43
v_mul_f32 v40, v220, v40
s_waitcnt lgkmcnt(3)
v_mfma_f32_16x16x32_bf16 v[144:147], a[24:27], v[72:75], v[144:147]
buffer_load_dwordx4 v20, s[24:27], s49 offen offset:2048 sc1 lds
ds_read_b128 v[108:111], v21 offset:15360
v_mul_f32_e64 v41, v221, v41
v_mfma_f32_16x16x32_bf16 v[148:151], a[28:31], v[72:75], v[148:151]
v_mul_f32 v42, v222, v42
v_mul_f32 v43, v223, v43
v_cvt_pk_bf16_f32 v54, v40, v41
v_mfma_f32_16x16x32_bf16 v[156:159], a[28:31], v[76:79], v[156:159]
buffer_store_dwordx4 v[14:17], v20, s[24:27], s68 offen offset:1024 sc1
ds_read_b128 v[64:67], v21 offset:16384
v_cvt_pk_bf16_f32 v55, v42, v43
ds_read_b128 v[116:119], v22 offset:6672
v_mfma_f32_16x16x32_bf16 v[152:155], a[24:27], v[76:79], v[152:155]
v_mul_f32 v36, v224, v224
v_mul_f32 v37, v225, v225
v_mul_f32 v38, v226, v226
v_mul_f32 v39, v227, v227
v_mfma_f32_16x16x32_bf16 v[144:147], a[32:35], v[80:83], v[144:147]
buffer_load_dwordx4 v20, s[24:27], s49 offen offset:3072 sc1 lds
ds_read_b128 v[68:71], v21 offset:17408
s_add_u32 m0, s5, 0x8000
v_mfma_f32_16x16x32_bf16 v[148:151], a[36:39], v[80:83], v[148:151]
s_add_u32 s49, s56, 114688
v_fma_f32 v36, v36, v112, v113
v_fma_f32 v37, v37, v112, v113
v_fma_f32 v38, v38, v112, v113
v_mfma_f32_16x16x32_bf16 v[156:159], a[36:39], v[84:87], v[156:159]
buffer_store_dwordx4 v[52:55], v20, s[24:27], s44 offen offset:1024 sc1
ds_read_b128 v[72:75], v21 offset:18432
s_add_u32 s44, s44, 57344
v_fma_f32 v39, v39, v112, v113
v_mfma_f32_16x16x32_bf16 v[152:155], a[32:35], v[84:87], v[152:155]
v_mul_f32 v36, v224, v36
v_mul_f32 v37, v225, v37
v_mul_f32 v38, v226, v38
v_mul_f32 v39, v227, v39
v_mfma_f32_16x16x32_bf16 v[144:147], a[40:43], v[88:91], v[144:147]
buffer_load_dwordx4 v20, s[24:27], s49 offen offset:0 sc1 lds
ds_read_b128 v[76:79], v21 offset:19456
v_mfma_f32_16x16x32_bf16 v[148:151], a[44:47], v[88:91], v[148:151]
v_exp_f32 v36, v36
v_exp_f32 v37, v37
v_mfma_f32_16x16x32_bf16 v[156:159], a[44:47], v[92:95], v[156:159]
ds_read_b128 v[80:83], v21 offset:20480
v_exp_f32_e64 v38, v38
v_mfma_f32_16x16x32_bf16 v[152:155], a[40:43], v[92:95], v[152:155]
v_exp_f32 v39, v39
v_fma_f32 v36, v36, v114, v114
s_waitcnt lgkmcnt(3)
v_mfma_f32_16x16x32_bf16 v[144:147], a[48:51], v[96:99], v[144:147]
buffer_load_dwordx4 v20, s[24:27], s49 offen offset:1024 sc1 lds
ds_read_b128 v[84:87], v21 offset:21504
s_add_u32 s49, s57, 114688
v_mfma_f32_16x16x32_bf16 v[148:151], a[52:55], v[96:99], v[148:151]
v_fma_f32 v37, v37, v114, v114
v_fma_f32 v38, v38, v114, v114
v_fma_f32 v39, v39, v114, v114
v_mfma_f32_16x16x32_bf16 v[156:159], a[52:55], v[100:103], v[156:159]
ds_read_b128 v[88:91], v21 offset:22528
v_rcp_f32_e64 v36, v36
v_mfma_f32_16x16x32_bf16 v[152:155], a[48:51], v[100:103], v[152:155]
v_rcp_f32 v37, v37
v_rcp_f32 v38, v38
v_mfma_f32_16x16x32_bf16 v[144:147], a[56:59], v[104:107], v[144:147]
buffer_load_dwordx4 v20, s[24:27], s49 offen offset:2048 sc1 lds
ds_read_b128 v[92:95], v21 offset:23552
v_mfma_f32_16x16x32_bf16 v[148:151], a[60:63], v[104:107], v[148:151]
v_rcp_f32 v39, v39
v_mul_f32 v36, v224, v36
v_mul_f32_e64 v37, v225, v37
v_mfma_f32_16x16x32_bf16 v[156:159], a[60:63], v[108:111], v[156:159]
ds_read_b128 v[96:99], v21 offset:24576
v_mul_f32 v38, v226, v38
v_mul_f32 v39, v227, v39
v_cvt_pk_bf16_f32 v48, v36, v37
v_mfma_f32_16x16x32_bf16 v[152:155], a[56:59], v[108:111], v[152:155]
v_cvt_pk_bf16_f32 v49, v38, v39
v_mul_f32 v40, v228, v228
v_mul_f32 v41, v229, v229
v_mul_f32_e64 v42, v230, v230
v_mfma_f32_16x16x32_bf16 v[144:147], a[64:67], v[64:67], v[144:147]
ds_read_b128 v[100:103], v21 offset:25600
v_mul_f32_e64 v43, v231, v231
v_fma_f32 v40, v40, v112, v113
v_fma_f32 v41, v41, v112, v113
v_mfma_f32_16x16x32_bf16 v[148:151], a[68:71], v[64:67], v[148:151]
v_fma_f32 v42, v42, v112, v113
v_fma_f32 v43, v43, v112, v113
v_mul_f32 v40, v228, v40
v_mul_f32 v41, v229, v41
v_mfma_f32_16x16x32_bf16 v[156:159], a[68:71], v[68:71], v[156:159]
buffer_load_dwordx4 v20, s[24:27], s49 offen offset:3072 sc1 lds
ds_read_b128 v[104:107], v21 offset:26624
s_add_u32 m0, s5, 0x9000
v_mfma_f32_16x16x32_bf16 v[152:155], a[64:67], v[68:71], v[152:155]
s_add_u32 s49, s58, 114688
v_mul_f32_e64 v42, v230, v42
v_mul_f32 v43, v231, v43
s_waitcnt lgkmcnt(3)
v_mfma_f32_16x16x32_bf16 v[144:147], a[72:75], v[72:75], v[144:147]
ds_read_b128 v[108:111], v21 offset:27648
v_exp_f32_e64 v40, v40
v_mfma_f32_16x16x32_bf16 v[148:151], a[76:79], v[72:75], v[148:151]
v_exp_f32 v41, v41
v_exp_f32 v42, v42
v_mfma_f32_16x16x32_bf16 v[156:159], a[76:79], v[76:79], v[156:159]
ds_read_b128 v[64:67], v21 offset:28672
v_exp_f32_e64 v43, v43
v_fma_f32 v40, v40, v114, v114
v_mfma_f32_16x16x32_bf16 v[152:155], a[72:75], v[76:79], v[152:155]
v_fma_f32 v41, v41, v114, v114
v_fma_f32 v42, v42, v114, v114
v_fma_f32 v43, v43, v114, v114
v_mfma_f32_16x16x32_bf16 v[144:147], a[80:83], v[80:83], v[144:147]
buffer_load_dwordx4 v20, s[24:27], s49 offen offset:0 sc1 lds
ds_read_b128 v[68:71], v21 offset:29696
v_mfma_f32_16x16x32_bf16 v[148:151], a[84:87], v[80:83], v[148:151]
v_rcp_f32 v40, v40
v_rcp_f32 v41, v41
v_mfma_f32_16x16x32_bf16 v[156:159], a[84:87], v[84:87], v[156:159]
ds_read_b128 v[72:75], v21 offset:30720
v_rcp_f32_e64 v42, v42
v_mfma_f32_16x16x32_bf16 v[152:155], a[80:83], v[84:87], v[152:155]
v_rcp_f32 v43, v43
v_mul_f32 v40, v228, v40
v_mul_f32_e64 v41, v229, v41
v_mfma_f32_16x16x32_bf16 v[144:147], a[88:91], v[88:91], v[144:147]
ds_read_b128 v[76:79], v21 offset:31744
v_mul_f32 v42, v230, v42
v_mul_f32 v43, v231, v43
v_cvt_pk_bf16_f32 v50, v40, v41
v_mfma_f32_16x16x32_bf16 v[148:151], a[92:95], v[88:91], v[148:151]
v_cvt_pk_bf16_f32 v51, v42, v43
ds_read_b128 v[112:115], v22 offset:7184
v_mul_f32 v36, v232, v232
v_mul_f32 v37, v233, v233
v_mfma_f32_16x16x32_bf16 v[156:159], a[92:95], v[92:95], v[156:159]
buffer_load_dword v5, v4, s[24:27], s80 offen sc1
v_mul_f32_e64 v38, v234, v234
v_mul_f32 v39, v235, v235
v_mfma_f32_16x16x32_bf16 v[152:155], a[88:91], v[92:95], v[152:155]
v_fma_f32 v36, v36, v116, v117
v_fma_f32 v37, v37, v116, v117
v_fma_f32 v38, v38, v116, v117
s_waitcnt lgkmcnt(3)
v_mfma_f32_16x16x32_bf16 v[144:147], a[96:99], v[96:99], v[144:147]
buffer_load_dwordx4 v20, s[24:27], s49 offen offset:1024 sc1 lds
s_add_u32 m0, s48, 0x10000
s_add_u32 s49, s55, 172032
v_mfma_f32_16x16x32_bf16 v[148:151], a[100:103], v[96:99], v[148:151]
v_fma_f32 v39, v39, v116, v117
v_mul_f32 v36, v232, v36
v_mul_f32 v37, v233, v37
v_mul_f32_e64 v38, v234, v38
v_mfma_f32_16x16x32_bf16 v[156:159], a[100:103], v[100:103], v[156:159]
s_waitcnt lgkmcnt(0)
s_barrier
ds_read_b128 v[80:83], v21 offset:32768
v_mul_f32_e64 v39, v235, v39
v_mfma_f32_16x16x32_bf16 v[152:155], a[96:99], v[100:103], v[152:155]
ds_read_b128 v[84:87], v21 offset:33792
v_exp_f32_e64 v36, v36
v_mfma_f32_16x16x32_bf16 v[144:147], a[104:107], v[104:107], v[144:147]
buffer_load_dwordx4 v20, s[24:27], s49 offen offset:0 sc1 lds
ds_read_b128 v[88:91], v21 offset:34816
v_mfma_f32_16x16x32_bf16 v[148:151], a[108:111], v[104:107], v[148:151]
ds_read_b128 v[92:95], v21 offset:35840
v_exp_f32_e64 v37, v37
v_mfma_f32_16x16x32_bf16 v[156:159], a[108:111], v[108:111], v[156:159]
buffer_store_dwordx4 v[48:51], v20, s[24:27], s44 offen offset:0 sc1
ds_read_b128 v[96:99], v21 offset:36864
v_exp_f32_e64 v38, v38
v_mfma_f32_16x16x32_bf16 v[152:155], a[104:107], v[108:111], v[152:155]
v_exp_f32_e64 v39, v39
v_fma_f32 v36, v36, v118, v118
v_fma_f32 v37, v37, v118, v118
v_mfma_f32_16x16x32_bf16 v[144:147], a[112:115], v[64:67], v[144:147]
ds_read_b128 v[100:103], v21 offset:37888
v_fma_f32 v38, v38, v118, v118
v_fma_f32 v39, v39, v118, v118
v_mfma_f32_16x16x32_bf16 v[148:151], a[116:119], v[64:67], v[148:151]
v_rcp_f32 v36, v36
v_rcp_f32 v37, v37
v_mfma_f32_16x16x32_bf16 v[156:159], a[116:119], v[68:71], v[156:159]
buffer_load_dwordx4 v20, s[24:27], s49 offen offset:1024 sc1 lds
ds_read_b128 v[104:107], v21 offset:38912
v_mfma_f32_16x16x32_bf16 v[152:155], a[112:115], v[68:71], v[152:155]
v_rcp_f32 v38, v38
v_rcp_f32 v39, v39
v_mfma_f32_16x16x32_bf16 v[144:147], a[120:123], v[72:75], v[144:147]
ds_read_b128 v[108:111], v21 offset:39936
v_mul_f32 v36, v232, v36
v_mul_f32 v37, v233, v37
v_mul_f32_e64 v38, v234, v38
v_mfma_f32_16x16x32_bf16 v[148:151], a[124:127], v[72:75], v[148:151]
v_mul_f32_e64 v39, v235, v39
v_cvt_pk_bf16_f32 v52, v36, v37
v_cvt_pk_bf16_f32 v53, v38, v39
v_mul_f32_e64 v40, v236, v236
v_mfma_f32_16x16x32_bf16 v[156:159], a[124:127], v[76:79], v[156:159]
ds_read_b128 v[64:67], v21 offset:40960
v_mul_f32 v41, v237, v237
v_mul_f32 v42, v238, v238
v_mul_f32 v43, v239, v239
v_mfma_f32_16x16x32_bf16 v[152:155], a[120:123], v[76:79], v[152:155]
v_fma_f32 v40, v40, v116, v117
v_fma_f32 v41, v41, v116, v117
v_fma_f32 v42, v42, v116, v117
s_waitcnt lgkmcnt(3)
v_mfma_f32_16x16x32_bf16 v[144:147], a[128:131], v[80:83], v[144:147]
buffer_load_dwordx4 v20, s[24:27], s49 offen offset:2048 sc1 lds
ds_read_b128 v[68:71], v21 offset:41984
v_fma_f32 v43, v43, v116, v117
v_mfma_f32_16x16x32_bf16 v[148:151], a[132:135], v[80:83], v[148:151]
v_mul_f32 v40, v236, v40
v_mul_f32 v41, v237, v41
v_mul_f32 v42, v238, v42
v_mul_f32 v43, v239, v43
v_mfma_f32_16x16x32_bf16 v[156:159], a[132:135], v[84:87], v[156:159]
ds_read_b128 v[72:75], v21 offset:43008
v_exp_f32_e64 v40, v40
v_mfma_f32_16x16x32_bf16 v[152:155], a[128:131], v[84:87], v[152:155]
v_exp_f32 v41, v41
v_exp_f32 v42, v42
v_mfma_f32_16x16x32_bf16 v[144:147], a[136:139], v[88:91], v[144:147]
ds_read_b128 v[76:79], v21 offset:44032
v_exp_f32_e64 v43, v43
v_fma_f32 v40, v40, v118, v118
v_mfma_f32_16x16x32_bf16 v[148:151], a[140:143], v[88:91], v[148:151]
v_fma_f32 v41, v41, v118, v118
v_fma_f32 v42, v42, v118, v118
v_fma_f32 v43, v43, v118, v118
v_mfma_f32_16x16x32_bf16 v[156:159], a[140:143], v[92:95], v[156:159]
buffer_load_dwordx4 v20, s[24:27], s49 offen offset:3072 sc1 lds
ds_read_b128 v[80:83], v21 offset:45056
s_add_u32 m0, s48, 0x11000
v_mfma_f32_16x16x32_bf16 v[152:155], a[136:139], v[92:95], v[152:155]
s_add_u32 s49, s55, 176128
v_rcp_f32_e64 v40, v40
v_mfma_f32_16x16x32_bf16 v[144:147], a[144:147], v[96:99], v[144:147]
ds_read_b128 v[84:87], v21 offset:46080
v_rcp_f32_e64 v41, v41
v_mfma_f32_16x16x32_bf16 v[148:151], a[148:151], v[96:99], v[148:151]
v_rcp_f32 v42, v42
v_rcp_f32 v43, v43
v_mfma_f32_16x16x32_bf16 v[156:159], a[148:151], v[100:103], v[156:159]
ds_read_b128 v[88:91], v21 offset:47104
v_mul_f32 v40, v236, v40
v_mul_f32 v41, v237, v41
v_mul_f32_e64 v42, v238, v42
v_mfma_f32_16x16x32_bf16 v[152:155], a[144:147], v[100:103], v[152:155]
v_mul_f32 v43, v239, v43
v_cvt_pk_bf16_f32 v54, v40, v41
v_cvt_pk_bf16_f32 v55, v42, v43
s_waitcnt lgkmcnt(3)
v_mfma_f32_16x16x32_bf16 v[144:147], a[152:155], v[104:107], v[144:147]
buffer_load_dwordx4 v20, s[24:27], s49 offen offset:0 sc1 lds
ds_read_b128 v[92:95], v21 offset:48128
ds_read_b128 v[116:119], v22 offset:7696
v_mfma_f32_16x16x32_bf16 v[148:151], a[156:159], v[104:107], v[148:151]
v_mul_f32 v36, v240, v240
v_mul_f32 v37, v241, v241
v_mul_f32 v38, v242, v242
v_mul_f32 v39, v243, v243
v_mfma_f32_16x16x32_bf16 v[156:159], a[156:159], v[108:111], v[156:159]
buffer_store_dwordx4 v[52:55], v20, s[24:27], s44 offen offset:1024 sc1
ds_read_b128 v[96:99], v21 offset:49152
s_add_u32 s44, s44, 57344
v_fma_f32 v36, v36, v112, v113
v_mfma_f32_16x16x32_bf16 v[152:155], a[152:155], v[108:111], v[152:155]
v_fma_f32 v37, v37, v112, v113
v_fma_f32 v38, v38, v112, v113
v_fma_f32 v39, v39, v112, v113
v_mul_f32_e64 v36, v240, v36
v_mfma_f32_16x16x32_bf16 v[144:147], a[160:163], v[64:67], v[144:147]
ds_read_b128 v[100:103], v21 offset:50176
v_mul_f32 v37, v241, v37
v_mul_f32 v38, v242, v38
v_mul_f32_e64 v39, v243, v39
v_mfma_f32_16x16x32_bf16 v[148:151], a[164:167], v[64:67], v[148:151]
v_exp_f32 v36, v36
v_exp_f32 v37, v37
v_mfma_f32_16x16x32_bf16 v[156:159], a[164:167], v[68:71], v[156:159]
buffer_load_dwordx4 v20, s[24:27], s49 offen offset:1024 sc1 lds
ds_read_b128 v[104:107], v21 offset:51200
v_mfma_f32_16x16x32_bf16 v[152:155], a[160:163], v[68:71], v[152:155]
v_exp_f32 v38, v38
v_exp_f32 v39, v39
v_mfma_f32_16x16x32_bf16 v[144:147], a[168:171], v[72:75], v[144:147]
ds_read_b128 v[108:111], v21 offset:52224
v_fma_f32 v36, v36, v114, v114
v_fma_f32 v37, v37, v114, v114
v_fma_f32 v38, v38, v114, v114
v_mfma_f32_16x16x32_bf16 v[148:151], a[172:175], v[72:75], v[148:151]
v_fma_f32 v39, v39, v114, v114
v_rcp_f32 v36, v36
v_mfma_f32_16x16x32_bf16 v[156:159], a[172:175], v[76:79], v[156:159]
ds_read_b128 v[64:67], v21 offset:53248
s_waitcnt vmcnt(9)
v_cmp_ne_u32 vcc, s53, v5
s_cbranch_vccnz L_spin3
L_back3:
v_mfma_f32_16x16x32_bf16 v[152:155], a[168:171], v[76:79], v[152:155]
v_lshrrev_b32 v2, 4, v0
s_waitcnt lgkmcnt(3)
v_mfma_f32_16x16x32_bf16 v[144:147], a[176:179], v[80:83], v[144:147]
buffer_load_dwordx4 v20, s[24:27], s49 offen offset:2048 sc1 lds
ds_read_b128 v[68:71], v21 offset:54272
v_lshl_add_u32 v2, s36, 2, v2
v_mfma_f32_16x16x32_bf16 v[148:151], a[180:183], v[80:83], v[148:151]
v_xor_b32 v22, v2, v0
v_lshlrev_b32 v2, 11, v2
v_and_b32_e64 v22, 15, v22
v_lshl_add_u32 v22, v22, 4, v2
v_mfma_f32_16x16x32_bf16 v[156:159], a[180:183], v[84:87], v[156:159]
buffer_load_dwordx4 v20, s[24:27], s49 offen offset:3072 sc1 lds
ds_read_b128 v[72:75], v21 offset:55296
s_add_u32 m0, s47, 147456
v_mfma_f32_16x16x32_bf16 v[152:155], a[176:179], v[84:87], v[152:155]
v_rcp_f32 v37, v37
v_rcp_f32 v38, v38
v_mfma_f32_16x16x32_bf16 v[144:147], a[184:187], v[88:91], v[144:147]
buffer_load_dwordx4 v62, s[24:27], s81 offen offset:0 sc1 lds
ds_read_b128 v[76:79], v21 offset:56320
s_add_u32 s81, s81, 261120
v_mfma_f32_16x16x32_bf16 v[148:151], a[188:191], v[88:91], v[148:151]
v_rcp_f32 v39, v39
v_mul_f32 v36, v240, v36
v_mul_f32_e64 v37, v241, v37
v_mfma_f32_16x16x32_bf16 v[156:159], a[188:191], v[92:95], v[156:159]
buffer_load_dwordx4 v62, s[24:27], s81 offen offset:1024 sc1 lds
s_add_u32 s81, s81, 261120
v_mul_f32_e64 v38, v242, v38
v_mfma_f32_16x16x32_bf16 v[152:155], a[184:187], v[92:95], v[152:155]
v_mul_f32_e64 v39, v243, v39
v_cvt_pk_bf16_f32 v48, v36, v37
v_cvt_pk_bf16_f32 v49, v38, v39
v_mul_f32_e64 v40, v244, v244
v_mfma_f32_16x16x32_bf16 v[144:147], a[192:195], v[96:99], v[144:147]
buffer_load_dwordx4 v62, s[24:27], s81 offen offset:2048 sc1 lds
s_add_u32 s81, s81, 261120
v_mul_f32_e64 v41, v245, v245
v_mfma_f32_16x16x32_bf16 v[148:151], a[196:199], v[96:99], v[148:151]
v_mul_f32 v42, v246, v246
v_mul_f32 v43, v247, v247
v_fma_f32 v40, v40, v112, v113
v_fma_f32 v41, v41, v112, v113
v_mfma_f32_16x16x32_bf16 v[156:159], a[196:199], v[100:103], v[156:159]
s_waitcnt lgkmcnt(0)
s_barrier
ds_read_b128 v[80:83], v20 offset:0
v_fma_f32 v42, v42, v112, v113
v_mfma_f32_16x16x32_bf16 v[152:155], a[192:195], v[100:103], v[152:155]
ds_read_b128 v[84:87], v20 offset:1024
v_fma_f32 v43, v43, v112, v113
v_mul_f32 v40, v244, v40
v_mul_f32 v41, v245, v41
v_mfma_f32_16x16x32_bf16 v[144:147], a[200:203], v[104:107], v[144:147]
buffer_store_dword v56, v57, s[24:27], s63 offen offset:256 sc1
ds_read_b128 v[88:91], v20 offset:2048
v_mul_f32_e64 v42, v246, v42
v_mfma_f32_16x16x32_bf16 v[148:151], a[204:207], v[104:107], v[148:151]
ds_read_b128 v[92:95], v20 offset:3072
v_mul_f32 v43, v247, v43
v_exp_f32 v40, v40
v_mfma_f32_16x16x32_bf16 v[156:159], a[204:207], v[108:111], v[156:159]
buffer_load_dwordx4 v62, s[24:27], s81 offen offset:3072 sc1 lds
ds_read_b128 v[96:99], v20 offset:4096
s_add_u32 m0, s5, 0x18000
v_mfma_f32_16x16x32_bf16 v[152:155], a[200:203], v[108:111], v[152:155]
s_add_u32 s49, s56, 172032
v_exp_f32_e64 v41, v41
v_mfma_f32_16x16x32_bf16 v[144:147], a[208:211], v[64:67], v[144:147]
ds_read_b128 v[100:103], v20 offset:5120
v_exp_f32_e64 v42, v42
v_mfma_f32_16x16x32_bf16 v[148:151], a[212:215], v[64:67], v[148:151]
v_exp_f32_e64 v43, v43
v_fma_f32 v40, v40, v114, v114
v_fma_f32 v41, v41, v114, v114
v_mfma_f32_16x16x32_bf16 v[156:159], a[212:215], v[68:71], v[156:159]
buffer_load_dwordx4 v20, s[24:27], s49 offen offset:0 sc1 lds
ds_read_b128 v[104:107], v20 offset:6144
v_fma_f32 v42, v42, v114, v114
v_mfma_f32_16x16x32_bf16 v[152:155], a[208:211], v[68:71], v[152:155]
v_fma_f32 v43, v43, v114, v114
v_rcp_f32_e64 v40, v40
v_mfma_f32_16x16x32_bf16 v[144:147], a[216:219], v[72:75], v[144:147]
ds_read_b128 v[108:111], v20 offset:7168
v_rcp_f32_e64 v41, v41
v_mfma_f32_16x16x32_bf16 v[148:151], a[220:223], v[72:75], v[148:151]
v_rcp_f32 v42, v42
v_rcp_f32 v43, v43
v_mfma_f32_16x16x32_bf16 v[156:159], a[220:223], v[76:79], v[156:159]
buffer_load_dwordx4 v20, s[24:27], s49 offen offset:1024 sc1 lds
ds_read_b128 v[64:67], v20 offset:8192
s_add_u32 s49, s57, 172032
v_mfma_f32_16x16x32_bf16 v[152:155], a[216:219], v[76:79], v[152:155]
v_mul_f32 v40, v244, v40
v_mul_f32 v41, v245, v41
v_mul_f32 v42, v246, v42
s_waitcnt lgkmcnt(3)
v_mfma_f32_16x16x32_bf16 v[128:131], a[0:3], v[80:83], 0
ds_read_b128 v[68:71], v20 offset:9216
v_mul_f32_e64 v43, v247, v43
v_cvt_pk_bf16_f32 v50, v40, v41
v_cvt_pk_bf16_f32 v51, v42, v43
v_mfma_f32_16x16x32_bf16 v[132:135], a[4:7], v[80:83], 0
buffer_store_dwordx4 v[48:51], v20, s[24:27], s44 offen offset:0 sc1
v_mul_f32 v36, v248, v248
v_mul_f32 v37, v249, v249
v_mul_f32_e64 v38, v250, v250
v_mfma_f32_16x16x32_bf16 v[140:143], a[4:7], v[84:87], 0
ds_read_b128 v[72:75], v20 offset:10240
v_mul_f32_e64 v39, v251, v251
v_fma_f32 v36, v36, v116, v117
v_fma_f32 v37, v37, v116, v117
v_mfma_f32_16x16x32_bf16 v[136:139], a[0:3], v[84:87], 0
v_fma_f32 v38, v38, v116, v117
v_fma_f32 v39, v39, v116, v117
v_mul_f32 v36, v248, v36
v_mul_f32 v37, v249, v37
v_mfma_f32_16x16x32_bf16 v[128:131], a[8:11], v[88:91], v[128:131]
buffer_load_dwordx4 v20, s[24:27], s49 offen offset:2048 sc1 lds
ds_read_b128 v[76:79], v20 offset:11264
v_cvt_pk_bf16_f32 v10, v144, v145
v_mfma_f32_16x16x32_bf16 v[132:135], a[12:15], v[88:91], v[132:135]
v_cvt_pk_bf16_f32 v11, v146, v147
v_cvt_pk_bf16_f32 v12, v148, v149
v_cvt_pk_bf16_f32 v13, v150, v151
v_cvt_pk_bf16_f32 v14, v152, v153
v_mfma_f32_16x16x32_bf16 v[140:143], a[12:15], v[92:95], v[140:143]
ds_read_b128 v[80:83], v20 offset:12288
v_cvt_pk_bf16_f32 v15, v154, v155
v_cvt_pk_bf16_f32 v16, v156, v157
v_cvt_pk_bf16_f32 v17, v158, v159
v_mfma_f32_16x16x32_bf16 v[136:139], a[8:11], v[92:95], v[136:139]
v_cvt_pk_bf16_f32 v7, v151, v159
v_bfi_b32 v13, s72, v13, v56
v_bfi_b32 v17, s72, v17, v56
v_mul_f32_e64 v38, v250, v38
v_mfma_f32_16x16x32_bf16 v[128:131], a[16:19], v[96:99], v[128:131]
buffer_store_dwordx4 v[10:13], v20, s[24:27], s68 offen offset:2048 sc1
ds_read_b128 v[84:87], v20 offset:13312
v_mul_f32_e64 v39, v251, v39
v_mfma_f32_16x16x32_bf16 v[132:135], a[20:23], v[96:99], v[132:135]
v_exp_f32 v36, v36
v_exp_f32 v37, v37
v_mfma_f32_16x16x32_bf16 v[140:143], a[20:23], v[100:103], v[140:143]
buffer_load_dwordx4 v20, s[24:27], s49 offen offset:3072 sc1 lds
ds_read_b128 v[88:91], v20 offset:14336
s_add_u32 m0, s5, 0x19000
v_mfma_f32_16x16x32_bf16 v[136:139], a[16:19], v[100:103], v[136:139]
s_add_u32 s49, s58, 172032
v_exp_f32 v38, v38
s_waitcnt lgkmcnt(3)
v_mfma_f32_16x16x32_bf16 v[128:131], a[24:27], v[104:107], v[128:131]
buffer_store_dwordx4 v[14:17], v20, s[24:27], s68 offen offset:3072 sc1
ds_read_b128 v[92:95], v20 offset:15360
s_add_u32 s68, s68, 4096
v_mfma_f32_16x16x32_bf16 v[132:135], a[28:31], v[104:107], v[132:135]
v_exp_f32_e64 v39, v39
v_fma_f32 v36, v36, v118, v118
v_fma_f32 v37, v37, v118, v118
v_mfma_f32_16x16x32_bf16 v[140:143], a[28:31], v[108:111], v[140:143]
buffer_store_dwordx4 v[6:9], v20, s[24:27], s68 offen sc1
ds_read_b128 v[96:99], v20 offset:16384
v_fma_f32 v38, v38, v118, v118
v_fma_f32 v39, v39, v118, v118
v_mfma_f32_16x16x32_bf16 v[136:139], a[24:27], v[108:111], v[136:139]
v_rcp_f32 v36, v36
v_rcp_f32 v37, v37
v_mfma_f32_16x16x32_bf16 v[128:131], a[32:35], v[64:67], v[128:131]
buffer_load_dwordx4 v20, s[24:27], s49 offen offset:0 sc1 lds
ds_read_b128 v[100:103], v20 offset:17408
v_mfma_f32_16x16x32_bf16 v[132:135], a[36:39], v[64:67], v[132:135]
v_rcp_f32 v38, v38
v_rcp_f32 v39, v39
v_mfma_f32_16x16x32_bf16 v[140:143], a[36:39], v[68:71], v[140:143]
ds_read_b128 v[104:107], v20 offset:18432
v_mul_f32 v36, v248, v36
v_mul_f32 v37, v249, v37
v_mul_f32_e64 v38, v250, v38
v_mfma_f32_16x16x32_bf16 v[136:139], a[32:35], v[68:71], v[136:139]
v_mul_f32_e64 v39, v251, v39
v_cvt_pk_bf16_f32 v52, v36, v37
v_cvt_pk_bf16_f32 v53, v38, v39
v_mul_f32_e64 v40, v252, v252
v_mfma_f32_16x16x32_bf16 v[128:131], a[40:43], v[72:75], v[128:131]
ds_read_b128 v[108:111], v20 offset:19456
v_mul_f32 v41, v253, v253
v_mul_f32 v42, v254, v254
v_mul_f32_e64 v43, v255, v255
v_mfma_f32_16x16x32_bf16 v[132:135], a[44:47], v[72:75], v[132:135]
v_fma_f32 v40, v40, v116, v117
v_fma_f32 v41, v41, v116, v117
v_fma_f32 v42, v42, v116, v117
v_fma_f32 v43, v43, v116, v117
v_mfma_f32_16x16x32_bf16 v[140:143], a[44:47], v[76:79], v[140:143]
buffer_load_dwordx4 v20, s[24:27], s49 offen offset:1024 sc1 lds
ds_read_b128 v[64:67], v20 offset:20480
s_add_u32 m0, s47, 131072
v_mfma_f32_16x16x32_bf16 v[136:139], a[40:43], v[76:79], v[136:139]
v_mul_f32 v40, v252, v40
v_mul_f32 v41, v253, v41
v_mul_f32 v42, v254, v42
s_waitcnt lgkmcnt(3)
v_mfma_f32_16x16x32_bf16 v[128:131], a[48:51], v[80:83], v[128:131]
ds_read_b128 v[68:71], v20 offset:21504
v_mul_f32 v43, v255, v43
v_exp_f32 v40, v40
v_mfma_f32_16x16x32_bf16 v[132:135], a[52:55], v[80:83], v[132:135]
v_exp_f32 v41, v41
v_exp_f32 v42, v42
v_mfma_f32_16x16x32_bf16 v[140:143], a[52:55], v[84:87], v[140:143]
ds_read_b128 v[72:75], v20 offset:22528
v_exp_f32_e64 v43, v43
v_fma_f32 v40, v40, v118, v118
v_mfma_f32_16x16x32_bf16 v[136:139], a[48:51], v[84:87], v[136:139]
v_fma_f32 v41, v41, v118, v118
v_fma_f32 v42, v42, v118, v118
v_fma_f32 v43, v43, v118, v118
v_mfma_f32_16x16x32_bf16 v[128:131], a[56:59], v[88:91], v[128:131]
buffer_load_dwordx4 v22, s[16:19], s74 offen offset:0 lds
ds_read_b128 v[76:79], v20 offset:23552
s_add_u32 s74, s74, 31744
v_mfma_f32_16x16x32_bf16 v[132:135], a[60:63], v[88:91], v[132:135]
v_rcp_f32 v40, v40
v_rcp_f32 v41, v41
v_mfma_f32_16x16x32_bf16 v[140:143], a[60:63], v[92:95], v[140:143]
ds_read_b128 v[80:83], v20 offset:24576
v_rcp_f32_e64 v42, v42
v_mfma_f32_16x16x32_bf16 v[136:139], a[56:59], v[92:95], v[136:139]
v_rcp_f32 v43, v43
v_mul_f32 v40, v252, v40
v_mul_f32_e64 v41, v253, v41
v_mfma_f32_16x16x32_bf16 v[128:131], a[64:67], v[96:99], v[128:131]
ds_read_b128 v[84:87], v20 offset:25600
v_mul_f32_e64 v42, v254, v42
v_mul_f32 v43, v255, v43
v_cvt_pk_bf16_f32 v54, v40, v41
v_mfma_f32_16x16x32_bf16 v[132:135], a[68:71], v[96:99], v[132:135]
v_cvt_pk_bf16_f32 v55, v42, v43
v_mfma_f32_16x16x32_bf16 v[140:143], a[68:71], v[100:103], v[140:143]
buffer_load_dwordx4 v22, s[16:19], s74 offen offset:1024 lds
ds_read_b128 v[88:91], v20 offset:26624
s_add_u32 s74, s74, 31744
v_mfma_f32_16x16x32_bf16 v[136:139], a[64:67], v[100:103], v[136:139]
s_waitcnt lgkmcnt(3)
v_mfma_f32_16x16x32_bf16 v[128:131], a[72:75], v[104:107], v[128:131]
buffer_store_dwordx4 v[52:55], v20, s[24:27], s44 offen offset:1024 sc1
ds_read_b128 v[92:95], v20 offset:27648
v_mfma_f32_16x16x32_bf16 v[132:135], a[76:79], v[104:107], v[132:135]
v_mfma_f32_16x16x32_bf16 v[140:143], a[76:79], v[108:111], v[140:143]
ds_read_b128 v[96:99], v20 offset:28672
v_mfma_f32_16x16x32_bf16 v[136:139], a[72:75], v[108:111], v[136:139]
v_mfma_f32_16x16x32_bf16 v[128:131], a[80:83], v[64:67], v[128:131]
buffer_load_dwordx4 v22, s[16:19], s74 offen offset:2048 lds
ds_read_b128 v[100:103], v20 offset:29696
s_add_u32 s74, s74, 31744
v_mfma_f32_16x16x32_bf16 v[132:135], a[84:87], v[64:67], v[132:135]
v_mfma_f32_16x16x32_bf16 v[140:143], a[84:87], v[68:71], v[140:143]
ds_read_b128 v[104:107], v20 offset:30720
v_mfma_f32_16x16x32_bf16 v[136:139], a[80:83], v[68:71], v[136:139]
v_mfma_f32_16x16x32_bf16 v[128:131], a[88:91], v[72:75], v[128:131]
ds_read_b128 v[108:111], v20 offset:31744
v_mfma_f32_16x16x32_bf16 v[132:135], a[92:95], v[72:75], v[132:135]
v_mfma_f32_16x16x32_bf16 v[140:143], a[92:95], v[76:79], v[140:143]
buffer_load_dwordx4 v22, s[16:19], s74 offen offset:3072 lds
s_waitcnt vmcnt(23)
v_mfma_f32_16x16x32_bf16 v[136:139], a[88:91], v[76:79], v[136:139]
s_waitcnt lgkmcnt(2)
v_mfma_f32_16x16x32_bf16 v[128:131], a[96:99], v[80:83], v[128:131]
buffer_store_dword v56, v57, s[24:27], s63 offen offset:384 sc1
v_mfma_f32_16x16x32_bf16 v[132:135], a[100:103], v[80:83], v[132:135]
v_mfma_f32_16x16x32_bf16 v[140:143], a[100:103], v[84:87], v[140:143]
s_waitcnt vmcnt(16) lgkmcnt(0)
s_barrier
ds_read_b128 v[64:67], v20 offset:32768
v_and_b32_e64 v244, 48, v0
v_mfma_f32_16x16x32_bf16 v[136:139], a[96:99], v[84:87], v[136:139]
ds_read_b128 v[68:71], v20 offset:33792
v_mfma_f32_16x16x32_bf16 v[128:131], a[104:107], v[88:91], v[128:131]
buffer_load_dwordx4 v[240:243], v244, s[28:31], s78 offen
ds_read_b128 v[72:75], v20 offset:34816
ds_read2st64_b32 v[48:49], v59 offset0:0 offset1:4
v_mfma_f32_16x16x32_bf16 v[132:135], a[108:111], v[88:91], v[132:135]
ds_read_b128 v[76:79], v20 offset:35840
ds_read2st64_b32 v[50:51], v59 offset0:16 offset1:20
ds_read2st64_b32 v[52:53], v59 offset0:32 offset1:36
ds_read2st64_b32 v[54:55], v59 offset0:48 offset1:52
v_mfma_f32_16x16x32_bf16 v[140:143], a[108:111], v[92:95], v[140:143]
ds_read_b128 v[80:83], v20 offset:36864
ds_read_b32 v40, v61 offset:512
ds_read_b32 v41, v60 offset:1536
ds_read_b32 v42, v60 offset:4608
v_mfma_f32_16x16x32_bf16 v[136:139], a[104:107], v[92:95], v[136:139]
ds_read_b32 v43, v60 offset:5632
ds_read_b32 v44, v60 offset:8704
ds_read_b32 v45, v60 offset:9728
ds_read_b32 v46, v60 offset:12800
v_mfma_f32_16x16x32_bf16 v[128:131], a[112:115], v[96:99], v[128:131]
ds_read_b128 v[84:87], v20 offset:37888
ds_read_b32 v47, v60 offset:13824
v_lshlrev_b32 v61, 31, v0
v_or_b32 v61, 0.5, v61
v_mfma_f32_16x16x32_bf16 v[132:135], a[116:119], v[96:99], v[132:135]
v_cmp_gt_u32 s[66:67], 32, v0
v_mfma_f32_16x16x32_bf16 v[140:143], a[116:119], v[100:103], v[140:143]
ds_read_b128 v[88:91], v20 offset:38912
v_mfma_f32_16x16x32_bf16 v[136:139], a[112:115], v[100:103], v[136:139]
v_mfma_f32_16x16x32_bf16 v[128:131], a[120:123], v[104:107], v[128:131]
buffer_load_dword v23, v1, s[24:27], s59 offen offset:256 sc1
ds_read_b128 v[92:95], v20 offset:39936
v_mfma_f32_16x16x32_bf16 v[132:135], a[124:127], v[104:107], v[132:135]
s_waitcnt lgkmcnt(15)
v_readlane_b32 s64, v48, 0
v_writelane_b32 v48, 0, 0
v_mfma_f32_16x16x32_bf16 v[140:143], a[124:127], v[108:111], v[140:143]
ds_read_b128 v[96:99], v20 offset:40960
s_waitcnt lgkmcnt(11)
v_readlane_b32 s65, v40, 0
v_writelane_b32 v40, 0, 0
v_mfma_f32_16x16x32_bf16 v[136:139], a[120:123], v[108:111], v[136:139]
v_cndmask_b32 v60, 0, v61, s[66:67]
s_lshl_b32 s64, s64, 16
s_lshl_b32 s65, s65, 16
v_mfma_f32_32x32x16_bf16 v[224:239], v[48:51], a[224:227], 0
v_mfma_f32_32x32x16_bf16 v[112:127], v[48:51], a[232:235], 0
v_mfma_f32_32x32x16_bf16 v[224:239], v[52:55], a[228:231], v[224:239]
v_mfma_f32_32x32x16_bf16 v[112:127], v[52:55], a[236:239], v[112:127]
v_mfma_f32_16x16x32_bf16 v[128:131], a[128:131], v[64:67], v[128:131]
ds_read_b128 v[100:103], v20 offset:41984
v_mfma_f32_16x16x32_bf16 v[132:135], a[132:135], v[64:67], v[132:135]
v_mfma_f32_16x16x32_bf16 v[140:143], a[132:135], v[68:71], v[140:143]
ds_read_b128 v[104:107], v20 offset:43008
v_mfma_f32_16x16x32_bf16 v[136:139], a[128:131], v[68:71], v[136:139]
v_mfma_f32_16x16x32_bf16 v[128:131], a[136:139], v[72:75], v[128:131]
ds_read_b128 v[108:111], v20 offset:44032
v_mfma_f32_16x16x32_bf16 v[132:135], a[140:143], v[72:75], v[132:135]
v_mfma_f32_16x16x32_bf16 v[140:143], a[140:143], v[76:79], v[140:143]
ds_read_b128 v[64:67], v20 offset:45056
v_mul_f32 v2, v224, v176
v_mul_f32 v3, v225, v177
v_mul_f32_e64 v224, v224, v160
v_mfma_f32_16x16x32_bf16 v[136:139], a[136:139], v[76:79], v[136:139]
v_mul_f32_e64 v225, v225, v161
v_fma_f32 v224, -v112, v176, v224
v_fma_f32 v225, -v113, v177, v225
v_fma_f32 v112, v112, v160, v2
v_mfma_f32_16x16x32_bf16 v[128:131], a[144:147], v[80:83], v[128:131]
ds_read_b128 v[68:71], v20 offset:46080
v_fma_f32 v113, v113, v161, v3
v_mul_f32 v2, v226, v178
v_mul_f32 v3, v227, v179
v_mfma_f32_16x16x32_bf16 v[132:135], a[148:151], v[80:83], v[132:135]
v_mul_f32_e64 v226, v226, v162
v_mul_f32 v227, v227, v163
s_waitcnt lgkmcnt(3)
v_mfma_f32_16x16x32_bf16 v[140:143], a[148:151], v[84:87], v[140:143]
ds_read_b128 v[72:75], v20 offset:47104
v_fma_f32 v226, -v114, v178, v226
v_fma_f32 v227, -v115, v179, v227
v_fma_f32 v114, v114, v162, v2
v_mfma_f32_16x16x32_bf16 v[136:139], a[144:147], v[84:87], v[136:139]
v_fma_f32 v115, v115, v163, v3
v_mul_f32 v2, v228, v180
v_mul_f32 v3, v229, v181
v_mul_f32_e64 v228, v228, v164
v_mfma_f32_16x16x32_bf16 v[128:131], a[152:155], v[88:91], v[128:131]
ds_read_b128 v[76:79], v20 offset:48128
v_mul_f32_e64 v229, v229, v165
v_fma_f32 v228, -v116, v180, v228
v_fma_f32 v229, -v117, v181, v229
v_mfma_f32_16x16x32_bf16 v[132:135], a[156:159], v[88:91], v[132:135]
v_fma_f32 v116, v116, v164, v2
v_fma_f32 v117, v117, v165, v3
v_mul_f32_e64 v2, v230, v182
v_mfma_f32_16x16x32_bf16 v[140:143], a[156:159], v[92:95], v[140:143]
ds_read_b128 v[80:83], v20 offset:49152
v_mul_f32 v3, v231, v183
v_mul_f32 v230, v230, v166
v_mul_f32_e64 v231, v231, v167
v_mfma_f32_16x16x32_bf16 v[136:139], a[152:155], v[92:95], v[136:139]
v_fma_f32 v230, -v118, v182, v230
v_fma_f32 v231, -v119, v183, v231
v_fma_f32 v118, v118, v166, v2
v_fma_f32 v119, v119, v167, v3
v_mfma_f32_16x16x32_bf16 v[128:131], a[160:163], v[96:99], v[128:131]
ds_read_b128 v[84:87], v20 offset:50176
v_mul_f32 v2, v232, v184
v_mul_f32 v3, v233, v185
v_mul_f32_e64 v232, v232, v168
v_mfma_f32_16x16x32_bf16 v[132:135], a[164:167], v[96:99], v[132:135]
v_mul_f32_e64 v233, v233, v169
v_fma_f32 v232, -v120, v184, v232
v_fma_f32 v233, -v121, v185, v233
v_mfma_f32_16x16x32_bf16 v[140:143], a[164:167], v[100:103], v[140:143]
ds_read_b128 v[88:91], v20 offset:51200
v_fma_f32 v120, v120, v168, v2
v_fma_f32 v121, v121, v169, v3
v_mul_f32_e64 v2, v234, v186
v_mfma_f32_16x16x32_bf16 v[136:139], a[160:163], v[100:103], v[136:139]
v_mul_f32 v3, v235, v187
v_mul_f32 v234, v234, v170
v_mul_f32_e64 v235, v235, v171
v_fma_f32 v234, -v122, v186, v234
v_mfma_f32_16x16x32_bf16 v[128:131], a[168:171], v[104:107], v[128:131]
ds_read_b128 v[92:95], v20 offset:52224
v_fma_f32 v235, -v123, v187, v235
v_fma_f32 v122, v122, v170, v2
v_fma_f32 v123, v123, v171, v3
v_mfma_f32_16x16x32_bf16 v[132:135], a[172:175], v[104:107], v[132:135]
v_mul_f32_e64 v2, v236, v188
v_mul_f32 v3, v237, v189
s_waitcnt lgkmcnt(3)
v_mfma_f32_16x16x32_bf16 v[140:143], a[172:175], v[108:111], v[140:143]
ds_read_b128 v[96:99], v20 offset:53248
v_mul_f32 v236, v236, v172
v_mul_f32 v237, v237, v173
v_fma_f32 v236, -v124, v188, v236
v_mfma_f32_16x16x32_bf16 v[136:139], a[168:171], v[108:111], v[136:139]
v_fma_f32 v237, -v125, v189, v237
v_fma_f32 v124, v124, v172, v2
v_fma_f32 v125, v125, v173, v3
v_mul_f32_e64 v2, v238, v190
v_mfma_f32_16x16x32_bf16 v[128:131], a[176:179], v[64:67], v[128:131]
ds_read_b128 v[100:103], v20 offset:54272
s_add_u32 m0, s48, 0x0
s_add_u32 s49, s55, 229376
v_mul_f32 v3, v239, v191
v_mfma_f32_16x16x32_bf16 v[132:135], a[180:183], v[64:67], v[132:135]
v_mul_f32 v238, v238, v174
v_mul_f32 v239, v239, v175
v_fma_f32 v238, -v126, v190, v238
v_mfma_f32_16x16x32_bf16 v[140:143], a[180:183], v[68:71], v[140:143]
ds_read_b128 v[104:107], v20 offset:55296
v_fma_f32 v239, -v127, v191, v239
v_fma_f32 v126, v126, v174, v2
v_fma_f32 v127, v127, v175, v3
v_mfma_f32_16x16x32_bf16 v[136:139], a[176:179], v[68:71], v[136:139]
v_fmac_f32 v224, s64, v60
v_cvt_pk_bf16_f32 v112, v224, v112
v_cvt_pk_bf16_f32 v113, v225, v113
v_cvt_pk_bf16_f32 v114, v226, v114
v_mfma_f32_16x16x32_bf16 v[128:131], a[184:187], v[72:75], v[128:131]
ds_read_b128 v[108:111], v20 offset:56320
s_waitcnt vmcnt(0)
v_cmp_ne_u32 vcc, s53, v23
s_cbranch_vccnz L_spin4
L_back4:
v_mfma_f32_16x16x32_bf16 v[132:135], a[188:191], v[72:75], v[132:135]
v_cvt_pk_bf16_f32 v115, v227, v115
v_cvt_pk_bf16_f32 v116, v228, v116
v_mfma_f32_16x16x32_bf16 v[140:143], a[188:191], v[76:79], v[140:143]
v_cvt_pk_bf16_f32 v117, v229, v117
v_cvt_pk_bf16_f32 v118, v230, v118
v_cvt_pk_bf16_f32 v119, v231, v119
v_mfma_f32_16x16x32_bf16 v[136:139], a[184:187], v[76:79], v[136:139]
v_cvt_pk_bf16_f32 v120, v232, v120
v_cvt_pk_bf16_f32 v121, v233, v121
v_cvt_pk_bf16_f32 v122, v234, v122
v_cvt_pk_bf16_f32 v123, v235, v123
v_mfma_f32_16x16x32_bf16 v[128:131], a[192:195], v[80:83], v[128:131]
v_cvt_pk_bf16_f32 v124, v236, v124
v_cvt_pk_bf16_f32 v125, v237, v125
v_cvt_pk_bf16_f32 v126, v238, v126
v_cvt_pk_bf16_f32 v127, v239, v127
v_mfma_f32_16x16x32_bf16 v[132:135], a[196:199], v[80:83], v[132:135]
v_mfma_f32_32x32x16_bf16 v[224:239], v[112:115], a[240:243], 0
v_mfma_f32_32x32x16_bf16 v[224:239], v[116:119], a[244:247], v[224:239]
v_mfma_f32_32x32x16_bf16 v[224:239], v[120:123], a[248:251], v[224:239]
v_mfma_f32_32x32x16_bf16 v[224:239], v[124:127], a[252:255], v[224:239]
v_mfma_f32_32x32x16_bf16 v[24:39], v[40:43], a[224:227], 0
v_mfma_f32_32x32x16_bf16 v[112:127], v[40:43], a[232:235], 0
v_mfma_f32_32x32x16_bf16 v[24:39], v[44:47], a[228:231], v[24:39]
v_mfma_f32_32x32x16_bf16 v[112:127], v[44:47], a[236:239], v[112:127]
s_waitcnt lgkmcnt(1)
v_mfma_f32_16x16x32_bf16 v[140:143], a[196:199], v[84:87], v[140:143]
s_waitcnt lgkmcnt(0)
s_barrier
ds_read_b128 v[64:67], v21 offset:0
v_mfma_f32_16x16x32_bf16 v[136:139], a[192:195], v[84:87], v[136:139]
ds_read_b128 v[68:71], v21 offset:1024
v_mfma_f32_16x16x32_bf16 v[128:131], a[200:203], v[88:91], v[128:131]
buffer_load_dwordx4 v20, s[24:27], s49 offen offset:0 sc1 lds
ds_read_b128 v[72:75], v21 offset:2048
v_mfma_f32_16x16x32_bf16 v[132:135], a[204:207], v[88:91], v[132:135]
ds_read_b128 v[76:79], v21 offset:3072
v_mul_f32 v2, v24, v176
v_mul_f32_e64 v3, v25, v177
v_mfma_f32_16x16x32_bf16 v[140:143], a[204:207], v[92:95], v[140:143]
ds_read_b128 v[80:83], v21 offset:4096
v_mul_f32 v24, v24, v160
v_mul_f32 v25, v25, v161
v_fma_f32 v24, -v112, v176, v24
v_mfma_f32_16x16x32_bf16 v[136:139], a[200:203], v[92:95], v[136:139]
v_fma_f32 v25, -v113, v177, v25
v_fma_f32 v112, v112, v160, v2
v_fma_f32 v113, v113, v161, v3
v_mul_f32_e64 v2, v26, v178
v_mfma_f32_16x16x32_bf16 v[128:131], a[208:211], v[96:99], v[128:131]
buffer_load_dwordx4 v20, s[24:27], s49 offen offset:1024 sc1 lds
ds_read_b128 v[84:87], v21 offset:5120
v_mul_f32_e64 v3, v27, v179
v_mfma_f32_16x16x32_bf16 v[132:135], a[212:215], v[96:99], v[132:135]
v_mul_f32 v26, v26, v162
v_mul_f32 v27, v27, v163
v_fma_f32 v26, -v114, v178, v26
v_mfma_f32_16x16x32_bf16 v[140:143], a[212:215], v[100:103], v[140:143]
ds_read_b128 v[88:91], v21 offset:6144
v_fma_f32 v27, -v115, v179, v27
v_fma_f32 v114, v114, v162, v2
v_fma_f32 v115, v115, v163, v3
v_mfma_f32_16x16x32_bf16 v[136:139], a[208:211], v[100:103], v[136:139]
v_mul_f32 v2, v28, v180
v_mul_f32 v3, v29, v181
v_mul_f32 v28, v28, v164
v_mul_f32 v29, v29, v165
v_mfma_f32_16x16x32_bf16 v[128:131], a[216:219], v[104:107], v[128:131]
buffer_load_dwordx4 v20, s[24:27], s49 offen offset:2048 sc1 lds
ds_read_b128 v[92:95], v21 offset:7168
v_fma_f32 v28, -v116, v180, v28
v_mfma_f32_16x16x32_bf16 v[132:135], a[220:223], v[104:107], v[132:135]
v_fma_f32 v29, -v117, v181, v29
v_fma_f32 v116, v116, v164, v2
v_fma_f32 v117, v117, v165, v3
v_mfma_f32_16x16x32_bf16 v[140:143], a[220:223], v[108:111], v[140:143]
ds_read_b128 v[96:99], v21 offset:8192
v_mul_f32 v2, v30, v182
v_mul_f32 v3, v31, v183
v_mul_f32_e64 v30, v30, v166
v_mfma_f32_16x16x32_bf16 v[136:139], a[216:219], v[108:111], v[136:139]
v_mul_f32 v31, v31, v167
v_fma_f32 v30, -v118, v182, v30
v_fma_f32 v31, -v119, v183, v31
s_waitcnt lgkmcnt(3)
v_mfma_f32_16x16x32_bf16 v[144:147], a[0:3], v[64:67], 0
buffer_load_dwordx4 v20, s[24:27], s49 offen offset:3072 sc1 lds
ds_read_b128 v[100:103], v21 offset:9216
s_add_u32 m0, s48, 0x1000
v_mfma_f32_16x16x32_bf16 v[148:151], a[4:7], v[64:67], 0
s_add_u32 s49, s55, 233472
v_fma_f32 v118, v118, v166, v2
v_fma_f32 v119, v119, v167, v3
v_mfma_f32_16x16x32_bf16 v[156:159], a[4:7], v[68:71], 0
ds_read_b128 v[104:107], v21 offset:10240
v_mul_f32 v2, v32, v184
v_mul_f32 v3, v33, v185
v_mul_f32_e64 v32, v32, v168
v_mfma_f32_16x16x32_bf16 v[152:155], a[0:3], v[68:71], 0
v_mul_f32_e64 v33, v33, v169
v_fma_f32 v32, -v120, v184, v32
v_fma_f32 v33, -v121, v185, v33
v_fma_f32 v120, v120, v168, v2
v_mfma_f32_16x16x32_bf16 v[144:147], a[8:11], v[72:75], v[144:147]
buffer_load_dwordx4 v20, s[24:27], s49 offen offset:0 sc1 lds
ds_read_b128 v[108:111], v21 offset:11264
v_cvt_pk_bf16_f32 v10, v128, v129
v_mfma_f32_16x16x32_bf16 v[148:151], a[12:15], v[72:75], v[148:151]
v_cvt_pk_bf16_f32 v11, v130, v131
v_cvt_pk_bf16_f32 v12, v132, v133
v_cvt_pk_bf16_f32 v13, v134, v135
v_mfma_f32_16x16x32_bf16 v[156:159], a[12:15], v[76:79], v[156:159]
buffer_store_dword v56, v57, s[24:27], s63 offen offset:512 sc1
ds_read_b128 v[64:67], v21 offset:12288
v_cvt_pk_bf16_f32 v14, v136, v137
v_mfma_f32_16x16x32_bf16 v[152:155], a[8:11], v[76:79], v[152:155]
v_cvt_pk_bf16_f32 v15, v138, v139
v_cvt_pk_bf16_f32 v16, v140, v141
v_cvt_pk_bf16_f32 v17, v142, v143
v_cvt_pk_bf16_f32 v6, v135, v143
v_mfma_f32_16x16x32_bf16 v[144:147], a[16:19], v[80:83], v[144:147]
buffer_load_dwordx4 v20, s[24:27], s49 offen offset:1024 sc1 lds
ds_read_b128 v[68:71], v21 offset:13312
v_bfi_b32 v13, s72, v13, v56
v_mfma_f32_16x16x32_bf16 v[148:151], a[20:23], v[80:83], v[148:151]
v_bfi_b32 v17, s72, v17, v56
v_fma_f32 v121, v121, v169, v3
v_mul_f32_e64 v2, v34, v186
v_mfma_f32_16x16x32_bf16 v[156:159], a[20:23], v[84:87], v[156:159]
buffer_store_dwordx4 v[10:13], v20, s[24:27], s69 offen offset:0 sc1
ds_read_b128 v[72:75], v21 offset:14336
v_mul_f32 v3, v35, v187
v_mul_f32 v34, v34, v170
v_mfma_f32_16x16x32_bf16 v[152:155], a[16:19], v[84:87], v[152:155]
v_mul_f32 v35, v35, v171
v_fma_f32 v34, -v122, v186, v34
v_fma_f32 v35, -v123, v187, v35
s_waitcnt lgkmcnt(3)
v_mfma_f32_16x16x32_bf16 v[144:147], a[24:27], v[88:91], v[144:147]
buffer_load_dwordx4 v20, s[24:27], s49 offen offset:2048 sc1 lds
ds_read_b128 v[76:79], v21 offset:15360
v_fma_f32 v122, v122, v170, v2
v_mfma_f32_16x16x32_bf16 v[148:151], a[28:31], v[88:91], v[148:151]
v_fma_f32 v123, v123, v171, v3
v_mul_f32 v2, v36, v188
v_mul_f32 v3, v37, v189
v_mfma_f32_16x16x32_bf16 v[156:159], a[28:31], v[92:95], v[156:159]
buffer_store_dwordx4 v[14:17], v20, s[24:27], s69 offen offset:1024 sc1
ds_read_b128 v[80:83], v21 offset:16384
v_mul_f32 v36, v36, v172
v_mul_f32 v37, v37, v173
v_mfma_f32_16x16x32_bf16 v[152:155], a[24:27], v[92:95], v[152:155]
v_fma_f32 v36, -v124, v188, v36
v_fma_f32 v37, -v125, v189, v37
v_fma_f32 v124, v124, v172, v2
v_fma_f32 v125, v125, v173, v3
v_mfma_f32_16x16x32_bf16 v[144:147], a[32:35], v[96:99], v[144:147]
buffer_load_dwordx4 v20, s[24:27], s49 offen offset:3072 sc1 lds
ds_read_b128 v[84:87], v21 offset:17408
s_add_u32 m0, s5, 0x8000
v_mfma_f32_16x16x32_bf16 v[148:151], a[36:39], v[96:99], v[148:151]
s_add_u32 s49, s56, 229376
v_mul_f32 v2, v38, v190
v_mul_f32 v3, v39, v191
v_mfma_f32_16x16x32_bf16 v[156:159], a[36:39], v[100:103], v[156:159]
ds_read_b128 v[88:91], v21 offset:18432
v_mul_f32 v38, v38, v174
v_mul_f32 v39, v39, v175
v_fma_f32 v38, -v126, v190, v38
v_mfma_f32_16x16x32_bf16 v[152:155], a[32:35], v[100:103], v[152:155]
v_fma_f32 v39, -v127, v191, v39
v_fma_f32 v126, v126, v174, v2
v_fma_f32 v127, v127, v175, v3
v_fmac_f32 v24, s65, v60
v_mfma_f32_16x16x32_bf16 v[144:147], a[40:43], v[104:107], v[144:147]
buffer_load_dwordx4 v20, s[24:27], s49 offen offset:0 sc1 lds
ds_read_b128 v[92:95], v21 offset:19456
v_cvt_pk_bf16_f32 v112, v24, v112
v_mfma_f32_16x16x32_bf16 v[148:151], a[44:47], v[104:107], v[148:151]
v_cvt_pk_bf16_f32 v113, v25, v113
v_cvt_pk_bf16_f32 v114, v26, v114
v_cvt_pk_bf16_f32 v115, v27, v115
v_mfma_f32_16x16x32_bf16 v[156:159], a[44:47], v[108:111], v[156:159]
ds_read_b128 v[96:99], v21 offset:20480
v_cvt_pk_bf16_f32 v116, v28, v116
v_cvt_pk_bf16_f32 v117, v29, v117
v_cvt_pk_bf16_f32 v118, v30, v118
v_mfma_f32_16x16x32_bf16 v[152:155], a[40:43], v[108:111], v[152:155]
v_cvt_pk_bf16_f32 v119, v31, v119
v_cvt_pk_bf16_f32 v120, v32, v120
v_cvt_pk_bf16_f32 v121, v33, v121
s_waitcnt lgkmcnt(3)
v_mfma_f32_16x16x32_bf16 v[144:147], a[48:51], v[64:67], v[144:147]
buffer_load_dwordx4 v20, s[24:27], s49 offen offset:1024 sc1 lds
ds_read_b128 v[100:103], v21 offset:21504
s_add_u32 s49, s57, 229376
v_mfma_f32_16x16x32_bf16 v[148:151], a[52:55], v[64:67], v[148:151]
v_cvt_pk_bf16_f32 v122, v34, v122
v_cvt_pk_bf16_f32 v123, v35, v123
v_cvt_pk_bf16_f32 v124, v36, v124
v_mfma_f32_16x16x32_bf16 v[156:159], a[52:55], v[68:71], v[156:159]
ds_read_b128 v[104:107], v21 offset:22528
v_cvt_pk_bf16_f32 v125, v37, v125
v_cvt_pk_bf16_f32 v126, v38, v126
v_cvt_pk_bf16_f32 v127, v39, v127
v_mfma_f32_16x16x32_bf16 v[152:155], a[48:51], v[68:71], v[152:155]
v_mfma_f32_32x32x16_bf16 v[24:39], v[112:115], a[240:243], 0
buffer_load_dwordx4 v20, s[24:27], s49 offen offset:2048 sc1 lds
v_mfma_f32_32x32x16_bf16 v[24:39], v[116:119], a[244:247], v[24:39]
buffer_load_dwordx4 v20, s[24:27], s49 offen offset:3072 sc1 lds
s_add_u32 m0, s5, 0x9000
s_add_u32 s49, s58, 229376
v_mfma_f32_32x32x16_bf16 v[24:39], v[120:123], a[248:251], v[24:39]
buffer_load_dwordx4 v20, s[24:27], s49 offen offset:0 sc1 lds
v_mfma_f32_32x32x16_bf16 v[24:39], v[124:127], a[252:255], v[24:39]
buffer_load_dwordx4 v20, s[24:27], s49 offen offset:1024 sc1 lds
v_mfma_f32_16x16x32_bf16 v[144:147], a[56:59], v[72:75], v[144:147]
ds_read_b128 v[108:111], v21 offset:23552
v_mfma_f32_16x16x32_bf16 v[148:151], a[60:63], v[72:75], v[148:151]
v_mfma_f32_16x16x32_bf16 v[156:159], a[60:63], v[76:79], v[156:159]
ds_read_b128 v[64:67], v21 offset:24576
v_mfma_f32_16x16x32_bf16 v[152:155], a[56:59], v[76:79], v[152:155]
v_mfma_f32_16x16x32_bf16 v[144:147], a[64:67], v[80:83], v[144:147]
ds_read_b128 v[68:71], v21 offset:25600
v_mfma_f32_16x16x32_bf16 v[148:151], a[68:71], v[80:83], v[148:151]
v_mfma_f32_16x16x32_bf16 v[156:159], a[68:71], v[84:87], v[156:159]
ds_read_b128 v[72:75], v21 offset:26624
v_add_f32 v48, v224, v24
v_add_f32 v49, v225, v25
v_add_f32_e64 v50, v226, v26
v_mfma_f32_16x16x32_bf16 v[152:155], a[64:67], v[84:87], v[152:155]
v_add_f32 v51, v227, v27
v_add_f32 v52, v228, v28
v_add_f32 v53, v229, v29
s_waitcnt lgkmcnt(3)
v_mfma_f32_16x16x32_bf16 v[144:147], a[72:75], v[88:91], v[144:147]
ds_read_b128 v[76:79], v21 offset:27648
v_add_f32 v54, v230, v30
v_add_f32 v55, v231, v31
v_cvt_pk_bf16_f32 v112, v48, v49
v_mfma_f32_16x16x32_bf16 v[148:151], a[76:79], v[88:91], v[148:151]
v_cvt_pk_bf16_f32 v113, v50, v51
v_cvt_pk_bf16_f32 v114, v52, v53
v_cvt_pk_bf16_f32 v115, v54, v55
v_mfma_f32_16x16x32_bf16 v[156:159], a[76:79], v[92:95], v[156:159]
buffer_store_dwordx4 v[112:115], v62, s[24:27], s82 offen sc1
ds_read_b128 v[80:83], v21 offset:28672
v_add_f32 v48, v232, v32
v_add_f32 v49, v233, v33
v_mfma_f32_16x16x32_bf16 v[152:155], a[72:75], v[92:95], v[152:155]
v_add_f32 v50, v234, v34
v_add_f32 v51, v235, v35
v_add_f32 v52, v236, v36
v_add_f32 v53, v237, v37
v_mfma_f32_16x16x32_bf16 v[144:147], a[80:83], v[96:99], v[144:147]
ds_read_b128 v[84:87], v21 offset:29696
s_add_u32 m0, s48, 0x10000
s_add_u32 s49, s55, 286720
v_add_f32_e64 v54, v238, v38
v_mfma_f32_16x16x32_bf16 v[148:151], a[84:87], v[96:99], v[148:151]
v_add_f32_e64 v55, v239, v39
v_cvt_pk_bf16_f32 v116, v48, v49
v_cvt_pk_bf16_f32 v117, v50, v51
v_mfma_f32_16x16x32_bf16 v[156:159], a[84:87], v[100:103], v[156:159]
ds_read_b128 v[88:91], v21 offset:30720
v_cvt_pk_bf16_f32 v118, v52, v53
v_cvt_pk_bf16_f32 v119, v54, v55
v_sub_f32_e64 v48, v224, v24
v_mfma_f32_16x16x32_bf16 v[152:155], a[80:83], v[100:103], v[152:155]
v_sub_f32 v49, v225, v25
v_sub_f32 v50, v226, v26
v_sub_f32 v51, v227, v27
v_sub_f32 v52, v228, v28
v_mfma_f32_16x16x32_bf16 v[144:147], a[88:91], v[104:107], v[144:147]
ds_read_b128 v[92:95], v21 offset:31744
v_sub_f32 v53, v229, v29
v_sub_f32 v54, v230, v30
v_sub_f32_e64 v55, v231, v31
v_mfma_f32_16x16x32_bf16 v[148:151], a[92:95], v[104:107], v[148:151]
v_cvt_pk_bf16_f32 v120, v48, v49
v_cvt_pk_bf16_f32 v121, v50, v51
v_cvt_pk_bf16_f32 v122, v52, v53
v_mfma_f32_16x16x32_bf16 v[156:159], a[92:95], v[108:111], v[156:159]
v_cvt_pk_bf16_f32 v123, v54, v55
v_sub_f32 v48, v232, v32
v_sub_f32 v49, v233, v33
v_sub_f32_e64 v50, v234, v34
v_mfma_f32_16x16x32_bf16 v[152:155], a[88:91], v[108:111], v[152:155]
v_sub_f32 v51, v235, v35
v_sub_f32 v52, v236, v36
v_sub_f32 v53, v237, v37
s_waitcnt lgkmcnt(2)
v_mfma_f32_16x16x32_bf16 v[144:147], a[96:99], v[64:67], v[144:147]
v_sub_f32 v54, v238, v38
v_sub_f32 v55, v239, v39
v_cvt_pk_bf16_f32 v124, v48, v49
v_cvt_pk_bf16_f32 v125, v50, v51
v_mfma_f32_16x16x32_bf16 v[148:151], a[100:103], v[64:67], v[148:151]
v_cvt_pk_bf16_f32 v126, v52, v53
v_cvt_pk_bf16_f32 v127, v54, v55
s_add_u32 s82, s82, 0x40000
v_mfma_f32_16x16x32_bf16 v[156:159], a[100:103], v[68:71], v[156:159]
s_waitcnt lgkmcnt(0)
s_barrier
ds_read_b128 v[96:99], v21 offset:32768
v_mfma_f32_16x16x32_bf16 v[152:155], a[96:99], v[68:71], v[152:155]
ds_read_b128 v[100:103], v21 offset:33792
v_mfma_f32_16x16x32_bf16 v[144:147], a[104:107], v[72:75], v[144:147]
buffer_load_dwordx4 v20, s[24:27], s49 offen offset:0 sc1 lds
ds_read_b128 v[104:107], v21 offset:34816
v_lshrrev_b32_e64 v40, 4, v0
v_mfma_f32_16x16x32_bf16 v[148:151], a[108:111], v[72:75], v[148:151]
ds_read_b128 v[108:111], v21 offset:35840
v_lshlrev_b32_e64 v3, 4, v40
v_bfe_u32 v41, v0, 2, 2
v_mfma_f32_16x16x32_bf16 v[156:159], a[108:111], v[76:79], v[156:159]
buffer_store_dwordx4 v[116:119], v62, s[24:27], s82 offen sc1
ds_read_b128 v[64:67], v21 offset:36864
s_add_u32 s82, s82, 0x40000
v_and_b32_e64 v42, 3, v0
v_mfma_f32_16x16x32_bf16 v[152:155], a[104:107], v[76:79], v[152:155]
v_lshl_add_u32 v41, v41, 4, v42
v_lshlrev_b32_e64 v41, 8, v41
v_add_u32 v41, 131072, v41
v_and_b32_e64 v42, 15, v0
v_mfma_f32_16x16x32_bf16 v[144:147], a[112:115], v[80:83], v[144:147]
buffer_store_dwordx4 v[120:123], v62, s[24:27], s82 offen sc1
ds_read_b128 v[68:71], v21 offset:37888
s_add_u32 s82, s82, 0x40000
v_lshl_add_u32 v43, s36, 2, v40
v_mfma_f32_16x16x32_bf16 v[148:151], a[116:119], v[80:83], v[148:151]
v_xor_b32_e64 v43, v43, v42
v_lshl_add_u32 v4, v43, 4, v41
ds_read_b128 v[24:27], v4 offset:0
v_mfma_f32_16x16x32_bf16 v[156:159], a[116:119], v[84:87], v[156:159]
buffer_load_dwordx4 v20, s[24:27], s49 offen offset:1024 sc1 lds
ds_read_b128 v[72:75], v21 offset:38912
ds_read_b128 v[28:31], v4 offset:1024
v_mfma_f32_16x16x32_bf16 v[152:155], a[112:115], v[84:87], v[152:155]
ds_read_b128 v[32:35], v4 offset:2048
ds_read_b128 v[36:39], v4 offset:3072
v_lshl_add_u32 v43, v40, 2, s36
v_xor_b32_e64 v43, v43, v42
v_mfma_f32_16x16x32_bf16 v[144:147], a[120:123], v[88:91], v[144:147]
buffer_store_dwordx4 v[124:127], v62, s[24:27], s82 offen sc1
ds_read_b128 v[76:79], v21 offset:39936
v_lshl_add_u32 v60, v43, 4, v41
v_lshl_add_u32 v2, v42, 11, v3
v_mfma_f32_16x16x32_bf16 v[148:151], a[124:127], v[88:91], v[148:151]
v_min_u32 v42, 15, v0
v_and_b32 v43, 12, v42
v_mul_u32_u24_e64 v43, 3, v43
v_mfma_f32_16x16x32_bf16 v[156:159], a[124:127], v[92:95], v[156:159]
ds_read_b128 v[80:83], v21 offset:40960
v_add_u32_e64 v42, v42, v43
v_lshl_add_u32 v42, s36, 2, v42
v_lshlrev_b32_e64 v62, 7, v42
v_mfma_f32_16x16x32_bf16 v[152:155], a[120:123], v[92:95], v[152:155]
v_lshrrev_b32_e64 v42, 4, v0
v_lshl_add_u32 v42, s36, 2, v42
v_xor_b32 v22, v42, v0
s_waitcnt lgkmcnt(7)
v_mfma_f32_16x16x32_bf16 v[144:147], a[128:131], v[96:99], v[144:147]
buffer_load_dword v23, v1, s[24:27], s59 offen offset:384 sc1
ds_read_b128 v[84:87], v21 offset:41984
v_lshlrev_b32_e64 v42, 12, v42
v_mfma_f32_16x16x32_bf16 v[148:151], a[132:135], v[96:99], v[148:151]
v_bfe_u32 v43, v22, 2, 2
v_lshl_add_u32 v42, v43, 17, v42
v_and_b32_e64 v22, 3, v22
v_mfma_f32_16x16x32_bf16 v[156:159], a[132:135], v[100:103], v[156:159]
buffer_load_dwordx4 v20, s[24:27], s49 offen offset:2048 sc1 lds
ds_read_b128 v[88:91], v21 offset:43008
v_lshl_add_u32 v22, v22, 4, v42
v_mfma_f32_16x16x32_bf16 v[152:155], a[128:131], v[100:103], v[152:155]
s_add_u32 s45, s71, 4096
s_add_u32 s46, s71, 8192
s_add_u32 s62, s71, 12288
v_mfma_f32_16x16x32_bf16 v[144:147], a[136:139], v[104:107], v[144:147]
ds_read_b128 v[92:95], v21 offset:44032
s_waitcnt lgkmcnt(9)
v_permlane32_swap_b32 v24, v26
v_permlane32_swap_b32_e64 v25, v27
v_mfma_f32_16x16x32_bf16 v[148:151], a[140:143], v[104:107], v[148:151]
s_waitcnt lgkmcnt(7)
v_permlane32_swap_b32 v28, v30
v_permlane32_swap_b32_e64 v29, v31
v_mfma_f32_16x16x32_bf16 v[156:159], a[140:143], v[108:111], v[156:159]
buffer_load_dwordx4 v20, s[24:27], s49 offen offset:3072 sc1 lds
ds_read_b128 v[96:99], v21 offset:45056
s_add_u32 m0, s48, 0x11000
v_mfma_f32_16x16x32_bf16 v[152:155], a[136:139], v[108:111], v[152:155]
s_add_u32 s49, s55, 290816
s_waitcnt lgkmcnt(7)
v_permlane32_swap_b32 v32, v34
v_permlane32_swap_b32_e64 v33, v35
v_mfma_f32_16x16x32_bf16 v[144:147], a[144:147], v[64:67], v[144:147]
ds_read_b128 v[100:103], v21 offset:46080
s_waitcnt lgkmcnt(7)
v_permlane32_swap_b32 v36, v38
v_permlane32_swap_b32_e64 v37, v39
v_mfma_f32_16x16x32_bf16 v[148:151], a[148:151], v[64:67], v[148:151]
v_lshlrev_b32_e64 v192, 16, v24
v_and_b32 v193, 0xffff0000, v24
v_lshlrev_b32_e64 v194, 16, v25
v_mfma_f32_16x16x32_bf16 v[156:159], a[148:151], v[68:71], v[156:159]
ds_read_b128 v[104:107], v21 offset:47104
v_and_b32 v195, 0xffff0000, v25
v_lshlrev_b32_e64 v196, 16, v26
v_and_b32 v197, 0xffff0000, v26
v_mfma_f32_16x16x32_bf16 v[152:155], a[144:147], v[68:71], v[152:155]
v_lshlrev_b32_e64 v198, 16, v27
v_and_b32 v199, 0xffff0000, v27
v_lshlrev_b32_e64 v200, 16, v28
v_and_b32 v201, 0xffff0000, v28
v_mfma_f32_16x16x32_bf16 v[144:147], a[152:155], v[72:75], v[144:147]
buffer_load_dwordx4 v20, s[24:27], s49 offen offset:0 sc1 lds
ds_read_b128 v[108:111], v21 offset:48128
v_lshlrev_b32_e64 v202, 16, v29
v_mfma_f32_16x16x32_bf16 v[148:151], a[156:159], v[72:75], v[148:151]
v_and_b32 v203, 0xffff0000, v29
v_lshlrev_b32 v204, 16, v30
s_waitcnt lgkmcnt(3)
v_mfma_f32_16x16x32_bf16 v[156:159], a[156:159], v[76:79], v[156:159]
ds_read_b128 v[64:67], v21 offset:49152
v_and_b32 v205, 0xffff0000, v30
v_lshlrev_b32_e64 v206, 16, v31
v_and_b32 v207, 0xffff0000, v31
v_mfma_f32_16x16x32_bf16 v[152:155], a[152:155], v[76:79], v[152:155]
v_lshlrev_b32_e64 v208, 16, v32
v_and_b32 v209, 0xffff0000, v32
v_lshlrev_b32_e64 v210, 16, v33
v_and_b32 v211, 0xffff0000, v33
v_mfma_f32_16x16x32_bf16 v[144:147], a[160:163], v[80:83], v[144:147]
ds_read_b128 v[68:71], v21 offset:50176
v_lshlrev_b32_e64 v212, 16, v34
v_and_b32 v213, 0xffff0000, v34
v_lshlrev_b32_e64 v214, 16, v35
v_mfma_f32_16x16x32_bf16 v[148:151], a[164:167], v[80:83], v[148:151]
v_and_b32 v215, 0xffff0000, v35
v_lshlrev_b32_e64 v216, 16, v36
v_and_b32 v217, 0xffff0000, v36
v_mfma_f32_16x16x32_bf16 v[156:159], a[164:167], v[84:87], v[156:159]
buffer_load_dwordx4 v20, s[24:27], s49 offen offset:1024 sc1 lds
ds_read_b128 v[72:75], v21 offset:51200
v_lshlrev_b32_e64 v218, 16, v37
v_mfma_f32_16x16x32_bf16 v[152:155], a[160:163], v[84:87], v[152:155]
v_and_b32 v219, 0xffff0000, v37
v_lshlrev_b32_e64 v220, 16, v38
v_and_b32 v221, 0xffff0000, v38
v_lshlrev_b32_e64 v222, 16, v39
v_mfma_f32_16x16x32_bf16 v[144:147], a[168:171], v[88:91], v[144:147]
ds_read_b128 v[76:79], v21 offset:52224
v_and_b32 v223, 0xffff0000, v39
v_permlane32_swap_b32 v240, v242
v_permlane32_swap_b32 v241, v243
v_mfma_f32_16x16x32_bf16 v[148:151], a[172:175], v[88:91], v[148:151]
v_lshlrev_b32_e64 v44, 16, v240
v_and_b32 v45, 0xffff0000, v240
v_add_f32_e64 v192, v192, v44
v_mfma_f32_16x16x32_bf16 v[156:159], a[172:175], v[92:95], v[156:159]
ds_read_b128 v[80:83], v21 offset:53248
v_add_f32 v193, v193, v45
v_add_f32 v200, v200, v44
v_add_f32_e64 v201, v201, v45
v_mfma_f32_16x16x32_bf16 v[152:155], a[168:171], v[92:95], v[152:155]
v_add_f32 v208, v208, v44
v_add_f32 v209, v209, v45
v_add_f32 v216, v216, v44
v_add_f32 v217, v217, v45
v_mfma_f32_16x16x32_bf16 v[144:147], a[176:179], v[96:99], v[144:147]
buffer_load_dwordx4 v20, s[24:27], s49 offen offset:2048 sc1 lds
ds_read_b128 v[84:87], v21 offset:54272
v_lshlrev_b32_e64 v46, 16, v241
v_mfma_f32_16x16x32_bf16 v[148:151], a[180:183], v[96:99], v[148:151]
v_and_b32 v47, 0xffff0000, v241
v_add_f32 v194, v194, v46
s_waitcnt lgkmcnt(3)
v_mfma_f32_16x16x32_bf16 v[156:159], a[180:183], v[100:103], v[156:159]
buffer_load_dwordx4 v[160:163], v20, s[24:27], s71 offen offset:0 sc1
ds_read_b128 v[88:91], v21 offset:55296
v_add_f32_e64 v195, v195, v47
v_mfma_f32_16x16x32_bf16 v[152:155], a[176:179], v[100:103], v[152:155]
v_add_f32 v202, v202, v46
v_add_f32 v203, v203, v47
v_add_f32 v210, v210, v46
v_add_f32 v211, v211, v47
v_mfma_f32_16x16x32_bf16 v[144:147], a[184:187], v[104:107], v[144:147]
buffer_load_dwordx4 v[164:167], v20, s[24:27], s71 offen offset:1024 sc1
ds_read_b128 v[92:95], v21 offset:56320
v_add_f32_e64 v218, v218, v46
v_mfma_f32_16x16x32_bf16 v[148:151], a[188:191], v[104:107], v[148:151]
v_add_f32 v219, v219, v47
v_lshlrev_b32 v44, 16, v242
v_and_b32 v45, 0xffff0000, v242
v_mfma_f32_16x16x32_bf16 v[156:159], a[188:191], v[108:111], v[156:159]
buffer_load_dwordx4 v20, s[24:27], s49 offen offset:3072 sc1 lds
s_add_u32 m0, s5, 0x18000
s_add_u32 s49, s56, 286720
v_mfma_f32_16x16x32_bf16 v[152:155], a[184:187], v[108:111], v[152:155]
v_add_f32 v196, v196, v44
v_add_f32 v197, v197, v45
v_add_f32 v204, v204, v44
v_add_f32 v205, v205, v45
v_mfma_f32_16x16x32_bf16 v[144:147], a[192:195], v[64:67], v[144:147]
buffer_load_dwordx4 v[168:171], v20, s[24:27], s71 offen offset:2048 sc1
v_add_f32_e64 v212, v212, v44
v_mfma_f32_16x16x32_bf16 v[148:151], a[196:199], v[64:67], v[148:151]
v_add_f32 v213, v213, v45
v_add_f32 v220, v220, v44
v_mfma_f32_16x16x32_bf16 v[156:159], a[196:199], v[68:71], v[156:159]
s_waitcnt vmcnt(22) lgkmcnt(0)
s_barrier
ds_read_b128 v[96:99], v20 offset:0
v_mfma_f32_16x16x32_bf16 v[152:155], a[192:195], v[68:71], v[152:155]
ds_read_b128 v[100:103], v20 offset:1024
v_add_f32_e64 v221, v221, v45
v_mfma_f32_16x16x32_bf16 v[144:147], a[200:203], v[72:75], v[144:147]
buffer_load_dwordx4 v[172:175], v20, s[24:27], s71 offen offset:3072 sc1
ds_read_b128 v[104:107], v20 offset:2048
v_mfma_f32_16x16x32_bf16 v[148:151], a[204:207], v[72:75], v[148:151]
ds_read_b128 v[108:111], v20 offset:3072
v_lshlrev_b32_e64 v46, 16, v243
v_mfma_f32_16x16x32_bf16 v[156:159], a[204:207], v[76:79], v[156:159]
buffer_load_dwordx4 v20, s[24:27], s49 offen offset:0 sc1 lds
ds_read_b128 v[64:67], v20 offset:4096
v_mfma_f32_16x16x32_bf16 v[152:155], a[200:203], v[76:79], v[152:155]
v_and_b32 v47, 0xffff0000, v243
v_add_f32_e64 v198, v198, v46
v_mfma_f32_16x16x32_bf16 v[144:147], a[208:211], v[80:83], v[144:147]
buffer_load_dwordx4 v[40:43], v20, s[24:27], s45 offen offset:0 sc1
ds_read_b128 v[68:71], v20 offset:5120
v_mfma_f32_16x16x32_bf16 v[148:151], a[212:215], v[80:83], v[148:151]
v_add_f32 v199, v199, v47
v_add_f32 v206, v206, v46
v_mfma_f32_16x16x32_bf16 v[156:159], a[212:215], v[84:87], v[156:159]
ds_read_b128 v[72:75], v20 offset:6144
v_add_f32 v207, v207, v47
v_add_f32 v214, v214, v46
v_mfma_f32_16x16x32_bf16 v[152:155], a[208:211], v[84:87], v[152:155]
v_add_f32 v215, v215, v47
v_add_f32 v222, v222, v46
v_mfma_f32_16x16x32_bf16 v[144:147], a[216:219], v[88:91], v[144:147]
ds_read_b128 v[76:79], v20 offset:7168
v_add_f32 v223, v223, v47
v_mfma_f32_16x16x32_bf16 v[148:151], a[220:223], v[88:91], v[148:151]
v_mfma_f32_16x16x32_bf16 v[156:159], a[220:223], v[92:95], v[156:159]
buffer_load_dwordx4 v20, s[24:27], s49 offen offset:1024 sc1 lds
ds_read_b128 v[80:83], v20 offset:8192
v_mfma_f32_16x16x32_bf16 v[152:155], a[216:219], v[92:95], v[152:155]
s_add_u32 s49, s57, 286720
s_waitcnt lgkmcnt(3)
v_mfma_f32_16x16x32_bf16 v[128:131], a[0:3], v[96:99], 0
ds_read_b128 v[84:87], v20 offset:9216
v_mfma_f32_16x16x32_bf16 v[132:135], a[4:7], v[96:99], 0
v_mfma_f32_16x16x32_bf16 v[140:143], a[4:7], v[100:103], 0
ds_read_b128 v[88:91], v20 offset:10240
v_mfma_f32_16x16x32_bf16 v[136:139], a[0:3], v[100:103], 0
v_mfma_f32_16x16x32_bf16 v[128:131], a[8:11], v[104:107], v[128:131]
ds_read_b128 v[92:95], v20 offset:11264
v_cvt_pk_bf16_f32 v10, v144, v145
v_cvt_pk_bf16_f32 v11, v146, v147
v_mfma_f32_16x16x32_bf16 v[132:135], a[12:15], v[104:107], v[132:135]
v_cvt_pk_bf16_f32 v12, v148, v149
v_cvt_pk_bf16_f32 v13, v150, v151
v_mfma_f32_16x16x32_bf16 v[140:143], a[12:15], v[108:111], v[140:143]
buffer_load_dwordx4 v20, s[24:27], s49 offen offset:2048 sc1 lds
ds_read_b128 v[96:99], v20 offset:12288
v_mfma_f32_16x16x32_bf16 v[136:139], a[8:11], v[108:111], v[136:139]
v_cvt_pk_bf16_f32 v14, v152, v153
v_cvt_pk_bf16_f32 v15, v154, v155
v_mfma_f32_16x16x32_bf16 v[128:131], a[16:19], v[64:67], v[128:131]
ds_read_b128 v[100:103], v20 offset:13312
v_cvt_pk_bf16_f32 v16, v156, v157
v_cvt_pk_bf16_f32 v17, v158, v159
v_mfma_f32_16x16x32_bf16 v[132:135], a[20:23], v[64:67], v[132:135]
v_cvt_pk_bf16_f32 v7, v151, v159
v_bfi_b32 v13, s72, v13, v56
v_mfma_f32_16x16x32_bf16 v[140:143], a[20:23], v[68:71], v[140:143]
ds_read_b128 v[104:107], v20 offset:14336
v_bfi_b32 v17, s72, v17, v56
v_mfma_f32_16x16x32_bf16 v[136:139], a[16:19], v[68:71], v[136:139]
buffer_store_dwordx4 v[10:13], v20, s[24:27], s69 offen offset:2048 sc1
s_waitcnt lgkmcnt(3)
v_mfma_f32_16x16x32_bf16 v[128:131], a[24:27], v[72:75], v[128:131]
buffer_store_dwordx4 v[14:17], v20, s[24:27], s69 offen offset:3072 sc1
ds_read_b128 v[108:111], v20 offset:15360
s_add_u32 s69, s69, 4096
v_mfma_f32_16x16x32_bf16 v[132:135], a[28:31], v[72:75], v[132:135]
v_mfma_f32_16x16x32_bf16 v[140:143], a[28:31], v[76:79], v[140:143]
buffer_load_dwordx4 v20, s[24:27], s49 offen offset:3072 sc1 lds
ds_read_b128 v[64:67], v20 offset:16384
v_mfma_f32_16x16x32_bf16 v[136:139], a[24:27], v[76:79], v[136:139]
s_add_u32 m0, s5, 0x19000
s_add_u32 s49, s58, 286720
v_mfma_f32_16x16x32_bf16 v[128:131], a[32:35], v[80:83], v[128:131]
buffer_store_dwordx4 v[6:9], v20, s[24:27], s69 offen sc1
ds_read_b128 v[68:71], v20 offset:17408
v_mfma_f32_16x16x32_bf16 v[132:135], a[36:39], v[80:83], v[132:135]
v_mfma_f32_16x16x32_bf16 v[140:143], a[36:39], v[84:87], v[140:143]
ds_read_b128 v[72:75], v20 offset:18432
v_mfma_f32_16x16x32_bf16 v[136:139], a[32:35], v[84:87], v[136:139]
v_mfma_f32_16x16x32_bf16 v[128:131], a[40:43], v[88:91], v[128:131]
ds_read_b128 v[76:79], v20 offset:19456
v_mfma_f32_16x16x32_bf16 v[132:135], a[44:47], v[88:91], v[132:135]
v_mfma_f32_16x16x32_bf16 v[140:143], a[44:47], v[92:95], v[140:143]
buffer_load_dwordx4 v20, s[24:27], s49 offen offset:0 sc1 lds
ds_read_b128 v[80:83], v20 offset:20480
v_mfma_f32_16x16x32_bf16 v[136:139], a[40:43], v[92:95], v[136:139]
s_waitcnt lgkmcnt(3)
v_mfma_f32_16x16x32_bf16 v[128:131], a[48:51], v[96:99], v[128:131]
ds_read_b128 v[84:87], v20 offset:21504
v_mfma_f32_16x16x32_bf16 v[132:135], a[52:55], v[96:99], v[132:135]
v_mfma_f32_16x16x32_bf16 v[140:143], a[52:55], v[100:103], v[140:143]
ds_read_b128 v[88:91], v20 offset:22528
v_mfma_f32_16x16x32_bf16 v[136:139], a[48:51], v[100:103], v[136:139]
v_mfma_f32_16x16x32_bf16 v[128:131], a[56:59], v[104:107], v[128:131]
ds_read_b128 v[92:95], v20 offset:23552
v_mfma_f32_16x16x32_bf16 v[132:135], a[60:63], v[104:107], v[132:135]
v_mfma_f32_16x16x32_bf16 v[140:143], a[60:63], v[108:111], v[140:143]
buffer_load_dwordx4 v20, s[24:27], s49 offen offset:1024 sc1 lds
ds_read_b128 v[96:99], v20 offset:24576
v_mfma_f32_16x16x32_bf16 v[136:139], a[56:59], v[108:111], v[136:139]
v_mfma_f32_16x16x32_bf16 v[128:131], a[64:67], v[64:67], v[128:131]
ds_read_b128 v[100:103], v20 offset:25600
v_mfma_f32_16x16x32_bf16 v[132:135], a[68:71], v[64:67], v[132:135]
v_mfma_f32_16x16x32_bf16 v[140:143], a[68:71], v[68:71], v[140:143]
ds_read_b128 v[104:107], v20 offset:26624
v_mfma_f32_16x16x32_bf16 v[136:139], a[64:67], v[68:71], v[136:139]
s_waitcnt lgkmcnt(3)
v_mfma_f32_16x16x32_bf16 v[128:131], a[72:75], v[72:75], v[128:131]
ds_read_b128 v[108:111], v20 offset:27648
v_mfma_f32_16x16x32_bf16 v[132:135], a[76:79], v[72:75], v[132:135]
v_mfma_f32_16x16x32_bf16 v[140:143], a[76:79], v[76:79], v[140:143]
ds_read_b128 v[64:67], v20 offset:28672
v_mfma_f32_16x16x32_bf16 v[136:139], a[72:75], v[76:79], v[136:139]
v_mfma_f32_16x16x32_bf16 v[128:131], a[80:83], v[80:83], v[128:131]
ds_read_b128 v[68:71], v20 offset:29696
s_add_u32 m0, s48, 0x0
s_add_u32 s49, s55, 344064
v_mfma_f32_16x16x32_bf16 v[132:135], a[84:87], v[80:83], v[132:135]
v_mfma_f32_16x16x32_bf16 v[140:143], a[84:87], v[84:87], v[140:143]
ds_read_b128 v[72:75], v20 offset:30720
v_mfma_f32_16x16x32_bf16 v[136:139], a[80:83], v[84:87], v[136:139]
v_mfma_f32_16x16x32_bf16 v[128:131], a[88:91], v[88:91], v[128:131]
ds_read_b128 v[76:79], v20 offset:31744
s_waitcnt vmcnt(20)
v_cmp_ne_u32 vcc, s53, v23
s_cbranch_vccnz L_spin5
L_back5:
v_mfma_f32_16x16x32_bf16 v[132:135], a[92:95], v[88:91], v[132:135]
v_mfma_f32_16x16x32_bf16 v[140:143], a[92:95], v[92:95], v[140:143]
v_mfma_f32_16x16x32_bf16 v[136:139], a[88:91], v[92:95], v[136:139]
s_waitcnt lgkmcnt(2)
v_mfma_f32_16x16x32_bf16 v[128:131], a[96:99], v[96:99], v[128:131]
buffer_store_dword v56, v57, s[24:27], s83 offen offset:0 sc1
v_mfma_f32_16x16x32_bf16 v[132:135], a[100:103], v[96:99], v[132:135]
v_mfma_f32_16x16x32_bf16 v[140:143], a[100:103], v[100:103], v[140:143]
s_waitcnt lgkmcnt(0)
s_barrier
v_mfma_f32_16x16x32_bf16 v[136:139], a[96:99], v[100:103], v[136:139]
ds_read_b128 v[80:83], v20 offset:32768
v_mfma_f32_16x16x32_bf16 v[128:131], a[104:107], v[104:107], v[128:131]
buffer_load_dwordx4 v20, s[24:27], s49 offen offset:0 sc1 lds
ds_read_b128 v[84:87], v20 offset:33792
v_mfma_f32_16x16x32_bf16 v[132:135], a[108:111], v[104:107], v[132:135]
ds_read_b128 v[88:91], v20 offset:34816
v_mfma_f32_16x16x32_bf16 v[140:143], a[108:111], v[108:111], v[140:143]
ds_read_b128 v[92:95], v20 offset:35840
v_mfma_f32_16x16x32_bf16 v[136:139], a[104:107], v[108:111], v[136:139]
ds_read_b128 v[96:99], v20 offset:36864
v_mfma_f32_16x16x32_bf16 v[128:131], a[112:115], v[64:67], v[128:131]
ds_read_b128 v[100:103], v20 offset:37888
v_mfma_f32_16x16x32_bf16 v[132:135], a[116:119], v[64:67], v[132:135]
v_mfma_f32_16x16x32_bf16 v[140:143], a[116:119], v[68:71], v[140:143]
buffer_load_dwordx4 v20, s[24:27], s49 offen offset:1024 sc1 lds
ds_read_b128 v[104:107], v20 offset:38912
v_mfma_f32_16x16x32_bf16 v[136:139], a[112:115], v[68:71], v[136:139]
v_mfma_f32_16x16x32_bf16 v[128:131], a[120:123], v[72:75], v[128:131]
ds_read_b128 v[108:111], v20 offset:39936
v_mfma_f32_16x16x32_bf16 v[132:135], a[124:127], v[72:75], v[132:135]
v_mfma_f32_16x16x32_bf16 v[140:143], a[124:127], v[76:79], v[140:143]
ds_read_b128 v[64:67], v20 offset:40960
s_waitcnt vmcnt(11)
v_xor_b32 v44, s53, v43
v_mfma_f32_16x16x32_bf16 v[136:139], a[120:123], v[76:79], v[136:139]
v_xor_b32 v45, s53, v175
s_waitcnt lgkmcnt(3)
v_mfma_f32_16x16x32_bf16 v[128:131], a[128:131], v[80:83], v[128:131]
buffer_load_dword v23, v1, s[24:27], s59 offen offset:512 sc1
ds_read_b128 v[68:71], v20 offset:41984
v_mfma_f32_16x16x32_bf16 v[132:135], a[132:135], v[80:83], v[132:135]
v_xor_b32_e64 v46, s53, v171
v_or3_b32 v44, v44, v45, v46
v_mfma_f32_16x16x32_bf16 v[140:143], a[132:135], v[84:87], v[140:143]
buffer_load_dwordx4 v20, s[24:27], s49 offen offset:2048 sc1 lds
ds_read_b128 v[72:75], v20 offset:43008
v_mfma_f32_16x16x32_bf16 v[136:139], a[128:131], v[84:87], v[136:139]
v_xor_b32 v45, s53, v167
v_xor_b32 v46, s53, v163
v_mfma_f32_16x16x32_bf16 v[128:131], a[136:139], v[88:91], v[128:131]
ds_read_b128 v[76:79], v20 offset:44032
v_or3_b32 v44, v44, v45, v46
v_mfma_f32_16x16x32_bf16 v[132:135], a[140:143], v[88:91], v[132:135]
v_cmp_lt_u32 vcc, s72, v44
s_cbranch_vccnz L_spin6
L_back6:
v_mfma_f32_16x16x32_bf16 v[140:143], a[140:143], v[92:95], v[140:143]
buffer_load_dwordx4 v20, s[24:27], s49 offen offset:3072 sc1 lds
v_mfma_f32_16x16x32_bf16 v[136:139], a[136:139], v[92:95], v[136:139]
ds_read_b128 v[80:83], v20 offset:45056
s_add_u32 m0, s48, 0x1000
v_mfma_f32_16x16x32_bf16 v[128:131], a[144:147], v[96:99], v[128:131]
ds_read_b128 v[84:87], v20 offset:46080
s_add_u32 s49, s55, 348160
v_mfma_f32_16x16x32_bf16 v[132:135], a[148:151], v[96:99], v[132:135]
v_lshlrev_b32_e64 v44, 16, v160
v_and_b32 v45, 0xffff0000, v160
v_mfma_f32_16x16x32_bf16 v[140:143], a[148:151], v[100:103], v[140:143]
ds_read_b128 v[88:91], v20 offset:47104
v_add_f32 v192, v192, v44
v_add_f32 v193, v193, v45
v_mfma_f32_16x16x32_bf16 v[136:139], a[144:147], v[100:103], v[136:139]
v_lshlrev_b32 v46, 16, v161
s_waitcnt lgkmcnt(3)
v_mfma_f32_16x16x32_bf16 v[128:131], a[152:155], v[104:107], v[128:131]
buffer_load_dwordx4 v20, s[24:27], s49 offen offset:0 sc1 lds
ds_read_b128 v[92:95], v20 offset:48128
v_mfma_f32_16x16x32_bf16 v[132:135], a[156:159], v[104:107], v[132:135]
v_and_b32 v47, 0xffff0000, v161
v_add_f32_e64 v194, v194, v46
v_mfma_f32_16x16x32_bf16 v[140:143], a[156:159], v[108:111], v[140:143]
ds_read_b128 v[96:99], v20 offset:49152
v_add_f32 v195, v195, v47
v_lshlrev_b32 v44, 16, v162
v_mfma_f32_16x16x32_bf16 v[136:139], a[152:155], v[108:111], v[136:139]
v_and_b32 v45, 0xffff0000, v162
v_add_f32_e64 v196, v196, v44
v_mfma_f32_16x16x32_bf16 v[128:131], a[160:163], v[64:67], v[128:131]
ds_read_b128 v[100:103], v20 offset:50176
v_add_f32 v197, v197, v45
v_lshlrev_b32 v46, 16, v163
v_mfma_f32_16x16x32_bf16 v[132:135], a[164:167], v[64:67], v[132:135]
v_lshlrev_b32 v47, 16, v40
v_add_f32 v198, v198, v46
v_mfma_f32_16x16x32_bf16 v[140:143], a[164:167], v[68:71], v[140:143]
buffer_load_dwordx4 v20, s[24:27], s49 offen offset:1024 sc1 lds
ds_read_b128 v[104:107], v20 offset:51200
v_mfma_f32_16x16x32_bf16 v[136:139], a[160:163], v[68:71], v[136:139]
v_add_f32 v199, v199, v47
v_lshlrev_b32 v44, 16, v164
v_mfma_f32_16x16x32_bf16 v[128:131], a[168:171], v[72:75], v[128:131]
ds_read_b128 v[108:111], v20 offset:52224
v_and_b32 v45, 0xffff0000, v164
v_add_f32_e64 v200, v200, v44
v_mfma_f32_16x16x32_bf16 v[132:135], a[172:175], v[72:75], v[132:135]
v_add_f32 v201, v201, v45
v_lshlrev_b32 v46, 16, v165
v_mfma_f32_16x16x32_bf16 v[140:143], a[172:175], v[76:79], v[140:143]
ds_read_b128 v[64:67], v20 offset:53248
v_and_b32 v47, 0xffff0000, v165
v_add_f32_e64 v202, v202, v46
v_mfma_f32_16x16x32_bf16 v[136:139], a[168:171], v[76:79], v[136:139]
v_add_f32 v203, v203, v47
s_waitcnt lgkmcnt(3)
v_mfma_f32_16x16x32_bf16 v[128:131], a[176:179], v[80:83], v[128:131]
buffer_load_dwordx4 v20, s[24:27], s49 offen offset:2048 sc1 lds
ds_read_b128 v[68:71], v20 offset:54272
v_mfma_f32_16x16x32_bf16 v[132:135], a[180:183], v[80:83], v[132:135]
v_lshlrev_b32_e64 v44, 16, v166
v_and_b32 v45, 0xffff0000, v166
v_mfma_f32_16x16x32_bf16 v[140:143], a[180:183], v[84:87], v[140:143]
ds_read_b128 v[72:75], v20 offset:55296
v_add_f32 v204, v204, v44
v_add_f32 v205, v205, v45
v_mfma_f32_16x16x32_bf16 v[136:139], a[176:179], v[84:87], v[136:139]
v_lshlrev_b32_e64 v46, 16, v167
v_and_b32 v47, 0xffff0000, v40
v_mfma_f32_16x16x32_bf16 v[128:131], a[184:187], v[88:91], v[128:131]
ds_read_b128 v[76:79], v20 offset:56320
v_add_f32 v206, v206, v46
v_add_f32 v207, v207, v47
v_mfma_f32_16x16x32_bf16 v[132:135], a[188:191], v[88:91], v[132:135]
v_lshlrev_b32_e64 v44, 16, v168
v_and_b32 v45, 0xffff0000, v168
v_mfma_f32_16x16x32_bf16 v[140:143], a[188:191], v[92:95], v[140:143]
buffer_load_dwordx4 v20, s[24:27], s49 offen offset:3072 sc1 lds
s_add_u32 m0, s5, 0x8000
v_mfma_f32_16x16x32_bf16 v[136:139], a[184:187], v[92:95], v[136:139]
s_add_u32 s49, s56, 344064
v_add_f32_e64 v208, v208, v44
v_mfma_f32_16x16x32_bf16 v[128:131], a[192:195], v[96:99], v[128:131]
v_add_f32 v209, v209, v45
v_lshlrev_b32 v46, 16, v169
v_and_b32 v47, 0xffff0000, v169
v_mfma_f32_16x16x32_bf16 v[132:135], a[196:199], v[96:99], v[132:135]
v_add_f32 v210, v210, v46
v_add_f32 v211, v211, v47
v_mfma_f32_16x16x32_bf16 v[140:143], a[196:199], v[100:103], v[140:143]
s_waitcnt lgkmcnt(0)
s_barrier
ds_read_b128 v[80:83], v21 offset:0
v_mfma_f32_16x16x32_bf16 v[136:139], a[192:195], v[100:103], v[136:139]
ds_read_b128 v[84:87], v21 offset:1024
v_lshlrev_b32_e64 v44, 16, v170
v_mfma_f32_16x16x32_bf16 v[128:131], a[200:203], v[104:107], v[128:131]
ds_read_b128 v[88:91], v21 offset:2048
v_and_b32 v45, 0xffff0000, v170
v_add_f32_e64 v212, v212, v44
v_mfma_f32_16x16x32_bf16 v[132:135], a[204:207], v[104:107], v[132:135]
ds_read_b128 v[92:95], v21 offset:3072
v_add_f32_e64 v213, v213, v45
v_mfma_f32_16x16x32_bf16 v[140:143], a[204:207], v[108:111], v[140:143]
buffer_load_dwordx4 v20, s[24:27], s49 offen offset:0 sc1 lds
ds_read_b128 v[96:99], v21 offset:4096
v_mfma_f32_16x16x32_bf16 v[136:139], a[200:203], v[108:111], v[136:139]
v_lshlrev_b32 v46, 16, v171
v_lshlrev_b32 v47, 16, v41
v_mfma_f32_16x16x32_bf16 v[128:131], a[208:211], v[64:67], v[128:131]
ds_read_b128 v[100:103], v21 offset:5120
v_add_f32 v214, v214, v46
v_add_f32 v215, v215, v47
v_mfma_f32_16x16x32_bf16 v[132:135], a[212:215], v[64:67], v[132:135]
v_lshlrev_b32_e64 v44, 16, v172
v_and_b32 v45, 0xffff0000, v172
v_mfma_f32_16x16x32_bf16 v[140:143], a[212:215], v[68:71], v[140:143]
ds_read_b128 v[104:107], v21 offset:6144
v_add_f32 v216, v216, v44
v_add_f32 v217, v217, v45
v_mfma_f32_16x16x32_bf16 v[136:139], a[208:211], v[68:71], v[136:139]
v_lshlrev_b32_e64 v46, 16, v173
v_and_b32 v47, 0xffff0000, v173
v_mfma_f32_16x16x32_bf16 v[128:131], a[216:219], v[72:75], v[128:131]
ds_read_b128 v[108:111], v21 offset:7168
v_add_f32 v218, v218, v46
v_add_f32 v219, v219, v47
v_mfma_f32_16x16x32_bf16 v[132:135], a[220:223], v[72:75], v[132:135]
v_lshlrev_b32_e64 v44, 16, v174
v_and_b32 v45, 0xffff0000, v174
v_mfma_f32_16x16x32_bf16 v[140:143], a[220:223], v[76:79], v[140:143]
buffer_load_dwordx4 v20, s[24:27], s49 offen offset:1024 sc1 lds
ds_read_b128 v[64:67], v21 offset:8192
v_mfma_f32_16x16x32_bf16 v[136:139], a[216:219], v[76:79], v[136:139]
s_add_u32 s49, s57, 344064
s_waitcnt lgkmcnt(3)
v_mfma_f32_16x16x32_bf16 v[144:147], a[0:3], v[80:83], 0
buffer_load_dwordx4 v[176:179], v20, s[24:27], s45 offen offset:1024 sc1
ds_read_b128 v[68:71], v21 offset:9216
v_mfma_f32_16x16x32_bf16 v[148:151], a[4:7], v[80:83], 0
v_add_f32 v220, v220, v44
v_add_f32_e64 v221, v221, v45
v_mfma_f32_16x16x32_bf16 v[156:159], a[4:7], v[84:87], 0
buffer_load_dwordx4 v[180:183], v20, s[24:27], s45 offen offset:2048 sc1
ds_read_b128 v[72:75], v21 offset:10240
v_mfma_f32_16x16x32_bf16 v[152:155], a[0:3], v[84:87], 0
v_lshlrev_b32_e64 v46, 16, v175
v_and_b32 v47, 0xffff0000, v41
v_mfma_f32_16x16x32_bf16 v[144:147], a[8:11], v[88:91], v[144:147]
buffer_load_dwordx4 v[184:187], v20, s[24:27], s45 offen offset:3072 sc1
ds_read_b128 v[76:79], v21 offset:11264
v_mfma_f32_16x16x32_bf16 v[148:151], a[12:15], v[88:91], v[148:151]
v_cvt_pk_bf16_f32 v10, v128, v129
v_cvt_pk_bf16_f32 v11, v130, v131
v_mfma_f32_16x16x32_bf16 v[156:159], a[12:15], v[92:95], v[156:159]
buffer_load_dwordx4 v20, s[24:27], s49 offen offset:2048 sc1 lds
ds_read_b128 v[80:83], v21 offset:12288
v_mfma_f32_16x16x32_bf16 v[152:155], a[8:11], v[92:95], v[152:155]
v_cvt_pk_bf16_f32 v12, v132, v133
v_cvt_pk_bf16_f32 v13, v134, v135
v_mfma_f32_16x16x32_bf16 v[144:147], a[16:19], v[96:99], v[144:147]
buffer_load_dwordx4 v[188:191], v20, s[24:27], s46 offen offset:0 sc1
ds_read_b128 v[84:87], v21 offset:13312
v_mfma_f32_16x16x32_bf16 v[148:151], a[20:23], v[96:99], v[148:151]
v_cvt_pk_bf16_f32 v14, v136, v137
v_cvt_pk_bf16_f32 v15, v138, v139
v_mfma_f32_16x16x32_bf16 v[156:159], a[20:23], v[100:103], v[156:159]
buffer_load_dwordx4 v[24:27], v20, s[24:27], s46 offen offset:1024 sc1
ds_read_b128 v[88:91], v21 offset:14336
v_mfma_f32_16x16x32_bf16 v[152:155], a[16:19], v[100:103], v[152:155]
v_cvt_pk_bf16_f32 v16, v140, v141
s_waitcnt lgkmcnt(3)
v_mfma_f32_16x16x32_bf16 v[144:147], a[24:27], v[104:107], v[144:147]
ds_read_b128 v[92:95], v21 offset:15360
v_cvt_pk_bf16_f32 v17, v142, v143
v_cvt_pk_bf16_f32 v8, v135, v143
v_mfma_f32_16x16x32_bf16 v[148:151], a[28:31], v[104:107], v[148:151]
v_bfi_b32 v13, s72, v13, v56
v_bfi_b32 v17, s72, v17, v56
v_mfma_f32_16x16x32_bf16 v[156:159], a[28:31], v[108:111], v[156:159]
buffer_load_dwordx4 v20, s[24:27], s49 offen offset:3072 sc1 lds
ds_read_b128 v[96:99], v21 offset:16384
v_mfma_f32_16x16x32_bf16 v[152:155], a[24:27], v[108:111], v[152:155]
s_add_u32 m0, s5, 0x9000
s_add_u32 s49, s58, 344064
v_mfma_f32_16x16x32_bf16 v[144:147], a[32:35], v[64:67], v[144:147]
buffer_store_dwordx4 v[10:13], v20, s[24:27], s70 offen offset:0 sc1
ds_read_b128 v[100:103], v21 offset:17408
v_add_f32 v222, v222, v46
v_mfma_f32_16x16x32_bf16 v[148:151], a[36:39], v[64:67], v[148:151]
v_add_f32_e64 v223, v223, v47
v_mfma_f32_16x16x32_bf16 v[156:159], a[36:39], v[68:71], v[156:159]
buffer_store_dwordx4 v[14:17], v20, s[24:27], s70 offen offset:1024 sc1
ds_read_b128 v[104:107], v21 offset:18432
v_mfma_f32_16x16x32_bf16 v[152:155], a[32:35], v[68:71], v[152:155]
v_mfma_f32_16x16x32_bf16 v[144:147], a[40:43], v[72:75], v[144:147]
buffer_store_dwordx2 v[8:9], v63, s[24:27], s70 offen offset:2048 sc1
ds_read_b128 v[108:111], v21 offset:19456
v_mfma_f32_16x16x32_bf16 v[148:151], a[44:47], v[72:75], v[148:151]
s_add_u32 s70, s70, 1024
v_mfma_f32_16x16x32_bf16 v[156:159], a[44:47], v[76:79], v[156:159]
buffer_load_dwordx4 v20, s[24:27], s49 offen offset:0 sc1 lds
ds_read_b128 v[64:67], v21 offset:20480
v_mfma_f32_16x16x32_bf16 v[152:155], a[40:43], v[76:79], v[152:155]
s_waitcnt lgkmcnt(3)
v_mfma_f32_16x16x32_bf16 v[144:147], a[48:51], v[80:83], v[144:147]
ds_read_b128 v[68:71], v21 offset:21504
v_mfma_f32_16x16x32_bf16 v[148:151], a[52:55], v[80:83], v[148:151]
v_mfma_f32_16x16x32_bf16 v[156:159], a[52:55], v[84:87], v[156:159]
ds_read_b128 v[72:75], v21 offset:22528
v_mfma_f32_16x16x32_bf16 v[152:155], a[48:51], v[84:87], v[152:155]
v_mfma_f32_16x16x32_bf16 v[144:147], a[56:59], v[88:91], v[144:147]
ds_read_b128 v[76:79], v21 offset:23552
v_mfma_f32_16x16x32_bf16 v[148:151], a[60:63], v[88:91], v[148:151]
v_mfma_f32_16x16x32_bf16 v[156:159], a[60:63], v[92:95], v[156:159]
buffer_load_dwordx4 v20, s[24:27], s49 offen offset:1024 sc1 lds
ds_read_b128 v[80:83], v21 offset:24576
v_mfma_f32_16x16x32_bf16 v[152:155], a[56:59], v[92:95], v[152:155]
v_mfma_f32_16x16x32_bf16 v[144:147], a[64:67], v[96:99], v[144:147]
ds_read_b128 v[84:87], v21 offset:25600
v_mfma_f32_16x16x32_bf16 v[148:151], a[68:71], v[96:99], v[148:151]
v_mfma_f32_16x16x32_bf16 v[156:159], a[68:71], v[100:103], v[156:159]
ds_read_b128 v[88:91], v21 offset:26624
v_mfma_f32_16x16x32_bf16 v[152:155], a[64:67], v[100:103], v[152:155]
s_waitcnt lgkmcnt(3)
v_mfma_f32_16x16x32_bf16 v[144:147], a[72:75], v[104:107], v[144:147]
ds_read_b128 v[92:95], v21 offset:27648
v_mfma_f32_16x16x32_bf16 v[148:151], a[76:79], v[104:107], v[148:151]
v_mfma_f32_16x16x32_bf16 v[156:159], a[76:79], v[108:111], v[156:159]
ds_read_b128 v[96:99], v21 offset:28672
v_mfma_f32_16x16x32_bf16 v[152:155], a[72:75], v[108:111], v[152:155]
v_mfma_f32_16x16x32_bf16 v[144:147], a[80:83], v[64:67], v[144:147]
ds_read_b128 v[100:103], v21 offset:29696
s_add_u32 m0, s48, 0x10000
s_add_u32 s49, s55, 401408
v_mfma_f32_16x16x32_bf16 v[148:151], a[84:87], v[64:67], v[148:151]
v_mfma_f32_16x16x32_bf16 v[156:159], a[84:87], v[68:71], v[156:159]
ds_read_b128 v[104:107], v21 offset:30720
v_mfma_f32_16x16x32_bf16 v[152:155], a[80:83], v[68:71], v[152:155]
v_mfma_f32_16x16x32_bf16 v[144:147], a[88:91], v[72:75], v[144:147]
ds_read_b128 v[108:111], v21 offset:31744
s_waitcnt vmcnt(20)
v_cmp_ne_u32 vcc, s53, v23
s_cbranch_vccnz L_spin7
L_back7:
v_mfma_f32_16x16x32_bf16 v[148:151], a[92:95], v[72:75], v[148:151]
v_mfma_f32_16x16x32_bf16 v[156:159], a[92:95], v[76:79], v[156:159]
v_mfma_f32_16x16x32_bf16 v[152:155], a[88:91], v[76:79], v[152:155]
s_waitcnt lgkmcnt(2)
v_mfma_f32_16x16x32_bf16 v[144:147], a[96:99], v[80:83], v[144:147]
v_mfma_f32_16x16x32_bf16 v[148:151], a[100:103], v[80:83], v[148:151]
v_mfma_f32_16x16x32_bf16 v[156:159], a[100:103], v[84:87], v[156:159]
s_waitcnt lgkmcnt(0)
s_barrier
v_mfma_f32_16x16x32_bf16 v[152:155], a[96:99], v[84:87], v[152:155]
ds_read_b128 v[64:67], v21 offset:32768
v_mfma_f32_16x16x32_bf16 v[144:147], a[104:107], v[88:91], v[144:147]
buffer_load_dwordx4 v20, s[24:27], s49 offen offset:0 sc1 lds
ds_read_b128 v[68:71], v21 offset:33792
v_mfma_f32_16x16x32_bf16 v[148:151], a[108:111], v[88:91], v[148:151]
ds_read_b128 v[72:75], v21 offset:34816
v_mfma_f32_16x16x32_bf16 v[156:159], a[108:111], v[92:95], v[156:159]
ds_read_b128 v[76:79], v21 offset:35840
v_mfma_f32_16x16x32_bf16 v[152:155], a[104:107], v[92:95], v[152:155]
ds_read_b128 v[80:83], v21 offset:36864
v_mfma_f32_16x16x32_bf16 v[144:147], a[112:115], v[96:99], v[144:147]
ds_read_b128 v[84:87], v21 offset:37888
v_mfma_f32_16x16x32_bf16 v[148:151], a[116:119], v[96:99], v[148:151]
v_mfma_f32_16x16x32_bf16 v[156:159], a[116:119], v[100:103], v[156:159]
buffer_load_dwordx4 v20, s[24:27], s49 offen offset:1024 sc1 lds
ds_read_b128 v[88:91], v21 offset:38912
v_mfma_f32_16x16x32_bf16 v[152:155], a[112:115], v[100:103], v[152:155]
v_mfma_f32_16x16x32_bf16 v[144:147], a[120:123], v[104:107], v[144:147]
buffer_load_dwordx4 v[240:243], v20, s[24:27], s46 offen offset:2048 sc1
ds_read_b128 v[92:95], v21 offset:39936
v_mfma_f32_16x16x32_bf16 v[148:151], a[124:127], v[104:107], v[148:151]
v_mfma_f32_16x16x32_bf16 v[156:159], a[124:127], v[108:111], v[156:159]
buffer_load_dwordx4 v[244:247], v20, s[24:27], s46 offen offset:3072 sc1
ds_read_b128 v[96:99], v21 offset:40960
v_mfma_f32_16x16x32_bf16 v[152:155], a[120:123], v[108:111], v[152:155]
s_waitcnt lgkmcnt(3)
v_mfma_f32_16x16x32_bf16 v[144:147], a[128:131], v[64:67], v[144:147]
buffer_load_dwordx4 v20, s[24:27], s49 offen offset:2048 sc1 lds
ds_read_b128 v[100:103], v21 offset:41984
v_mfma_f32_16x16x32_bf16 v[148:151], a[132:135], v[64:67], v[148:151]
v_mfma_f32_16x16x32_bf16 v[156:159], a[132:135], v[68:71], v[156:159]
buffer_load_dwordx2 v[248:249], v63, s[24:27], s62 offen offset:0 sc1
ds_read_b128 v[104:107], v21 offset:43008
v_mfma_f32_16x16x32_bf16 v[152:155], a[128:131], v[68:71], v[152:155]
v_mfma_f32_16x16x32_bf16 v[144:147], a[136:139], v[72:75], v[144:147]
ds_read_b128 v[108:111], v21 offset:44032
v_mfma_f32_16x16x32_bf16 v[148:151], a[140:143], v[72:75], v[148:151]
v_mfma_f32_16x16x32_bf16 v[156:159], a[140:143], v[76:79], v[156:159]
buffer_load_dwordx4 v20, s[24:27], s49 offen offset:3072 sc1 lds
ds_read_b128 v[64:67], v21 offset:45056
v_mfma_f32_16x16x32_bf16 v[152:155], a[136:139], v[76:79], v[152:155]
s_add_u32 m0, s48, 0x11000
s_add_u32 s49, s55, 405504
v_mfma_f32_16x16x32_bf16 v[144:147], a[144:147], v[80:83], v[144:147]
ds_read_b128 v[68:71], v21 offset:46080
v_mfma_f32_16x16x32_bf16 v[148:151], a[148:151], v[80:83], v[148:151]
v_mfma_f32_16x16x32_bf16 v[156:159], a[148:151], v[84:87], v[156:159]
ds_read_b128 v[72:75], v21 offset:47104
v_mfma_f32_16x16x32_bf16 v[152:155], a[144:147], v[84:87], v[152:155]
s_waitcnt lgkmcnt(3)
v_mfma_f32_16x16x32_bf16 v[144:147], a[152:155], v[88:91], v[144:147]
buffer_load_dwordx4 v20, s[24:27], s49 offen offset:0 sc1 lds
ds_read_b128 v[76:79], v21 offset:48128
v_mfma_f32_16x16x32_bf16 v[148:151], a[156:159], v[88:91], v[148:151]
v_mfma_f32_16x16x32_bf16 v[156:159], a[156:159], v[92:95], v[156:159]
ds_read_b128 v[80:83], v21 offset:49152
v_mfma_f32_16x16x32_bf16 v[152:155], a[152:155], v[92:95], v[152:155]
v_mfma_f32_16x16x32_bf16 v[144:147], a[160:163], v[96:99], v[144:147]
ds_read_b128 v[84:87], v21 offset:50176
s_waitcnt vmcnt(14)
v_xor_b32 v44, s53, v27
v_mfma_f32_16x16x32_bf16 v[148:151], a[164:167], v[96:99], v[148:151]
v_xor_b32 v45, s53, v191
v_xor_b32 v46, s53, v187
v_mfma_f32_16x16x32_bf16 v[156:159], a[164:167], v[100:103], v[156:159]
buffer_load_dwordx4 v20, s[24:27], s49 offen offset:1024 sc1 lds
ds_read_b128 v[88:91], v21 offset:51200
v_mfma_f32_16x16x32_bf16 v[152:155], a[160:163], v[100:103], v[152:155]
v_or3_b32 v44, v44, v45, v46
v_xor_b32_e64 v45, s53, v183
v_mfma_f32_16x16x32_bf16 v[144:147], a[168:171], v[104:107], v[144:147]
ds_read_b128 v[92:95], v21 offset:52224
v_xor_b32_e64 v46, s53, v179
v_or3_b32 v44, v44, v45, v46
v_mfma_f32_16x16x32_bf16 v[148:151], a[172:175], v[104:107], v[148:151]
v_cmp_lt_u32 vcc, s72, v44
s_cbranch_vccnz L_spin8
L_back8:
v_mfma_f32_16x16x32_bf16 v[156:159], a[172:175], v[108:111], v[156:159]
ds_read_b128 v[96:99], v21 offset:53248
v_lshlrev_b32 v44, 16, v176
v_mfma_f32_16x16x32_bf16 v[152:155], a[168:171], v[108:111], v[152:155]
v_and_b32 v45, 0xffff0000, v176
s_waitcnt lgkmcnt(3)
v_mfma_f32_16x16x32_bf16 v[144:147], a[176:179], v[64:67], v[144:147]
buffer_load_dwordx4 v20, s[24:27], s49 offen offset:2048 sc1 lds
v_mfma_f32_16x16x32_bf16 v[148:151], a[180:183], v[64:67], v[148:151]
ds_read_b128 v[100:103], v21 offset:54272
v_add_f32_e64 v192, v192, v44
v_mfma_f32_16x16x32_bf16 v[156:159], a[180:183], v[68:71], v[156:159]
ds_read_b128 v[104:107], v21 offset:55296
v_add_f32 v193, v193, v45
v_lshlrev_b32 v46, 16, v177
v_mfma_f32_16x16x32_bf16 v[152:155], a[176:179], v[68:71], v[152:155]
v_and_b32 v47, 0xffff0000, v177
v_add_f32_e64 v194, v194, v46
v_mfma_f32_16x16x32_bf16 v[144:147], a[184:187], v[72:75], v[144:147]
ds_read_b128 v[108:111], v21 offset:56320
v_add_f32 v195, v195, v47
v_lshlrev_b32 v44, 16, v178
v_mfma_f32_16x16x32_bf16 v[148:151], a[188:191], v[72:75], v[148:151]
v_and_b32 v45, 0xffff0000, v178
v_add_f32_e64 v196, v196, v44
v_mfma_f32_16x16x32_bf16 v[156:159], a[188:191], v[76:79], v[156:159]
buffer_load_dwordx4 v20, s[24:27], s49 offen offset:3072 sc1 lds
s_add_u32 m0, s5, 0x18000
v_mfma_f32_16x16x32_bf16 v[152:155], a[184:187], v[76:79], v[152:155]
s_add_u32 s49, s56, 401408
v_add_f32_e64 v197, v197, v45
v_mfma_f32_16x16x32_bf16 v[144:147], a[192:195], v[80:83], v[144:147]
v_lshlrev_b32 v46, 16, v179
v_lshlrev_b32 v47, 16, v24
v_add_f32_e64 v198, v198, v46
v_mfma_f32_16x16x32_bf16 v[148:151], a[196:199], v[80:83], v[148:151]
v_add_f32 v199, v199, v47
v_lshlrev_b32 v44, 16, v180
v_mfma_f32_16x16x32_bf16 v[156:159], a[196:199], v[84:87], v[156:159]
s_waitcnt lgkmcnt(0)
s_barrier
ds_read_b128 v[64:67], v20 offset:0
v_mfma_f32_16x16x32_bf16 v[152:155], a[192:195], v[84:87], v[152:155]
ds_read_b128 v[68:71], v20 offset:1024
v_and_b32 v45, 0xffff0000, v180
v_mfma_f32_16x16x32_bf16 v[144:147], a[200:203], v[88:91], v[144:147]
ds_read_b128 v[72:75], v20 offset:2048
v_add_f32 v200, v200, v44
v_add_f32 v201, v201, v45
v_mfma_f32_16x16x32_bf16 v[148:151], a[204:207], v[88:91], v[148:151]
ds_read_b128 v[76:79], v20 offset:3072
v_lshlrev_b32_e64 v46, 16, v181
v_mfma_f32_16x16x32_bf16 v[156:159], a[204:207], v[92:95], v[156:159]
buffer_load_dwordx4 v20, s[24:27], s49 offen offset:0 sc1 lds
ds_read_b128 v[80:83], v20 offset:4096
v_mfma_f32_16x16x32_bf16 v[152:155], a[200:203], v[92:95], v[152:155]
v_and_b32 v47, 0xffff0000, v181
v_add_f32_e64 v202, v202, v46
v_mfma_f32_16x16x32_bf16 v[144:147], a[208:211], v[96:99], v[144:147]
ds_read_b128 v[84:87], v20 offset:5120
v_add_f32 v203, v203, v47
v_lshlrev_b32 v44, 16, v182
v_mfma_f32_16x16x32_bf16 v[148:151], a[212:215], v[96:99], v[148:151]
v_and_b32 v45, 0xffff0000, v182
v_add_f32_e64 v204, v204, v44
v_mfma_f32_16x16x32_bf16 v[156:159], a[212:215], v[100:103], v[156:159]
ds_read_b128 v[88:91], v20 offset:6144
v_add_f32 v205, v205, v45
v_lshlrev_b32 v46, 16, v183
v_mfma_f32_16x16x32_bf16 v[152:155], a[208:211], v[100:103], v[152:155]
v_and_b32 v47, 0xffff0000, v24
v_add_f32_e64 v206, v206, v46
v_mfma_f32_16x16x32_bf16 v[144:147], a[216:219], v[104:107], v[144:147]
ds_read_b128 v[92:95], v20 offset:7168
v_add_f32 v207, v207, v47
v_lshlrev_b32 v44, 16, v184
v_mfma_f32_16x16x32_bf16 v[148:151], a[220:223], v[104:107], v[148:151]
v_and_b32 v45, 0xffff0000, v184
v_add_f32_e64 v208, v208, v44
v_mfma_f32_16x16x32_bf16 v[156:159], a[220:223], v[108:111], v[156:159]
buffer_load_dwordx4 v20, s[24:27], s49 offen offset:1024 sc1 lds
ds_read_b128 v[96:99], v20 offset:8192
v_mfma_f32_16x16x32_bf16 v[152:155], a[216:219], v[108:111], v[152:155]
s_add_u32 s49, s57, 401408
s_waitcnt lgkmcnt(3)
v_mfma_f32_16x16x32_bf16 v[128:131], a[0:3], v[64:67], 0
ds_read_b128 v[100:103], v20 offset:9216
v_add_f32 v209, v209, v45
v_lshlrev_b32_e64 v46, 16, v185
v_mfma_f32_16x16x32_bf16 v[132:135], a[4:7], v[64:67], 0
v_and_b32 v47, 0xffff0000, v185
v_add_f32_e64 v210, v210, v46
v_mfma_f32_16x16x32_bf16 v[140:143], a[4:7], v[68:71], 0
ds_read_b128 v[104:107], v20 offset:10240
v_add_f32 v211, v211, v47
v_lshlrev_b32 v44, 16, v186
v_mfma_f32_16x16x32_bf16 v[136:139], a[0:3], v[68:71], 0
v_and_b32 v45, 0xffff0000, v186
v_add_f32_e64 v212, v212, v44
v_mfma_f32_16x16x32_bf16 v[128:131], a[8:11], v[72:75], v[128:131]
ds_read_b128 v[108:111], v20 offset:11264
v_cvt_pk_bf16_f32 v10, v144, v145
v_cvt_pk_bf16_f32 v11, v146, v147
v_mfma_f32_16x16x32_bf16 v[132:135], a[12:15], v[72:75], v[132:135]
v_cvt_pk_bf16_f32 v12, v148, v149
v_cvt_pk_bf16_f32 v13, v150, v151
v_mfma_f32_16x16x32_bf16 v[140:143], a[12:15], v[76:79], v[140:143]
buffer_load_dwordx4 v20, s[24:27], s49 offen offset:2048 sc1 lds
ds_read_b128 v[64:67], v20 offset:12288
v_mfma_f32_16x16x32_bf16 v[136:139], a[8:11], v[76:79], v[136:139]
v_cvt_pk_bf16_f32 v14, v152, v153
v_cvt_pk_bf16_f32 v15, v154, v155
v_mfma_f32_16x16x32_bf16 v[128:131], a[16:19], v[80:83], v[128:131]
ds_read_b128 v[68:71], v20 offset:13312
v_cvt_pk_bf16_f32 v16, v156, v157
v_cvt_pk_bf16_f32 v17, v158, v159
v_mfma_f32_16x16x32_bf16 v[132:135], a[20:23], v[80:83], v[132:135]
v_cvt_pk_bf16_f32 v8, v151, v159
v_bfi_b32 v13, s72, v13, v56
v_mfma_f32_16x16x32_bf16 v[140:143], a[20:23], v[84:87], v[140:143]
ds_read_b128 v[72:75], v20 offset:14336
v_bfi_b32 v17, s72, v17, v56
v_add_f32_e64 v213, v213, v45
v_mfma_f32_16x16x32_bf16 v[136:139], a[16:19], v[84:87], v[136:139]
v_lshlrev_b32 v46, 16, v187
s_waitcnt lgkmcnt(3)
v_mfma_f32_16x16x32_bf16 v[128:131], a[24:27], v[88:91], v[128:131]
buffer_load_dword v3, v62, s[24:27], s79 offen sc1
ds_read_b128 v[76:79], v20 offset:15360
v_mfma_f32_16x16x32_bf16 v[132:135], a[28:31], v[88:91], v[132:135]
v_lshlrev_b32 v47, 16, v25
v_add_f32 v214, v214, v46
v_mfma_f32_16x16x32_bf16 v[140:143], a[28:31], v[92:95], v[140:143]
buffer_load_dwordx4 v20, s[24:27], s49 offen offset:3072 sc1 lds
ds_read_b128 v[80:83], v20 offset:16384
v_mfma_f32_16x16x32_bf16 v[136:139], a[24:27], v[92:95], v[136:139]
s_add_u32 m0, s5, 0x19000
s_add_u32 s49, s58, 401408
v_mfma_f32_16x16x32_bf16 v[128:131], a[32:35], v[96:99], v[128:131]
ds_read_b128 v[84:87], v20 offset:17408
v_add_f32 v215, v215, v47
v_lshlrev_b32 v44, 16, v188
v_mfma_f32_16x16x32_bf16 v[132:135], a[36:39], v[96:99], v[132:135]
v_and_b32 v45, 0xffff0000, v188
v_add_f32_e64 v216, v216, v44
v_mfma_f32_16x16x32_bf16 v[140:143], a[36:39], v[100:103], v[140:143]
ds_read_b128 v[88:91], v20 offset:18432
v_add_f32 v217, v217, v45
v_lshlrev_b32 v46, 16, v189
v_mfma_f32_16x16x32_bf16 v[136:139], a[32:35], v[100:103], v[136:139]
v_and_b32 v47, 0xffff0000, v189
v_add_f32_e64 v218, v218, v46
v_mfma_f32_16x16x32_bf16 v[128:131], a[40:43], v[104:107], v[128:131]
ds_read_b128 v[92:95], v20 offset:19456
v_add_f32 v219, v219, v47
v_lshlrev_b32 v44, 16, v190
v_mfma_f32_16x16x32_bf16 v[132:135], a[44:47], v[104:107], v[132:135]
v_and_b32 v45, 0xffff0000, v190
v_add_f32_e64 v220, v220, v44
v_mfma_f32_16x16x32_bf16 v[140:143], a[44:47], v[108:111], v[140:143]
buffer_load_dwordx4 v20, s[24:27], s49 offen offset:0 sc1 lds
ds_read_b128 v[96:99], v20 offset:20480
v_mfma_f32_16x16x32_bf16 v[136:139], a[40:43], v[108:111], v[136:139]
v_add_f32 v221, v221, v45
s_waitcnt lgkmcnt(3)
v_mfma_f32_16x16x32_bf16 v[128:131], a[48:51], v[64:67], v[128:131]
ds_read_b128 v[100:103], v20 offset:21504
v_lshlrev_b32_e64 v46, 16, v191
v_and_b32 v47, 0xffff0000, v25
v_mfma_f32_16x16x32_bf16 v[132:135], a[52:55], v[64:67], v[132:135]
v_add_f32 v222, v222, v46
v_add_f32 v223, v223, v47
v_mfma_f32_16x16x32_bf16 v[140:143], a[52:55], v[68:71], v[140:143]
ds_read_b128 v[104:107], v20 offset:22528
s_waitcnt vmcnt(11)
v_xor_b32 v44, s53, v249
v_mfma_f32_16x16x32_bf16 v[136:139], a[48:51], v[68:71], v[136:139]
v_xor_b32 v45, s53, v247
v_xor_b32 v46, s53, v243
v_mfma_f32_16x16x32_bf16 v[128:131], a[56:59], v[72:75], v[128:131]
ds_read_b128 v[108:111], v20 offset:23552
v_or3_b32 v44, v44, v45, v46
v_mfma_f32_16x16x32_bf16 v[132:135], a[60:63], v[72:75], v[132:135]
v_cmp_lt_u32 vcc, s72, v44
s_cbranch_vccnz L_spin9
L_back9:
v_mfma_f32_16x16x32_bf16 v[140:143], a[60:63], v[76:79], v[140:143]
buffer_load_dwordx4 v20, s[24:27], s49 offen offset:1024 sc1 lds
v_mfma_f32_16x16x32_bf16 v[136:139], a[56:59], v[76:79], v[136:139]
ds_read_b128 v[64:67], v20 offset:24576
v_lshlrev_b32_e64 v44, 16, v240
v_mfma_f32_16x16x32_bf16 v[128:131], a[64:67], v[80:83], v[128:131]
ds_read_b128 v[68:71], v20 offset:25600
v_and_b32 v45, 0xffff0000, v240
v_mfma_f32_16x16x32_bf16 v[132:135], a[68:71], v[80:83], v[132:135]
v_add_f32 v192, v192, v44
v_add_f32 v193, v193, v45
v_mfma_f32_16x16x32_bf16 v[140:143], a[68:71], v[84:87], v[140:143]
ds_read_b128 v[72:75], v20 offset:26624
v_lshlrev_b32_e64 v46, 16, v241
v_and_b32 v47, 0xffff0000, v241
v_mfma_f32_16x16x32_bf16 v[136:139], a[64:67], v[84:87], v[136:139]
v_add_f32 v194, v194, v46
s_waitcnt lgkmcnt(3)
v_mfma_f32_16x16x32_bf16 v[128:131], a[72:75], v[88:91], v[128:131]
ds_read_b128 v[76:79], v20 offset:27648
v_add_f32 v195, v195, v47
v_lshlrev_b32 v44, 16, v242
v_mfma_f32_16x16x32_bf16 v[132:135], a[76:79], v[88:91], v[132:135]
v_and_b32 v45, 0xffff0000, v242
v_add_f32_e64 v196, v196, v44
v_mfma_f32_16x16x32_bf16 v[140:143], a[76:79], v[92:95], v[140:143]
ds_read_b128 v[80:83], v20 offset:28672
v_add_f32 v197, v197, v45
v_lshlrev_b32 v46, 16, v243
v_mfma_f32_16x16x32_bf16 v[136:139], a[72:75], v[92:95], v[136:139]
v_lshlrev_b32 v47, 16, v248
v_add_f32 v198, v198, v46
v_mfma_f32_16x16x32_bf16 v[128:131], a[80:83], v[96:99], v[128:131]
ds_read_b128 v[84:87], v20 offset:29696
v_add_f32 v199, v199, v47
v_lshlrev_b32 v44, 16, v244
v_mfma_f32_16x16x32_bf16 v[132:135], a[84:87], v[96:99], v[132:135]
v_and_b32 v45, 0xffff0000, v244
v_add_f32_e64 v200, v200, v44
v_mfma_f32_16x16x32_bf16 v[140:143], a[84:87], v[100:103], v[140:143]
ds_read_b128 v[88:91], v20 offset:30720
v_add_f32 v201, v201, v45
v_lshlrev_b32 v46, 16, v245
v_mfma_f32_16x16x32_bf16 v[136:139], a[80:83], v[100:103], v[136:139]
v_and_b32 v47, 0xffff0000, v245
v_add_f32_e64 v202, v202, v46
v_mfma_f32_16x16x32_bf16 v[128:131], a[88:91], v[104:107], v[128:131]
ds_read_b128 v[92:95], v20 offset:31744
v_add_f32 v203, v203, v47
v_lshlrev_b32 v44, 16, v246
v_mfma_f32_16x16x32_bf16 v[132:135], a[92:95], v[104:107], v[132:135]
v_and_b32 v45, 0xffff0000, v246
v_add_f32_e64 v204, v204, v44
v_mfma_f32_16x16x32_bf16 v[140:143], a[92:95], v[108:111], v[140:143]
buffer_store_dwordx4 v[10:13], v20, s[24:27], s70 offen offset:2048 sc1
v_add_f32 v205, v205, v45
v_lshlrev_b32 v46, 16, v247
v_mfma_f32_16x16x32_bf16 v[136:139], a[88:91], v[108:111], v[136:139]
v_and_b32 v47, 0xffff0000, v248
s_waitcnt lgkmcnt(2)
v_mfma_f32_16x16x32_bf16 v[128:131], a[96:99], v[64:67], v[128:131]
buffer_store_dwordx4 v[14:17], v20, s[24:27], s70 offen offset:3072 sc1
v_add_f32 v206, v206, v46
v_add_f32_e64 v207, v207, v47
v_mfma_f32_16x16x32_bf16 v[132:135], a[100:103], v[64:67], v[132:135]
v_mfma_f32_16x16x32_bf16 v[140:143], a[100:103], v[68:71], v[140:143]
s_waitcnt lgkmcnt(0)
s_barrier
ds_read_b128 v[96:99], v20 offset:32768
v_mfma_f32_16x16x32_bf16 v[136:139], a[96:99], v[68:71], v[136:139]
ds_read_b128 v[100:103], v20 offset:33792
v_mfma_f32_16x16x32_bf16 v[128:131], a[104:107], v[72:75], v[128:131]
buffer_store_dwordx2 v[8:9], v63, s[24:27], s70 offen offset:1536 sc1
ds_read_b128 v[104:107], v20 offset:34816
v_mfma_f32_16x16x32_bf16 v[132:135], a[108:111], v[72:75], v[132:135]
ds_read_b128 v[108:111], v20 offset:35840
v_mfma_f32_16x16x32_bf16 v[140:143], a[108:111], v[76:79], v[140:143]
ds_read_b128 v[64:67], v20 offset:36864
v_mfma_f32_16x16x32_bf16 v[136:139], a[104:107], v[76:79], v[136:139]
v_mfma_f32_16x16x32_bf16 v[128:131], a[112:115], v[80:83], v[128:131]
ds_read_b128 v[68:71], v20 offset:37888
v_mfma_f32_16x16x32_bf16 v[132:135], a[116:119], v[80:83], v[132:135]
v_mfma_f32_16x16x32_bf16 v[140:143], a[116:119], v[84:87], v[140:143]
ds_read_b128 v[72:75], v20 offset:38912
v_mfma_f32_16x16x32_bf16 v[136:139], a[112:115], v[84:87], v[136:139]
v_mfma_f32_16x16x32_bf16 v[128:131], a[120:123], v[88:91], v[128:131]
ds_read_b128 v[76:79], v20 offset:39936
v_mfma_f32_16x16x32_bf16 v[132:135], a[124:127], v[88:91], v[132:135]
v_mfma_f32_16x16x32_bf16 v[140:143], a[124:127], v[92:95], v[140:143]
ds_read_b128 v[80:83], v20 offset:40960
v_mfma_f32_16x16x32_bf16 v[136:139], a[120:123], v[92:95], v[136:139]
s_waitcnt lgkmcnt(3)
v_mfma_f32_16x16x32_bf16 v[128:131], a[128:131], v[96:99], v[128:131]
ds_read_b128 v[84:87], v20 offset:41984
v_mfma_f32_16x16x32_bf16 v[132:135], a[132:135], v[96:99], v[132:135]
v_mfma_f32_16x16x32_bf16 v[140:143], a[132:135], v[100:103], v[140:143]
ds_read_b128 v[88:91], v20 offset:43008
v_mfma_f32_16x16x32_bf16 v[136:139], a[128:131], v[100:103], v[136:139]
v_mfma_f32_16x16x32_bf16 v[128:131], a[136:139], v[104:107], v[128:131]
ds_read_b128 v[92:95], v20 offset:44032
v_mfma_f32_16x16x32_bf16 v[132:135], a[140:143], v[104:107], v[132:135]
v_mfma_f32_16x16x32_bf16 v[140:143], a[140:143], v[108:111], v[140:143]
ds_read_b128 v[96:99], v20 offset:45056
v_mfma_f32_16x16x32_bf16 v[136:139], a[136:139], v[108:111], v[136:139]
v_mfma_f32_16x16x32_bf16 v[128:131], a[144:147], v[64:67], v[128:131]
ds_read_b128 v[100:103], v20 offset:46080
v_mfma_f32_16x16x32_bf16 v[132:135], a[148:151], v[64:67], v[132:135]
v_mfma_f32_16x16x32_bf16 v[140:143], a[148:151], v[68:71], v[140:143]
ds_read_b128 v[104:107], v20 offset:47104
v_mfma_f32_16x16x32_bf16 v[136:139], a[144:147], v[68:71], v[136:139]
s_waitcnt lgkmcnt(3)
v_mfma_f32_16x16x32_bf16 v[128:131], a[152:155], v[72:75], v[128:131]
ds_read_b128 v[108:111], v20 offset:48128
v_mfma_f32_16x16x32_bf16 v[132:135], a[156:159], v[72:75], v[132:135]
v_mfma_f32_16x16x32_bf16 v[140:143], a[156:159], v[76:79], v[140:143]
ds_read_b128 v[64:67], v20 offset:49152
v_mfma_f32_16x16x32_bf16 v[136:139], a[152:155], v[76:79], v[136:139]
v_mfma_f32_16x16x32_bf16 v[128:131], a[160:163], v[80:83], v[128:131]
ds_read_b128 v[68:71], v20 offset:50176
v_mfma_f32_16x16x32_bf16 v[132:135], a[164:167], v[80:83], v[132:135]
v_mfma_f32_16x16x32_bf16 v[140:143], a[164:167], v[84:87], v[140:143]
ds_read_b128 v[72:75], v20 offset:51200
v_mfma_f32_16x16x32_bf16 v[136:139], a[160:163], v[84:87], v[136:139]
v_mfma_f32_16x16x32_bf16 v[128:131], a[168:171], v[88:91], v[128:131]
ds_read_b128 v[76:79], v20 offset:52224
v_mfma_f32_16x16x32_bf16 v[132:135], a[172:175], v[88:91], v[132:135]
v_mfma_f32_16x16x32_bf16 v[140:143], a[172:175], v[92:95], v[140:143]
ds_read_b128 v[80:83], v20 offset:53248
v_mfma_f32_16x16x32_bf16 v[136:139], a[168:171], v[92:95], v[136:139]
s_waitcnt lgkmcnt(3)
v_mfma_f32_16x16x32_bf16 v[128:131], a[176:179], v[96:99], v[128:131]
ds_read_b128 v[84:87], v20 offset:54272
s_waitcnt vmcnt(6)
v_cmp_ne_u32 vcc, s53, v3
s_cbranch_vccnz L_spin10
L_back10:
v_mfma_f32_16x16x32_bf16 v[132:135], a[180:183], v[96:99], v[132:135]
v_mfma_f32_16x16x32_bf16 v[140:143], a[180:183], v[100:103], v[140:143]
ds_read_b128 v[88:91], v20 offset:55296
s_add_u32 m0, s47, 147456
v_mfma_f32_16x16x32_bf16 v[136:139], a[176:179], v[100:103], v[136:139]
buffer_load_dwordx4 v22, s[24:27], s77 offen offset:0 sc1 lds
v_mfma_f32_16x16x32_bf16 v[128:131], a[184:187], v[104:107], v[128:131]
ds_read_b128 v[92:95], v20 offset:56320
s_add_u32 s77, s77, 64512
v_mfma_f32_16x16x32_bf16 v[132:135], a[188:191], v[104:107], v[132:135]
buffer_load_dwordx4 v22, s[24:27], s77 offen offset:1024 sc1 lds
v_mfma_f32_16x16x32_bf16 v[140:143], a[188:191], v[108:111], v[140:143]
s_add_u32 s77, s77, 982016
v_mfma_f32_16x16x32_bf16 v[136:139], a[184:187], v[108:111], v[136:139]
buffer_load_dwordx4 v22, s[24:27], s77 offen offset:2048 sc1 lds
v_mfma_f32_16x16x32_bf16 v[128:131], a[192:195], v[64:67], v[128:131]
s_add_u32 s77, s77, 64512
v_mfma_f32_16x16x32_bf16 v[132:135], a[196:199], v[64:67], v[132:135]
buffer_load_dwordx4 v22, s[24:27], s77 offen offset:3072 sc1 lds
v_mfma_f32_16x16x32_bf16 v[140:143], a[196:199], v[68:71], v[140:143]
s_waitcnt lgkmcnt(0)
s_barrier
ds_read_b128 v[96:99], v21 offset:0
v_mfma_f32_16x16x32_bf16 v[136:139], a[192:195], v[68:71], v[136:139]
ds_read_b128 v[100:103], v21 offset:1024
v_mfma_f32_16x16x32_bf16 v[128:131], a[200:203], v[72:75], v[128:131]
ds_read_b128 v[104:107], v21 offset:2048
v_mfma_f32_16x16x32_bf16 v[132:135], a[204:207], v[72:75], v[132:135]
ds_read_b128 v[108:111], v21 offset:3072
v_mfma_f32_16x16x32_bf16 v[140:143], a[204:207], v[76:79], v[140:143]
ds_read_b128 v[64:67], v21 offset:4096
v_mfma_f32_16x16x32_bf16 v[136:139], a[200:203], v[76:79], v[136:139]
v_mfma_f32_16x16x32_bf16 v[128:131], a[208:211], v[80:83], v[128:131]
ds_read_b128 v[68:71], v21 offset:5120
v_mfma_f32_16x16x32_bf16 v[132:135], a[212:215], v[80:83], v[132:135]
v_mfma_f32_16x16x32_bf16 v[140:143], a[212:215], v[84:87], v[140:143]
ds_read_b128 v[72:75], v21 offset:6144
v_mfma_f32_16x16x32_bf16 v[136:139], a[208:211], v[84:87], v[136:139]
v_mfma_f32_16x16x32_bf16 v[128:131], a[216:219], v[88:91], v[128:131]
ds_read_b128 v[76:79], v21 offset:7168
v_mfma_f32_16x16x32_bf16 v[132:135], a[220:223], v[88:91], v[132:135]
v_mfma_f32_16x16x32_bf16 v[140:143], a[220:223], v[92:95], v[140:143]
ds_read_b128 v[80:83], v21 offset:8192
v_mfma_f32_16x16x32_bf16 v[136:139], a[216:219], v[92:95], v[136:139]
s_waitcnt lgkmcnt(3)
v_mfma_f32_16x16x32_bf16 v[144:147], a[0:3], v[96:99], 0
buffer_load_dwordx4 v[112:115], v20, s[24:27], s62 offen offset:1024 sc1
ds_read_b128 v[84:87], v21 offset:9216
v_mfma_f32_16x16x32_bf16 v[148:151], a[4:7], v[96:99], 0
v_mfma_f32_16x16x32_bf16 v[156:159], a[4:7], v[100:103], 0
buffer_load_dwordx4 v[116:119], v20, s[24:27], s62 offen offset:2048 sc1
ds_read_b128 v[88:91], v21 offset:10240
v_mfma_f32_16x16x32_bf16 v[152:155], a[0:3], v[100:103], 0
v_mfma_f32_16x16x32_bf16 v[144:147], a[8:11], v[104:107], v[144:147]
buffer_load_dwordx2 v[120:121], v63, s[24:27], s62 offen offset:512 sc1
ds_read_b128 v[92:95], v21 offset:11264
v_mfma_f32_16x16x32_bf16 v[148:151], a[12:15], v[104:107], v[148:151]
v_mfma_f32_16x16x32_bf16 v[156:159], a[12:15], v[108:111], v[156:159]
ds_read_b128 v[96:99], v21 offset:12288
v_mfma_f32_16x16x32_bf16 v[152:155], a[8:11], v[108:111], v[152:155]
v_mfma_f32_16x16x32_bf16 v[144:147], a[16:19], v[64:67], v[144:147]
ds_read_b128 v[100:103], v21 offset:13312
v_mfma_f32_16x16x32_bf16 v[148:151], a[20:23], v[64:67], v[148:151]
v_mfma_f32_16x16x32_bf16 v[156:159], a[20:23], v[68:71], v[156:159]
ds_read_b128 v[104:107], v21 offset:14336
v_mfma_f32_16x16x32_bf16 v[152:155], a[16:19], v[68:71], v[152:155]
s_waitcnt lgkmcnt(3)
v_mfma_f32_16x16x32_bf16 v[144:147], a[24:27], v[72:75], v[144:147]
ds_read_b128 v[108:111], v21 offset:15360
v_mfma_f32_16x16x32_bf16 v[148:151], a[28:31], v[72:75], v[148:151]
v_mfma_f32_16x16x32_bf16 v[156:159], a[28:31], v[76:79], v[156:159]
ds_read_b128 v[64:67], v21 offset:16384
v_mfma_f32_16x16x32_bf16 v[152:155], a[24:27], v[76:79], v[152:155]
v_mfma_f32_16x16x32_bf16 v[144:147], a[32:35], v[80:83], v[144:147]
ds_read_b128 v[68:71], v21 offset:17408
v_mfma_f32_16x16x32_bf16 v[148:151], a[36:39], v[80:83], v[148:151]
v_mfma_f32_16x16x32_bf16 v[156:159], a[36:39], v[84:87], v[156:159]
ds_read_b128 v[72:75], v21 offset:18432
v_mfma_f32_16x16x32_bf16 v[152:155], a[32:35], v[84:87], v[152:155]
v_mfma_f32_16x16x32_bf16 v[144:147], a[40:43], v[88:91], v[144:147]
ds_read_b128 v[76:79], v21 offset:19456
v_mfma_f32_16x16x32_bf16 v[148:151], a[44:47], v[88:91], v[148:151]
v_mfma_f32_16x16x32_bf16 v[156:159], a[44:47], v[92:95], v[156:159]
ds_read_b128 v[80:83], v21 offset:20480
v_mfma_f32_16x16x32_bf16 v[152:155], a[40:43], v[92:95], v[152:155]
s_waitcnt lgkmcnt(3)
v_mfma_f32_16x16x32_bf16 v[144:147], a[48:51], v[96:99], v[144:147]
ds_read_b128 v[84:87], v21 offset:21504
v_mfma_f32_16x16x32_bf16 v[148:151], a[52:55], v[96:99], v[148:151]
v_mfma_f32_16x16x32_bf16 v[156:159], a[52:55], v[100:103], v[156:159]
ds_read_b128 v[88:91], v21 offset:22528
v_mfma_f32_16x16x32_bf16 v[152:155], a[48:51], v[100:103], v[152:155]
v_mfma_f32_16x16x32_bf16 v[144:147], a[56:59], v[104:107], v[144:147]
ds_read_b128 v[92:95], v21 offset:23552
v_mfma_f32_16x16x32_bf16 v[148:151], a[60:63], v[104:107], v[148:151]
v_mfma_f32_16x16x32_bf16 v[156:159], a[60:63], v[108:111], v[156:159]
ds_read_b128 v[96:99], v21 offset:24576
v_mfma_f32_16x16x32_bf16 v[152:155], a[56:59], v[108:111], v[152:155]
v_mfma_f32_16x16x32_bf16 v[144:147], a[64:67], v[64:67], v[144:147]
ds_read_b128 v[100:103], v21 offset:25600
v_mfma_f32_16x16x32_bf16 v[148:151], a[68:71], v[64:67], v[148:151]
v_mfma_f32_16x16x32_bf16 v[156:159], a[68:71], v[68:71], v[156:159]
ds_read_b128 v[104:107], v21 offset:26624
v_mfma_f32_16x16x32_bf16 v[152:155], a[64:67], v[68:71], v[152:155]
s_waitcnt lgkmcnt(3)
v_mfma_f32_16x16x32_bf16 v[144:147], a[72:75], v[72:75], v[144:147]
ds_read_b128 v[108:111], v21 offset:27648
v_mfma_f32_16x16x32_bf16 v[148:151], a[76:79], v[72:75], v[148:151]
v_mfma_f32_16x16x32_bf16 v[156:159], a[76:79], v[76:79], v[156:159]
ds_read_b128 v[64:67], v21 offset:28672
v_mfma_f32_16x16x32_bf16 v[152:155], a[72:75], v[76:79], v[152:155]
v_mfma_f32_16x16x32_bf16 v[144:147], a[80:83], v[80:83], v[144:147]
ds_read_b128 v[68:71], v21 offset:29696
v_mfma_f32_16x16x32_bf16 v[148:151], a[84:87], v[80:83], v[148:151]
v_mfma_f32_16x16x32_bf16 v[156:159], a[84:87], v[84:87], v[156:159]
ds_read_b128 v[72:75], v21 offset:30720
v_mfma_f32_16x16x32_bf16 v[152:155], a[80:83], v[84:87], v[152:155]
v_mfma_f32_16x16x32_bf16 v[144:147], a[88:91], v[88:91], v[144:147]
ds_read_b128 v[76:79], v21 offset:31744
v_mfma_f32_16x16x32_bf16 v[148:151], a[92:95], v[88:91], v[148:151]
v_mfma_f32_16x16x32_bf16 v[156:159], a[92:95], v[92:95], v[156:159]
v_mfma_f32_16x16x32_bf16 v[152:155], a[88:91], v[92:95], v[152:155]
s_waitcnt lgkmcnt(2)
v_mfma_f32_16x16x32_bf16 v[144:147], a[96:99], v[96:99], v[144:147]
v_mfma_f32_16x16x32_bf16 v[148:151], a[100:103], v[96:99], v[148:151]
v_mfma_f32_16x16x32_bf16 v[156:159], a[100:103], v[100:103], v[156:159]
s_waitcnt vmcnt(3) lgkmcnt(0)
s_barrier
ds_read_b128 v[80:83], v21 offset:32768
v_mfma_f32_16x16x32_bf16 v[152:155], a[96:99], v[100:103], v[152:155]
ds_read_b128 v[84:87], v21 offset:33792
v_mfma_f32_16x16x32_bf16 v[144:147], a[104:107], v[104:107], v[144:147]
ds_read_b128 v[88:91], v21 offset:34816
ds_read_b128 v[224:227], v60 offset:16384
ds_read_b128 v[228:231], v60 offset:17408
ds_read_b128 v[232:235], v60 offset:18432
v_mfma_f32_16x16x32_bf16 v[148:151], a[108:111], v[104:107], v[148:151]
ds_read_b128 v[92:95], v21 offset:35840
ds_read_b128 v[236:239], v60 offset:19456
v_mfma_f32_16x16x32_bf16 v[156:159], a[108:111], v[108:111], v[156:159]
ds_read_b128 v[96:99], v21 offset:36864
v_mfma_f32_16x16x32_bf16 v[152:155], a[104:107], v[108:111], v[152:155]
v_mfma_f32_16x16x32_bf16 v[144:147], a[112:115], v[64:67], v[144:147]
ds_read_b128 v[100:103], v21 offset:37888
v_mfma_f32_16x16x32_bf16 v[148:151], a[116:119], v[64:67], v[148:151]
v_mfma_f32_16x16x32_bf16 v[156:159], a[116:119], v[68:71], v[156:159]
ds_read_b128 v[104:107], v21 offset:38912
v_mfma_f32_16x16x32_bf16 v[152:155], a[112:115], v[68:71], v[152:155]
v_mfma_f32_16x16x32_bf16 v[144:147], a[120:123], v[72:75], v[144:147]
ds_read_b128 v[108:111], v21 offset:39936
s_waitcnt lgkmcnt(8)
v_permlane32_swap_b32 v224, v226
v_permlane32_swap_b32 v225, v227
v_mfma_f32_16x16x32_bf16 v[148:151], a[124:127], v[72:75], v[148:151]
s_waitcnt lgkmcnt(7)
v_permlane32_swap_b32 v228, v230
v_permlane32_swap_b32_e64 v229, v231
v_mfma_f32_16x16x32_bf16 v[156:159], a[124:127], v[76:79], v[156:159]
ds_read_b128 v[64:67], v21 offset:40960
s_waitcnt lgkmcnt(7)
v_permlane32_swap_b32 v232, v234
v_permlane32_swap_b32_e64 v233, v235
v_mfma_f32_16x16x32_bf16 v[152:155], a[120:123], v[76:79], v[152:155]
s_waitcnt lgkmcnt(5)
v_permlane32_swap_b32 v236, v238
v_permlane32_swap_b32_e64 v237, v239
v_mfma_f32_16x16x32_bf16 v[144:147], a[128:131], v[80:83], v[144:147]
ds_read_b128 v[68:71], v21 offset:41984
v_lshlrev_b32_e64 v44, 16, v224
v_and_b32 v45, 0xffff0000, v224
v_fmac_f32 v192, 0x35800000, v44
v_mfma_f32_16x16x32_bf16 v[148:151], a[132:135], v[80:83], v[148:151]
v_fmac_f32 v193, 0x35800000, v45
v_lshlrev_b32_e64 v46, 16, v225
v_and_b32 v47, 0xffff0000, v225
v_mfma_f32_16x16x32_bf16 v[156:159], a[132:135], v[84:87], v[156:159]
ds_read_b128 v[72:75], v21 offset:43008
v_fmac_f32 v194, 0x35800000, v46
v_fmac_f32 v195, 0x35800000, v47
v_lshlrev_b32_e64 v44, 16, v226
v_mfma_f32_16x16x32_bf16 v[152:155], a[128:131], v[84:87], v[152:155]
v_and_b32 v45, 0xffff0000, v226
v_fmac_f32 v196, 0x35800000, v44
v_fmac_f32 v197, 0x35800000, v45
v_mfma_f32_16x16x32_bf16 v[144:147], a[136:139], v[88:91], v[144:147]
ds_read_b128 v[76:79], v21 offset:44032
v_lshlrev_b32_e64 v46, 16, v227
v_and_b32 v47, 0xffff0000, v227
v_fmac_f32 v198, 0x35800000, v46
v_mfma_f32_16x16x32_bf16 v[148:151], a[140:143], v[88:91], v[148:151]
v_fmac_f32 v199, 0x35800000, v47
v_lshlrev_b32_e64 v44, 16, v228
v_and_b32 v45, 0xffff0000, v228
v_mfma_f32_16x16x32_bf16 v[156:159], a[140:143], v[92:95], v[156:159]
ds_read_b128 v[80:83], v21 offset:45056
v_fmac_f32 v200, 0x35800000, v44
v_fmac_f32 v201, 0x35800000, v45
v_lshlrev_b32 v46, 16, v229
v_mfma_f32_16x16x32_bf16 v[152:155], a[136:139], v[92:95], v[152:155]
v_and_b32 v47, 0xffff0000, v229
v_fmac_f32 v202, 0x35800000, v46
s_waitcnt lgkmcnt(3)
v_mfma_f32_16x16x32_bf16 v[144:147], a[144:147], v[96:99], v[144:147]
ds_read_b128 v[84:87], v21 offset:46080
v_fmac_f32 v203, 0x35800000, v47
v_lshlrev_b32_e64 v44, 16, v230
v_and_b32 v45, 0xffff0000, v230
v_mfma_f32_16x16x32_bf16 v[148:151], a[148:151], v[96:99], v[148:151]
v_fmac_f32 v204, 0x35800000, v44
v_fmac_f32 v205, 0x35800000, v45
v_lshlrev_b32_e64 v46, 16, v231
v_mfma_f32_16x16x32_bf16 v[156:159], a[148:151], v[100:103], v[156:159]
ds_read_b128 v[88:91], v21 offset:47104
v_and_b32 v47, 0xffff0000, v231
v_fmac_f32 v206, 0x35800000, v46
v_fmac_f32 v207, 0x35800000, v47
v_mfma_f32_16x16x32_bf16 v[152:155], a[144:147], v[100:103], v[152:155]
v_lshlrev_b32_e64 v44, 16, v232
v_and_b32 v45, 0xffff0000, v232
v_fmac_f32 v208, 0x35800000, v44
v_mfma_f32_16x16x32_bf16 v[144:147], a[152:155], v[104:107], v[144:147]
ds_read_b128 v[92:95], v21 offset:48128
v_fmac_f32 v209, 0x35800000, v45
v_lshlrev_b32_e64 v46, 16, v233
v_and_b32 v47, 0xffff0000, v233
v_mfma_f32_16x16x32_bf16 v[148:151], a[156:159], v[104:107], v[148:151]
v_fmac_f32 v210, 0x35800000, v46
v_fmac_f32 v211, 0x35800000, v47
v_lshlrev_b32_e64 v44, 16, v234
v_mfma_f32_16x16x32_bf16 v[156:159], a[156:159], v[108:111], v[156:159]
ds_read_b128 v[96:99], v21 offset:49152
v_and_b32 v45, 0xffff0000, v234
v_fmac_f32 v212, 0x35800000, v44
v_fmac_f32 v213, 0x35800000, v45
v_mfma_f32_16x16x32_bf16 v[152:155], a[152:155], v[108:111], v[152:155]
v_lshlrev_b32_e64 v46, 16, v235
v_and_b32 v47, 0xffff0000, v235
v_fmac_f32 v214, 0x35800000, v46
v_mfma_f32_16x16x32_bf16 v[144:147], a[160:163], v[64:67], v[144:147]
ds_read_b128 v[100:103], v21 offset:50176
v_fmac_f32 v215, 0x35800000, v47
v_lshlrev_b32_e64 v44, 16, v236
v_and_b32 v45, 0xffff0000, v236
v_mfma_f32_16x16x32_bf16 v[148:151], a[164:167], v[64:67], v[148:151]
v_fmac_f32 v216, 0x35800000, v44
v_fmac_f32 v217, 0x35800000, v45
v_lshlrev_b32_e64 v46, 16, v237
v_mfma_f32_16x16x32_bf16 v[156:159], a[164:167], v[68:71], v[156:159]
ds_read_b128 v[104:107], v21 offset:51200
v_and_b32 v47, 0xffff0000, v237
v_fmac_f32 v218, 0x35800000, v46
v_fmac_f32 v219, 0x35800000, v47
v_mfma_f32_16x16x32_bf16 v[152:155], a[160:163], v[68:71], v[152:155]
v_lshlrev_b32 v44, 16, v238
v_and_b32 v45, 0xffff0000, v238
s_waitcnt lgkmcnt(3)
v_mfma_f32_16x16x32_bf16 v[144:147], a[168:171], v[72:75], v[144:147]
ds_read_b128 v[108:111], v21 offset:52224
v_fmac_f32 v220, 0x35800000, v44
v_fmac_f32 v221, 0x35800000, v45
v_lshlrev_b32_e64 v46, 16, v239
v_mfma_f32_16x16x32_bf16 v[148:151], a[172:175], v[72:75], v[148:151]
v_and_b32 v47, 0xffff0000, v239
v_fmac_f32 v222, 0x35800000, v46
v_fmac_f32 v223, 0x35800000, v47
v_mfma_f32_16x16x32_bf16 v[156:159], a[172:175], v[76:79], v[156:159]
ds_read_b128 v[64:67], v21 offset:53248
s_waitcnt vmcnt(0)
v_xor_b32 v44, s53, v121
v_xor_b32_e64 v45, s53, v119
v_mfma_f32_16x16x32_bf16 v[152:155], a[168:171], v[76:79], v[152:155]
v_xor_b32_e64 v46, s53, v115
v_or3_b32 v44, v44, v45, v46
v_mfma_f32_16x16x32_bf16 v[144:147], a[176:179], v[80:83], v[144:147]
ds_read_b128 v[68:71], v21 offset:54272
v_cmp_lt_u32 vcc, s72, v44
s_cbranch_vccnz L_spin11
L_back11:
v_mfma_f32_16x16x32_bf16 v[148:151], a[180:183], v[80:83], v[148:151]
v_lshlrev_b32_e64 v44, 16, v112
v_and_b32 v45, 0xffff0000, v112
v_mfma_f32_16x16x32_bf16 v[156:159], a[180:183], v[84:87], v[156:159]
ds_read_b128 v[72:75], v21 offset:55296
v_add_f32 v208, v208, v44
v_add_f32 v209, v209, v45
v_lshlrev_b32_e64 v46, 16, v113
v_mfma_f32_16x16x32_bf16 v[152:155], a[176:179], v[84:87], v[152:155]
v_and_b32 v47, 0xffff0000, v113
v_add_f32 v210, v210, v46
v_add_f32 v211, v211, v47
v_mfma_f32_16x16x32_bf16 v[144:147], a[184:187], v[88:91], v[144:147]
ds_read_b128 v[76:79], v21 offset:56320
v_lshlrev_b32_e64 v44, 16, v114
v_and_b32 v45, 0xffff0000, v114
v_add_f32_e64 v212, v212, v44
v_mfma_f32_16x16x32_bf16 v[148:151], a[188:191], v[88:91], v[148:151]
v_add_f32 v213, v213, v45
v_lshlrev_b32 v46, 16, v115
v_lshlrev_b32_e64 v47, 16, v120
v_mfma_f32_16x16x32_bf16 v[156:159], a[188:191], v[92:95], v[156:159]
v_add_f32 v214, v214, v46
v_add_f32 v215, v215, v47
v_lshlrev_b32_e64 v44, 16, v116
v_and_b32 v45, 0xffff0000, v116
v_mfma_f32_16x16x32_bf16 v[152:155], a[184:187], v[92:95], v[152:155]
v_add_f32_e64 v216, v216, v44
v_add_f32 v217, v217, v45
s_waitcnt lgkmcnt(2)
v_mfma_f32_16x16x32_bf16 v[144:147], a[192:195], v[96:99], v[144:147]
v_lshlrev_b32_e64 v46, 16, v117
v_and_b32 v47, 0xffff0000, v117
v_add_f32 v218, v218, v46
v_add_f32 v219, v219, v47
v_mfma_f32_16x16x32_bf16 v[148:151], a[196:199], v[96:99], v[148:151]
v_lshlrev_b32_e64 v44, 16, v118
v_and_b32 v45, 0xffff0000, v118
v_add_f32_e64 v220, v220, v44
v_mfma_f32_16x16x32_bf16 v[156:159], a[196:199], v[100:103], v[156:159]
v_add_f32 v221, v221, v45
v_lshlrev_b32 v46, 16, v119
v_and_b32 v47, 0xffff0000, v120
v_add_f32_e64 v222, v222, v46
v_mfma_f32_16x16x32_bf16 v[152:155], a[192:195], v[100:103], v[152:155]
v_add_f32 v223, v223, v47
v_add_f32 v192, v192, v128
v_add_f32_e64 v193, v193, v129
v_mfma_f32_16x16x32_bf16 v[144:147], a[200:203], v[104:107], v[144:147]
v_add_f32 v194, v194, v130
v_add_f32 v195, v195, v131
v_add_f32 v196, v196, v132
v_add_f32 v197, v197, v133
v_mfma_f32_16x16x32_bf16 v[148:151], a[204:207], v[104:107], v[148:151]
v_add_f32 v198, v198, v134
v_add_f32 v199, v199, v135
v_cvt_pk_bf16_f32 v48, v192, v193
v_mfma_f32_16x16x32_bf16 v[156:159], a[204:207], v[108:111], v[156:159]
v_cvt_pk_bf16_f32 v50, v196, v197
v_cvt_pk_bf16_f32 v49, v194, v195
v_cvt_pk_bf16_f32 v51, v198, v199
v_add_f32_e64 v200, v200, v136
v_mfma_f32_16x16x32_bf16 v[152:155], a[200:203], v[108:111], v[152:155]
v_add_f32 v201, v201, v137
v_permlane32_swap_b32 v48, v50
v_permlane32_swap_b32_e64 v49, v51
v_mfma_f32_16x16x32_bf16 v[144:147], a[208:211], v[64:67], v[144:147]
buffer_store_dwordx4 v[48:51], v2, s[32:35], s76 offen
s_add_u32 s76, s76, 0x8000
v_add_f32 v202, v202, v138
v_add_f32 v203, v203, v139
v_mfma_f32_16x16x32_bf16 v[148:151], a[212:215], v[64:67], v[148:151]
v_add_f32 v204, v204, v140
v_add_f32 v205, v205, v141
v_add_f32_e64 v206, v206, v142
v_mfma_f32_16x16x32_bf16 v[156:159], a[212:215], v[68:71], v[156:159]
v_add_f32_e64 v207, v207, v143
v_cvt_pk_bf16_f32 v52, v200, v201
v_cvt_pk_bf16_f32 v54, v204, v205
v_cvt_pk_bf16_f32 v53, v202, v203
v_mfma_f32_16x16x32_bf16 v[152:155], a[208:211], v[68:71], v[152:155]
v_cvt_pk_bf16_f32 v55, v206, v207
v_permlane32_swap_b32 v52, v54
s_waitcnt lgkmcnt(0)
v_mfma_f32_16x16x32_bf16 v[144:147], a[216:219], v[72:75], v[144:147]
v_permlane32_swap_b32_e64 v53, v55
v_mfma_f32_16x16x32_bf16 v[148:151], a[220:223], v[72:75], v[148:151]
buffer_store_dwordx4 v[52:55], v2, s[32:35], s76 offen
s_add_u32 s76, s76, 0x8000
v_mfma_f32_16x16x32_bf16 v[156:159], a[220:223], v[76:79], v[156:159]
v_mfma_f32_16x16x32_bf16 v[152:155], a[216:219], v[76:79], v[152:155]
s_nop 1
v_add_f32 v208, v208, v144
v_add_f32 v209, v209, v145
v_add_f32 v210, v210, v146
v_add_f32 v211, v211, v147
v_add_f32 v212, v212, v148
v_add_f32 v213, v213, v149
v_add_f32 v214, v214, v150
v_add_f32_e64 v215, v215, v151
v_cvt_pk_bf16_f32 v48, v208, v209
v_cvt_pk_bf16_f32 v50, v212, v213
v_cvt_pk_bf16_f32 v49, v210, v211
v_cvt_pk_bf16_f32 v51, v214, v215
v_add_f32 v216, v216, v152
v_add_f32 v217, v217, v153
v_permlane32_swap_b32 v48, v50
v_permlane32_swap_b32 v49, v51
buffer_store_dwordx4 v[48:51], v2, s[32:35], s76 offen
s_add_u32 s76, s76, 0x8000
v_add_f32 v218, v218, v154
v_add_f32 v219, v219, v155
v_add_f32 v220, v220, v156
v_add_f32 v221, v221, v157
v_add_f32 v222, v222, v158
v_add_f32 v223, v223, v159
v_cvt_pk_bf16_f32 v52, v216, v217
v_cvt_pk_bf16_f32 v54, v220, v221
v_cvt_pk_bf16_f32 v53, v218, v219
v_cvt_pk_bf16_f32 v55, v222, v223
v_permlane32_swap_b32 v52, v54
s_nop 0
v_permlane32_swap_b32_e64 v53, v55
buffer_store_dwordx4 v[52:55], v2, s[32:35], s76 offen
s_add_u32 s76, s76, 0x8000
s_or_b32 s45, s2, s36
s_cmp_lg_u32 s45, 0
s_cbranch_scc1 L_noep
s_mov_b32 s45, 0
buffer_store_dword v56, v57, s[24:27], s45 offen offset:0 sc1
L_noep:
L_end:
s_endpgm
s_nop 0
L_fft:
s_mov_b32 s88, s6
s_mov_b32 s89, s7
s_mov_b32 s90, 0x201000
s_mov_b32 s91, 0x20000
v_bfe_u32 v24, v0, 2, 2
v_xor_b32 v24, s36, v24
v_lshlrev_b32 v24, 4, v24
v_and_b32_e64 v25, 31, v0
v_lshl_add_u32 v24, v25, 6, v24
v_lshrrev_b32_e64 v25, 5, v0
v_lshl_add_u32 v10, v25, 13, v24
v_add_u32 v11, 0x10000, v10
s_and_b32 s45, s36, 1
v_lshrrev_b32 v24, 3, v0
v_xor_b32 v24, s45, v24
v_and_b32 v25, 7, v0
v_lshlrev_b32_e64 v25, 4, v25
v_lshl_add_u32 v12, v24, 9, v25
v_add_u32 v13, 3072, v12
v_add_u32 v14, 6144, v12
v_add_u32 v15, 9216, v12
s_lshl_b32 s44, s41, 17
s_lshl_b32 s45, s36, 15
s_add_u32 s44, s44, s45
s_lshl_b32 s45, s36, 1
v_and_b32 v24, 7, v0
v_xor_b32 v24, s45, v24
v_lshlrev_b32 v24, 4, v24
v_lshrrev_b32 v25, 2, v0
v_xor_b32_e64 v25, v25, v0
v_bfe_u32 v25, v25, 3, 1
v_lshl_add_u32 v24, v25, 7, v24
v_and_b32_e64 v25, 31, v0
v_lshl_add_u32 v2, v25, 10, v24
v_xor_b32_e64 v3, 16, v2
v_add_u32 v4, 0x10000, v2
v_add_u32 v5, 0x10000, v3
v_mov_b32 v56, s53
v_lshrrev_b32 v57, 5, v0
v_lshlrev_b32_e64 v57, 28, v57
v_add_lshl_u32 v57, v57, v0, 2
v_lshlrev_b32 v1, 7, v0
s_waitcnt vmcnt(5)
ds_read_b64_tr_b16 v[128:129], v62 offset:0
ds_read_b64_tr_b16 v[130:131], v62 offset:256
ds_read_b64_tr_b16 v[132:133], v62 offset:1024
ds_read_b64_tr_b16 v[134:135], v62 offset:1280
ds_read_b64_tr_b16 v[136:137], v62 offset:2048
ds_read_b64_tr_b16 v[138:139], v62 offset:2304
ds_read_b64_tr_b16 v[140:141], v62 offset:3072
ds_read_b64_tr_b16 v[142:143], v62 offset:3328
s_waitcnt lgkmcnt(7)
v_dot2_f32_bf16 v240, v128, v253, 0
v_dot2_f32_bf16 v241, v128, v128, 0
v_dot2_f32_bf16 v240, v129, v253, v240
v_dot2_f32_bf16 v241, v129, v129, v241
s_waitcnt lgkmcnt(6)
v_dot2_f32_bf16 v240, v130, v253, v240
v_dot2_f32_bf16 v241, v130, v130, v241
v_dot2_f32_bf16 v240, v131, v253, v240
v_dot2_f32_bf16 v241, v131, v131, v241
s_waitcnt lgkmcnt(5)
v_dot2_f32_bf16 v240, v132, v253, v240
v_dot2_f32_bf16 v241, v132, v132, v241
v_dot2_f32_bf16 v240, v133, v253, v240
v_dot2_f32_bf16 v241, v133, v133, v241
s_waitcnt lgkmcnt(4)
v_dot2_f32_bf16 v240, v134, v253, v240
v_dot2_f32_bf16 v241, v134, v134, v241
v_dot2_f32_bf16 v240, v135, v253, v240
v_dot2_f32_bf16 v241, v135, v135, v241
s_waitcnt lgkmcnt(3)
v_dot2_f32_bf16 v243, v136, v253, 0
v_dot2_f32_bf16 v244, v136, v136, 0
v_dot2_f32_bf16 v243, v137, v253, v243
v_dot2_f32_bf16 v244, v137, v137, v244
s_waitcnt lgkmcnt(2)
v_dot2_f32_bf16 v243, v138, v253, v243
v_dot2_f32_bf16 v244, v138, v138, v244
v_dot2_f32_bf16 v243, v139, v253, v243
v_dot2_f32_bf16 v244, v139, v139, v244
s_waitcnt lgkmcnt(1)
v_dot2_f32_bf16 v243, v140, v253, v243
v_dot2_f32_bf16 v244, v140, v140, v244
v_dot2_f32_bf16 v243, v141, v253, v243
v_dot2_f32_bf16 v244, v141, v141, v244
s_waitcnt lgkmcnt(0)
v_dot2_f32_bf16 v243, v142, v253, v243
v_dot2_f32_bf16 v244, v142, v142, v244
v_dot2_f32_bf16 v243, v143, v253, v243
v_dot2_f32_bf16 v244, v143, v143, v244
v_mfma_f32_32x32x16_bf16 v[144:159], v[128:131], v[64:67], 0
v_mul_f32 v242, v240, v252
v_mul_f32 v245, v243, v252
v_add_f32_dpp v240, v240, v240 row_shr:1 row_mask:0xf bank_mask:0xf bound_ctrl:0
v_add_f32_dpp v241, v241, v241 row_shr:1 row_mask:0xf bank_mask:0xf bound_ctrl:0
buffer_load_dwordx4 v43, s[84:87], s51 offen offset:3072 lds
v_add_f32_dpp v242, v242, v242 row_shr:1 row_mask:0xf bank_mask:0xf bound_ctrl:0
v_add_f32_dpp v243, v243, v243 row_shr:1 row_mask:0xf bank_mask:0xf bound_ctrl:0
v_mfma_f32_32x32x16_bf16 v[160:175], v[128:131], v[72:75], 0
v_add_f32_dpp v244, v244, v244 row_shr:1 row_mask:0xf bank_mask:0xf bound_ctrl:0
v_add_f32_dpp v245, v245, v245 row_shr:1 row_mask:0xf bank_mask:0xf bound_ctrl:0
v_add_f32_dpp v240, v240, v240 row_shr:2 row_mask:0xf bank_mask:0xf bound_ctrl:0
v_add_f32_dpp v241, v241, v241 row_shr:2 row_mask:0xf bank_mask:0xf bound_ctrl:0
v_add_f32_dpp v242, v242, v242 row_shr:2 row_mask:0xf bank_mask:0xf bound_ctrl:0
v_add_f32_dpp v243, v243, v243 row_shr:2 row_mask:0xf bank_mask:0xf bound_ctrl:0
v_mfma_f32_32x32x16_bf16 v[144:159], v[132:135], v[68:71], v[144:159]
v_add_f32_dpp v244, v244, v244 row_shr:2 row_mask:0xf bank_mask:0xf bound_ctrl:0
v_add_f32_dpp v245, v245, v245 row_shr:2 row_mask:0xf bank_mask:0xf bound_ctrl:0
v_add_f32_dpp v240, v240, v240 row_shr:4 row_mask:0xf bank_mask:0xf bound_ctrl:0
v_add_f32_dpp v241, v241, v241 row_shr:4 row_mask:0xf bank_mask:0xf bound_ctrl:0
v_add_f32_dpp v242, v242, v242 row_shr:4 row_mask:0xf bank_mask:0xf bound_ctrl:0
v_add_f32_dpp v243, v243, v243 row_shr:4 row_mask:0xf bank_mask:0xf bound_ctrl:0
v_mfma_f32_32x32x16_bf16 v[160:175], v[132:135], v[76:79], v[160:175]
v_add_f32_dpp v244, v244, v244 row_shr:4 row_mask:0xf bank_mask:0xf bound_ctrl:0
v_add_f32_dpp v245, v245, v245 row_shr:4 row_mask:0xf bank_mask:0xf bound_ctrl:0
v_add_f32_dpp v240, v240, v240 row_shr:8 row_mask:0xf bank_mask:0xf bound_ctrl:0
v_add_f32_dpp v241, v241, v241 row_shr:8 row_mask:0xf bank_mask:0xf bound_ctrl:0
v_add_f32_dpp v242, v242, v242 row_shr:8 row_mask:0xf bank_mask:0xf bound_ctrl:0
v_add_f32_dpp v243, v243, v243 row_shr:8 row_mask:0xf bank_mask:0xf bound_ctrl:0
v_mfma_f32_32x32x16_bf16 v[176:191], v[136:139], v[64:67], 0
v_add_f32_dpp v244, v244, v244 row_shr:8 row_mask:0xf bank_mask:0xf bound_ctrl:0
v_add_f32_dpp v245, v245, v245 row_shr:8 row_mask:0xf bank_mask:0xf bound_ctrl:0
v_add_f32_dpp v240, v240, v240 row_bcast:15 row_mask:0xa bank_mask:0xf
v_add_f32_dpp v241, v241, v241 row_bcast:15 row_mask:0xa bank_mask:0xf
v_add_f32_dpp v242, v242, v242 row_bcast:15 row_mask:0xa bank_mask:0xf
v_add_f32_dpp v243, v243, v243 row_bcast:15 row_mask:0xa bank_mask:0xf
v_mfma_f32_32x32x16_bf16 v[192:207], v[136:139], v[72:75], 0
v_add_f32_dpp v244, v244, v244 row_bcast:15 row_mask:0xa bank_mask:0xf
v_add_f32_dpp v245, v245, v245 row_bcast:15 row_mask:0xa bank_mask:0xf
v_add_f32_dpp v240, v240, v240 row_bcast:31 row_mask:0xc bank_mask:0xf
v_add_f32_dpp v241, v241, v241 row_bcast:31 row_mask:0xc bank_mask:0xf
v_add_f32_dpp v242, v242, v242 row_bcast:31 row_mask:0xc bank_mask:0xf
v_add_f32_dpp v243, v243, v243 row_bcast:31 row_mask:0xc bank_mask:0xf
v_mfma_f32_32x32x16_bf16 v[176:191], v[140:143], v[68:71], v[176:191]
v_add_f32_dpp v244, v244, v244 row_bcast:31 row_mask:0xc bank_mask:0xf
v_add_f32_dpp v245, v245, v245 row_bcast:31 row_mask:0xc bank_mask:0xf
v_readlane_b32 s58, v240, 63
v_readlane_b32 s59, v241, 63
v_readlane_b32 s60, v242, 63
v_readlane_b32 s61, v243, 63
v_mfma_f32_32x32x16_bf16 v[192:207], v[140:143], v[76:79], v[192:207]
s_xor_b32 m0, s42, 4096
s_add_u32 s51, s43, 131328
buffer_load_dwordx4 v40, s[84:87], s51 offen offset:0 lds
v_readlane_b32 s62, v244, 63
v_readlane_b32 s63, v245, 63
v_cmp_gt_f32 vcc, 0, v252
v_mov_b32 v240, s58
v_mov_b32 v241, s61
v_mov_b32 v242, s59
v_mov_b32 v243, s62
v_cndmask_b32 v240, v240, v241, vcc
v_cndmask_b32 v242, v242, v243, vcc
v_cmp_eq_f32 vcc, 0, v248
v_mov_b32 v244, 0xbd000000
v_mul_f32 v240, 0xba800000, v240
v_mul_f32 v242, 0x3a800000, v242
v_cndmask_b32 v244, 0, v244, vcc
v_fma_f32 v242, -v240, v240, v242
v_mul_f32 v246, s61, v244
v_max_f32 v242, 0, v242
v_mul_f32 v244, s58, v244
v_add_f32 v242, 0x3727c5ac, v242
v_rsq_f32_e64 v243, v242
v_pk_mul_f32 v[248:249], v[144:145], v[96:97]
v_pk_fma_f32 v[144:145], v[144:145], v[80:81], v[244:245] op_sel_hi:[1,1,0]
v_pk_fma_f32 v[144:145], v[160:161], v[96:97], v[144:145]
v_pk_fma_f32 v[160:161], v[160:161], v[80:81], v[248:249] neg_lo:[0,0,1] neg_hi:[0,0,1]
v_pk_mul_f32 v[250:251], v[146:147], v[98:99]
v_pk_fma_f32 v[146:147], v[146:147], v[82:83], v[244:245] op_sel_hi:[1,1,0]
v_pk_fma_f32 v[146:147], v[162:163], v[98:99], v[146:147]
v_pk_fma_f32 v[162:163], v[162:163], v[82:83], v[250:251] neg_lo:[0,0,1] neg_hi:[0,0,1]
v_pk_mul_f32 v[248:249], v[148:149], v[100:101]
v_pk_fma_f32 v[148:149], v[148:149], v[84:85], v[244:245] op_sel_hi:[1,1,0]
v_pk_fma_f32 v[148:149], v[164:165], v[100:101], v[148:149]
v_pk_fma_f32 v[164:165], v[164:165], v[84:85], v[248:249] neg_lo:[0,0,1] neg_hi:[0,0,1]
v_pk_mul_f32 v[250:251], v[150:151], v[102:103]
v_pk_fma_f32 v[150:151], v[150:151], v[86:87], v[244:245] op_sel_hi:[1,1,0]
v_pk_fma_f32 v[150:151], v[166:167], v[102:103], v[150:151]
v_pk_fma_f32 v[166:167], v[166:167], v[86:87], v[250:251] neg_lo:[0,0,1] neg_hi:[0,0,1]
v_pk_mul_f32 v[248:249], v[152:153], v[104:105]
v_pk_fma_f32 v[152:153], v[152:153], v[88:89], v[244:245] op_sel_hi:[1,1,0]
v_pk_fma_f32 v[152:153], v[168:169], v[104:105], v[152:153]
v_pk_fma_f32 v[168:169], v[168:169], v[88:89], v[248:249] neg_lo:[0,0,1] neg_hi:[0,0,1]
v_pk_mul_f32 v[250:251], v[154:155], v[106:107]
v_pk_fma_f32 v[154:155], v[154:155], v[90:91], v[244:245] op_sel_hi:[1,1,0]
v_pk_fma_f32 v[154:155], v[170:171], v[106:107], v[154:155]
v_pk_fma_f32 v[170:171], v[170:171], v[90:91], v[250:251] neg_lo:[0,0,1] neg_hi:[0,0,1]
v_pk_mul_f32 v[248:249], v[156:157], v[108:109]
v_pk_fma_f32 v[156:157], v[156:157], v[92:93], v[244:245] op_sel_hi:[1,1,0]
v_pk_fma_f32 v[156:157], v[172:173], v[108:109], v[156:157]
v_pk_fma_f32 v[172:173], v[172:173], v[92:93], v[248:249] neg_lo:[0,0,1] neg_hi:[0,0,1]
v_pk_mul_f32 v[250:251], v[158:159], v[110:111]
v_pk_fma_f32 v[158:159], v[158:159], v[94:95], v[244:245] op_sel_hi:[1,1,0]
v_pk_fma_f32 v[158:159], v[174:175], v[110:111], v[158:159]
v_pk_fma_f32 v[174:175], v[174:175], v[94:95], v[250:251] neg_lo:[0,0,1] neg_hi:[0,0,1]
v_cvt_pk_bf16_f32 v208, v144, v160
v_cvt_pk_bf16_f32 v209, v145, v161
v_cvt_pk_bf16_f32 v210, v146, v162
v_cvt_pk_bf16_f32 v211, v147, v163
v_cvt_pk_bf16_f32 v212, v148, v164
v_cvt_pk_bf16_f32 v213, v149, v165
v_cvt_pk_bf16_f32 v214, v150, v166
v_cvt_pk_bf16_f32 v215, v151, v167
v_cvt_pk_bf16_f32 v216, v152, v168
v_cvt_pk_bf16_f32 v217, v153, v169
v_cvt_pk_bf16_f32 v218, v154, v170
v_cvt_pk_bf16_f32 v219, v155, v171
v_cvt_pk_bf16_f32 v220, v156, v172
v_cvt_pk_bf16_f32 v221, v157, v173
v_cvt_pk_bf16_f32 v222, v158, v174
v_cvt_pk_bf16_f32 v223, v159, v175
v_pk_mul_f32 v[248:249], v[176:177], v[96:97]
v_pk_fma_f32 v[176:177], v[176:177], v[80:81], v[246:247] op_sel_hi:[1,1,0]
v_pk_fma_f32 v[176:177], v[192:193], v[96:97], v[176:177]
v_pk_fma_f32 v[192:193], v[192:193], v[80:81], v[248:249] neg_lo:[0,0,1] neg_hi:[0,0,1]
v_pk_mul_f32 v[250:251], v[178:179], v[98:99]
v_pk_fma_f32 v[178:179], v[178:179], v[82:83], v[246:247] op_sel_hi:[1,1,0]
v_pk_fma_f32 v[178:179], v[194:195], v[98:99], v[178:179]
v_pk_fma_f32 v[194:195], v[194:195], v[82:83], v[250:251] neg_lo:[0,0,1] neg_hi:[0,0,1]
v_pk_mul_f32 v[248:249], v[180:181], v[100:101]
v_pk_fma_f32 v[180:181], v[180:181], v[84:85], v[246:247] op_sel_hi:[1,1,0]
v_pk_fma_f32 v[180:181], v[196:197], v[100:101], v[180:181]
v_pk_fma_f32 v[196:197], v[196:197], v[84:85], v[248:249] neg_lo:[0,0,1] neg_hi:[0,0,1]
v_pk_mul_f32 v[250:251], v[182:183], v[102:103]
v_pk_fma_f32 v[182:183], v[182:183], v[86:87], v[246:247] op_sel_hi:[1,1,0]
v_pk_fma_f32 v[182:183], v[198:199], v[102:103], v[182:183]
v_pk_fma_f32 v[198:199], v[198:199], v[86:87], v[250:251] neg_lo:[0,0,1] neg_hi:[0,0,1]
v_pk_mul_f32 v[248:249], v[184:185], v[104:105]
v_pk_fma_f32 v[184:185], v[184:185], v[88:89], v[246:247] op_sel_hi:[1,1,0]
v_pk_fma_f32 v[184:185], v[200:201], v[104:105], v[184:185]
v_pk_fma_f32 v[200:201], v[200:201], v[88:89], v[248:249] neg_lo:[0,0,1] neg_hi:[0,0,1]
v_pk_mul_f32 v[250:251], v[186:187], v[106:107]
buffer_load_dwordx4 v41, s[84:87], s51 offen offset:1024 lds
v_pk_fma_f32 v[186:187], v[186:187], v[90:91], v[246:247] op_sel_hi:[1,1,0]
v_pk_fma_f32 v[186:187], v[202:203], v[106:107], v[186:187]
v_pk_fma_f32 v[202:203], v[202:203], v[90:91], v[250:251] neg_lo:[0,0,1] neg_hi:[0,0,1]
v_pk_mul_f32 v[248:249], v[188:189], v[108:109]
v_pk_fma_f32 v[188:189], v[188:189], v[92:93], v[246:247] op_sel_hi:[1,1,0]
v_pk_fma_f32 v[188:189], v[204:205], v[108:109], v[188:189]
v_pk_fma_f32 v[204:205], v[204:205], v[92:93], v[248:249] neg_lo:[0,0,1] neg_hi:[0,0,1]
v_pk_mul_f32 v[250:251], v[190:191], v[110:111]
v_pk_fma_f32 v[190:191], v[190:191], v[94:95], v[246:247] op_sel_hi:[1,1,0]
v_pk_fma_f32 v[190:191], v[206:207], v[110:111], v[190:191]
v_pk_fma_f32 v[206:207], v[206:207], v[94:95], v[250:251] neg_lo:[0,0,1] neg_hi:[0,0,1]
v_cvt_pk_bf16_f32 v224, v176, v192
v_cvt_pk_bf16_f32 v225, v177, v193
v_cvt_pk_bf16_f32 v226, v178, v194
v_cvt_pk_bf16_f32 v227, v179, v195
v_cvt_pk_bf16_f32 v228, v180, v196
v_cvt_pk_bf16_f32 v229, v181, v197
v_cvt_pk_bf16_f32 v230, v182, v198
v_cvt_pk_bf16_f32 v231, v183, v199
v_cvt_pk_bf16_f32 v232, v184, v200
v_cvt_pk_bf16_f32 v233, v185, v201
v_cvt_pk_bf16_f32 v234, v186, v202
v_cvt_pk_bf16_f32 v235, v187, v203
v_cvt_pk_bf16_f32 v236, v188, v204
v_cvt_pk_bf16_f32 v237, v189, v205
v_cvt_pk_bf16_f32 v238, v190, v206
v_cvt_pk_bf16_f32 v239, v191, v207
v_mfma_f32_32x32x16_bf16 v[144:159], v[112:115], v[208:211], 0
v_readlane_b32 s64, v243, 0
v_readlane_b32 s65, v243, 1
v_mul_f32_e64 v70, v242, v243
v_cvt_pk_bf16_f32 v65, v240, v240
v_cvt_pk_bf16_f32 v64, v70, v70
v_mfma_f32_32x32x16_bf16 v[160:175], v[112:115], v[224:227], 0
v_and_b32 v67, 0xffff0000, v65
v_and_b32 v66, 0xffff0000, v64
v_sub_f32 v67, v240, v67
v_sub_f32 v68, v70, v66
v_mul_f32 v69, 0xc0135761, v243
v_mfma_f32_32x32x16_bf16 v[144:159], v[116:119], v[212:215], v[144:159]
v_cvt_pk_bf16_f32 v64, v66, v68
v_cvt_pk_bf16_f32 v66, v67, v67
s_and_b32 s55, s53, 0xbfffbfff
v_mov_b32 v67, s55
v_mul_f32 v68, v243, v243
v_mfma_f32_32x32x16_bf16 v[160:175], v[116:119], v[228:231], v[160:175]
v_mov_b32 v71, s55
v_mul_f32 v68, v68, v69
v_lshlrev_b32 v72, 15, v0
v_mul_f32 v68, 0x3d372713, v68
s_lshl_b32 s55, s56, 5
v_mfma_f32_32x32x16_bf16 v[144:159], v[120:123], v[216:219], v[144:159]
s_add_u32 s55, s55, 65536
v_mov_b32 v240, s64
v_mov_b32 v242, s65
buffer_load_dwordx4 v42, s[84:87], s51 offen offset:2048 lds
s_add_u32 s57, s47, 147456
v_add_u32_e64 v248, s57, v20
v_mfma_f32_32x32x16_bf16 v[160:175], v[120:123], v[232:235], v[160:175]
v_lshrrev_b32 v249, 5, v0
v_and_b32 v250, 31, v0
v_lshlrev_b32 v250, 4, v250
v_lshl_add_u32 v62, v249, 17, v250
s_lshl_b32 s57, s36, 20
v_mfma_f32_32x32x16_bf16 v[144:159], v[124:127], v[220:223], v[144:159]
s_lshl_b32 s54, s2, 9
s_add_u32 s57, s57, s54
s_add_u32 s57, s57, 2097152
s_lshl_b32 s54, s36, 28
s_waitcnt vmcnt(5)
v_and_b32 v50, 0xffff, v50
v_mfma_f32_32x32x16_bf16 v[160:175], v[124:127], v[236:239], v[160:175]
s_add_u32 s54, s54, 4096
s_waitcnt vmcnt(4)
v_lshl_or_b32 v50, v51, 16, v50
v_lshl_add_u32 v49, v49, 2, s54
s_mov_b64 exec, 15
buffer_store_dword v50, v49, s[24:27], 0 offen sc1
s_mov_b64 exec, 3
buffer_store_dwordx4 v[64:67], v72, s[24:27], s55 offen sc1
buffer_store_dwordx4 v[68:71], v72, s[24:27], s55 offen offset:16 sc1
s_mov_b64 exec, -1
v_writelane_b32 v144, s60, 0
v_writelane_b32 v145, 0, 0
v_writelane_b32 v160, s63, 0
v_writelane_b32 v161, 0, 0
v_pk_mul_f32 v[160:161], v[160:161], v[242:243] op_sel_hi:[1,0]
v_pk_mul_f32 v[162:163], v[162:163], v[242:243] op_sel_hi:[1,0]
v_pk_fma_f32 v[176:177], v[144:145], v[240:241], v[160:161] op_sel_hi:[1,0,1] neg_lo:[0,0,1] neg_hi:[0,0,1]
v_pk_fma_f32 v[178:179], v[146:147], v[240:241], v[162:163] op_sel_hi:[1,0,1] neg_lo:[0,0,1] neg_hi:[0,0,1]
v_pk_fma_f32 v[144:145], v[144:145], v[240:241], v[160:161] op_sel_hi:[1,0,1]
v_pk_fma_f32 v[146:147], v[146:147], v[240:241], v[162:163] op_sel_hi:[1,0,1]
v_cvt_pk_bf16_f32 v216, v176, v177
v_cvt_pk_bf16_f32 v217, v178, v179
v_cvt_pk_bf16_f32 v208, v144, v145
v_cvt_pk_bf16_f32 v209, v146, v147
ds_write_b32 v61, v216 offset:512
ds_write_b32 v60, v217 offset:1536
ds_write2st64_b32 v59, v208, v209 offset0:0 offset1:4
v_pk_mul_f32 v[164:165], v[164:165], v[242:243] op_sel_hi:[1,0]
v_pk_mul_f32 v[166:167], v[166:167], v[242:243] op_sel_hi:[1,0]
v_pk_fma_f32 v[180:181], v[148:149], v[240:241], v[164:165] op_sel_hi:[1,0,1] neg_lo:[0,0,1] neg_hi:[0,0,1]
v_pk_fma_f32 v[182:183], v[150:151], v[240:241], v[166:167] op_sel_hi:[1,0,1] neg_lo:[0,0,1] neg_hi:[0,0,1]
v_pk_fma_f32 v[148:149], v[148:149], v[240:241], v[164:165] op_sel_hi:[1,0,1]
v_pk_fma_f32 v[150:151], v[150:151], v[240:241], v[166:167] op_sel_hi:[1,0,1]
v_cvt_pk_bf16_f32 v218, v180, v181
v_cvt_pk_bf16_f32 v219, v182, v183
v_cvt_pk_bf16_f32 v210, v148, v149
v_cvt_pk_bf16_f32 v211, v150, v151
ds_write_b32 v60, v218 offset:4608
ds_write_b32 v60, v219 offset:5632
ds_write2st64_b32 v59, v210, v211 offset0:16 offset1:20
v_pk_mul_f32 v[168:169], v[168:169], v[242:243] op_sel_hi:[1,0]
v_pk_mul_f32 v[170:171], v[170:171], v[242:243] op_sel_hi:[1,0]
v_pk_fma_f32 v[184:185], v[152:153], v[240:241], v[168:169] op_sel_hi:[1,0,1] neg_lo:[0,0,1] neg_hi:[0,0,1]
v_pk_fma_f32 v[186:187], v[154:155], v[240:241], v[170:171] op_sel_hi:[1,0,1] neg_lo:[0,0,1] neg_hi:[0,0,1]
v_pk_fma_f32 v[152:153], v[152:153], v[240:241], v[168:169] op_sel_hi:[1,0,1]
v_pk_fma_f32 v[154:155], v[154:155], v[240:241], v[170:171] op_sel_hi:[1,0,1]
v_cvt_pk_bf16_f32 v220, v184, v185
v_cvt_pk_bf16_f32 v221, v186, v187
v_cvt_pk_bf16_f32 v212, v152, v153
v_cvt_pk_bf16_f32 v213, v154, v155
ds_write_b32 v60, v220 offset:8704
ds_write_b32 v60, v221 offset:9728
ds_write2st64_b32 v59, v212, v213 offset0:32 offset1:36
v_pk_mul_f32 v[172:173], v[172:173], v[242:243] op_sel_hi:[1,0]
v_pk_mul_f32 v[174:175], v[174:175], v[242:243] op_sel_hi:[1,0]
buffer_load_dwordx4 v43, s[84:87], s51 offen offset:3072 lds
v_pk_fma_f32 v[188:189], v[156:157], v[240:241], v[172:173] op_sel_hi:[1,0,1] neg_lo:[0,0,1] neg_hi:[0,0,1]
v_pk_fma_f32 v[190:191], v[158:159], v[240:241], v[174:175] op_sel_hi:[1,0,1] neg_lo:[0,0,1] neg_hi:[0,0,1]
v_pk_fma_f32 v[156:157], v[156:157], v[240:241], v[172:173] op_sel_hi:[1,0,1]
v_pk_fma_f32 v[158:159], v[158:159], v[240:241], v[174:175] op_sel_hi:[1,0,1]
v_cvt_pk_bf16_f32 v222, v188, v189
v_cvt_pk_bf16_f32 v223, v190, v191
v_cvt_pk_bf16_f32 v214, v156, v157
v_cvt_pk_bf16_f32 v215, v158, v159
ds_write_b32 v60, v222 offset:12800
ds_write_b32 v60, v223 offset:13824
ds_write2st64_b32 v59, v214, v215 offset0:48 offset1:52
s_and_b32 s54, s2, 7
s_lshl_b32 s54, s54, 5
s_lshr_b32 s55, s2, 3
s_add_u32 s54, s54, s55
s_lshl_b32 s54, s54, 7
s_lshl_b32 s55, s36, 15
s_add_u32 s54, s54, s55
s_add_u32 s64, s54, 131072
s_waitcnt lgkmcnt(0)
s_barrier
ds_read_b128 v[144:147], v248 offset:0
ds_read_b128 v[148:151], v248 offset:1024
ds_read_b128 v[152:155], v248 offset:2048
ds_read_b128 v[156:159], v248 offset:3072
s_waitcnt lgkmcnt(3)
buffer_store_dwordx4 v[144:147], v62, s[24:27], s57 offen sc1
s_add_u32 s57, s57, 0x40000
s_waitcnt lgkmcnt(2)
buffer_store_dwordx4 v[148:151], v62, s[24:27], s57 offen sc1
s_add_u32 s57, s57, 0x40000
s_waitcnt lgkmcnt(1)
buffer_store_dwordx4 v[152:155], v62, s[24:27], s57 offen sc1
s_add_u32 s57, s57, 0x40000
s_waitcnt lgkmcnt(0)
buffer_store_dwordx4 v[156:159], v62, s[24:27], s57 offen sc1
s_lshr_b32 s62, s41, 3
s_lshl_b32 s62, s62, 15
s_lshl_b32 s45, s36, 13
s_add_u32 s62, s62, s45
s_add_u32 s62, s62, 131072
s_lshl_b32 s63, s36, 5
s_add_u32 s63, s63, s41
s_lshl_b32 s63, s63, 9
s_add_u32 s63, s63, 393216
s_and_b32 s45, s41, 1
v_cvt_f32_u32 v37, s45
v_and_b32 v32, 31, v0
v_cvt_f32_u32 v32, v32
v_lshrrev_b32 v33, 5, v0
v_cvt_f32_u32 v33, v33
v_mul_f32_e64 v33, 4.0, v33
v_fma_f32 v34, v32, 2.0, v37
v_mul_f32 v34, 0x3c800000, v34
v_mul_f32 v35, v34, v33
v_mov_b32 v24, v35
v_fmamk_f32 v25, v34, 0x3f800000, v35
v_cos_f32 v26, v24
v_sin_f32 v27, v24
v_cos_f32 v28, v25
v_sin_f32 v29, v25
v_cvt_pk_bf16_f32 v24, v26, v27
s_xor_b32 m0, s42, 32768
s_add_u32 s51, s52, 1050624
buffer_load_dwordx4 v40, s[84:87], s51 offen offset:0 lds
v_cvt_pk_bf16_f32 v26, -v27, v26
v_accvgpr_write_b32 a0, v24
v_accvgpr_write_b32 a16, v26
v_cvt_pk_bf16_f32 v25, v28, v29
v_cvt_pk_bf16_f32 v28, -v29, v28
v_accvgpr_write_b32 a1, v25
v_accvgpr_write_b32 a17, v28
v_fmamk_f32 v24, v34, 0x40000000, v35
v_fmamk_f32 v25, v34, 0x40400000, v35
v_cos_f32 v26, v24
v_sin_f32 v27, v24
v_cos_f32 v28, v25
v_sin_f32 v29, v25
v_cvt_pk_bf16_f32 v24, v26, v27
v_cvt_pk_bf16_f32 v26, -v27, v26
v_accvgpr_write_b32 a2, v24
v_accvgpr_write_b32 a18, v26
v_cvt_pk_bf16_f32 v25, v28, v29
v_cvt_pk_bf16_f32 v28, -v29, v28
v_accvgpr_write_b32 a3, v25
v_accvgpr_write_b32 a19, v28
v_fmamk_f32 v24, v34, 0x41000000, v35
v_fmamk_f32 v25, v34, 0x41100000, v35
v_cos_f32 v26, v24
v_sin_f32 v27, v24
v_cos_f32 v28, v25
v_sin_f32 v29, v25
v_cvt_pk_bf16_f32 v24, v26, v27
v_cvt_pk_bf16_f32 v26, -v27, v26
v_accvgpr_write_b32 a4, v24
v_accvgpr_write_b32 a20, v26
v_cvt_pk_bf16_f32 v25, v28, v29
v_cvt_pk_bf16_f32 v28, -v29, v28
v_accvgpr_write_b32 a5, v25
v_accvgpr_write_b32 a21, v28
v_fmamk_f32 v24, v34, 0x41200000, v35
v_fmamk_f32 v25, v34, 0x41300000, v35
v_cos_f32 v26, v24
v_sin_f32 v27, v24
v_cos_f32 v28, v25
v_sin_f32 v29, v25
v_cvt_pk_bf16_f32 v24, v26, v27
v_cvt_pk_bf16_f32 v26, -v27, v26
v_accvgpr_write_b32 a6, v24
v_accvgpr_write_b32 a22, v26
v_cvt_pk_bf16_f32 v25, v28, v29
v_cvt_pk_bf16_f32 v28, -v29, v28
v_accvgpr_write_b32 a7, v25
buffer_load_dwordx4 v41, s[84:87], s51 offen offset:1024 lds
v_accvgpr_write_b32 a23, v28
v_fmamk_f32 v24, v34, 0x41800000, v35
v_fmamk_f32 v25, v34, 0x41880000, v35
v_cos_f32 v26, v24
v_sin_f32 v27, v24
v_cos_f32 v28, v25
v_sin_f32 v29, v25
v_cvt_pk_bf16_f32 v24, v26, v27
v_cvt_pk_bf16_f32 v26, -v27, v26
v_accvgpr_write_b32 a8, v24
v_accvgpr_write_b32 a24, v26
v_cvt_pk_bf16_f32 v25, v28, v29
v_cvt_pk_bf16_f32 v28, -v29, v28
v_accvgpr_write_b32 a9, v25
v_accvgpr_write_b32 a25, v28
v_fmamk_f32 v24, v34, 0x41900000, v35
v_fmamk_f32 v25, v34, 0x41980000, v35
v_cos_f32 v26, v24
v_sin_f32 v27, v24
v_cos_f32 v28, v25
v_sin_f32 v29, v25
v_cvt_pk_bf16_f32 v24, v26, v27
v_cvt_pk_bf16_f32 v26, -v27, v26
v_accvgpr_write_b32 a10, v24
v_accvgpr_write_b32 a26, v26
v_cvt_pk_bf16_f32 v25, v28, v29
v_cvt_pk_bf16_f32 v28, -v29, v28
v_accvgpr_write_b32 a11, v25
v_accvgpr_write_b32 a27, v28
v_fmamk_f32 v24, v34, 0x41c00000, v35
v_fmamk_f32 v25, v34, 0x41c80000, v35
v_cos_f32 v26, v24
v_sin_f32 v27, v24
v_cos_f32 v28, v25
v_sin_f32 v29, v25
v_cvt_pk_bf16_f32 v24, v26, v27
v_cvt_pk_bf16_f32 v26, -v27, v26
v_accvgpr_write_b32 a12, v24
v_accvgpr_write_b32 a28, v26
v_cvt_pk_bf16_f32 v25, v28, v29
v_cvt_pk_bf16_f32 v28, -v29, v28
v_accvgpr_write_b32 a13, v25
v_accvgpr_write_b32 a29, v28
v_fmamk_f32 v24, v34, 0x41d00000, v35
v_fmamk_f32 v25, v34, 0x41d80000, v35
v_cos_f32 v26, v24
v_sin_f32 v27, v24
buffer_load_dwordx4 v42, s[84:87], s51 offen offset:2048 lds
v_cos_f32 v28, v25
v_sin_f32 v29, v25
v_cvt_pk_bf16_f32 v24, v26, v27
v_cvt_pk_bf16_f32 v26, -v27, v26
v_accvgpr_write_b32 a14, v24
v_accvgpr_write_b32 a30, v26
v_cvt_pk_bf16_f32 v25, v28, v29
v_cvt_pk_bf16_f32 v28, -v29, v28
v_accvgpr_write_b32 a15, v25
v_accvgpr_write_b32 a31, v28
v_mul_f32 v34, 0x3a000000, v37
v_fmac_f32 v34, 0x3d000000, v32
v_mul_f32 v35, v34, v33
v_mov_b32 v24, v35
v_fmamk_f32 v25, v34, 0x3f800000, v35
v_cos_f32 v26, v24
v_sin_f32 v27, v24
v_cos_f32 v28, v25
v_sin_f32 v29, v25
v_cvt_pk_bf16_f32 v24, v26, v27
v_cvt_pk_bf16_f32 v26, -v27, v26
v_accvgpr_write_b32 a32, v24
v_accvgpr_write_b32 a48, v26
v_cvt_pk_bf16_f32 v25, v28, v29
v_cvt_pk_bf16_f32 v28, -v29, v28
v_accvgpr_write_b32 a33, v25
v_accvgpr_write_b32 a49, v28
v_fmamk_f32 v24, v34, 0x40000000, v35
v_fmamk_f32 v25, v34, 0x40400000, v35
v_cos_f32 v26, v24
v_sin_f32 v27, v24
v_cos_f32 v28, v25
v_sin_f32 v29, v25
v_cvt_pk_bf16_f32 v24, v26, v27
v_cvt_pk_bf16_f32 v26, -v27, v26
v_accvgpr_write_b32 a34, v24
v_accvgpr_write_b32 a50, v26
v_cvt_pk_bf16_f32 v25, v28, v29
v_cvt_pk_bf16_f32 v28, -v29, v28
v_accvgpr_write_b32 a35, v25
v_accvgpr_write_b32 a51, v28
v_fmamk_f32 v24, v34, 0x41000000, v35
v_fmamk_f32 v25, v34, 0x41100000, v35
v_cos_f32 v26, v24
v_sin_f32 v27, v24
v_cos_f32 v28, v25
v_sin_f32 v29, v25
buffer_load_dwordx4 v43, s[84:87], s51 offen offset:3072 lds
v_cvt_pk_bf16_f32 v24, v26, v27
v_cvt_pk_bf16_f32 v26, -v27, v26
v_accvgpr_write_b32 a36, v24
v_accvgpr_write_b32 a52, v26
v_cvt_pk_bf16_f32 v25, v28, v29
v_cvt_pk_bf16_f32 v28, -v29, v28
v_accvgpr_write_b32 a37, v25
v_accvgpr_write_b32 a53, v28
v_fmamk_f32 v24, v34, 0x41200000, v35
v_fmamk_f32 v25, v34, 0x41300000, v35
v_cos_f32 v26, v24
v_sin_f32 v27, v24
v_cos_f32 v28, v25
v_sin_f32 v29, v25
v_cvt_pk_bf16_f32 v24, v26, v27
v_cvt_pk_bf16_f32 v26, -v27, v26
v_accvgpr_write_b32 a38, v24
v_accvgpr_write_b32 a54, v26
v_cvt_pk_bf16_f32 v25, v28, v29
v_cvt_pk_bf16_f32 v28, -v29, v28
v_accvgpr_write_b32 a39, v25
v_accvgpr_write_b32 a55, v28
v_fmamk_f32 v24, v34, 0x41800000, v35
v_fmamk_f32 v25, v34, 0x41880000, v35
v_cos_f32 v26, v24
v_sin_f32 v27, v24
v_cos_f32 v28, v25
v_sin_f32 v29, v25
v_cvt_pk_bf16_f32 v24, v26, v27
v_cvt_pk_bf16_f32 v26, -v27, v26
v_accvgpr_write_b32 a40, v24
v_accvgpr_write_b32 a56, v26
v_cvt_pk_bf16_f32 v25, v28, v29
v_cvt_pk_bf16_f32 v28, -v29, v28
v_accvgpr_write_b32 a41, v25
v_accvgpr_write_b32 a57, v28
v_fmamk_f32 v24, v34, 0x41900000, v35
v_fmamk_f32 v25, v34, 0x41980000, v35
v_cos_f32 v26, v24
v_sin_f32 v27, v24
v_cos_f32 v28, v25
v_sin_f32 v29, v25
v_cvt_pk_bf16_f32 v24, v26, v27
v_cvt_pk_bf16_f32 v26, -v27, v26
v_accvgpr_write_b32 a42, v24
v_accvgpr_write_b32 a58, v26
v_cvt_pk_bf16_f32 v25, v28, v29
v_cvt_pk_bf16_f32 v28, -v29, v28
s_xor_b32 m0, s42, 36864
s_add_u32 s51, s52, 1181952
buffer_load_dwordx4 v40, s[84:87], s51 offen offset:0 lds
v_accvgpr_write_b32 a43, v25
v_accvgpr_write_b32 a59, v28
v_fmamk_f32 v24, v34, 0x41c00000, v35
v_fmamk_f32 v25, v34, 0x41c80000, v35
v_cos_f32 v26, v24
v_sin_f32 v27, v24
v_cos_f32 v28, v25
v_sin_f32 v29, v25
v_cvt_pk_bf16_f32 v24, v26, v27
v_cvt_pk_bf16_f32 v26, -v27, v26
v_accvgpr_write_b32 a44, v24
v_accvgpr_write_b32 a60, v26
v_cvt_pk_bf16_f32 v25, v28, v29
v_cvt_pk_bf16_f32 v28, -v29, v28
v_accvgpr_write_b32 a45, v25
v_accvgpr_write_b32 a61, v28
v_fmamk_f32 v24, v34, 0x41d00000, v35
v_fmamk_f32 v25, v34, 0x41d80000, v35
v_cos_f32 v26, v24
v_sin_f32 v27, v24
v_cos_f32 v28, v25
v_sin_f32 v29, v25
v_cvt_pk_bf16_f32 v24, v26, v27
v_cvt_pk_bf16_f32 v26, -v27, v26
v_accvgpr_write_b32 a46, v24
v_accvgpr_write_b32 a62, v26
v_cvt_pk_bf16_f32 v25, v28, v29
v_cvt_pk_bf16_f32 v28, -v29, v28
v_accvgpr_write_b32 a47, v25
v_accvgpr_write_b32 a63, v28
v_mul_f32 v34, 0x3d000000, v32
v_mul_f32 v36, v34, v37
v_mul_f32 v35, v34, v33
v_fmac_f32 v35, 0x3c800000, v36
v_mov_b32_e64 v24, v35
v_fmamk_f32 v25, v34, 0x3f800000, v35
v_cos_f32 v26, v24
v_sin_f32 v27, v24
v_cos_f32 v28, v25
v_sin_f32 v29, v25
v_cvt_pk_bf16_f32 v24, v26, -v27
v_cvt_pk_bf16_f32 v26, v27, v26
v_accvgpr_write_b32 a64, v24
v_accvgpr_write_b32 a80, v26
s_mov_b64 exec, 0x77777777
global_load_dword v54, v54, s[6:7]
s_mov_b64 exec, 0x7777
buffer_load_dword v52, v52, s[84:87], 0 offen
s_mov_b64 exec, -1
v_cvt_pk_bf16_f32 v25, v28, -v29
v_cvt_pk_bf16_f32 v28, v29, v28
v_accvgpr_write_b32 a65, v25
v_accvgpr_write_b32 a81, v28
buffer_load_dwordx4 v41, s[84:87], s51 offen offset:1024 lds
v_fmamk_f32 v24, v34, 0x40000000, v35
v_fmamk_f32 v25, v34, 0x40400000, v35
v_cos_f32 v26, v24
v_sin_f32 v27, v24
v_cos_f32 v28, v25
v_sin_f32_e64 v29, v25
v_cvt_pk_bf16_f32 v24, v26, -v27
v_cvt_pk_bf16_f32 v26, v27, v26
v_accvgpr_write_b32 a66, v24
v_accvgpr_write_b32 a82, v26
v_cvt_pk_bf16_f32 v25, v28, -v29
v_cvt_pk_bf16_f32 v28, v29, v28
v_accvgpr_write_b32 a67, v25
v_accvgpr_write_b32 a83, v28
v_fmamk_f32 v24, v34, 0x41000000, v35
v_fmamk_f32 v25, v34, 0x41100000, v35
v_cos_f32 v26, v24
v_sin_f32 v27, v24
v_cos_f32 v28, v25
v_sin_f32 v29, v25
v_cvt_pk_bf16_f32 v24, v26, -v27
v_cvt_pk_bf16_f32 v26, v27, v26
v_accvgpr_write_b32 a68, v24
v_accvgpr_write_b32 a84, v26
v_cvt_pk_bf16_f32 v25, v28, -v29
v_cvt_pk_bf16_f32 v28, v29, v28
v_accvgpr_write_b32 a69, v25
v_accvgpr_write_b32 a85, v28
v_fmamk_f32 v24, v34, 0x41200000, v35
v_fmamk_f32 v25, v34, 0x41300000, v35
v_cos_f32 v26, v24
v_sin_f32 v27, v24
v_cos_f32 v28, v25
v_sin_f32 v29, v25
v_cvt_pk_bf16_f32 v24, v26, -v27
v_cvt_pk_bf16_f32 v26, v27, v26
v_accvgpr_write_b32 a70, v24
v_accvgpr_write_b32 a86, v26
v_cvt_pk_bf16_f32 v25, v28, -v29
v_cvt_pk_bf16_f32 v28, v29, v28
v_accvgpr_write_b32 a71, v25
v_accvgpr_write_b32 a87, v28
v_fmamk_f32 v24, v34, 0x41800000, v35
v_fmamk_f32 v25, v34, 0x41880000, v35
v_cos_f32 v26, v24
v_sin_f32 v27, v24
buffer_load_dwordx4 v42, s[84:87], s51 offen offset:2048 lds
v_cos_f32 v28, v25
v_sin_f32 v29, v25
v_cvt_pk_bf16_f32 v24, v26, -v27
v_cvt_pk_bf16_f32 v26, v27, v26
v_accvgpr_write_b32 a72, v24
v_accvgpr_write_b32 a88, v26
v_cvt_pk_bf16_f32 v25, v28, -v29
v_cvt_pk_bf16_f32 v28, v29, v28
v_accvgpr_write_b32 a73, v25
v_accvgpr_write_b32 a89, v28
v_fmamk_f32 v24, v34, 0x41900000, v35
v_fmamk_f32 v25, v34, 0x41980000, v35
v_cos_f32 v26, v24
v_sin_f32 v27, v24
v_cos_f32 v28, v25
v_sin_f32 v29, v25
v_cvt_pk_bf16_f32 v24, v26, -v27
v_cvt_pk_bf16_f32 v26, v27, v26
v_accvgpr_write_b32 a74, v24
v_accvgpr_write_b32 a90, v26
v_cvt_pk_bf16_f32 v25, v28, -v29
v_cvt_pk_bf16_f32 v28, v29, v28
v_accvgpr_write_b32 a75, v25
v_accvgpr_write_b32 a91, v28
v_fmamk_f32 v24, v34, 0x41c00000, v35
v_fmamk_f32 v25, v34, 0x41c80000, v35
v_cos_f32 v26, v24
v_sin_f32 v27, v24
v_cos_f32 v28, v25
v_sin_f32 v29, v25
v_cvt_pk_bf16_f32 v24, v26, -v27
v_cvt_pk_bf16_f32 v26, v27, v26
v_accvgpr_write_b32 a76, v24
v_accvgpr_write_b32 a92, v26
v_cvt_pk_bf16_f32 v25, v28, -v29
v_cvt_pk_bf16_f32 v28, v29, v28
v_accvgpr_write_b32 a77, v25
v_accvgpr_write_b32 a93, v28
v_fmamk_f32 v24, v34, 0x41d00000, v35
v_fmamk_f32 v25, v34, 0x41d80000, v35
s_waitcnt vmcnt(9)
buffer_store_dword v56, v57, s[24:27], s64 offen offset:0 sc1
v_cos_f32 v26, v24
v_sin_f32 v27, v24
v_cos_f32 v28, v25
v_sin_f32_e64 v29, v25
v_cvt_pk_bf16_f32 v24, v26, -v27
v_cvt_pk_bf16_f32 v26, v27, v26
buffer_load_dwordx4 v43, s[84:87], s51 offen offset:3072 lds
v_accvgpr_write_b32 a78, v24
v_accvgpr_write_b32 a94, v26
v_cvt_pk_bf16_f32 v25, v28, -v29
v_cvt_pk_bf16_f32 v28, v29, v28
v_accvgpr_write_b32 a79, v25
v_accvgpr_write_b32 a95, v28
v_mul_f32 v35, v34, v33
v_fmac_f32 v35, 0.5, v36
v_mov_b32_e64 v24, v35
v_fmamk_f32 v25, v34, 0x3f800000, v35
v_cos_f32 v26, v24
v_sin_f32 v27, v24
v_cos_f32_e64 v28, v25
v_sin_f32 v29, v25
v_cvt_pk_bf16_f32 v24, v26, -v27
v_cvt_pk_bf16_f32 v26, v27, v26
s_add_u32 m0, s48, 65536
s_add_u32 s51, s40, 0
buffer_load_dwordx4 v40, s[88:91], s51 offen offset:0 lds
v_accvgpr_write_b32 a96, v24
v_accvgpr_write_b32 a112, v26
v_cvt_pk_bf16_f32 v25, v28, -v29
v_cvt_pk_bf16_f32 v28, v29, v28
v_accvgpr_write_b32 a97, v25
v_accvgpr_write_b32 a113, v28
v_fmamk_f32 v24, v34, 0x40000000, v35
v_fmamk_f32 v25, v34, 0x40400000, v35
v_cos_f32 v26, v24
v_sin_f32 v27, v24
v_cos_f32 v28, v25
v_sin_f32 v29, v25
v_cvt_pk_bf16_f32 v24, v26, -v27
v_cvt_pk_bf16_f32 v26, v27, v26
v_accvgpr_write_b32 a98, v24
v_accvgpr_write_b32 a114, v26
buffer_load_dwordx4 v41, s[88:91], s51 offen offset:1024 lds
v_cvt_pk_bf16_f32 v25, v28, -v29
v_cvt_pk_bf16_f32 v28, v29, v28
v_accvgpr_write_b32 a99, v25
v_accvgpr_write_b32 a115, v28
v_fmamk_f32 v24, v34, 0x41000000, v35
v_fmamk_f32 v25, v34, 0x41100000, v35
v_cos_f32 v26, v24
v_sin_f32 v27, v24
v_cos_f32 v28, v25
v_sin_f32 v29, v25
v_cvt_pk_bf16_f32 v24, v26, -v27
v_cvt_pk_bf16_f32 v26, v27, v26
v_accvgpr_write_b32 a100, v24
v_accvgpr_write_b32 a116, v26
v_cvt_pk_bf16_f32 v25, v28, -v29
v_cvt_pk_bf16_f32 v28, v29, v28
buffer_load_dwordx4 v42, s[88:91], s51 offen offset:2048 lds
s_waitcnt vmcnt(3)
s_barrier
v_accvgpr_write_b32 a101, v25
ds_read_b128 a[128:131], v10 offset:0
v_accvgpr_write_b32 a117, v28
v_fmamk_f32 v24, v34, 0x41200000, v35
v_fmamk_f32 v25, v34, 0x41300000, v35
v_cos_f32_e64 v26, v24
ds_read_b128 a[132:135], v10 offset:2048
v_sin_f32 v27, v24
v_cos_f32 v28, v25
v_sin_f32_e64 v29, v25
v_cvt_pk_bf16_f32 v24, v26, -v27
ds_read_b128 a[136:139], v10 offset:4096
v_cvt_pk_bf16_f32 v26, v27, v26
v_accvgpr_write_b32 a102, v24
v_accvgpr_write_b32 a118, v26
v_cvt_pk_bf16_f32 v25, v28, -v29
buffer_load_dwordx4 v43, s[88:91], s51 offen offset:3072 lds
ds_read_b128 a[140:143], v10 offset:6144
v_cvt_pk_bf16_f32 v28, v29, v28
v_accvgpr_write_b32 a103, v25
v_accvgpr_write_b32 a119, v28
v_fmamk_f32 v24, v34, 0x41800000, v35
ds_read_b128 a[144:147], v10 offset:16384
v_fmamk_f32 v25, v34, 0x41880000, v35
v_cos_f32 v26, v24
v_sin_f32 v27, v24
v_cos_f32_e64 v28, v25
ds_read_b128 a[148:151], v10 offset:18432
v_sin_f32_e64 v29, v25
v_cvt_pk_bf16_f32 v24, v26, -v27
v_cvt_pk_bf16_f32 v26, v27, v26
v_accvgpr_write_b32 a104, v24
ds_read_b128 a[152:155], v10 offset:20480
s_add_u32 m0, s48, 69632
s_add_u32 s51, s40, 131328
buffer_load_dwordx4 v40, s[88:91], s51 offen offset:0 lds
v_accvgpr_write_b32 a120, v26
v_cvt_pk_bf16_f32 v25, v28, -v29
v_cvt_pk_bf16_f32 v28, v29, v28
v_accvgpr_write_b32 a105, v25
ds_read_b128 a[156:159], v10 offset:22528
v_accvgpr_write_b32 a121, v28
v_fmamk_f32 v24, v34, 0x41900000, v35
v_fmamk_f32 v25, v34, 0x41980000, v35
v_cos_f32_e64 v26, v24
ds_read_b128 a[160:163], v10 offset:32768
v_sin_f32 v27, v24
v_cos_f32 v28, v25
v_sin_f32_e64 v29, v25
v_cvt_pk_bf16_f32 v24, v26, -v27
ds_read_b128 a[164:167], v10 offset:34816
v_cvt_pk_bf16_f32 v26, v27, v26
buffer_load_dwordx4 v41, s[88:91], s51 offen offset:1024 lds
v_accvgpr_write_b32 a106, v24
v_accvgpr_write_b32 a122, v26
v_cvt_pk_bf16_f32 v25, v28, -v29
ds_read_b128 a[168:171], v10 offset:36864
v_cvt_pk_bf16_f32 v28, v29, v28
v_accvgpr_write_b32 a107, v25
v_accvgpr_write_b32 a123, v28
v_fmamk_f32 v24, v34, 0x41c00000, v35
ds_read_b128 a[172:175], v10 offset:38912
v_fmamk_f32 v25, v34, 0x41c80000, v35
v_cos_f32 v26, v24
v_sin_f32 v27, v24
v_cos_f32_e64 v28, v25
ds_read_b128 a[176:179], v10 offset:49152
v_sin_f32_e64 v29, v25
v_cvt_pk_bf16_f32 v24, v26, -v27
buffer_load_dwordx4 v42, s[88:91], s51 offen offset:2048 lds
v_cvt_pk_bf16_f32 v26, v27, v26
v_accvgpr_write_b32 a108, v24
ds_read_b128 a[180:183], v10 offset:51200
v_accvgpr_write_b32 a124, v26
v_cvt_pk_bf16_f32 v25, v28, -v29
v_cvt_pk_bf16_f32 v28, v29, v28
v_accvgpr_write_b32 a109, v25
ds_read_b128 a[184:187], v10 offset:53248
v_accvgpr_write_b32 a125, v28
v_fmamk_f32 v24, v34, 0x41d00000, v35
v_fmamk_f32 v25, v34, 0x41d80000, v35
v_cos_f32_e64 v26, v24
ds_read_b128 a[188:191], v10 offset:55296
v_sin_f32 v27, v24
v_cos_f32 v28, v25
v_sin_f32 v29, v25
buffer_load_dwordx4 v43, s[88:91], s51 offen offset:3072 lds
v_cvt_pk_bf16_f32 v24, v26, -v27
v_cvt_pk_bf16_f32 v26, v27, v26
v_accvgpr_write_b32 a110, v24
v_accvgpr_write_b32 a126, v26
v_cvt_pk_bf16_f32 v25, v28, -v29
v_cvt_pk_bf16_f32 v28, v29, v28
v_accvgpr_write_b32 a111, v25
v_accvgpr_write_b32 a127, v28
s_lshl_b32 s45, s37, 2
s_add_u32 s45, s45, s38
s_lshl_b32 s59, s45, 15
s_add_u32 s59, s59, 524288
s_mul_i32 s55, s45, 458752
s_add_u32 s55, s55, 31457280
s_mov_b32 s20, s12
s_mov_b32 s21, s13
s_mov_b32 s22, 0x700000
s_mov_b32 s23, 0x20000
s_mov_b32 s28, s14
s_mov_b32 s29, s15
s_add_u32 m0, s48, 98304
s_add_u32 s51, s40, 1050624
buffer_load_dwordx4 v40, s[88:91], s51 offen offset:0 lds
s_mov_b32 s30, 0x800
s_mov_b32 s31, 0x20000
s_mul_i32 s46, s38, 1835008
s_lshl_b32 s45, s36, 15
s_add_u32 s46, s46, s45
s_lshl_b32 s45, s39, 8
s_add_u32 s46, s46, s45
v_lshrrev_b32 v44, 4, v0
v_lshlrev_b32 v45, 1, v44
v_and_b32 v46, 15, v0
v_xor_b32 v45, v45, v46
v_mul_u32_u24 v44, 2048, v44
v_lshl_add_u32 v6, v45, 4, v44
v_add_u32_e64 v6, s46, v6
v_xor_b32 v9, 128, v6
v_add_u32 v7, 7168, v9
v_add_u32 v8, 14336, v6
v_add_u32 v9, 21504, v9
v_bfe_u32 v44, v0, 2, 3
s_lshl_b32 s45, s36, 1
buffer_load_dwordx4 v41, s[88:91], s51 offen offset:1024 lds
v_xor_b32 v44, s45, v44
v_and_b32_e64 v46, 1, v0
v_lshl_add_u32 v44, v44, 1, v46
v_bfe_u32 v46, v0, 1, 1
v_lshl_add_u32 v44, v44, 1, v46
v_lshrrev_b32 v45, 2, v0
v_lshlrev_b32 v44, 3, v44
v_lshl_add_u32 v120, v45, 8, v44
v_add_u32 v21, 0x10000, v20
s_mul_i32 s54, s36, 57344
s_add_u32 s54, s54, s55
v_add_u32_e64 v63, s54, v20
s_lshl_b32 s45, s39, 3
s_mul_i32 s46, s36, 6
s_add_u32 s46, s46, s45
s_add_u32 s56, s46, 32
s_sub_u32 s60, s56, 56
s_min_u32 s56, s56, s60
s_lshl_b32 s56, s56, 10
s_add_u32 s56, s56, s55
buffer_load_dwordx4 v42, s[88:91], s51 offen offset:2048 lds
s_waitcnt vmcnt(3)
s_barrier
s_add_u32 s57, s46, 34
ds_read_b128 a[192:195], v11 offset:0
s_sub_u32 s60, s57, 56
s_min_u32 s57, s57, s60
s_lshl_b32 s57, s57, 10
s_add_u32 s57, s57, s55
ds_read_b128 a[196:199], v11 offset:2048
s_sub_u32 s57, s57, 2048
s_add_u32 s58, s46, 36
s_sub_u32 s60, s58, 56
s_min_u32 s58, s58, s60
ds_read_b128 a[200:203], v11 offset:4096
s_lshl_b32 s58, s58, 10
s_add_u32 s58, s58, s55
s_add_u32 s46, s39, s36
s_sub_u32 s60, s46, 7
ds_read_b128 a[204:207], v11 offset:6144
s_min_u32 s46, s46, s60
s_lshl_b32 s46, s46, 13
s_add_u32 s55, s55, s46
buffer_load_dwordx4 v43, s[88:91], s51 offen offset:3072 lds
s_mul_i32 s5, s36, 6144
ds_read_b128 a[208:211], v11 offset:16384
v_add_u32 v16, 0x4000, v120
v_add_u32 v18, 0x14000, v120
v_xor_b32 v17, 32, v16
v_xor_b32 v19, 32, v18
ds_read_b128 a[212:215], v11 offset:18432
s_add_u32 s45, s38, 1
s_and_b32 s45, s45, 3
s_lshl_b32 s45, s45, 1
s_and_b32 s46, s37, 1
ds_read_b128 a[216:219], v11 offset:20480
s_or_b32 s45, s45, s46
s_andn2_b32 s46, s2, 7
s_or_b32 s45, s45, s46
s_lshl2_add_u32 s45, s45, s36
ds_read_b128 a[220:223], v11 offset:22528
s_mul_i32 s46, s45, 15360
s_add_u32 s68, s46, 14680064
s_add_u32 s45, s38, 2
s_add_u32 m0, s48, 102400
s_add_u32 s51, s40, 1181952
buffer_load_dwordx4 v40, s[88:91], s51 offen offset:0 lds
s_and_b32 s45, s45, 3
s_lshl_b32 s45, s45, 1
s_and_b32 s46, s37, 1
s_or_b32 s45, s45, s46
s_andn2_b32 s46, s2, 7
s_or_b32 s45, s45, s46
s_lshl2_add_u32 s45, s45, s36
s_mul_i32 s46, s45, 15360
s_add_u32 s69, s46, 14685184
s_add_u32 s45, s38, 3
s_and_b32 s45, s45, 3
s_lshl_b32 s45, s45, 1
s_and_b32 s46, s37, 1
s_or_b32 s45, s45, s46
s_andn2_b32 s46, s2, 7
s_or_b32 s45, s45, s46
s_lshl2_add_u32 s45, s45, s36
s_mul_i32 s46, s45, 15360
s_add_u32 s70, s46, 14690304
s_add_u32 s45, s38, 4
buffer_load_dwordx4 v41, s[88:91], s51 offen offset:1024 lds
buffer_load_dword v23, v1, s[24:27], s62 offen sc1
s_and_b32 s45, s45, 3
s_lshl_b32 s45, s45, 1
s_and_b32 s46, s37, 1
s_or_b32 s45, s45, s46
s_andn2_b32 s46, s2, 7
s_or_b32 s45, s45, s46
s_lshl2_add_u32 s45, s45, s36
s_mul_i32 s46, s45, 15360
s_add_u32 s71, s46, 14680064
s_lshl2_add_u32 s45, s37, s38
s_lshl_b32 s45, s45, 17
s_lshl2_add_u32 s46, s39, s36
s_lshl_b32 s78, s46, 6
s_lshl_b32 s46, s39, 6
s_add_u32 s76, s45, s78
s_andn2_b32 s74, s76, 0xc0
s_bfe_u32 s77, s45, 0x30012
s_lshl3_add_u32 s46, s77, s39
s_lshl_b32 s46, s46, 6
s_lshr_b32 s77, s37, 2
buffer_load_dwordx4 v42, s[88:91], s51 offen offset:2048 lds
s_lshl_b32 s77, s77, 19
s_add_u32 s46, s46, s77
s_and_b32 s77, s38, 1
s_lshl_b32 s77, s77, 21
s_add_u32 s46, s46, s77
s_add_u32 s77, s46, 2097152
s_lshr_b32 s45, s45, 4
s_and_b32 s45, s45, 0x1e000
s_add_u32 s79, s45, 262144
s_lshr_b32 s45, s2, 6
s_lshl2_add_u32 s45, s45, s36
s_lshl_b32 s45, s45, 12
s_add_u32 s80, s45, 393600
s_lshl_b32 s45, s36, 20
s_lshl_b32 s46, s2, 9
s_add_u32 s45, s45, s46
s_add_u32 s81, s45, 2097152
s_and_b32 s45, s2, 7
s_lshl2_add_u32 s45, s45, s36
s_lshl_b32 s45, s45, 5
buffer_load_dwordx4 v43, s[88:91], s51 offen offset:3072 lds
s_waitcnt vmcnt(2)
v_cmp_ne_u32 vcc, s53, v23
s_cbranch_vccnz L_spin12
L_back12:
s_waitcnt lgkmcnt(0)
s_barrier
s_or_b32 s51, s41, s36
s_cmp_lg_u32 s51, 0
s_cbranch_scc1 L_nonyq
v_and_b32 v240, 31, v0
v_lshrrev_b32 v241, 5, v0
v_lshl_add_u32 v240, v241, 7, v240
v_lshlrev_b32_e64 v240, 2, v240
s_mov_b32 s51, 4096
buffer_load_dword v224, v240, s[24:27], s51 offen offset:0 sc1
buffer_load_dword v225, v240, s[24:27], s51 offen offset:128 sc1
buffer_load_dword v226, v240, s[24:27], s51 offen offset:256 sc1
buffer_load_dword v227, v240, s[24:27], s51 offen offset:384 sc1
buffer_load_dword v228, v240, s[24:27], s51 offen offset:1024 sc1
buffer_load_dword v229, v240, s[24:27], s51 offen offset:1152 sc1
buffer_load_dword v230, v240, s[24:27], s51 offen offset:1280 sc1
buffer_load_dword v231, v240, s[24:27], s51 offen offset:1408 sc1
buffer_load_dword v232, v240, s[24:27], s51 offen offset:2048 sc1
buffer_load_dword v233, v240, s[24:27], s51 offen offset:2176 sc1
buffer_load_dword v234, v240, s[24:27], s51 offen offset:2304 sc1
buffer_load_dword v235, v240, s[24:27], s51 offen offset:2432 sc1
buffer_load_dword v236, v240, s[24:27], s51 offen offset:3072 sc1
buffer_load_dword v237, v240, s[24:27], s51 offen offset:3200 sc1
buffer_load_dword v238, v240, s[24:27], s51 offen offset:3328 sc1
buffer_load_dword v239, v240, s[24:27], s51 offen offset:3456 sc1
L_nonyq:
s_add_u32 m0, s48, 0
s_add_u32 s51, s44, 2097152
buffer_load_dwordx4 v12, s[24:27], s51 offen offset:0 sc1 lds
buffer_load_dwordx4 v13, s[24:27], s51 offen offset:1024 sc1 lds
buffer_load_dwordx4 v14, s[24:27], s51 offen offset:2048 sc1 lds
buffer_load_dwordx4 v15, s[24:27], s51 offen offset:3072 sc1 lds
s_add_u32 m0, s48, 4096
s_add_u32 s51, s44, 2113536
buffer_load_dwordx4 v12, s[24:27], s51 offen offset:0 sc1 lds
buffer_load_dwordx4 v13, s[24:27], s51 offen offset:1024 sc1 lds
buffer_load_dwordx4 v14, s[24:27], s51 offen offset:2048 sc1 lds
buffer_load_dwordx4 v15, s[24:27], s51 offen offset:3072 sc1 lds
s_lshr_b32 s46, s2, 3
s_add_u32 s45, s45, s46
s_mov_b32 s82, s81
s_lshl_b32 s46, s45, 7
s_add_u32 s83, s46, 262144
v_and_b32 v112, 0x13, v0
v_bfe_u32 v113, v0, 2, 1
v_lshl_add_u32 v112, v113, 3, v112
v_bfe_u32 v113, v0, 3, 1
v_lshl_add_u32 v112, v113, 2, v112
v_cvt_f32_u32 v112, v112
v_lshrrev_b32 v113, 5, v0
v_lshl_add_u32 v113, s36, 1, v113
v_cvt_f32_u32 v113, v113
s_lshl_b32 s45, s36, 10
s_add_u32 s45, s45, 147456
v_add_u32_e64 v119, s45, v20
v_mul_f32 v114, 0x3a800000, v112
v_mul_f32 v115, v114, v113
v_mul_f32 v115, 4.0, v115
v_cos_f32 v120, v115
v_sin_f32 v124, v115
v_add_f32 v115, v115, v114
v_cos_f32 v121, v115
v_sin_f32 v125, v115
v_add_f32 v115, v115, v114
v_cos_f32 v122, v115
v_sin_f32 v126, v115
v_add_f32 v115, v115, v114
v_cos_f32 v123, v115
v_sin_f32 v127, v115
v_and_b32 v114, 31, v0
ds_write_b128 v119, v[120:123]
v_cvt_f32_u32_e64 v114, v114
v_mul_f32 v114, 0x3d000000, v114
ds_write_b128 v119, v[124:127] offset:4096
v_mul_f32 v115, v114, v113
v_mul_f32 v115, 4.0, v115
v_cos_f32_e64 v116, v115
v_sin_f32 v117, v115
s_nop 0
v_cvt_pk_bf16_f32 v128, v116, -v117
v_add_f32 v115, v115, v114
v_cos_f32 v116, v115
v_sin_f32 v117, v115
s_nop 0
v_cvt_pk_bf16_f32 v129, v116, -v117
v_add_f32 v115, v115, v114
v_cos_f32 v116, v115
v_sin_f32 v117, v115
s_nop 0
v_cvt_pk_bf16_f32 v130, v116, -v117
v_add_f32 v115, v115, v114
v_cos_f32 v116, v115
v_sin_f32_e64 v117, v115
v_mul_f32 v114, 0x3d000000, v112
v_cvt_pk_bf16_f32 v131, v116, -v117
v_mul_f32_e64 v115, v114, v113
ds_write_b128 v119, v[128:131] offset:8192
v_add_f32_e64 v115, v115, v115
s_lshr_b32 s45, s36, 1
s_lshl_b32 s45, s45, 10
s_and_b32 s46, s36, 1
s_lshl3_add_u32 s45, s46, s45
s_add_u32 s45, s45, 147456
v_cos_f32 v116, v115
v_sin_f32 v117, v115
v_add_u32_e64 v118, s45, v20
v_cvt_pk_bf16_f32 v132, v116, -v117
v_cvt_pk_bf16_f32 v134, v117, v116
v_add_f32 v115, v115, v114
v_cos_f32 v116, v115
v_sin_f32 v117, v115
v_add_u32 v118, s45, v20
v_cvt_pk_bf16_f32 v133, v116, -v117
v_cvt_pk_bf16_f32 v135, v117, v116
ds_write_b64 v118, v[132:133] offset:12288
ds_write_b64 v118, v[134:135] offset:14336
v_min_u32_e64 v1, 6, v0
v_lshl_add_u32 v1, v1, 2, s36
v_lshlrev_b32_e64 v1, 10, v1
v_accvgpr_read_b32 v192, a128
v_accvgpr_read_b32 v193, a132
v_accvgpr_read_b32 v194, a136
v_accvgpr_read_b32 v195, a140
v_accvgpr_read_b32 v196, a144
v_accvgpr_read_b32 v197, a148
v_accvgpr_read_b32 v198, a152
v_accvgpr_read_b32 v199, a156
v_accvgpr_read_b32 v200, a160
v_accvgpr_read_b32 v201, a164
v_accvgpr_read_b32 v202, a168
v_accvgpr_read_b32 v203, a172
v_accvgpr_read_b32 v204, a176
v_accvgpr_read_b32 v205, a180
v_accvgpr_read_b32 v206, a184
v_accvgpr_read_b32 v207, a188
v_accvgpr_read_b32 v208, a192
v_accvgpr_read_b32 v209, a196
v_accvgpr_read_b32 v210, a200
v_accvgpr_read_b32 v211, a204
v_accvgpr_read_b32 v212, a208
v_accvgpr_read_b32 v213, a212
v_accvgpr_read_b32 v214, a216
v_accvgpr_read_b32 v215, a220
s_waitcnt vmcnt(8)
s_barrier
ds_read_b128 a[224:227], v11 offset:32768
ds_read_b128 a[228:231], v11 offset:34816
ds_read_b128 a[232:235], v11 offset:36864
ds_read_b128 a[236:239], v11 offset:38912
ds_read_b128 a[240:243], v11 offset:49152
ds_read_b128 a[244:247], v11 offset:51200
ds_read_b128 a[248:251], v11 offset:53248
ds_read_b128 a[252:255], v11 offset:55296
v_add_u32_e64 v10, s48, v20
v_add_u32 v11, 0x10000, v10
s_waitcnt lgkmcnt(7)
v_accvgpr_read_b32 v216, a224
s_waitcnt lgkmcnt(6)
v_accvgpr_read_b32 v217, a228
s_waitcnt lgkmcnt(5)
v_accvgpr_read_b32 v218, a232
s_waitcnt lgkmcnt(4)
v_accvgpr_read_b32 v219, a236
s_waitcnt lgkmcnt(3)
v_accvgpr_read_b32 v220, a240
s_waitcnt lgkmcnt(2)
v_accvgpr_read_b32 v221, a244
s_waitcnt lgkmcnt(1)
v_accvgpr_read_b32 v222, a248
s_waitcnt lgkmcnt(0)
v_accvgpr_read_b32 v223, a252
s_or_b32 s45, s41, s36
s_cmp_lg_u32 s45, 0
s_cbranch_scc1 L_nopatch
s_mov_b32 s45, 0xffff
s_mov_b32 s46, 0x07060302
s_waitcnt vmcnt(8)
v_bfi_b32 v192, s45, v224, v192
v_perm_b32 v208, v208, v224, s46
v_bfi_b32 v193, s45, v225, v193
v_perm_b32 v209, v209, v225, s46
v_bfi_b32 v194, s45, v226, v194
v_perm_b32 v210, v210, v226, s46
v_bfi_b32 v195, s45, v227, v195
v_perm_b32 v211, v211, v227, s46
v_bfi_b32 v196, s45, v228, v196
v_perm_b32 v212, v212, v228, s46
v_bfi_b32 v197, s45, v229, v197
v_perm_b32 v213, v213, v229, s46
v_bfi_b32 v198, s45, v230, v198
v_perm_b32 v214, v214, v230, s46
v_bfi_b32 v199, s45, v231, v199
v_perm_b32 v215, v215, v231, s46
v_bfi_b32 v200, s45, v232, v200
v_perm_b32 v216, v216, v232, s46
v_bfi_b32 v201, s45, v233, v201
v_perm_b32 v217, v217, v233, s46
v_bfi_b32 v202, s45, v234, v202
v_perm_b32 v218, v218, v234, s46
v_bfi_b32 v203, s45, v235, v203
v_perm_b32 v219, v219, v235, s46
v_bfi_b32 v204, s45, v236, v204
v_perm_b32 v220, v220, v236, s46
v_bfi_b32 v205, s45, v237, v205
v_perm_b32 v221, v221, v237, s46
v_bfi_b32 v206, s45, v238, v206
v_perm_b32 v222, v222, v238, s46
v_bfi_b32 v207, s45, v239, v207
v_perm_b32 v223, v223, v239, s46
L_nopatch:
v_lshlrev_b32 v224, 16, v192
v_lshlrev_b32 v225, 16, v193
v_lshlrev_b32 v226, 16, v194
v_lshlrev_b32 v227, 16, v195
v_lshlrev_b32 v228, 16, v196
v_lshlrev_b32 v229, 16, v197
v_lshlrev_b32 v230, 16, v198
v_lshlrev_b32 v231, 16, v199
v_lshlrev_b32 v232, 16, v200
v_lshlrev_b32 v233, 16, v201
v_lshlrev_b32 v234, 16, v202
v_lshlrev_b32 v235, 16, v203
v_lshlrev_b32 v236, 16, v204
v_lshlrev_b32 v237, 16, v205
v_lshlrev_b32 v238, 16, v206
v_lshlrev_b32 v239, 16, v207
v_lshlrev_b32 v240, 16, v208
v_lshlrev_b32 v241, 16, v209
v_lshlrev_b32 v242, 16, v210
v_lshlrev_b32 v243, 16, v211
v_lshlrev_b32 v244, 16, v212
v_lshlrev_b32 v245, 16, v213
v_lshlrev_b32 v246, 16, v214
v_lshlrev_b32 v247, 16, v215
v_lshlrev_b32 v248, 16, v216
v_lshlrev_b32 v249, 16, v217
v_lshlrev_b32 v250, 16, v218
v_lshlrev_b32 v251, 16, v219
v_lshlrev_b32 v252, 16, v220
v_lshlrev_b32 v253, 16, v221
v_lshlrev_b32_e64 v254, 16, v222
v_lshlrev_b32 v255, 16, v223
s_waitcnt vmcnt(0)
s_barrier
ds_read_b128 v[128:131], v2 offset:0
ds_read_b128 v[132:135], v2 offset:256
ds_read_b128 v[136:139], v2 offset:512
ds_read_b128 v[140:143], v2 offset:768
ds_read_b128 v[176:179], v3 offset:0
ds_read_b128 v[180:183], v3 offset:256
ds_read_b128 v[184:187], v3 offset:512
ds_read_b128 v[188:191], v3 offset:768
s_waitcnt lgkmcnt(7)
v_mfma_f32_32x32x16_bf16 v[64:79], v[128:131], a[0:3], 0
s_add_u32 m0, s48, 32768
s_add_u32 s51, s44, 2097280
buffer_load_dwordx4 v12, s[24:27], s51 offen offset:0 sc1 lds
v_mfma_f32_32x32x16_bf16 v[112:127], v[128:131], a[16:19], 0
buffer_load_dwordx4 v13, s[24:27], s51 offen offset:1024 sc1 lds
buffer_load_dwordx4 v14, s[24:27], s51 offen offset:2048 sc1 lds
s_waitcnt lgkmcnt(6)
v_mfma_f32_32x32x16_bf16 v[64:79], v[132:135], a[4:7], v[64:79]
buffer_load_dwordx4 v15, s[24:27], s51 offen offset:3072 sc1 lds
s_add_u32 m0, s48, 36864
s_add_u32 s51, s44, 2113664
v_mfma_f32_32x32x16_bf16 v[112:127], v[132:135], a[20:23], v[112:127]
buffer_load_dwordx4 v12, s[24:27], s51 offen offset:0 sc1 lds
buffer_load_dwordx4 v13, s[24:27], s51 offen offset:1024 sc1 lds
s_waitcnt lgkmcnt(5)
v_mfma_f32_32x32x16_bf16 v[64:79], v[136:139], a[8:11], v[64:79]
buffer_load_dwordx4 v14, s[24:27], s51 offen offset:2048 sc1 lds
buffer_load_dwordx4 v15, s[24:27], s51 offen offset:3072 sc1 lds
v_mfma_f32_32x32x16_bf16 v[112:127], v[136:139], a[24:27], v[112:127]
s_waitcnt lgkmcnt(4)
v_mfma_f32_32x32x16_bf16 v[64:79], v[140:143], a[12:15], v[64:79]
v_mfma_f32_32x32x16_bf16 v[112:127], v[140:143], a[28:31], v[112:127]
s_nop 10
v_pk_mul_f32 v[24:25], v[64:65], v[96:97]
v_pk_mul_f32 v[26:27], v[66:67], v[98:99]
v_pk_mul_f32 v[64:65], v[64:65], v[80:81]
v_pk_mul_f32 v[66:67], v[66:67], v[82:83]
v_pk_fma_f32 v[64:65], v[112:113], v[96:97], v[64:65]
v_pk_fma_f32 v[66:67], v[114:115], v[98:99], v[66:67]
v_pk_fma_f32 v[112:113], v[112:113], v[80:81], v[24:25] neg_lo:[0,0,1] neg_hi:[0,0,1]
v_pk_fma_f32 v[114:115], v[114:115], v[82:83], v[26:27] neg_lo:[0,0,1] neg_hi:[0,0,1]
v_pk_mul_f32 v[24:25], v[68:69], v[100:101]
v_pk_mul_f32 v[26:27], v[70:71], v[102:103]
v_pk_mul_f32 v[68:69], v[68:69], v[84:85]
v_pk_mul_f32 v[70:71], v[70:71], v[86:87]
v_pk_fma_f32 v[68:69], v[116:117], v[100:101], v[68:69]
v_pk_fma_f32 v[70:71], v[118:119], v[102:103], v[70:71]
v_pk_fma_f32 v[116:117], v[116:117], v[84:85], v[24:25] neg_lo:[0,0,1] neg_hi:[0,0,1]
v_pk_fma_f32 v[118:119], v[118:119], v[86:87], v[26:27] neg_lo:[0,0,1] neg_hi:[0,0,1]
v_pk_mul_f32 v[24:25], v[72:73], v[104:105]
v_pk_mul_f32 v[72:73], v[72:73], v[88:89]
v_pk_fma_f32 v[72:73], v[120:121], v[104:105], v[72:73]
v_pk_fma_f32 v[120:121], v[120:121], v[88:89], v[24:25] neg_lo:[0,0,1] neg_hi:[0,0,1]
s_waitcnt lgkmcnt(3)
v_mfma_f32_32x32x16_bf16 v[144:159], v[176:179], a[0:3], 0
v_mul_f32 v24, v74, v106
v_mul_f32 v25, v75, v107
v_mul_f32 v74, v74, v90
v_mul_f32_e64 v75, v75, v91
v_fma_f32 v74, v122, v106, v74
v_mfma_f32_32x32x16_bf16 v[160:175], v[176:179], a[16:19], 0
v_fma_f32 v75, v123, v107, v75
v_fma_f32 v122, v122, v90, -v24
v_fma_f32 v123, v123, v91, -v25
v_mul_f32_e64 v24, v76, v108
v_mul_f32 v25, v77, v109
s_waitcnt lgkmcnt(2)
v_mfma_f32_32x32x16_bf16 v[144:159], v[180:183], a[4:7], v[144:159]
v_mul_f32 v76, v76, v92
v_mul_f32 v77, v77, v93
v_fma_f32 v76, v124, v108, v76
v_fma_f32 v77, v125, v109, v77
v_fma_f32 v124, v124, v92, -v24
v_mfma_f32_32x32x16_bf16 v[160:175], v[180:183], a[20:23], v[160:175]
v_fma_f32 v125, v125, v93, -v25
v_mul_f32 v24, v78, v110
v_mul_f32 v25, v79, v111
v_mul_f32 v78, v78, v94
v_mul_f32 v79, v79, v95
s_waitcnt lgkmcnt(1)
v_mfma_f32_32x32x16_bf16 v[144:159], v[184:187], a[8:11], v[144:159]
v_fma_f32 v78, v126, v110, v78
v_fma_f32 v79, v127, v111, v79
v_fma_f32 v126, v126, v94, -v24
v_fma_f32 v127, v127, v95, -v25
v_cvt_pk_bf16_f32 v112, v64, v112
v_mfma_f32_32x32x16_bf16 v[160:175], v[184:187], a[24:27], v[160:175]
v_cvt_pk_bf16_f32 v113, v65, v113
v_cvt_pk_bf16_f32 v114, v66, v114
v_cvt_pk_bf16_f32 v115, v67, v115
v_cvt_pk_bf16_f32 v116, v68, v116
v_cvt_pk_bf16_f32 v117, v69, v117
s_waitcnt lgkmcnt(0)
v_mfma_f32_32x32x16_bf16 v[144:159], v[188:191], a[12:15], v[144:159]
v_cvt_pk_bf16_f32 v118, v70, v118
v_cvt_pk_bf16_f32 v119, v71, v119
v_cvt_pk_bf16_f32 v120, v72, v120
v_cvt_pk_bf16_f32 v121, v73, v121
v_cvt_pk_bf16_f32 v122, v74, v122
v_mfma_f32_32x32x16_bf16 v[160:175], v[188:191], a[28:31], v[160:175]
v_cvt_pk_bf16_f32 v123, v75, v123
v_cvt_pk_bf16_f32 v124, v76, v124
v_cvt_pk_bf16_f32 v125, v77, v125
v_cvt_pk_bf16_f32 v126, v78, v126
v_cvt_pk_bf16_f32 v127, v79, v127
s_nop 0
v_pk_mul_f32 v[24:25], v[144:145], v[96:97]
v_pk_mul_f32 v[26:27], v[146:147], v[98:99]
v_pk_mul_f32 v[144:145], v[144:145], v[80:81]
v_pk_mul_f32 v[146:147], v[146:147], v[82:83]
s_nop 1
v_pk_fma_f32 v[144:145], v[160:161], v[96:97], v[144:145]
v_pk_fma_f32 v[146:147], v[162:163], v[98:99], v[146:147]
v_pk_fma_f32 v[160:161], v[160:161], v[80:81], v[24:25] neg_lo:[0,0,1] neg_hi:[0,0,1]
v_pk_fma_f32 v[162:163], v[162:163], v[82:83], v[26:27] neg_lo:[0,0,1] neg_hi:[0,0,1]
v_pk_mul_f32 v[24:25], v[148:149], v[100:101]
v_pk_mul_f32 v[26:27], v[150:151], v[102:103]
v_pk_mul_f32 v[148:149], v[148:149], v[84:85]
v_pk_mul_f32 v[150:151], v[150:151], v[86:87]
v_pk_fma_f32 v[148:149], v[164:165], v[100:101], v[148:149]
v_pk_fma_f32 v[150:151], v[166:167], v[102:103], v[150:151]
v_pk_fma_f32 v[164:165], v[164:165], v[84:85], v[24:25] neg_lo:[0,0,1] neg_hi:[0,0,1]
v_pk_fma_f32 v[166:167], v[166:167], v[86:87], v[26:27] neg_lo:[0,0,1] neg_hi:[0,0,1]
v_pk_mul_f32 v[24:25], v[152:153], v[104:105]
v_pk_mul_f32 v[152:153], v[152:153], v[88:89]
v_pk_fma_f32 v[152:153], v[168:169], v[104:105], v[152:153]
v_pk_fma_f32 v[168:169], v[168:169], v[88:89], v[24:25] neg_lo:[0,0,1] neg_hi:[0,0,1]
v_mfma_f32_32x32x16_bf16 v[64:79], a[32:35], v[112:115], 0
v_mul_f32 v24, v154, v106
v_mul_f32 v25, v155, v107
v_mul_f32 v154, v154, v90
v_mul_f32 v155, v155, v91
v_fma_f32 v154, v170, v106, v154
v_mfma_f32_32x32x16_bf16 v[128:143], a[48:51], v[112:115], 0
v_fma_f32 v155, v171, v107, v155
v_fma_f32 v170, v170, v90, -v24
v_fma_f32 v171, v171, v91, -v25
v_mul_f32 v24, v156, v108
v_mul_f32 v25, v157, v109
v_mfma_f32_32x32x16_bf16 v[64:79], a[36:39], v[116:119], v[64:79]
v_mul_f32 v156, v156, v92
v_mul_f32 v157, v157, v93
v_fma_f32 v156, v172, v108, v156
v_fma_f32 v157, v173, v109, v157
v_fma_f32 v172, v172, v92, -v24
v_mfma_f32_32x32x16_bf16 v[128:143], a[52:55], v[116:119], v[128:143]
v_fma_f32 v173, v173, v93, -v25
v_mul_f32 v24, v158, v110
v_mul_f32 v25, v159, v111
v_mul_f32 v158, v158, v94
v_mul_f32 v159, v159, v95
v_mfma_f32_32x32x16_bf16 v[64:79], a[40:43], v[120:123], v[64:79]
v_fma_f32 v158, v174, v110, v158
v_fma_f32 v159, v175, v111, v159
v_fma_f32 v174, v174, v94, -v24
v_fma_f32 v175, v175, v95, -v25
v_cvt_pk_bf16_f32 v160, v144, v160
v_mfma_f32_32x32x16_bf16 v[128:143], a[56:59], v[120:123], v[128:143]
v_cvt_pk_bf16_f32 v161, v145, v161
v_cvt_pk_bf16_f32 v162, v146, v162
v_cvt_pk_bf16_f32 v163, v147, v163
v_cvt_pk_bf16_f32 v164, v148, v164
v_cvt_pk_bf16_f32 v165, v149, v165
v_mfma_f32_32x32x16_bf16 v[64:79], a[44:47], v[124:127], v[64:79]
v_cvt_pk_bf16_f32 v166, v150, v166
v_cvt_pk_bf16_f32 v167, v151, v167
v_cvt_pk_bf16_f32 v168, v152, v168
v_cvt_pk_bf16_f32 v169, v153, v169
v_cvt_pk_bf16_f32 v170, v154, v170
v_mfma_f32_32x32x16_bf16 v[128:143], a[60:63], v[124:127], v[128:143]
v_cvt_pk_bf16_f32 v171, v155, v171
v_cvt_pk_bf16_f32 v172, v156, v172
v_cvt_pk_bf16_f32 v173, v157, v173
v_cvt_pk_bf16_f32 v174, v158, v174
v_cvt_pk_bf16_f32 v175, v159, v175
s_nop 0
v_pk_mul_f32 v[24:25], v[64:65], v[240:241]
v_pk_mul_f32 v[26:27], v[66:67], v[242:243]
v_pk_mul_f32 v[64:65], v[64:65], v[224:225]
v_pk_mul_f32 v[66:67], v[66:67], v[226:227]
s_nop 1
v_pk_fma_f32 v[64:65], v[128:129], v[240:241], v[64:65] neg_lo:[1,0,0] neg_hi:[1,0,0]
v_pk_fma_f32 v[66:67], v[130:131], v[242:243], v[66:67] neg_lo:[1,0,0] neg_hi:[1,0,0]
v_pk_fma_f32 v[128:129], v[128:129], v[224:225], v[24:25]
v_pk_fma_f32 v[130:131], v[130:131], v[226:227], v[26:27]
v_pk_mul_f32 v[24:25], v[68:69], v[244:245]
v_pk_mul_f32 v[26:27], v[70:71], v[246:247]
v_pk_mul_f32 v[68:69], v[68:69], v[228:229]
v_pk_mul_f32 v[70:71], v[70:71], v[230:231]
v_pk_fma_f32 v[68:69], v[132:133], v[244:245], v[68:69] neg_lo:[1,0,0] neg_hi:[1,0,0]
v_pk_fma_f32 v[70:71], v[134:135], v[246:247], v[70:71] neg_lo:[1,0,0] neg_hi:[1,0,0]
v_pk_fma_f32 v[132:133], v[132:133], v[228:229], v[24:25]
v_pk_fma_f32 v[134:135], v[134:135], v[230:231], v[26:27]
v_pk_mul_f32 v[24:25], v[72:73], v[248:249]
v_pk_mul_f32 v[26:27], v[74:75], v[250:251]
v_pk_mul_f32 v[72:73], v[72:73], v[232:233]
v_pk_mul_f32 v[74:75], v[74:75], v[234:235]
v_pk_fma_f32 v[72:73], v[136:137], v[248:249], v[72:73] neg_lo:[1,0,0] neg_hi:[1,0,0]
v_pk_fma_f32 v[74:75], v[138:139], v[250:251], v[74:75] neg_lo:[1,0,0] neg_hi:[1,0,0]
v_pk_fma_f32 v[136:137], v[136:137], v[232:233], v[24:25]
v_pk_fma_f32 v[138:139], v[138:139], v[234:235], v[26:27]
v_pk_mul_f32 v[24:25], v[76:77], v[252:253]
v_pk_mul_f32 v[26:27], v[78:79], v[254:255]
v_pk_mul_f32 v[76:77], v[76:77], v[236:237]
v_pk_mul_f32 v[78:79], v[78:79], v[238:239]
v_pk_fma_f32 v[76:77], v[140:141], v[252:253], v[76:77] neg_lo:[1,0,0] neg_hi:[1,0,0]
v_pk_fma_f32 v[78:79], v[142:143], v[254:255], v[78:79] neg_lo:[1,0,0] neg_hi:[1,0,0]
v_pk_fma_f32 v[140:141], v[140:141], v[236:237], v[24:25]
v_pk_fma_f32 v[142:143], v[142:143], v[238:239], v[26:27]
v_mfma_f32_32x32x16_bf16 v[144:159], a[32:35], v[160:163], 0
v_and_b32 v192, 0xffff0000, v192
v_cvt_pk_bf16_f32 v128, v64, v128
v_and_b32 v193, 0xffff0000, v193
v_and_b32 v194, 0xffff0000, v194
v_cvt_pk_bf16_f32 v129, v65, v129
v_mfma_f32_32x32x16_bf16 v[176:191], a[48:51], v[160:163], 0
v_and_b32 v195, 0xffff0000, v195
v_and_b32 v196, 0xffff0000, v196
v_cvt_pk_bf16_f32 v130, v66, v130
v_and_b32 v197, 0xffff0000, v197
v_and_b32 v198, 0xffff0000, v198
v_mfma_f32_32x32x16_bf16 v[144:159], a[36:39], v[164:167], v[144:159]
v_cvt_pk_bf16_f32 v131, v67, v131
v_and_b32 v199, 0xffff0000, v199
v_and_b32 v200, 0xffff0000, v200
v_cvt_pk_bf16_f32 v132, v68, v132
v_and_b32 v201, 0xffff0000, v201
v_mfma_f32_32x32x16_bf16 v[176:191], a[52:55], v[164:167], v[176:191]
v_and_b32 v202, 0xffff0000, v202
v_cvt_pk_bf16_f32 v133, v69, v133
v_and_b32 v203, 0xffff0000, v203
v_and_b32 v204, 0xffff0000, v204
v_cvt_pk_bf16_f32 v134, v70, v134
v_mfma_f32_32x32x16_bf16 v[144:159], a[40:43], v[168:171], v[144:159]
v_and_b32 v205, 0xffff0000, v205
v_and_b32 v206, 0xffff0000, v206
v_cvt_pk_bf16_f32 v135, v71, v135
v_and_b32 v207, 0xffff0000, v207
v_and_b32 v208, 0xffff0000, v208
v_mfma_f32_32x32x16_bf16 v[176:191], a[56:59], v[168:171], v[176:191]
v_cvt_pk_bf16_f32 v136, v72, v136
v_and_b32 v209, 0xffff0000, v209
v_and_b32 v210, 0xffff0000, v210
v_cvt_pk_bf16_f32 v137, v73, v137
v_and_b32 v211, 0xffff0000, v211
v_mfma_f32_32x32x16_bf16 v[144:159], a[44:47], v[172:175], v[144:159]
v_and_b32 v212, 0xffff0000, v212
v_cvt_pk_bf16_f32 v138, v74, v138
v_and_b32 v213, 0xffff0000, v213
v_and_b32 v214, 0xffff0000, v214
v_cvt_pk_bf16_f32 v139, v75, v139
v_mfma_f32_32x32x16_bf16 v[176:191], a[60:63], v[172:175], v[176:191]
v_and_b32 v215, 0xffff0000, v215
v_and_b32 v216, 0xffff0000, v216
v_cvt_pk_bf16_f32 v140, v76, v140
v_and_b32 v217, 0xffff0000, v217
v_and_b32 v218, 0xffff0000, v218
v_cvt_pk_bf16_f32 v141, v77, v141
v_and_b32 v219, 0xffff0000, v219
v_and_b32 v220, 0xffff0000, v220
v_cvt_pk_bf16_f32 v142, v78, v142
v_and_b32 v221, 0xffff0000, v221
v_and_b32 v222, 0xffff0000, v222
v_cvt_pk_bf16_f32 v143, v79, v143
v_and_b32 v223, 0xffff0000, v223
v_pk_mul_f32 v[24:25], v[144:145], v[208:209]
v_pk_mul_f32 v[26:27], v[146:147], v[210:211]
v_pk_mul_f32 v[144:145], v[144:145], v[192:193]
v_pk_mul_f32 v[146:147], v[146:147], v[194:195]
v_pk_fma_f32 v[144:145], v[176:177], v[208:209], v[144:145] neg_lo:[1,0,0] neg_hi:[1,0,0]
v_pk_fma_f32 v[146:147], v[178:179], v[210:211], v[146:147] neg_lo:[1,0,0] neg_hi:[1,0,0]
v_pk_fma_f32 v[176:177], v[176:177], v[192:193], v[24:25]
v_pk_fma_f32 v[178:179], v[178:179], v[194:195], v[26:27]
v_pk_mul_f32 v[24:25], v[148:149], v[212:213]
v_pk_mul_f32 v[26:27], v[150:151], v[214:215]
v_pk_mul_f32 v[148:149], v[148:149], v[196:197]
v_pk_mul_f32 v[150:151], v[150:151], v[198:199]
v_pk_fma_f32 v[148:149], v[180:181], v[212:213], v[148:149] neg_lo:[1,0,0] neg_hi:[1,0,0]
v_pk_fma_f32 v[150:151], v[182:183], v[214:215], v[150:151] neg_lo:[1,0,0] neg_hi:[1,0,0]
v_pk_fma_f32 v[180:181], v[180:181], v[196:197], v[24:25]
v_pk_fma_f32 v[182:183], v[182:183], v[198:199], v[26:27]
v_pk_mul_f32 v[24:25], v[152:153], v[216:217]
v_pk_mul_f32 v[26:27], v[154:155], v[218:219]
v_pk_mul_f32 v[152:153], v[152:153], v[200:201]
v_pk_mul_f32 v[154:155], v[154:155], v[202:203]
v_pk_fma_f32 v[152:153], v[184:185], v[216:217], v[152:153] neg_lo:[1,0,0] neg_hi:[1,0,0]
v_pk_fma_f32 v[154:155], v[186:187], v[218:219], v[154:155] neg_lo:[1,0,0] neg_hi:[1,0,0]
v_pk_fma_f32 v[184:185], v[184:185], v[200:201], v[24:25]
v_pk_fma_f32 v[186:187], v[186:187], v[202:203], v[26:27]
v_mfma_f32_32x32x16_bf16 v[64:79], v[128:131], a[64:67], 0
s_add_u32 m0, s48, 65536
s_add_u32 s51, s44, 2097408
buffer_load_dwordx4 v12, s[24:27], s51 offen offset:0 sc1 lds
v_mul_f32_e64 v24, v156, v220
v_mfma_f32_32x32x16_bf16 v[112:127], v[128:131], a[80:83], 0
v_mul_f32 v25, v157, v221
v_mul_f32 v156, v156, v204
v_mul_f32_e64 v157, v157, v205
v_fma_f32 v156, -v188, v220, v156
v_fma_f32 v157, -v189, v221, v157
v_mfma_f32_32x32x16_bf16 v[64:79], v[132:135], a[68:71], v[64:79]
v_fma_f32 v188, v188, v204, v24
v_fma_f32 v189, v189, v205, v25
buffer_load_dwordx4 v13, s[24:27], s51 offen offset:1024 sc1 lds
v_mul_f32_e64 v24, v158, v222
v_mfma_f32_32x32x16_bf16 v[112:127], v[132:135], a[84:87], v[112:127]
v_mul_f32 v25, v159, v223
v_mul_f32 v158, v158, v206
v_mul_f32_e64 v159, v159, v207
v_fma_f32 v158, -v190, v222, v158
v_fma_f32 v159, -v191, v223, v159
v_mfma_f32_32x32x16_bf16 v[64:79], v[136:139], a[72:75], v[64:79]
v_fma_f32 v190, v190, v206, v24
v_fma_f32 v191, v191, v207, v25
buffer_load_dwordx4 v14, s[24:27], s51 offen offset:2048 sc1 lds
v_cvt_pk_bf16_f32 v176, v144, v176
v_mfma_f32_32x32x16_bf16 v[112:127], v[136:139], a[88:91], v[112:127]
v_cvt_pk_bf16_f32 v177, v145, v177
v_cvt_pk_bf16_f32 v178, v146, v178
v_cvt_pk_bf16_f32 v179, v147, v179
v_cvt_pk_bf16_f32 v180, v148, v180
v_cvt_pk_bf16_f32 v181, v149, v181
v_mfma_f32_32x32x16_bf16 v[64:79], v[140:143], a[76:79], v[64:79]
v_cvt_pk_bf16_f32 v182, v150, v182
v_cvt_pk_bf16_f32 v183, v151, v183
buffer_load_dwordx4 v15, s[24:27], s51 offen offset:3072 sc1 lds
v_cvt_pk_bf16_f32 v184, v152, v184
v_mfma_f32_32x32x16_bf16 v[112:127], v[140:143], a[92:95], v[112:127]
v_cvt_pk_bf16_f32 v185, v153, v185
v_cvt_pk_bf16_f32 v186, v154, v186
v_cvt_pk_bf16_f32 v187, v155, v187
v_cvt_pk_bf16_f32 v188, v156, v188
v_cvt_pk_bf16_f32 v189, v157, v189
v_cvt_pk_bf16_f32 v190, v158, v190
v_cvt_pk_bf16_f32 v191, v159, v191
v_pk_mul_f32 v[24:25], v[64:65], v[96:97]
v_pk_mul_f32 v[26:27], v[66:67], v[98:99]
v_pk_mul_f32 v[64:65], v[64:65], v[80:81]
v_pk_mul_f32 v[66:67], v[66:67], v[82:83]
s_nop 0
v_pk_fma_f32 v[64:65], v[112:113], v[96:97], v[64:65] neg_lo:[1,0,0] neg_hi:[1,0,0]
v_pk_fma_f32 v[66:67], v[114:115], v[98:99], v[66:67] neg_lo:[1,0,0] neg_hi:[1,0,0]
v_pk_fma_f32 v[112:113], v[112:113], v[80:81], v[24:25]
v_pk_fma_f32 v[114:115], v[114:115], v[82:83], v[26:27]
v_pk_mul_f32 v[24:25], v[68:69], v[100:101]
v_pk_mul_f32 v[26:27], v[70:71], v[102:103]
v_pk_mul_f32 v[68:69], v[68:69], v[84:85]
v_pk_mul_f32 v[70:71], v[70:71], v[86:87]
v_pk_fma_f32 v[68:69], v[116:117], v[100:101], v[68:69] neg_lo:[1,0,0] neg_hi:[1,0,0]
v_pk_fma_f32 v[70:71], v[118:119], v[102:103], v[70:71] neg_lo:[1,0,0] neg_hi:[1,0,0]
v_pk_fma_f32 v[116:117], v[116:117], v[84:85], v[24:25]
v_pk_fma_f32 v[118:119], v[118:119], v[86:87], v[26:27]
v_pk_mul_f32 v[24:25], v[72:73], v[104:105]
v_pk_mul_f32 v[26:27], v[74:75], v[106:107]
v_pk_mul_f32 v[72:73], v[72:73], v[88:89]
v_pk_mul_f32 v[74:75], v[74:75], v[90:91]
v_pk_fma_f32 v[72:73], v[120:121], v[104:105], v[72:73] neg_lo:[1,0,0] neg_hi:[1,0,0]
v_pk_fma_f32 v[74:75], v[122:123], v[106:107], v[74:75] neg_lo:[1,0,0] neg_hi:[1,0,0]
v_pk_fma_f32 v[120:121], v[120:121], v[88:89], v[24:25]
v_pk_fma_f32 v[122:123], v[122:123], v[90:91], v[26:27]
v_mfma_f32_32x32x16_bf16 v[144:159], v[176:179], a[64:67], 0
s_add_u32 m0, s48, 69632
s_add_u32 s51, s44, 2113792
buffer_load_dwordx4 v12, s[24:27], s51 offen offset:0 sc1 lds
v_mul_f32 v24, v76, v108
v_mfma_f32_32x32x16_bf16 v[160:175], v[176:179], a[80:83], 0
v_mul_f32 v25, v77, v109
v_mul_f32 v76, v76, v92
v_mul_f32_e64 v77, v77, v93
v_fma_f32 v76, -v124, v108, v76
v_fma_f32 v77, -v125, v109, v77
v_mfma_f32_32x32x16_bf16 v[144:159], v[180:183], a[68:71], v[144:159]
v_fma_f32 v124, v124, v92, v24
v_fma_f32 v125, v125, v93, v25
buffer_load_dwordx4 v13, s[24:27], s51 offen offset:1024 sc1 lds
v_mul_f32_e64 v24, v78, v110
v_mfma_f32_32x32x16_bf16 v[160:175], v[180:183], a[84:87], v[160:175]
v_mul_f32 v25, v79, v111
v_mul_f32 v78, v78, v94
v_mul_f32_e64 v79, v79, v95
v_fma_f32 v78, -v126, v110, v78
v_fma_f32 v79, -v127, v111, v79
v_mfma_f32_32x32x16_bf16 v[144:159], v[184:187], a[72:75], v[144:159]
v_fma_f32 v126, v126, v94, v24
v_fma_f32 v127, v127, v95, v25
buffer_load_dwordx4 v14, s[24:27], s51 offen offset:2048 sc1 lds
v_cvt_pk_bf16_f32 v112, v64, v112
v_mfma_f32_32x32x16_bf16 v[160:175], v[184:187], a[88:91], v[160:175]
v_cvt_pk_bf16_f32 v113, v65, v113
v_cvt_pk_bf16_f32 v114, v66, v114
v_cvt_pk_bf16_f32 v115, v67, v115
v_cvt_pk_bf16_f32 v116, v68, v116
v_cvt_pk_bf16_f32 v117, v69, v117
v_mfma_f32_32x32x16_bf16 v[144:159], v[188:191], a[76:79], v[144:159]
v_cvt_pk_bf16_f32 v118, v70, v118
v_cvt_pk_bf16_f32 v119, v71, v119
buffer_load_dwordx4 v15, s[24:27], s51 offen offset:3072 sc1 lds
v_cvt_pk_bf16_f32 v120, v72, v120
v_mfma_f32_32x32x16_bf16 v[160:175], v[188:191], a[92:95], v[160:175]
v_cvt_pk_bf16_f32 v121, v73, v121
v_cvt_pk_bf16_f32 v122, v74, v122
v_cvt_pk_bf16_f32 v123, v75, v123
v_cvt_pk_bf16_f32 v124, v76, v124
v_cvt_pk_bf16_f32 v125, v77, v125
v_cvt_pk_bf16_f32 v126, v78, v126
v_cvt_pk_bf16_f32 v127, v79, v127
v_pk_mul_f32 v[24:25], v[144:145], v[96:97]
v_pk_mul_f32 v[26:27], v[146:147], v[98:99]
v_pk_mul_f32 v[144:145], v[144:145], v[80:81]
v_pk_mul_f32 v[146:147], v[146:147], v[82:83]
s_nop 0
v_pk_fma_f32 v[144:145], v[160:161], v[96:97], v[144:145] neg_lo:[1,0,0] neg_hi:[1,0,0]
v_pk_fma_f32 v[146:147], v[162:163], v[98:99], v[146:147] neg_lo:[1,0,0] neg_hi:[1,0,0]
v_pk_fma_f32 v[160:161], v[160:161], v[80:81], v[24:25]
v_pk_fma_f32 v[162:163], v[162:163], v[82:83], v[26:27]
v_pk_mul_f32 v[24:25], v[148:149], v[100:101]
v_pk_mul_f32 v[26:27], v[150:151], v[102:103]
v_pk_mul_f32 v[148:149], v[148:149], v[84:85]
v_pk_mul_f32 v[150:151], v[150:151], v[86:87]
v_pk_fma_f32 v[148:149], v[164:165], v[100:101], v[148:149] neg_lo:[1,0,0] neg_hi:[1,0,0]
v_pk_fma_f32 v[150:151], v[166:167], v[102:103], v[150:151] neg_lo:[1,0,0] neg_hi:[1,0,0]
v_pk_fma_f32 v[164:165], v[164:165], v[84:85], v[24:25]
v_pk_fma_f32 v[166:167], v[166:167], v[86:87], v[26:27]
v_pk_mul_f32 v[24:25], v[152:153], v[104:105]
v_pk_mul_f32 v[26:27], v[154:155], v[106:107]
v_pk_mul_f32 v[152:153], v[152:153], v[88:89]
v_pk_mul_f32 v[154:155], v[154:155], v[90:91]
v_pk_fma_f32 v[152:153], v[168:169], v[104:105], v[152:153] neg_lo:[1,0,0] neg_hi:[1,0,0]
v_pk_fma_f32 v[154:155], v[170:171], v[106:107], v[154:155] neg_lo:[1,0,0] neg_hi:[1,0,0]
v_pk_fma_f32 v[168:169], v[168:169], v[88:89], v[24:25]
v_pk_fma_f32 v[170:171], v[170:171], v[90:91], v[26:27]
v_mfma_f32_32x32x16_bf16 v[64:79], a[96:99], v[112:115], 0
s_waitcnt vmcnt(8)
s_barrier
v_mul_f32 v24, v156, v108
v_mul_f32_e64 v25, v157, v109
v_mfma_f32_32x32x16_bf16 v[128:143], a[112:115], v[112:115], 0
v_mul_f32 v156, v156, v92
v_mul_f32 v157, v157, v93
v_fma_f32 v156, -v172, v108, v156
v_fma_f32 v157, -v173, v109, v157
v_fma_f32 v172, v172, v92, v24
v_mfma_f32_32x32x16_bf16 v[64:79], a[100:103], v[116:119], v[64:79]
v_fma_f32 v173, v173, v93, v25
v_mul_f32 v24, v158, v110
v_mul_f32 v25, v159, v111
v_mul_f32 v158, v158, v94
v_mul_f32 v159, v159, v95
v_mfma_f32_32x32x16_bf16 v[128:143], a[116:119], v[116:119], v[128:143]
v_fma_f32 v158, -v174, v110, v158
v_fma_f32 v159, -v175, v111, v159
v_fma_f32 v174, v174, v94, v24
v_fma_f32 v175, v175, v95, v25
v_cvt_pk_bf16_f32 v160, v144, v160
v_mfma_f32_32x32x16_bf16 v[64:79], a[104:107], v[120:123], v[64:79]
v_cvt_pk_bf16_f32 v161, v145, v161
v_cvt_pk_bf16_f32 v162, v146, v162
v_cvt_pk_bf16_f32 v163, v147, v163
v_cvt_pk_bf16_f32 v164, v148, v164
v_cvt_pk_bf16_f32 v165, v149, v165
v_mfma_f32_32x32x16_bf16 v[128:143], a[120:123], v[120:123], v[128:143]
v_cvt_pk_bf16_f32 v166, v150, v166
v_cvt_pk_bf16_f32 v167, v151, v167
v_cvt_pk_bf16_f32 v168, v152, v168
v_cvt_pk_bf16_f32 v169, v153, v169
v_cvt_pk_bf16_f32 v170, v154, v170
v_mfma_f32_32x32x16_bf16 v[64:79], a[108:111], v[124:127], v[64:79]
v_cvt_pk_bf16_f32 v171, v155, v171
v_cvt_pk_bf16_f32 v172, v156, v172
v_cvt_pk_bf16_f32 v173, v157, v173
v_cvt_pk_bf16_f32 v174, v158, v174
v_cvt_pk_bf16_f32 v175, v159, v175
v_mfma_f32_32x32x16_bf16 v[128:143], a[124:127], v[124:127], v[128:143]
v_mfma_f32_32x32x16_bf16 v[144:159], a[96:99], v[160:163], 0
v_accvgpr_read_b32 v192, a129
v_accvgpr_read_b32 v193, a133
v_accvgpr_read_b32 v194, a137
v_accvgpr_read_b32 v195, a141
v_accvgpr_read_b32 v196, a145
v_mfma_f32_32x32x16_bf16 v[176:191], a[112:115], v[160:163], 0
v_accvgpr_read_b32 v197, a149
v_accvgpr_read_b32 v198, a153
v_accvgpr_read_b32 v199, a157
ds_read_b128 v[112:115], v2 offset:32768
ds_read_b128 v[116:119], v2 offset:33024
v_mfma_f32_32x32x16_bf16 v[144:159], a[100:103], v[164:167], v[144:159]
ds_read_b128 v[120:123], v2 offset:33280
ds_read_b128 v[124:127], v2 offset:33536
v_accvgpr_read_b32 v200, a161
v_accvgpr_read_b32 v201, a165
v_accvgpr_read_b32 v202, a169
v_mfma_f32_32x32x16_bf16 v[176:191], a[116:119], v[164:167], v[176:191]
v_accvgpr_read_b32 v203, a173
v_cvt_pk_bf16_f32 v128, v64, v128
v_cvt_pk_bf16_f32 v129, v65, v129
v_cvt_pk_bf16_f32 v130, v66, v130
v_cvt_pk_bf16_f32 v131, v67, v131
v_mfma_f32_32x32x16_bf16 v[144:159], a[104:107], v[168:171], v[144:159]
ds_write_b128 v2, v[128:131] offset:0
v_cvt_pk_bf16_f32 v132, v68, v132
v_mfma_f32_32x32x16_bf16 v[176:191], a[120:123], v[168:171], v[176:191]
v_cvt_pk_bf16_f32 v133, v69, v133
v_cvt_pk_bf16_f32 v134, v70, v134
v_cvt_pk_bf16_f32 v135, v71, v135
v_mfma_f32_32x32x16_bf16 v[144:159], a[108:111], v[172:175], v[144:159]
ds_write_b128 v2, v[132:135] offset:256
v_cvt_pk_bf16_f32 v136, v72, v136
v_mfma_f32_32x32x16_bf16 v[176:191], a[124:127], v[172:175], v[176:191]
v_cvt_pk_bf16_f32 v137, v73, v137
v_cvt_pk_bf16_f32 v138, v74, v138
v_cvt_pk_bf16_f32 v139, v75, v139
ds_write_b128 v2, v[136:139] offset:512
v_cvt_pk_bf16_f32 v140, v76, v140
v_cvt_pk_bf16_f32 v141, v77, v141
v_cvt_pk_bf16_f32 v142, v78, v142
v_cvt_pk_bf16_f32 v143, v79, v143
ds_write_b128 v2, v[140:143] offset:768
s_waitcnt lgkmcnt(7)
v_mfma_f32_32x32x16_bf16 v[64:79], v[112:115], a[0:3], 0
v_accvgpr_read_b32 v204, a177
v_accvgpr_read_b32 v205, a181
v_accvgpr_read_b32 v206, a185
v_accvgpr_read_b32 v207, a189
v_accvgpr_read_b32 v208, a193
v_mfma_f32_32x32x16_bf16 v[128:143], v[112:115], a[16:19], 0
v_accvgpr_read_b32 v209, a197
v_accvgpr_read_b32 v210, a201
v_accvgpr_read_b32 v211, a205
ds_read_b128 v[160:163], v3 offset:32768
ds_read_b128 v[164:167], v3 offset:33024
s_waitcnt lgkmcnt(8)
v_mfma_f32_32x32x16_bf16 v[64:79], v[116:119], a[4:7], v[64:79]
ds_read_b128 v[168:171], v3 offset:33280
ds_read_b128 v[172:175], v3 offset:33536
v_accvgpr_read_b32 v212, a209
v_accvgpr_read_b32 v213, a213
v_accvgpr_read_b32 v214, a217
v_mfma_f32_32x32x16_bf16 v[128:143], v[116:119], a[20:23], v[128:143]
v_accvgpr_read_b32 v215, a221
v_cvt_pk_bf16_f32 v176, v144, v176
v_cvt_pk_bf16_f32 v177, v145, v177
v_cvt_pk_bf16_f32 v178, v146, v178
v_cvt_pk_bf16_f32 v179, v147, v179
s_waitcnt lgkmcnt(9)
v_mfma_f32_32x32x16_bf16 v[64:79], v[120:123], a[8:11], v[64:79]
ds_write_b128 v3, v[176:179] offset:0
v_cvt_pk_bf16_f32 v180, v148, v180
v_mfma_f32_32x32x16_bf16 v[128:143], v[120:123], a[24:27], v[128:143]
v_cvt_pk_bf16_f32 v181, v149, v181
v_cvt_pk_bf16_f32 v182, v150, v182
v_cvt_pk_bf16_f32 v183, v151, v183
s_waitcnt lgkmcnt(9)
v_mfma_f32_32x32x16_bf16 v[64:79], v[124:127], a[12:15], v[64:79]
ds_write_b128 v3, v[180:183] offset:256
v_cvt_pk_bf16_f32 v184, v152, v184
v_mfma_f32_32x32x16_bf16 v[128:143], v[124:127], a[28:31], v[128:143]
v_cvt_pk_bf16_f32 v185, v153, v185
v_cvt_pk_bf16_f32 v186, v154, v186
v_cvt_pk_bf16_f32 v187, v155, v187
ds_write_b128 v3, v[184:187] offset:512
v_cvt_pk_bf16_f32 v188, v156, v188
v_cvt_pk_bf16_f32 v189, v157, v189
v_cvt_pk_bf16_f32 v190, v158, v190
v_cvt_pk_bf16_f32 v191, v159, v191
ds_write_b128 v3, v[188:191] offset:768
v_pk_mul_f32 v[24:25], v[64:65], v[96:97]
v_pk_mul_f32 v[26:27], v[66:67], v[98:99]
v_pk_mul_f32 v[64:65], v[64:65], v[80:81]
v_pk_mul_f32 v[66:67], v[66:67], v[82:83]
v_pk_fma_f32 v[64:65], v[128:129], v[96:97], v[64:65]
v_pk_fma_f32 v[66:67], v[130:131], v[98:99], v[66:67]
v_pk_fma_f32 v[128:129], v[128:129], v[80:81], v[24:25] neg_lo:[0,0,1] neg_hi:[0,0,1]
v_pk_fma_f32 v[130:131], v[130:131], v[82:83], v[26:27] neg_lo:[0,0,1] neg_hi:[0,0,1]
v_pk_mul_f32 v[24:25], v[68:69], v[100:101]
v_pk_mul_f32 v[26:27], v[70:71], v[102:103]
v_pk_mul_f32 v[68:69], v[68:69], v[84:85]
v_pk_mul_f32 v[70:71], v[70:71], v[86:87]
v_pk_fma_f32 v[68:69], v[132:133], v[100:101], v[68:69]
v_pk_fma_f32 v[70:71], v[134:135], v[102:103], v[70:71]
v_pk_fma_f32 v[132:133], v[132:133], v[84:85], v[24:25] neg_lo:[0,0,1] neg_hi:[0,0,1]
v_pk_fma_f32 v[134:135], v[134:135], v[86:87], v[26:27] neg_lo:[0,0,1] neg_hi:[0,0,1]
v_pk_mul_f32 v[24:25], v[72:73], v[104:105]
v_pk_mul_f32 v[26:27], v[74:75], v[106:107]
v_pk_mul_f32 v[72:73], v[72:73], v[88:89]
v_pk_mul_f32 v[74:75], v[74:75], v[90:91]
v_pk_fma_f32 v[72:73], v[136:137], v[104:105], v[72:73]
v_pk_fma_f32 v[74:75], v[138:139], v[106:107], v[74:75]
v_pk_fma_f32 v[136:137], v[136:137], v[88:89], v[24:25] neg_lo:[0,0,1] neg_hi:[0,0,1]
v_pk_fma_f32 v[138:139], v[138:139], v[90:91], v[26:27] neg_lo:[0,0,1] neg_hi:[0,0,1]
v_pk_mul_f32 v[24:25], v[76:77], v[108:109]
v_pk_mul_f32 v[26:27], v[78:79], v[110:111]
v_pk_mul_f32 v[76:77], v[76:77], v[92:93]
v_pk_mul_f32 v[78:79], v[78:79], v[94:95]
v_pk_fma_f32 v[76:77], v[140:141], v[108:109], v[76:77]
v_pk_fma_f32 v[78:79], v[142:143], v[110:111], v[78:79]
v_pk_fma_f32 v[140:141], v[140:141], v[92:93], v[24:25] neg_lo:[0,0,1] neg_hi:[0,0,1]
v_pk_fma_f32 v[142:143], v[142:143], v[94:95], v[26:27] neg_lo:[0,0,1] neg_hi:[0,0,1]
s_waitcnt lgkmcnt(7)
v_mfma_f32_32x32x16_bf16 v[144:159], v[160:163], a[0:3], 0
s_waitcnt lgkmcnt(0)
s_waitcnt vmcnt(0)
s_barrier
v_cvt_pk_bf16_f32 v128, v64, v128
v_lshlrev_b32_e64 v224, 16, v192
v_mfma_f32_32x32x16_bf16 v[176:191], v[160:163], a[16:19], 0
v_cvt_pk_bf16_f32 v129, v65, v129
v_lshlrev_b32_e64 v225, 16, v193
ds_read_b128 v[40:43], v10 offset:0
v_cvt_pk_bf16_f32 v130, v66, v130
v_lshlrev_b32_e64 v226, 16, v194
v_mfma_f32_32x32x16_bf16 v[144:159], v[164:167], a[4:7], v[144:159]
ds_read_b128 v[44:47], v10 offset:1024
v_cvt_pk_bf16_f32 v131, v67, v131
v_lshlrev_b32_e64 v227, 16, v195
v_cvt_pk_bf16_f32 v132, v68, v132
v_lshlrev_b32_e64 v228, 16, v196
v_mfma_f32_32x32x16_bf16 v[176:191], v[164:167], a[20:23], v[176:191]
v_accvgpr_read_b32 v216, a225
v_cvt_pk_bf16_f32 v133, v69, v133
v_lshlrev_b32_e64 v229, 16, v197
v_accvgpr_read_b32 v217, a229
v_cvt_pk_bf16_f32 v134, v70, v134
v_mfma_f32_32x32x16_bf16 v[144:159], v[168:171], a[8:11], v[144:159]
v_lshlrev_b32_e64 v230, 16, v198
v_cvt_pk_bf16_f32 v135, v71, v135
v_lshlrev_b32_e64 v231, 16, v199
v_accvgpr_read_b32 v218, a233
v_cvt_pk_bf16_f32 v136, v72, v136
v_mfma_f32_32x32x16_bf16 v[176:191], v[168:171], a[24:27], v[176:191]
v_lshlrev_b32_e64 v232, 16, v200
v_accvgpr_read_b32 v219, a237
v_cvt_pk_bf16_f32 v137, v73, v137
v_lshlrev_b32_e64 v233, 16, v201
v_cvt_pk_bf16_f32 v138, v74, v138
v_mfma_f32_32x32x16_bf16 v[144:159], v[172:175], a[12:15], v[144:159]
v_lshlrev_b32_e64 v234, 16, v202
v_accvgpr_read_b32 v220, a241
v_cvt_pk_bf16_f32 v139, v75, v139
v_lshlrev_b32_e64 v235, 16, v203
v_accvgpr_read_b32 v221, a245
v_mfma_f32_32x32x16_bf16 v[176:191], v[172:175], a[28:31], v[176:191]
v_cvt_pk_bf16_f32 v140, v76, v140
v_lshlrev_b32_e64 v236, 16, v204
v_cvt_pk_bf16_f32 v141, v77, v141
v_lshlrev_b32_e64 v237, 16, v205
v_accvgpr_read_b32 v222, a249
v_cvt_pk_bf16_f32 v142, v78, v142
v_lshlrev_b32_e64 v238, 16, v206
v_accvgpr_read_b32 v223, a253
v_cvt_pk_bf16_f32 v143, v79, v143
v_lshlrev_b32_e64 v239, 16, v207
v_pk_mul_f32 v[24:25], v[144:145], v[96:97]
v_pk_mul_f32 v[26:27], v[146:147], v[98:99]
v_pk_mul_f32 v[144:145], v[144:145], v[80:81]
v_pk_mul_f32 v[146:147], v[146:147], v[82:83]
v_pk_fma_f32 v[144:145], v[176:177], v[96:97], v[144:145]
v_pk_fma_f32 v[146:147], v[178:179], v[98:99], v[146:147]
v_pk_fma_f32 v[176:177], v[176:177], v[80:81], v[24:25] neg_lo:[0,0,1] neg_hi:[0,0,1]
v_pk_fma_f32 v[178:179], v[178:179], v[82:83], v[26:27] neg_lo:[0,0,1] neg_hi:[0,0,1]
v_pk_mul_f32 v[24:25], v[148:149], v[100:101]
v_pk_mul_f32 v[26:27], v[150:151], v[102:103]
v_pk_mul_f32 v[148:149], v[148:149], v[84:85]
v_pk_mul_f32 v[150:151], v[150:151], v[86:87]
v_pk_fma_f32 v[148:149], v[180:181], v[100:101], v[148:149]
v_pk_fma_f32 v[150:151], v[182:183], v[102:103], v[150:151]
v_pk_fma_f32 v[180:181], v[180:181], v[84:85], v[24:25] neg_lo:[0,0,1] neg_hi:[0,0,1]
v_pk_fma_f32 v[182:183], v[182:183], v[86:87], v[26:27] neg_lo:[0,0,1] neg_hi:[0,0,1]
v_pk_mul_f32 v[24:25], v[152:153], v[104:105]
v_pk_mul_f32 v[26:27], v[154:155], v[106:107]
v_pk_mul_f32 v[152:153], v[152:153], v[88:89]
v_pk_mul_f32 v[154:155], v[154:155], v[90:91]
v_pk_fma_f32 v[152:153], v[184:185], v[104:105], v[152:153]
v_pk_fma_f32 v[154:155], v[186:187], v[106:107], v[154:155]
v_pk_fma_f32 v[184:185], v[184:185], v[88:89], v[24:25] neg_lo:[0,0,1] neg_hi:[0,0,1]
v_pk_fma_f32 v[186:187], v[186:187], v[90:91], v[26:27] neg_lo:[0,0,1] neg_hi:[0,0,1]
v_pk_mul_f32 v[24:25], v[156:157], v[108:109]
v_pk_mul_f32 v[26:27], v[158:159], v[110:111]
v_pk_mul_f32 v[156:157], v[156:157], v[92:93]
v_pk_mul_f32 v[158:159], v[158:159], v[94:95]
v_pk_fma_f32 v[156:157], v[188:189], v[108:109], v[156:157]
v_pk_fma_f32 v[158:159], v[190:191], v[110:111], v[158:159]
v_pk_fma_f32 v[188:189], v[188:189], v[92:93], v[24:25] neg_lo:[0,0,1] neg_hi:[0,0,1]
v_pk_fma_f32 v[190:191], v[190:191], v[94:95], v[26:27] neg_lo:[0,0,1] neg_hi:[0,0,1]
v_mfma_f32_32x32x16_bf16 v[64:79], a[32:35], v[128:131], 0
s_add_u32 s40, s44, 2097152
s_waitcnt lgkmcnt(1)
buffer_store_dwordx4 v[40:43], v12, s[24:27], s40 offen offset:0 sc1
v_mfma_f32_32x32x16_bf16 v[112:127], a[48:51], v[128:131], 0
v_cvt_pk_bf16_f32 v176, v144, v176
v_lshlrev_b32 v240, 16, v208
v_cvt_pk_bf16_f32 v177, v145, v177
v_lshlrev_b32_e64 v241, 16, v209
v_cvt_pk_bf16_f32 v178, v146, v178
v_mfma_f32_32x32x16_bf16 v[64:79], a[36:39], v[132:135], v[64:79]
v_lshlrev_b32_e64 v242, 16, v210
v_cvt_pk_bf16_f32 v179, v147, v179
v_lshlrev_b32_e64 v243, 16, v211
v_cvt_pk_bf16_f32 v180, v148, v180
v_lshlrev_b32_e64 v244, 16, v212
v_mfma_f32_32x32x16_bf16 v[112:127], a[52:55], v[132:135], v[112:127]
v_cvt_pk_bf16_f32 v181, v149, v181
v_lshlrev_b32 v245, 16, v213
v_mfma_f32_32x32x16_bf16 v[64:79], a[40:43], v[136:139], v[64:79]
s_waitcnt lgkmcnt(0)
buffer_store_dwordx4 v[44:47], v13, s[24:27], s40 offen offset:1024 sc1
v_cvt_pk_bf16_f32 v182, v150, v182
v_mfma_f32_32x32x16_bf16 v[112:127], a[56:59], v[136:139], v[112:127]
v_lshlrev_b32_e64 v246, 16, v214
v_cvt_pk_bf16_f32 v183, v151, v183
v_lshlrev_b32_e64 v247, 16, v215
v_cvt_pk_bf16_f32 v184, v152, v184
v_lshlrev_b32_e64 v248, 16, v216
v_mfma_f32_32x32x16_bf16 v[64:79], a[44:47], v[140:143], v[64:79]
v_cvt_pk_bf16_f32 v185, v153, v185
v_lshlrev_b32_e64 v249, 16, v217
v_cvt_pk_bf16_f32 v186, v154, v186
v_lshlrev_b32_e64 v250, 16, v218
ds_read_b128 v[48:51], v10 offset:2048
v_mfma_f32_32x32x16_bf16 v[112:127], a[60:63], v[140:143], v[112:127]
v_cvt_pk_bf16_f32 v187, v155, v187
v_lshlrev_b32_e64 v251, 16, v219
v_cvt_pk_bf16_f32 v188, v156, v188
v_lshlrev_b32_e64 v252, 16, v220
v_cvt_pk_bf16_f32 v189, v157, v189
v_lshlrev_b32_e64 v253, 16, v221
v_cvt_pk_bf16_f32 v190, v158, v190
v_lshlrev_b32_e64 v254, 16, v222
v_cvt_pk_bf16_f32 v191, v159, v191
v_lshlrev_b32 v255, 16, v223
v_pk_mul_f32 v[24:25], v[64:65], v[240:241]
v_pk_mul_f32 v[26:27], v[66:67], v[242:243]
v_pk_mul_f32 v[64:65], v[64:65], v[224:225]
v_pk_mul_f32 v[66:67], v[66:67], v[226:227]
v_pk_fma_f32 v[64:65], v[112:113], v[240:241], v[64:65] neg_lo:[1,0,0] neg_hi:[1,0,0]
v_pk_fma_f32 v[66:67], v[114:115], v[242:243], v[66:67] neg_lo:[1,0,0] neg_hi:[1,0,0]
v_pk_fma_f32 v[112:113], v[112:113], v[224:225], v[24:25]
v_pk_fma_f32 v[114:115], v[114:115], v[226:227], v[26:27]
v_pk_mul_f32 v[24:25], v[68:69], v[244:245]
v_pk_mul_f32 v[26:27], v[70:71], v[246:247]
v_pk_mul_f32 v[68:69], v[68:69], v[228:229]
v_pk_mul_f32 v[70:71], v[70:71], v[230:231]
v_pk_fma_f32 v[68:69], v[116:117], v[244:245], v[68:69] neg_lo:[1,0,0] neg_hi:[1,0,0]
v_pk_fma_f32 v[70:71], v[118:119], v[246:247], v[70:71] neg_lo:[1,0,0] neg_hi:[1,0,0]
v_pk_fma_f32 v[116:117], v[116:117], v[228:229], v[24:25]
v_pk_fma_f32 v[118:119], v[118:119], v[230:231], v[26:27]
v_pk_mul_f32 v[24:25], v[72:73], v[248:249]
v_pk_mul_f32 v[26:27], v[74:75], v[250:251]
v_pk_mul_f32 v[72:73], v[72:73], v[232:233]
v_pk_mul_f32 v[74:75], v[74:75], v[234:235]
v_pk_fma_f32 v[72:73], v[120:121], v[248:249], v[72:73] neg_lo:[1,0,0] neg_hi:[1,0,0]
v_pk_fma_f32 v[74:75], v[122:123], v[250:251], v[74:75] neg_lo:[1,0,0] neg_hi:[1,0,0]
v_pk_fma_f32 v[120:121], v[120:121], v[232:233], v[24:25]
v_pk_fma_f32 v[122:123], v[122:123], v[234:235], v[26:27]
v_pk_mul_f32 v[24:25], v[76:77], v[252:253]
v_pk_mul_f32 v[26:27], v[78:79], v[254:255]
v_pk_mul_f32 v[76:77], v[76:77], v[236:237]
v_pk_mul_f32 v[78:79], v[78:79], v[238:239]
v_pk_fma_f32 v[76:77], v[124:125], v[252:253], v[76:77] neg_lo:[1,0,0] neg_hi:[1,0,0]
v_pk_fma_f32 v[78:79], v[126:127], v[254:255], v[78:79] neg_lo:[1,0,0] neg_hi:[1,0,0]
v_pk_fma_f32 v[124:125], v[124:125], v[236:237], v[24:25]
v_pk_fma_f32 v[126:127], v[126:127], v[238:239], v[26:27]
v_mfma_f32_32x32x16_bf16 v[144:159], a[32:35], v[176:179], 0
s_waitcnt lgkmcnt(0)
buffer_store_dwordx4 v[48:51], v14, s[24:27], s40 offen offset:2048 sc1
v_cvt_pk_bf16_f32 v112, v64, v112
v_mfma_f32_32x32x16_bf16 v[160:175], a[48:51], v[176:179], 0
v_and_b32 v192, 0xffff0000, v192
v_and_b32 v193, 0xffff0000, v193
v_cvt_pk_bf16_f32 v113, v65, v113
v_and_b32 v194, 0xffff0000, v194
v_and_b32 v195, 0xffff0000, v195
v_mfma_f32_32x32x16_bf16 v[144:159], a[36:39], v[180:183], v[144:159]
v_cvt_pk_bf16_f32 v114, v66, v114
v_and_b32 v196, 0xffff0000, v196
v_and_b32 v197, 0xffff0000, v197
v_cvt_pk_bf16_f32 v115, v67, v115
v_and_b32 v198, 0xffff0000, v198
v_mfma_f32_32x32x16_bf16 v[160:175], a[52:55], v[180:183], v[160:175]
v_and_b32 v199, 0xffff0000, v199
v_cvt_pk_bf16_f32 v116, v68, v116
v_and_b32 v200, 0xffff0000, v200
v_and_b32 v201, 0xffff0000, v201
v_cvt_pk_bf16_f32 v117, v69, v117
v_mfma_f32_32x32x16_bf16 v[144:159], a[40:43], v[184:187], v[144:159]
v_and_b32 v202, 0xffff0000, v202
v_and_b32 v203, 0xffff0000, v203
v_cvt_pk_bf16_f32 v118, v70, v118
v_and_b32 v204, 0xffff0000, v204
v_and_b32 v205, 0xffff0000, v205
v_mfma_f32_32x32x16_bf16 v[160:175], a[56:59], v[184:187], v[160:175]
v_cvt_pk_bf16_f32 v119, v71, v119
v_and_b32 v206, 0xffff0000, v206
v_and_b32 v207, 0xffff0000, v207
ds_read_b128 v[52:55], v10 offset:3072
v_cvt_pk_bf16_f32 v120, v72, v120
v_mfma_f32_32x32x16_bf16 v[144:159], a[44:47], v[188:191], v[144:159]
v_and_b32 v208, 0xffff0000, v208
v_and_b32 v209, 0xffff0000, v209
v_cvt_pk_bf16_f32 v121, v73, v121
v_and_b32 v210, 0xffff0000, v210
v_and_b32 v211, 0xffff0000, v211
v_mfma_f32_32x32x16_bf16 v[160:175], a[60:63], v[188:191], v[160:175]
v_cvt_pk_bf16_f32 v122, v74, v122
v_and_b32 v212, 0xffff0000, v212
v_and_b32 v213, 0xffff0000, v213
v_cvt_pk_bf16_f32 v123, v75, v123
v_and_b32 v214, 0xffff0000, v214
v_and_b32 v215, 0xffff0000, v215
v_cvt_pk_bf16_f32 v124, v76, v124
v_and_b32 v216, 0xffff0000, v216
v_and_b32 v217, 0xffff0000, v217
v_cvt_pk_bf16_f32 v125, v77, v125
v_and_b32 v218, 0xffff0000, v218
v_and_b32 v219, 0xffff0000, v219
v_cvt_pk_bf16_f32 v126, v78, v126
v_and_b32 v220, 0xffff0000, v220
v_and_b32 v221, 0xffff0000, v221
v_cvt_pk_bf16_f32 v127, v79, v127
v_and_b32 v222, 0xffff0000, v222
v_and_b32 v223, 0xffff0000, v223
v_pk_mul_f32 v[24:25], v[144:145], v[208:209]
v_pk_mul_f32 v[26:27], v[146:147], v[210:211]
v_pk_mul_f32 v[144:145], v[144:145], v[192:193]
v_pk_mul_f32 v[146:147], v[146:147], v[194:195]
v_pk_fma_f32 v[144:145], v[160:161], v[208:209], v[144:145] neg_lo:[1,0,0] neg_hi:[1,0,0]
v_pk_fma_f32 v[146:147], v[162:163], v[210:211], v[146:147] neg_lo:[1,0,0] neg_hi:[1,0,0]
v_pk_fma_f32 v[160:161], v[160:161], v[192:193], v[24:25]
v_pk_fma_f32 v[162:163], v[162:163], v[194:195], v[26:27]
v_pk_mul_f32 v[24:25], v[148:149], v[212:213]
v_pk_mul_f32 v[26:27], v[150:151], v[214:215]
v_pk_mul_f32 v[148:149], v[148:149], v[196:197]
v_pk_mul_f32 v[150:151], v[150:151], v[198:199]
v_pk_fma_f32 v[148:149], v[164:165], v[212:213], v[148:149] neg_lo:[1,0,0] neg_hi:[1,0,0]
v_pk_fma_f32 v[150:151], v[166:167], v[214:215], v[150:151] neg_lo:[1,0,0] neg_hi:[1,0,0]
v_pk_fma_f32 v[164:165], v[164:165], v[196:197], v[24:25]
v_pk_fma_f32 v[166:167], v[166:167], v[198:199], v[26:27]
v_pk_mul_f32 v[24:25], v[152:153], v[216:217]
v_pk_mul_f32 v[26:27], v[154:155], v[218:219]
v_pk_mul_f32 v[152:153], v[152:153], v[200:201]
v_pk_mul_f32 v[154:155], v[154:155], v[202:203]
v_pk_fma_f32 v[152:153], v[168:169], v[216:217], v[152:153] neg_lo:[1,0,0] neg_hi:[1,0,0]
v_pk_fma_f32 v[154:155], v[170:171], v[218:219], v[154:155] neg_lo:[1,0,0] neg_hi:[1,0,0]
v_pk_fma_f32 v[168:169], v[168:169], v[200:201], v[24:25]
v_pk_fma_f32 v[170:171], v[170:171], v[202:203], v[26:27]
v_pk_mul_f32 v[24:25], v[156:157], v[220:221]
v_pk_mul_f32 v[156:157], v[156:157], v[204:205]
v_pk_fma_f32 v[156:157], v[172:173], v[220:221], v[156:157] neg_lo:[1,0,0] neg_hi:[1,0,0]
v_pk_fma_f32 v[172:173], v[172:173], v[204:205], v[24:25]
v_mfma_f32_32x32x16_bf16 v[64:79], v[112:115], a[64:67], 0
s_waitcnt lgkmcnt(0)
buffer_store_dwordx4 v[52:55], v15, s[24:27], s40 offen offset:3072 sc1
v_mul_f32 v24, v158, v222
v_mfma_f32_32x32x16_bf16 v[128:143], v[112:115], a[80:83], 0
v_mul_f32 v25, v159, v223
v_mul_f32 v158, v158, v206
v_mul_f32_e64 v159, v159, v207
ds_read_b128 v[40:43], v10 offset:4096
v_fma_f32 v158, -v174, v222, v158
v_mfma_f32_32x32x16_bf16 v[64:79], v[116:119], a[68:71], v[64:79]
v_fma_f32 v159, -v175, v223, v159
v_fma_f32 v174, v174, v206, v24
v_fma_f32 v175, v175, v207, v25
s_add_u32 m0, s48, 98304
s_add_u32 s51, s44, 2097536
v_mfma_f32_32x32x16_bf16 v[128:143], v[116:119], a[84:87], v[128:143]
buffer_load_dwordx4 v12, s[24:27], s51 offen offset:0 sc1 lds
v_cvt_pk_bf16_f32 v160, v144, v160
v_cvt_pk_bf16_f32 v161, v145, v161
v_cvt_pk_bf16_f32 v162, v146, v162
v_mfma_f32_32x32x16_bf16 v[64:79], v[120:123], a[72:75], v[64:79]
v_cvt_pk_bf16_f32 v163, v147, v163
buffer_load_dwordx4 v13, s[24:27], s51 offen offset:1024 sc1 lds
v_cvt_pk_bf16_f32 v164, v148, v164
v_cvt_pk_bf16_f32 v165, v149, v165
v_mfma_f32_32x32x16_bf16 v[128:143], v[120:123], a[88:91], v[128:143]
v_cvt_pk_bf16_f32 v166, v150, v166
v_cvt_pk_bf16_f32 v167, v151, v167
buffer_load_dwordx4 v14, s[24:27], s51 offen offset:2048 sc1 lds
v_cvt_pk_bf16_f32 v168, v152, v168
v_mfma_f32_32x32x16_bf16 v[64:79], v[124:127], a[76:79], v[64:79]
v_cvt_pk_bf16_f32 v169, v153, v169
v_cvt_pk_bf16_f32 v170, v154, v170
v_cvt_pk_bf16_f32 v171, v155, v171
buffer_load_dwordx4 v15, s[24:27], s51 offen offset:3072 sc1 lds
v_mfma_f32_32x32x16_bf16 v[128:143], v[124:127], a[92:95], v[128:143]
v_cvt_pk_bf16_f32 v172, v156, v172
v_cvt_pk_bf16_f32 v173, v157, v173
v_cvt_pk_bf16_f32 v174, v158, v174
v_cvt_pk_bf16_f32 v175, v159, v175
s_nop 2
v_pk_mul_f32 v[24:25], v[64:65], v[96:97]
v_pk_mul_f32 v[26:27], v[66:67], v[98:99]
v_pk_mul_f32 v[64:65], v[64:65], v[80:81]
v_pk_mul_f32 v[66:67], v[66:67], v[82:83]
s_nop 0
v_pk_fma_f32 v[64:65], v[128:129], v[96:97], v[64:65] neg_lo:[1,0,0] neg_hi:[1,0,0]
v_pk_fma_f32 v[66:67], v[130:131], v[98:99], v[66:67] neg_lo:[1,0,0] neg_hi:[1,0,0]
v_pk_fma_f32 v[128:129], v[128:129], v[80:81], v[24:25]
v_pk_fma_f32 v[130:131], v[130:131], v[82:83], v[26:27]
v_pk_mul_f32 v[24:25], v[68:69], v[100:101]
v_pk_mul_f32 v[26:27], v[70:71], v[102:103]
v_pk_mul_f32 v[68:69], v[68:69], v[84:85]
v_pk_mul_f32 v[70:71], v[70:71], v[86:87]
v_pk_fma_f32 v[68:69], v[132:133], v[100:101], v[68:69] neg_lo:[1,0,0] neg_hi:[1,0,0]
v_pk_fma_f32 v[70:71], v[134:135], v[102:103], v[70:71] neg_lo:[1,0,0] neg_hi:[1,0,0]
v_pk_fma_f32 v[132:133], v[132:133], v[84:85], v[24:25]
v_pk_fma_f32 v[134:135], v[134:135], v[86:87], v[26:27]
v_pk_mul_f32 v[24:25], v[72:73], v[104:105]
v_pk_mul_f32 v[26:27], v[74:75], v[106:107]
v_pk_mul_f32 v[72:73], v[72:73], v[88:89]
v_pk_mul_f32 v[74:75], v[74:75], v[90:91]
v_pk_fma_f32 v[72:73], v[136:137], v[104:105], v[72:73] neg_lo:[1,0,0] neg_hi:[1,0,0]
v_pk_fma_f32 v[74:75], v[138:139], v[106:107], v[74:75] neg_lo:[1,0,0] neg_hi:[1,0,0]
v_pk_fma_f32 v[136:137], v[136:137], v[88:89], v[24:25]
v_pk_fma_f32 v[138:139], v[138:139], v[90:91], v[26:27]
v_pk_mul_f32 v[24:25], v[76:77], v[108:109]
v_pk_mul_f32 v[76:77], v[76:77], v[92:93]
v_pk_fma_f32 v[76:77], v[140:141], v[108:109], v[76:77] neg_lo:[1,0,0] neg_hi:[1,0,0]
v_pk_fma_f32 v[140:141], v[140:141], v[92:93], v[24:25]
v_mfma_f32_32x32x16_bf16 v[144:159], v[160:163], a[64:67], 0
s_add_u32 s40, s44, 2113536
s_waitcnt lgkmcnt(0)
buffer_store_dwordx4 v[40:43], v12, s[24:27], s40 offen offset:0 sc1
v_mfma_f32_32x32x16_bf16 v[176:191], v[160:163], a[80:83], 0
v_mul_f32 v24, v78, v110
v_mul_f32 v25, v79, v111
v_mul_f32 v78, v78, v94
v_mul_f32_e64 v79, v79, v95
ds_read_b128 v[44:47], v10 offset:5120
v_mfma_f32_32x32x16_bf16 v[144:159], v[164:167], a[68:71], v[144:159]
v_fma_f32 v78, -v142, v110, v78
v_fma_f32 v79, -v143, v111, v79
v_fma_f32 v142, v142, v94, v24
v_fma_f32 v143, v143, v95, v25
s_add_u32 m0, s48, 102400
v_mfma_f32_32x32x16_bf16 v[176:191], v[164:167], a[84:87], v[176:191]
s_add_u32 s51, s44, 2113920
buffer_load_dwordx4 v12, s[24:27], s51 offen offset:0 sc1 lds
v_cvt_pk_bf16_f32 v128, v64, v128
v_cvt_pk_bf16_f32 v129, v65, v129
v_mfma_f32_32x32x16_bf16 v[144:159], v[168:171], a[72:75], v[144:159]
v_cvt_pk_bf16_f32 v130, v66, v130
v_cvt_pk_bf16_f32 v131, v67, v131
buffer_load_dwordx4 v13, s[24:27], s51 offen offset:1024 sc1 lds
v_cvt_pk_bf16_f32 v132, v68, v132
v_mfma_f32_32x32x16_bf16 v[176:191], v[168:171], a[88:91], v[176:191]
v_cvt_pk_bf16_f32 v133, v69, v133
v_cvt_pk_bf16_f32 v134, v70, v134
v_cvt_pk_bf16_f32 v135, v71, v135
buffer_load_dwordx4 v14, s[24:27], s51 offen offset:2048 sc1 lds
v_mfma_f32_32x32x16_bf16 v[144:159], v[172:175], a[76:79], v[144:159]
v_cvt_pk_bf16_f32 v136, v72, v136
v_cvt_pk_bf16_f32 v137, v73, v137
v_cvt_pk_bf16_f32 v138, v74, v138
v_cvt_pk_bf16_f32 v139, v75, v139
v_mfma_f32_32x32x16_bf16 v[176:191], v[172:175], a[92:95], v[176:191]
buffer_load_dwordx4 v15, s[24:27], s51 offen offset:3072 sc1 lds
v_cvt_pk_bf16_f32 v140, v76, v140
v_cvt_pk_bf16_f32 v141, v77, v141
v_cvt_pk_bf16_f32 v142, v78, v142
v_cvt_pk_bf16_f32 v143, v79, v143
s_nop 1
v_pk_mul_f32 v[24:25], v[144:145], v[96:97]
v_pk_mul_f32 v[26:27], v[146:147], v[98:99]
v_pk_mul_f32 v[144:145], v[144:145], v[80:81]
v_pk_mul_f32 v[146:147], v[146:147], v[82:83]
s_nop 0
v_pk_fma_f32 v[144:145], v[176:177], v[96:97], v[144:145] neg_lo:[1,0,0] neg_hi:[1,0,0]
v_pk_fma_f32 v[146:147], v[178:179], v[98:99], v[146:147] neg_lo:[1,0,0] neg_hi:[1,0,0]
v_pk_fma_f32 v[176:177], v[176:177], v[80:81], v[24:25]
v_pk_fma_f32 v[178:179], v[178:179], v[82:83], v[26:27]
v_pk_mul_f32 v[24:25], v[148:149], v[100:101]
v_pk_mul_f32 v[26:27], v[150:151], v[102:103]
v_pk_mul_f32 v[148:149], v[148:149], v[84:85]
v_pk_mul_f32 v[150:151], v[150:151], v[86:87]
v_pk_fma_f32 v[148:149], v[180:181], v[100:101], v[148:149] neg_lo:[1,0,0] neg_hi:[1,0,0]
v_pk_fma_f32 v[150:151], v[182:183], v[102:103], v[150:151] neg_lo:[1,0,0] neg_hi:[1,0,0]
v_pk_fma_f32 v[180:181], v[180:181], v[84:85], v[24:25]
v_pk_fma_f32 v[182:183], v[182:183], v[86:87], v[26:27]
v_pk_mul_f32 v[24:25], v[152:153], v[104:105]
v_pk_mul_f32 v[26:27], v[154:155], v[106:107]
v_pk_mul_f32 v[152:153], v[152:153], v[88:89]
v_pk_mul_f32 v[154:155], v[154:155], v[90:91]
v_pk_fma_f32 v[152:153], v[184:185], v[104:105], v[152:153] neg_lo:[1,0,0] neg_hi:[1,0,0]
v_pk_fma_f32 v[154:155], v[186:187], v[106:107], v[154:155] neg_lo:[1,0,0] neg_hi:[1,0,0]
v_pk_fma_f32 v[184:185], v[184:185], v[88:89], v[24:25]
v_pk_fma_f32 v[186:187], v[186:187], v[90:91], v[26:27]
v_mfma_f32_32x32x16_bf16 v[64:79], a[96:99], v[128:131], 0
s_waitcnt lgkmcnt(0)
buffer_store_dwordx4 v[44:47], v13, s[24:27], s40 offen offset:1024 sc1
v_mul_f32 v24, v156, v108
v_mfma_f32_32x32x16_bf16 v[112:127], a[112:115], v[128:131], 0
v_mul_f32 v25, v157, v109
v_mul_f32 v156, v156, v92
v_mul_f32_e64 v157, v157, v93
v_fma_f32 v156, -v188, v108, v156
v_fma_f32 v157, -v189, v109, v157
v_mfma_f32_32x32x16_bf16 v[64:79], a[100:103], v[132:135], v[64:79]
v_fma_f32 v188, v188, v92, v24
v_fma_f32 v189, v189, v93, v25
v_mul_f32 v24, v158, v110
v_mul_f32 v25, v159, v111
v_mul_f32_e64 v158, v158, v94
v_mfma_f32_32x32x16_bf16 v[112:127], a[116:119], v[132:135], v[112:127]
v_mul_f32 v159, v159, v95
v_fma_f32 v158, -v190, v110, v158
v_fma_f32 v159, -v191, v111, v159
v_fma_f32 v190, v190, v94, v24
v_fma_f32 v191, v191, v95, v25
v_mfma_f32_32x32x16_bf16 v[64:79], a[104:107], v[136:139], v[64:79]
ds_read_b128 v[48:51], v10 offset:6144
v_cvt_pk_bf16_f32 v176, v144, v176
v_cvt_pk_bf16_f32 v177, v145, v177
v_cvt_pk_bf16_f32 v178, v146, v178
v_cvt_pk_bf16_f32 v179, v147, v179
v_mfma_f32_32x32x16_bf16 v[112:127], a[120:123], v[136:139], v[112:127]
v_cvt_pk_bf16_f32 v180, v148, v180
v_cvt_pk_bf16_f32 v181, v149, v181
v_cvt_pk_bf16_f32 v182, v150, v182
v_cvt_pk_bf16_f32 v183, v151, v183
v_cvt_pk_bf16_f32 v184, v152, v184
v_mfma_f32_32x32x16_bf16 v[64:79], a[108:111], v[140:143], v[64:79]
v_cvt_pk_bf16_f32 v185, v153, v185
v_cvt_pk_bf16_f32 v186, v154, v186
v_cvt_pk_bf16_f32 v187, v155, v187
v_cvt_pk_bf16_f32 v188, v156, v188
v_cvt_pk_bf16_f32 v189, v157, v189
v_mfma_f32_32x32x16_bf16 v[112:127], a[124:127], v[140:143], v[112:127]
v_cvt_pk_bf16_f32 v190, v158, v190
v_cvt_pk_bf16_f32 v191, v159, v191
v_mfma_f32_32x32x16_bf16 v[144:159], a[96:99], v[176:179], 0
s_waitcnt lgkmcnt(0)
buffer_store_dwordx4 v[48:51], v14, s[24:27], s40 offen offset:2048 sc1
ds_read_b128 v[52:55], v10 offset:7168
v_mfma_f32_32x32x16_bf16 v[160:175], a[112:115], v[176:179], 0
v_accvgpr_read_b32 v192, a130
v_accvgpr_read_b32 v193, a134
v_accvgpr_read_b32 v194, a138
v_accvgpr_read_b32 v195, a142
v_accvgpr_read_b32 v196, a146
v_mfma_f32_32x32x16_bf16 v[144:159], a[100:103], v[180:183], v[144:159]
v_accvgpr_read_b32 v197, a150
v_accvgpr_read_b32 v198, a154
v_accvgpr_read_b32 v199, a158
ds_read_b128 v[128:131], v4 offset:0
ds_read_b128 v[132:135], v4 offset:256
v_mfma_f32_32x32x16_bf16 v[160:175], a[116:119], v[180:183], v[160:175]
ds_read_b128 v[136:139], v4 offset:512
ds_read_b128 v[140:143], v4 offset:768
v_accvgpr_read_b32 v200, a162
v_accvgpr_read_b32 v201, a166
v_accvgpr_read_b32 v202, a170
v_mfma_f32_32x32x16_bf16 v[144:159], a[104:107], v[184:187], v[144:159]
v_accvgpr_read_b32 v203, a174
v_cvt_pk_bf16_f32 v112, v64, v112
v_cvt_pk_bf16_f32 v113, v65, v113
v_cvt_pk_bf16_f32 v114, v66, v114
v_cvt_pk_bf16_f32 v115, v67, v115
v_mfma_f32_32x32x16_bf16 v[160:175], a[120:123], v[184:187], v[160:175]
ds_write_b128 v2, v[112:115] offset:32768
v_cvt_pk_bf16_f32 v116, v68, v116
v_mfma_f32_32x32x16_bf16 v[144:159], a[108:111], v[188:191], v[144:159]
v_cvt_pk_bf16_f32 v117, v69, v117
v_cvt_pk_bf16_f32 v118, v70, v118
v_cvt_pk_bf16_f32 v119, v71, v119
v_mfma_f32_32x32x16_bf16 v[160:175], a[124:127], v[188:191], v[160:175]
ds_write_b128 v2, v[116:119] offset:33024
v_cvt_pk_bf16_f32 v120, v72, v120
v_cvt_pk_bf16_f32 v121, v73, v121
v_cvt_pk_bf16_f32 v122, v74, v122
v_cvt_pk_bf16_f32 v123, v75, v123
ds_write_b128 v2, v[120:123] offset:33280
v_cvt_pk_bf16_f32 v124, v76, v124
v_cvt_pk_bf16_f32 v125, v77, v125
v_cvt_pk_bf16_f32 v126, v78, v126
v_cvt_pk_bf16_f32 v127, v79, v127
ds_write_b128 v2, v[124:127] offset:33536
s_waitcnt lgkmcnt(7)
v_mfma_f32_32x32x16_bf16 v[64:79], v[128:131], a[0:3], 0
buffer_store_dwordx4 v[52:55], v15, s[24:27], s40 offen offset:3072 sc1
v_accvgpr_read_b32 v204, a178
v_mfma_f32_32x32x16_bf16 v[112:127], v[128:131], a[16:19], 0
v_accvgpr_read_b32 v205, a182
v_accvgpr_read_b32 v206, a186
v_accvgpr_read_b32 v207, a190
v_accvgpr_read_b32 v208, a194
v_accvgpr_read_b32 v209, a198
s_waitcnt lgkmcnt(6)
v_mfma_f32_32x32x16_bf16 v[64:79], v[132:135], a[4:7], v[64:79]
v_accvgpr_read_b32 v210, a202
v_accvgpr_read_b32 v211, a206
ds_read_b128 v[176:179], v5 offset:0
ds_read_b128 v[180:183], v5 offset:256
ds_read_b128 v[184:187], v5 offset:512
v_mfma_f32_32x32x16_bf16 v[112:127], v[132:135], a[20:23], v[112:127]
ds_read_b128 v[188:191], v5 offset:768
v_accvgpr_read_b32 v212, a210
v_accvgpr_read_b32 v213, a214
v_accvgpr_read_b32 v214, a218
v_accvgpr_read_b32 v215, a222
s_waitcnt lgkmcnt(9)
v_mfma_f32_32x32x16_bf16 v[64:79], v[136:139], a[8:11], v[64:79]
v_cvt_pk_bf16_f32 v160, v144, v160
v_cvt_pk_bf16_f32 v161, v145, v161
v_cvt_pk_bf16_f32 v162, v146, v162
v_cvt_pk_bf16_f32 v163, v147, v163
v_mfma_f32_32x32x16_bf16 v[112:127], v[136:139], a[24:27], v[112:127]
ds_write_b128 v3, v[160:163] offset:32768
v_cvt_pk_bf16_f32 v164, v148, v164
s_waitcnt lgkmcnt(9)
v_mfma_f32_32x32x16_bf16 v[64:79], v[140:143], a[12:15], v[64:79]
v_cvt_pk_bf16_f32 v165, v149, v165
v_cvt_pk_bf16_f32 v166, v150, v166
v_cvt_pk_bf16_f32 v167, v151, v167
v_mfma_f32_32x32x16_bf16 v[112:127], v[140:143], a[28:31], v[112:127]
ds_write_b128 v3, v[164:167] offset:33024
v_cvt_pk_bf16_f32 v168, v152, v168
v_cvt_pk_bf16_f32 v169, v153, v169
v_cvt_pk_bf16_f32 v170, v154, v170
v_cvt_pk_bf16_f32 v171, v155, v171
ds_write_b128 v3, v[168:171] offset:33280
v_cvt_pk_bf16_f32 v172, v156, v172
v_cvt_pk_bf16_f32 v173, v157, v173
v_cvt_pk_bf16_f32 v174, v158, v174
v_cvt_pk_bf16_f32 v175, v159, v175
ds_write_b128 v3, v[172:175] offset:33536
v_pk_mul_f32 v[24:25], v[64:65], v[96:97]
v_pk_mul_f32 v[26:27], v[66:67], v[98:99]
v_pk_mul_f32 v[64:65], v[64:65], v[80:81]
v_pk_mul_f32 v[66:67], v[66:67], v[82:83]
v_pk_fma_f32 v[64:65], v[112:113], v[96:97], v[64:65]
v_pk_fma_f32 v[66:67], v[114:115], v[98:99], v[66:67]
v_pk_fma_f32 v[112:113], v[112:113], v[80:81], v[24:25] neg_lo:[0,0,1] neg_hi:[0,0,1]
v_pk_fma_f32 v[114:115], v[114:115], v[82:83], v[26:27] neg_lo:[0,0,1] neg_hi:[0,0,1]
v_pk_mul_f32 v[24:25], v[68:69], v[100:101]
v_pk_mul_f32 v[26:27], v[70:71], v[102:103]
v_pk_mul_f32 v[68:69], v[68:69], v[84:85]
v_pk_mul_f32 v[70:71], v[70:71], v[86:87]
v_pk_fma_f32 v[68:69], v[116:117], v[100:101], v[68:69]
v_pk_fma_f32 v[70:71], v[118:119], v[102:103], v[70:71]
v_pk_fma_f32 v[116:117], v[116:117], v[84:85], v[24:25] neg_lo:[0,0,1] neg_hi:[0,0,1]
v_pk_fma_f32 v[118:119], v[118:119], v[86:87], v[26:27] neg_lo:[0,0,1] neg_hi:[0,0,1]
v_pk_mul_f32 v[24:25], v[72:73], v[104:105]
v_pk_mul_f32 v[26:27], v[74:75], v[106:107]
v_pk_mul_f32 v[72:73], v[72:73], v[88:89]
v_pk_mul_f32 v[74:75], v[74:75], v[90:91]
v_pk_fma_f32 v[72:73], v[120:121], v[104:105], v[72:73]
v_pk_fma_f32 v[74:75], v[122:123], v[106:107], v[74:75]
v_pk_fma_f32 v[120:121], v[120:121], v[88:89], v[24:25] neg_lo:[0,0,1] neg_hi:[0,0,1]
v_pk_fma_f32 v[122:123], v[122:123], v[90:91], v[26:27] neg_lo:[0,0,1] neg_hi:[0,0,1]
v_pk_mul_f32 v[24:25], v[76:77], v[108:109]
v_pk_mul_f32 v[26:27], v[78:79], v[110:111]
v_pk_mul_f32 v[76:77], v[76:77], v[92:93]
v_pk_mul_f32 v[78:79], v[78:79], v[94:95]
v_pk_fma_f32 v[76:77], v[124:125], v[108:109], v[76:77]
v_pk_fma_f32 v[78:79], v[126:127], v[110:111], v[78:79]
v_pk_fma_f32 v[124:125], v[124:125], v[92:93], v[24:25] neg_lo:[0,0,1] neg_hi:[0,0,1]
v_pk_fma_f32 v[126:127], v[126:127], v[94:95], v[26:27] neg_lo:[0,0,1] neg_hi:[0,0,1]
s_waitcnt lgkmcnt(7)
v_mfma_f32_32x32x16_bf16 v[144:159], v[176:179], a[0:3], 0
s_waitcnt lgkmcnt(0)
s_waitcnt vmcnt(3)
s_barrier
v_cvt_pk_bf16_f32 v112, v64, v112
v_lshlrev_b32_e64 v224, 16, v192
v_mfma_f32_32x32x16_bf16 v[160:175], v[176:179], a[16:19], 0
v_cvt_pk_bf16_f32 v113, v65, v113
v_lshlrev_b32_e64 v225, 16, v193
ds_read_b128 v[40:43], v10 offset:32768
v_cvt_pk_bf16_f32 v114, v66, v114
v_lshlrev_b32_e64 v226, 16, v194
v_mfma_f32_32x32x16_bf16 v[144:159], v[180:183], a[4:7], v[144:159]
ds_read_b128 v[44:47], v10 offset:33792
v_cvt_pk_bf16_f32 v115, v67, v115
v_lshlrev_b32_e64 v227, 16, v195
v_cvt_pk_bf16_f32 v116, v68, v116
v_lshlrev_b32_e64 v228, 16, v196
v_mfma_f32_32x32x16_bf16 v[160:175], v[180:183], a[20:23], v[160:175]
v_accvgpr_read_b32 v216, a226
v_cvt_pk_bf16_f32 v117, v69, v117
v_lshlrev_b32_e64 v229, 16, v197
v_accvgpr_read_b32 v217, a230
v_cvt_pk_bf16_f32 v118, v70, v118
v_mfma_f32_32x32x16_bf16 v[144:159], v[184:187], a[8:11], v[144:159]
v_lshlrev_b32_e64 v230, 16, v198
v_cvt_pk_bf16_f32 v119, v71, v119
v_lshlrev_b32_e64 v231, 16, v199
v_accvgpr_read_b32 v218, a234
v_cvt_pk_bf16_f32 v120, v72, v120
v_mfma_f32_32x32x16_bf16 v[160:175], v[184:187], a[24:27], v[160:175]
v_lshlrev_b32_e64 v232, 16, v200
v_accvgpr_read_b32 v219, a238
v_cvt_pk_bf16_f32 v121, v73, v121
v_lshlrev_b32_e64 v233, 16, v201
v_cvt_pk_bf16_f32 v122, v74, v122
v_mfma_f32_32x32x16_bf16 v[144:159], v[188:191], a[12:15], v[144:159]
v_lshlrev_b32_e64 v234, 16, v202
v_accvgpr_read_b32 v220, a242
v_cvt_pk_bf16_f32 v123, v75, v123
v_lshlrev_b32_e64 v235, 16, v203
v_accvgpr_read_b32 v221, a246
v_mfma_f32_32x32x16_bf16 v[160:175], v[188:191], a[28:31], v[160:175]
v_cvt_pk_bf16_f32 v124, v76, v124
v_lshlrev_b32_e64 v236, 16, v204
v_cvt_pk_bf16_f32 v125, v77, v125
v_lshlrev_b32_e64 v237, 16, v205
v_accvgpr_read_b32 v222, a250
v_cvt_pk_bf16_f32 v126, v78, v126
v_lshlrev_b32_e64 v238, 16, v206
v_accvgpr_read_b32 v223, a254
v_cvt_pk_bf16_f32 v127, v79, v127
v_lshlrev_b32_e64 v239, 16, v207
v_pk_mul_f32 v[24:25], v[144:145], v[96:97]
v_pk_mul_f32 v[26:27], v[146:147], v[98:99]
v_pk_mul_f32 v[144:145], v[144:145], v[80:81]
v_pk_mul_f32 v[146:147], v[146:147], v[82:83]
v_pk_fma_f32 v[144:145], v[160:161], v[96:97], v[144:145]
v_pk_fma_f32 v[146:147], v[162:163], v[98:99], v[146:147]
v_pk_fma_f32 v[160:161], v[160:161], v[80:81], v[24:25] neg_lo:[0,0,1] neg_hi:[0,0,1]
v_pk_fma_f32 v[162:163], v[162:163], v[82:83], v[26:27] neg_lo:[0,0,1] neg_hi:[0,0,1]
v_pk_mul_f32 v[24:25], v[148:149], v[100:101]
v_pk_mul_f32 v[26:27], v[150:151], v[102:103]
v_pk_mul_f32 v[148:149], v[148:149], v[84:85]
v_pk_mul_f32 v[150:151], v[150:151], v[86:87]
v_pk_fma_f32 v[148:149], v[164:165], v[100:101], v[148:149]
v_pk_fma_f32 v[150:151], v[166:167], v[102:103], v[150:151]
v_pk_fma_f32 v[164:165], v[164:165], v[84:85], v[24:25] neg_lo:[0,0,1] neg_hi:[0,0,1]
v_pk_fma_f32 v[166:167], v[166:167], v[86:87], v[26:27] neg_lo:[0,0,1] neg_hi:[0,0,1]
v_pk_mul_f32 v[24:25], v[152:153], v[104:105]
v_pk_mul_f32 v[26:27], v[154:155], v[106:107]
v_pk_mul_f32 v[152:153], v[152:153], v[88:89]
v_pk_mul_f32 v[154:155], v[154:155], v[90:91]
v_pk_fma_f32 v[152:153], v[168:169], v[104:105], v[152:153]
v_pk_fma_f32 v[154:155], v[170:171], v[106:107], v[154:155]
v_pk_fma_f32 v[168:169], v[168:169], v[88:89], v[24:25] neg_lo:[0,0,1] neg_hi:[0,0,1]
v_pk_fma_f32 v[170:171], v[170:171], v[90:91], v[26:27] neg_lo:[0,0,1] neg_hi:[0,0,1]
v_pk_mul_f32 v[24:25], v[156:157], v[108:109]
v_pk_mul_f32 v[26:27], v[158:159], v[110:111]
v_pk_mul_f32 v[156:157], v[156:157], v[92:93]
v_pk_mul_f32 v[158:159], v[158:159], v[94:95]
v_pk_fma_f32 v[156:157], v[172:173], v[108:109], v[156:157]
v_pk_fma_f32 v[158:159], v[174:175], v[110:111], v[158:159]
v_pk_fma_f32 v[172:173], v[172:173], v[92:93], v[24:25] neg_lo:[0,0,1] neg_hi:[0,0,1]
v_pk_fma_f32 v[174:175], v[174:175], v[94:95], v[26:27] neg_lo:[0,0,1] neg_hi:[0,0,1]
v_mfma_f32_32x32x16_bf16 v[64:79], a[32:35], v[112:115], 0
s_add_u32 s40, s44, 2097280
s_waitcnt lgkmcnt(1)
buffer_store_dwordx4 v[40:43], v12, s[24:27], s40 offen offset:0 sc1
v_mfma_f32_32x32x16_bf16 v[128:143], a[48:51], v[112:115], 0
v_cvt_pk_bf16_f32 v160, v144, v160
v_lshlrev_b32 v240, 16, v208
v_cvt_pk_bf16_f32 v161, v145, v161
v_lshlrev_b32_e64 v241, 16, v209
v_cvt_pk_bf16_f32 v162, v146, v162
v_mfma_f32_32x32x16_bf16 v[64:79], a[36:39], v[116:119], v[64:79]
v_lshlrev_b32_e64 v242, 16, v210
v_cvt_pk_bf16_f32 v163, v147, v163
v_lshlrev_b32_e64 v243, 16, v211
v_cvt_pk_bf16_f32 v164, v148, v164
v_lshlrev_b32_e64 v244, 16, v212
v_mfma_f32_32x32x16_bf16 v[128:143], a[52:55], v[116:119], v[128:143]
v_cvt_pk_bf16_f32 v165, v149, v165
v_lshlrev_b32 v245, 16, v213
v_mfma_f32_32x32x16_bf16 v[64:79], a[40:43], v[120:123], v[64:79]
s_waitcnt lgkmcnt(0)
buffer_store_dwordx4 v[44:47], v13, s[24:27], s40 offen offset:1024 sc1
v_cvt_pk_bf16_f32 v166, v150, v166
v_mfma_f32_32x32x16_bf16 v[128:143], a[56:59], v[120:123], v[128:143]
v_lshlrev_b32_e64 v246, 16, v214
v_cvt_pk_bf16_f32 v167, v151, v167
v_lshlrev_b32_e64 v247, 16, v215
v_cvt_pk_bf16_f32 v168, v152, v168
v_lshlrev_b32_e64 v248, 16, v216
v_mfma_f32_32x32x16_bf16 v[64:79], a[44:47], v[124:127], v[64:79]
v_cvt_pk_bf16_f32 v169, v153, v169
v_lshlrev_b32_e64 v249, 16, v217
v_cvt_pk_bf16_f32 v170, v154, v170
v_lshlrev_b32_e64 v250, 16, v218
ds_read_b128 v[48:51], v10 offset:34816
v_mfma_f32_32x32x16_bf16 v[128:143], a[60:63], v[124:127], v[128:143]
v_cvt_pk_bf16_f32 v171, v155, v171
v_lshlrev_b32_e64 v251, 16, v219
v_cvt_pk_bf16_f32 v172, v156, v172
v_lshlrev_b32_e64 v252, 16, v220
v_cvt_pk_bf16_f32 v173, v157, v173
v_lshlrev_b32_e64 v253, 16, v221
v_cvt_pk_bf16_f32 v174, v158, v174
v_lshlrev_b32_e64 v254, 16, v222
v_cvt_pk_bf16_f32 v175, v159, v175
v_lshlrev_b32 v255, 16, v223
v_pk_mul_f32 v[24:25], v[64:65], v[240:241]
v_pk_mul_f32 v[26:27], v[66:67], v[242:243]
v_pk_mul_f32 v[64:65], v[64:65], v[224:225]
v_pk_mul_f32 v[66:67], v[66:67], v[226:227]
v_pk_fma_f32 v[64:65], v[128:129], v[240:241], v[64:65] neg_lo:[1,0,0] neg_hi:[1,0,0]
v_pk_fma_f32 v[66:67], v[130:131], v[242:243], v[66:67] neg_lo:[1,0,0] neg_hi:[1,0,0]
v_pk_fma_f32 v[128:129], v[128:129], v[224:225], v[24:25]
v_pk_fma_f32 v[130:131], v[130:131], v[226:227], v[26:27]
v_pk_mul_f32 v[24:25], v[68:69], v[244:245]
v_pk_mul_f32 v[26:27], v[70:71], v[246:247]
v_pk_mul_f32 v[68:69], v[68:69], v[228:229]
v_pk_mul_f32 v[70:71], v[70:71], v[230:231]
v_pk_fma_f32 v[68:69], v[132:133], v[244:245], v[68:69] neg_lo:[1,0,0] neg_hi:[1,0,0]
v_pk_fma_f32 v[70:71], v[134:135], v[246:247], v[70:71] neg_lo:[1,0,0] neg_hi:[1,0,0]
v_pk_fma_f32 v[132:133], v[132:133], v[228:229], v[24:25]
v_pk_fma_f32 v[134:135], v[134:135], v[230:231], v[26:27]
v_pk_mul_f32 v[24:25], v[72:73], v[248:249]
v_pk_mul_f32 v[26:27], v[74:75], v[250:251]
v_pk_mul_f32 v[72:73], v[72:73], v[232:233]
v_pk_mul_f32 v[74:75], v[74:75], v[234:235]
v_pk_fma_f32 v[72:73], v[136:137], v[248:249], v[72:73] neg_lo:[1,0,0] neg_hi:[1,0,0]
v_pk_fma_f32 v[74:75], v[138:139], v[250:251], v[74:75] neg_lo:[1,0,0] neg_hi:[1,0,0]
v_pk_fma_f32 v[136:137], v[136:137], v[232:233], v[24:25]
v_pk_fma_f32 v[138:139], v[138:139], v[234:235], v[26:27]
v_pk_mul_f32 v[24:25], v[76:77], v[252:253]
v_pk_mul_f32 v[26:27], v[78:79], v[254:255]
v_pk_mul_f32 v[76:77], v[76:77], v[236:237]
v_pk_mul_f32 v[78:79], v[78:79], v[238:239]
v_pk_fma_f32 v[76:77], v[140:141], v[252:253], v[76:77] neg_lo:[1,0,0] neg_hi:[1,0,0]
v_pk_fma_f32 v[78:79], v[142:143], v[254:255], v[78:79] neg_lo:[1,0,0] neg_hi:[1,0,0]
v_pk_fma_f32 v[140:141], v[140:141], v[236:237], v[24:25]
v_pk_fma_f32 v[142:143], v[142:143], v[238:239], v[26:27]
v_mfma_f32_32x32x16_bf16 v[144:159], a[32:35], v[160:163], 0
s_waitcnt lgkmcnt(0)
buffer_store_dwordx4 v[48:51], v14, s[24:27], s40 offen offset:2048 sc1
v_cvt_pk_bf16_f32 v128, v64, v128
v_mfma_f32_32x32x16_bf16 v[176:191], a[48:51], v[160:163], 0
v_and_b32 v192, 0xffff0000, v192
v_and_b32 v193, 0xffff0000, v193
v_cvt_pk_bf16_f32 v129, v65, v129
v_and_b32 v194, 0xffff0000, v194
v_and_b32 v195, 0xffff0000, v195
v_mfma_f32_32x32x16_bf16 v[144:159], a[36:39], v[164:167], v[144:159]
v_cvt_pk_bf16_f32 v130, v66, v130
v_and_b32 v196, 0xffff0000, v196
v_and_b32 v197, 0xffff0000, v197
v_cvt_pk_bf16_f32 v131, v67, v131
v_and_b32 v198, 0xffff0000, v198
v_mfma_f32_32x32x16_bf16 v[176:191], a[52:55], v[164:167], v[176:191]
v_and_b32 v199, 0xffff0000, v199
v_cvt_pk_bf16_f32 v132, v68, v132
v_and_b32 v200, 0xffff0000, v200
v_and_b32 v201, 0xffff0000, v201
v_cvt_pk_bf16_f32 v133, v69, v133
v_mfma_f32_32x32x16_bf16 v[144:159], a[40:43], v[168:171], v[144:159]
v_and_b32 v202, 0xffff0000, v202
v_and_b32 v203, 0xffff0000, v203
v_cvt_pk_bf16_f32 v134, v70, v134
v_and_b32 v204, 0xffff0000, v204
v_and_b32 v205, 0xffff0000, v205
v_mfma_f32_32x32x16_bf16 v[176:191], a[56:59], v[168:171], v[176:191]
v_cvt_pk_bf16_f32 v135, v71, v135
v_and_b32 v206, 0xffff0000, v206
v_and_b32 v207, 0xffff0000, v207
ds_read_b128 v[52:55], v10 offset:35840
v_cvt_pk_bf16_f32 v136, v72, v136
v_mfma_f32_32x32x16_bf16 v[144:159], a[44:47], v[172:175], v[144:159]
v_and_b32 v208, 0xffff0000, v208
v_and_b32 v209, 0xffff0000, v209
v_cvt_pk_bf16_f32 v137, v73, v137
v_and_b32 v210, 0xffff0000, v210
v_and_b32 v211, 0xffff0000, v211
v_mfma_f32_32x32x16_bf16 v[176:191], a[60:63], v[172:175], v[176:191]
v_cvt_pk_bf16_f32 v138, v74, v138
v_and_b32 v212, 0xffff0000, v212
v_and_b32 v213, 0xffff0000, v213
v_cvt_pk_bf16_f32 v139, v75, v139
v_and_b32 v214, 0xffff0000, v214
v_and_b32 v215, 0xffff0000, v215
v_cvt_pk_bf16_f32 v140, v76, v140
v_and_b32 v216, 0xffff0000, v216
v_and_b32 v217, 0xffff0000, v217
v_cvt_pk_bf16_f32 v141, v77, v141
v_and_b32 v218, 0xffff0000, v218
v_and_b32 v219, 0xffff0000, v219
v_cvt_pk_bf16_f32 v142, v78, v142
v_and_b32 v220, 0xffff0000, v220
v_and_b32 v221, 0xffff0000, v221
v_cvt_pk_bf16_f32 v143, v79, v143
v_and_b32 v222, 0xffff0000, v222
v_and_b32 v223, 0xffff0000, v223
v_pk_mul_f32 v[24:25], v[144:145], v[208:209]
v_pk_mul_f32 v[26:27], v[146:147], v[210:211]
v_pk_mul_f32 v[144:145], v[144:145], v[192:193]
v_pk_mul_f32 v[146:147], v[146:147], v[194:195]
v_pk_fma_f32 v[144:145], v[176:177], v[208:209], v[144:145] neg_lo:[1,0,0] neg_hi:[1,0,0]
v_pk_fma_f32 v[146:147], v[178:179], v[210:211], v[146:147] neg_lo:[1,0,0] neg_hi:[1,0,0]
v_pk_fma_f32 v[176:177], v[176:177], v[192:193], v[24:25]
v_pk_fma_f32 v[178:179], v[178:179], v[194:195], v[26:27]
v_pk_mul_f32 v[24:25], v[148:149], v[212:213]
v_pk_mul_f32 v[26:27], v[150:151], v[214:215]
v_pk_mul_f32 v[148:149], v[148:149], v[196:197]
v_pk_mul_f32 v[150:151], v[150:151], v[198:199]
v_pk_fma_f32 v[148:149], v[180:181], v[212:213], v[148:149] neg_lo:[1,0,0] neg_hi:[1,0,0]
v_pk_fma_f32 v[150:151], v[182:183], v[214:215], v[150:151] neg_lo:[1,0,0] neg_hi:[1,0,0]
v_pk_fma_f32 v[180:181], v[180:181], v[196:197], v[24:25]
v_pk_fma_f32 v[182:183], v[182:183], v[198:199], v[26:27]
v_pk_mul_f32 v[24:25], v[152:153], v[216:217]
v_pk_mul_f32 v[26:27], v[154:155], v[218:219]
v_pk_mul_f32 v[152:153], v[152:153], v[200:201]
v_pk_mul_f32 v[154:155], v[154:155], v[202:203]
v_pk_fma_f32 v[152:153], v[184:185], v[216:217], v[152:153] neg_lo:[1,0,0] neg_hi:[1,0,0]
v_pk_fma_f32 v[154:155], v[186:187], v[218:219], v[154:155] neg_lo:[1,0,0] neg_hi:[1,0,0]
v_pk_fma_f32 v[184:185], v[184:185], v[200:201], v[24:25]
v_pk_fma_f32 v[186:187], v[186:187], v[202:203], v[26:27]
v_mfma_f32_32x32x16_bf16 v[64:79], v[128:131], a[64:67], 0
s_waitcnt lgkmcnt(0)
buffer_store_dwordx4 v[52:55], v15, s[24:27], s40 offen offset:3072 sc1
v_mul_f32 v24, v156, v220
v_mfma_f32_32x32x16_bf16 v[112:127], v[128:131], a[80:83], 0
v_mul_f32 v25, v157, v221
v_mul_f32 v156, v156, v204
v_mul_f32_e64 v157, v157, v205
v_fma_f32 v156, -v188, v220, v156
v_fma_f32 v157, -v189, v221, v157
v_mfma_f32_32x32x16_bf16 v[64:79], v[132:135], a[68:71], v[64:79]
v_fma_f32 v188, v188, v204, v24
v_fma_f32 v189, v189, v205, v25
v_mul_f32 v24, v158, v222
v_mul_f32 v25, v159, v223
v_mul_f32_e64 v158, v158, v206
v_mfma_f32_32x32x16_bf16 v[112:127], v[132:135], a[84:87], v[112:127]
v_mul_f32_e64 v159, v159, v207
v_fma_f32 v158, -v190, v222, v158
v_fma_f32 v159, -v191, v223, v159
v_fma_f32 v190, v190, v206, v24
v_fma_f32 v191, v191, v207, v25
v_mfma_f32_32x32x16_bf16 v[64:79], v[136:139], a[72:75], v[64:79]
ds_read_b128 v[40:43], v10 offset:36864
v_cvt_pk_bf16_f32 v176, v144, v176
v_cvt_pk_bf16_f32 v177, v145, v177
v_cvt_pk_bf16_f32 v178, v146, v178
v_cvt_pk_bf16_f32 v179, v147, v179
v_mfma_f32_32x32x16_bf16 v[112:127], v[136:139], a[88:91], v[112:127]
v_cvt_pk_bf16_f32 v180, v148, v180
v_cvt_pk_bf16_f32 v181, v149, v181
v_cvt_pk_bf16_f32 v182, v150, v182
v_cvt_pk_bf16_f32 v183, v151, v183
v_cvt_pk_bf16_f32 v184, v152, v184
v_mfma_f32_32x32x16_bf16 v[64:79], v[140:143], a[76:79], v[64:79]
v_cvt_pk_bf16_f32 v185, v153, v185
v_cvt_pk_bf16_f32 v186, v154, v186
v_cvt_pk_bf16_f32 v187, v155, v187
v_cvt_pk_bf16_f32 v188, v156, v188
v_cvt_pk_bf16_f32 v189, v157, v189
v_mfma_f32_32x32x16_bf16 v[112:127], v[140:143], a[92:95], v[112:127]
v_cvt_pk_bf16_f32 v190, v158, v190
v_cvt_pk_bf16_f32 v191, v159, v191
s_nop 3
v_pk_mul_f32 v[24:25], v[64:65], v[96:97]
v_pk_mul_f32 v[26:27], v[66:67], v[98:99]
v_pk_mul_f32 v[64:65], v[64:65], v[80:81]
v_pk_mul_f32 v[66:67], v[66:67], v[82:83]
s_nop 1
v_pk_fma_f32 v[64:65], v[112:113], v[96:97], v[64:65] neg_lo:[1,0,0] neg_hi:[1,0,0]
v_pk_fma_f32 v[66:67], v[114:115], v[98:99], v[66:67] neg_lo:[1,0,0] neg_hi:[1,0,0]
v_pk_fma_f32 v[112:113], v[112:113], v[80:81], v[24:25]
v_pk_fma_f32 v[114:115], v[114:115], v[82:83], v[26:27]
v_pk_mul_f32 v[24:25], v[68:69], v[100:101]
v_pk_mul_f32 v[26:27], v[70:71], v[102:103]
v_pk_mul_f32 v[68:69], v[68:69], v[84:85]
v_pk_mul_f32 v[70:71], v[70:71], v[86:87]
v_pk_fma_f32 v[68:69], v[116:117], v[100:101], v[68:69] neg_lo:[1,0,0] neg_hi:[1,0,0]
v_pk_fma_f32 v[70:71], v[118:119], v[102:103], v[70:71] neg_lo:[1,0,0] neg_hi:[1,0,0]
v_pk_fma_f32 v[116:117], v[116:117], v[84:85], v[24:25]
v_pk_fma_f32 v[118:119], v[118:119], v[86:87], v[26:27]
v_pk_mul_f32 v[24:25], v[72:73], v[104:105]
v_pk_mul_f32 v[26:27], v[74:75], v[106:107]
v_pk_mul_f32 v[72:73], v[72:73], v[88:89]
v_pk_mul_f32 v[74:75], v[74:75], v[90:91]
v_pk_fma_f32 v[72:73], v[120:121], v[104:105], v[72:73] neg_lo:[1,0,0] neg_hi:[1,0,0]
v_pk_fma_f32 v[74:75], v[122:123], v[106:107], v[74:75] neg_lo:[1,0,0] neg_hi:[1,0,0]
v_pk_fma_f32 v[120:121], v[120:121], v[88:89], v[24:25]
v_pk_fma_f32 v[122:123], v[122:123], v[90:91], v[26:27]
v_mfma_f32_32x32x16_bf16 v[144:159], v[176:179], a[64:67], 0
s_add_u32 s40, s44, 2113664
s_waitcnt lgkmcnt(0)
buffer_store_dwordx4 v[40:43], v12, s[24:27], s40 offen offset:0 sc1
v_mfma_f32_32x32x16_bf16 v[160:175], v[176:179], a[80:83], 0
v_mul_f32 v24, v76, v108
v_mul_f32 v25, v77, v109
v_mul_f32 v76, v76, v92
v_mul_f32_e64 v77, v77, v93
v_fma_f32 v76, -v124, v108, v76
v_mfma_f32_32x32x16_bf16 v[144:159], v[180:183], a[68:71], v[144:159]
v_fma_f32 v77, -v125, v109, v77
v_fma_f32 v124, v124, v92, v24
v_fma_f32 v125, v125, v93, v25
v_mul_f32 v24, v78, v110
v_mul_f32 v25, v79, v111
v_mfma_f32_32x32x16_bf16 v[160:175], v[180:183], a[84:87], v[160:175]
v_mul_f32 v78, v78, v94
v_mul_f32 v79, v79, v95
v_fma_f32 v78, -v126, v110, v78
v_fma_f32 v79, -v127, v111, v79
v_fma_f32 v126, v126, v94, v24
v_mfma_f32_32x32x16_bf16 v[144:159], v[184:187], a[72:75], v[144:159]
v_fma_f32 v127, v127, v95, v25
ds_read_b128 v[44:47], v10 offset:37888
v_cvt_pk_bf16_f32 v112, v64, v112
v_cvt_pk_bf16_f32 v113, v65, v113
v_cvt_pk_bf16_f32 v114, v66, v114
v_mfma_f32_32x32x16_bf16 v[160:175], v[184:187], a[88:91], v[160:175]
v_cvt_pk_bf16_f32 v115, v67, v115
v_cvt_pk_bf16_f32 v116, v68, v116
v_cvt_pk_bf16_f32 v117, v69, v117
v_cvt_pk_bf16_f32 v118, v70, v118
v_cvt_pk_bf16_f32 v119, v71, v119
v_mfma_f32_32x32x16_bf16 v[144:159], v[188:191], a[76:79], v[144:159]
v_cvt_pk_bf16_f32 v120, v72, v120
v_cvt_pk_bf16_f32 v121, v73, v121
v_cvt_pk_bf16_f32 v122, v74, v122
v_cvt_pk_bf16_f32 v123, v75, v123
v_cvt_pk_bf16_f32 v124, v76, v124
v_mfma_f32_32x32x16_bf16 v[160:175], v[188:191], a[92:95], v[160:175]
v_cvt_pk_bf16_f32 v125, v77, v125
v_cvt_pk_bf16_f32 v126, v78, v126
v_cvt_pk_bf16_f32 v127, v79, v127
s_nop 2
v_pk_mul_f32 v[24:25], v[144:145], v[96:97]
v_pk_mul_f32 v[26:27], v[146:147], v[98:99]
v_pk_mul_f32 v[144:145], v[144:145], v[80:81]
v_pk_mul_f32 v[146:147], v[146:147], v[82:83]
s_nop 1
v_pk_fma_f32 v[144:145], v[160:161], v[96:97], v[144:145] neg_lo:[1,0,0] neg_hi:[1,0,0]
v_pk_fma_f32 v[146:147], v[162:163], v[98:99], v[146:147] neg_lo:[1,0,0] neg_hi:[1,0,0]
v_pk_fma_f32 v[160:161], v[160:161], v[80:81], v[24:25]
v_pk_fma_f32 v[162:163], v[162:163], v[82:83], v[26:27]
v_pk_mul_f32 v[24:25], v[148:149], v[100:101]
v_pk_mul_f32 v[26:27], v[150:151], v[102:103]
v_pk_mul_f32 v[148:149], v[148:149], v[84:85]
v_pk_mul_f32 v[150:151], v[150:151], v[86:87]
v_pk_fma_f32 v[148:149], v[164:165], v[100:101], v[148:149] neg_lo:[1,0,0] neg_hi:[1,0,0]
v_pk_fma_f32 v[150:151], v[166:167], v[102:103], v[150:151] neg_lo:[1,0,0] neg_hi:[1,0,0]
v_pk_fma_f32 v[164:165], v[164:165], v[84:85], v[24:25]
v_pk_fma_f32 v[166:167], v[166:167], v[86:87], v[26:27]
v_pk_mul_f32 v[24:25], v[152:153], v[104:105]
v_pk_mul_f32 v[26:27], v[154:155], v[106:107]
v_pk_mul_f32 v[152:153], v[152:153], v[88:89]
v_pk_mul_f32 v[154:155], v[154:155], v[90:91]
v_pk_fma_f32 v[152:153], v[168:169], v[104:105], v[152:153] neg_lo:[1,0,0] neg_hi:[1,0,0]
v_pk_fma_f32 v[154:155], v[170:171], v[106:107], v[154:155] neg_lo:[1,0,0] neg_hi:[1,0,0]
v_pk_fma_f32 v[168:169], v[168:169], v[88:89], v[24:25]
v_pk_fma_f32 v[170:171], v[170:171], v[90:91], v[26:27]
v_mfma_f32_32x32x16_bf16 v[64:79], a[96:99], v[112:115], 0
s_waitcnt lgkmcnt(0)
buffer_store_dwordx4 v[44:47], v13, s[24:27], s40 offen offset:1024 sc1
v_mul_f32 v24, v156, v108
v_mfma_f32_32x32x16_bf16 v[128:143], a[112:115], v[112:115], 0
v_mul_f32 v25, v157, v109
v_mul_f32 v156, v156, v92
v_mul_f32_e64 v157, v157, v93
v_fma_f32 v156, -v172, v108, v156
v_fma_f32 v157, -v173, v109, v157
v_mfma_f32_32x32x16_bf16 v[64:79], a[100:103], v[116:119], v[64:79]
v_fma_f32 v172, v172, v92, v24
v_fma_f32 v173, v173, v93, v25
v_mul_f32 v24, v158, v110
v_mul_f32 v25, v159, v111
v_mul_f32_e64 v158, v158, v94
v_mfma_f32_32x32x16_bf16 v[128:143], a[116:119], v[116:119], v[128:143]
v_mul_f32_e64 v159, v159, v95
v_fma_f32 v158, -v174, v110, v158
v_fma_f32 v159, -v175, v111, v159
v_fma_f32 v174, v174, v94, v24
v_fma_f32 v175, v175, v95, v25
v_mfma_f32_32x32x16_bf16 v[64:79], a[104:107], v[120:123], v[64:79]
ds_read_b128 v[48:51], v10 offset:38912
v_cvt_pk_bf16_f32 v160, v144, v160
v_cvt_pk_bf16_f32 v161, v145, v161
v_cvt_pk_bf16_f32 v162, v146, v162
v_cvt_pk_bf16_f32 v163, v147, v163
v_mfma_f32_32x32x16_bf16 v[128:143], a[120:123], v[120:123], v[128:143]
v_cvt_pk_bf16_f32 v164, v148, v164
v_cvt_pk_bf16_f32 v165, v149, v165
v_cvt_pk_bf16_f32 v166, v150, v166
v_cvt_pk_bf16_f32 v167, v151, v167
v_cvt_pk_bf16_f32 v168, v152, v168
v_mfma_f32_32x32x16_bf16 v[64:79], a[108:111], v[124:127], v[64:79]
v_cvt_pk_bf16_f32 v169, v153, v169
v_cvt_pk_bf16_f32 v170, v154, v170
v_cvt_pk_bf16_f32 v171, v155, v171
v_cvt_pk_bf16_f32 v172, v156, v172
v_cvt_pk_bf16_f32 v173, v157, v173
v_mfma_f32_32x32x16_bf16 v[128:143], a[124:127], v[124:127], v[128:143]
v_cvt_pk_bf16_f32 v174, v158, v174
v_cvt_pk_bf16_f32 v175, v159, v175
v_mfma_f32_32x32x16_bf16 v[144:159], a[96:99], v[160:163], 0
s_waitcnt lgkmcnt(0)
buffer_store_dwordx4 v[48:51], v14, s[24:27], s40 offen offset:2048 sc1
ds_read_b128 v[52:55], v10 offset:39936
v_mfma_f32_32x32x16_bf16 v[176:191], a[112:115], v[160:163], 0
v_accvgpr_read_b32 v192, a131
v_accvgpr_read_b32 v193, a135
v_accvgpr_read_b32 v194, a139
v_accvgpr_read_b32 v195, a143
v_accvgpr_read_b32 v196, a147
v_mfma_f32_32x32x16_bf16 v[144:159], a[100:103], v[164:167], v[144:159]
v_accvgpr_read_b32 v197, a151
v_accvgpr_read_b32 v198, a155
v_accvgpr_read_b32 v199, a159
ds_read_b128 v[112:115], v4 offset:32768
ds_read_b128 v[116:119], v4 offset:33024
v_mfma_f32_32x32x16_bf16 v[176:191], a[116:119], v[164:167], v[176:191]
ds_read_b128 v[120:123], v4 offset:33280
ds_read_b128 v[124:127], v4 offset:33536
v_accvgpr_read_b32 v200, a163
v_accvgpr_read_b32 v201, a167
v_accvgpr_read_b32 v202, a171
v_mfma_f32_32x32x16_bf16 v[144:159], a[104:107], v[168:171], v[144:159]
v_accvgpr_read_b32 v203, a175
v_cvt_pk_bf16_f32 v128, v64, v128
v_cvt_pk_bf16_f32 v129, v65, v129
v_cvt_pk_bf16_f32 v130, v66, v130
v_cvt_pk_bf16_f32 v131, v67, v131
v_mfma_f32_32x32x16_bf16 v[176:191], a[120:123], v[168:171], v[176:191]
ds_write_b128 v4, v[128:131] offset:0
v_cvt_pk_bf16_f32 v132, v68, v132
v_mfma_f32_32x32x16_bf16 v[144:159], a[108:111], v[172:175], v[144:159]
v_cvt_pk_bf16_f32 v133, v69, v133
v_cvt_pk_bf16_f32 v134, v70, v134
v_cvt_pk_bf16_f32 v135, v71, v135
v_mfma_f32_32x32x16_bf16 v[176:191], a[124:127], v[172:175], v[176:191]
ds_write_b128 v4, v[132:135] offset:256
v_cvt_pk_bf16_f32 v136, v72, v136
v_cvt_pk_bf16_f32 v137, v73, v137
v_cvt_pk_bf16_f32 v138, v74, v138
v_cvt_pk_bf16_f32 v139, v75, v139
ds_write_b128 v4, v[136:139] offset:512
v_cvt_pk_bf16_f32 v140, v76, v140
v_cvt_pk_bf16_f32 v141, v77, v141
v_cvt_pk_bf16_f32 v142, v78, v142
v_cvt_pk_bf16_f32 v143, v79, v143
ds_write_b128 v4, v[140:143] offset:768
s_waitcnt lgkmcnt(7)
v_mfma_f32_32x32x16_bf16 v[64:79], v[112:115], a[0:3], 0
buffer_store_dwordx4 v[52:55], v15, s[24:27], s40 offen offset:3072 sc1
v_accvgpr_read_b32 v204, a179
v_mfma_f32_32x32x16_bf16 v[128:143], v[112:115], a[16:19], 0
v_accvgpr_read_b32 v205, a183
v_accvgpr_read_b32 v206, a187
v_accvgpr_read_b32 v207, a191
v_accvgpr_read_b32 v208, a195
v_accvgpr_read_b32 v209, a199
s_waitcnt lgkmcnt(6)
v_mfma_f32_32x32x16_bf16 v[64:79], v[116:119], a[4:7], v[64:79]
v_accvgpr_read_b32 v210, a203
v_accvgpr_read_b32 v211, a207
s_add_u32 m0, s47, 0x4000
s_mov_b32 s50, 0
v_mfma_f32_32x32x16_bf16 v[128:143], v[116:119], a[20:23], v[128:143]
buffer_load_dwordx4 v6, s[20:23], s50 offen offset:0 lds
ds_read_b128 v[160:163], v5 offset:32768
ds_read_b128 v[164:167], v5 offset:33024
ds_read_b128 v[168:171], v5 offset:33280
s_waitcnt lgkmcnt(8)
v_mfma_f32_32x32x16_bf16 v[64:79], v[120:123], a[8:11], v[64:79]
ds_read_b128 v[172:175], v5 offset:33536
v_accvgpr_read_b32 v212, a211
v_accvgpr_read_b32 v213, a215
v_accvgpr_read_b32 v214, a219
v_mfma_f32_32x32x16_bf16 v[128:143], v[120:123], a[24:27], v[128:143]
buffer_load_dwordx4 v7, s[20:23], s50 offen offset:1024 lds
v_accvgpr_read_b32 v215, a223
v_cvt_pk_bf16_f32 v176, v144, v176
v_cvt_pk_bf16_f32 v177, v145, v177
s_waitcnt lgkmcnt(8)
v_mfma_f32_32x32x16_bf16 v[64:79], v[124:127], a[12:15], v[64:79]
v_cvt_pk_bf16_f32 v178, v146, v178
v_cvt_pk_bf16_f32 v179, v147, v179
v_mfma_f32_32x32x16_bf16 v[128:143], v[124:127], a[28:31], v[128:143]
ds_write_b128 v5, v[176:179] offset:0
v_cvt_pk_bf16_f32 v180, v148, v180
buffer_load_dwordx4 v8, s[20:23], s50 offen offset:2048 lds
v_cvt_pk_bf16_f32 v181, v149, v181
v_cvt_pk_bf16_f32 v182, v150, v182
v_cvt_pk_bf16_f32 v183, v151, v183
ds_write_b128 v5, v[180:183] offset:256
v_cvt_pk_bf16_f32 v184, v152, v184
v_cvt_pk_bf16_f32 v185, v153, v185
v_cvt_pk_bf16_f32 v186, v154, v186
buffer_load_dwordx4 v9, s[20:23], s50 offen offset:3072 lds
v_cvt_pk_bf16_f32 v187, v155, v187
ds_write_b128 v5, v[184:187] offset:512
v_cvt_pk_bf16_f32 v188, v156, v188
v_cvt_pk_bf16_f32 v189, v157, v189
v_cvt_pk_bf16_f32 v190, v158, v190
v_cvt_pk_bf16_f32 v191, v159, v191
ds_write_b128 v5, v[188:191] offset:768
v_pk_mul_f32 v[24:25], v[64:65], v[96:97]
v_pk_mul_f32 v[26:27], v[66:67], v[98:99]
v_pk_mul_f32 v[64:65], v[64:65], v[80:81]
v_pk_mul_f32 v[66:67], v[66:67], v[82:83]
v_pk_fma_f32 v[64:65], v[128:129], v[96:97], v[64:65]
v_pk_fma_f32 v[66:67], v[130:131], v[98:99], v[66:67]
v_pk_fma_f32 v[128:129], v[128:129], v[80:81], v[24:25] neg_lo:[0,0,1] neg_hi:[0,0,1]
v_pk_fma_f32 v[130:131], v[130:131], v[82:83], v[26:27] neg_lo:[0,0,1] neg_hi:[0,0,1]
v_pk_mul_f32 v[24:25], v[68:69], v[100:101]
v_pk_mul_f32 v[26:27], v[70:71], v[102:103]
v_pk_mul_f32 v[68:69], v[68:69], v[84:85]
v_pk_mul_f32 v[70:71], v[70:71], v[86:87]
v_pk_fma_f32 v[68:69], v[132:133], v[100:101], v[68:69]
v_pk_fma_f32 v[70:71], v[134:135], v[102:103], v[70:71]
v_pk_fma_f32 v[132:133], v[132:133], v[84:85], v[24:25] neg_lo:[0,0,1] neg_hi:[0,0,1]
v_pk_fma_f32 v[134:135], v[134:135], v[86:87], v[26:27] neg_lo:[0,0,1] neg_hi:[0,0,1]
v_pk_mul_f32 v[24:25], v[72:73], v[104:105]
v_pk_mul_f32 v[26:27], v[74:75], v[106:107]
v_pk_mul_f32 v[72:73], v[72:73], v[88:89]
v_pk_mul_f32 v[74:75], v[74:75], v[90:91]
v_pk_fma_f32 v[72:73], v[136:137], v[104:105], v[72:73]
v_pk_fma_f32 v[74:75], v[138:139], v[106:107], v[74:75]
v_pk_fma_f32 v[136:137], v[136:137], v[88:89], v[24:25] neg_lo:[0,0,1] neg_hi:[0,0,1]
v_pk_fma_f32 v[138:139], v[138:139], v[90:91], v[26:27] neg_lo:[0,0,1] neg_hi:[0,0,1]
v_pk_mul_f32 v[24:25], v[76:77], v[108:109]
v_pk_mul_f32 v[26:27], v[78:79], v[110:111]
v_pk_mul_f32 v[76:77], v[76:77], v[92:93]
v_pk_mul_f32 v[78:79], v[78:79], v[94:95]
v_pk_fma_f32 v[76:77], v[140:141], v[108:109], v[76:77]
v_pk_fma_f32 v[78:79], v[142:143], v[110:111], v[78:79]
v_pk_fma_f32 v[140:141], v[140:141], v[92:93], v[24:25] neg_lo:[0,0,1] neg_hi:[0,0,1]
v_pk_fma_f32 v[142:143], v[142:143], v[94:95], v[26:27] neg_lo:[0,0,1] neg_hi:[0,0,1]
s_waitcnt lgkmcnt(7)
v_mfma_f32_32x32x16_bf16 v[144:159], v[160:163], a[0:3], 0
s_waitcnt lgkmcnt(0)
s_barrier
v_cvt_pk_bf16_f32 v128, v64, v128
v_lshlrev_b32 v224, 16, v192
v_mfma_f32_32x32x16_bf16 v[176:191], v[160:163], a[16:19], 0
v_cvt_pk_bf16_f32 v129, v65, v129
v_lshlrev_b32_e64 v225, 16, v193
ds_read_b128 v[40:43], v11 offset:0
v_cvt_pk_bf16_f32 v130, v66, v130
v_lshlrev_b32_e64 v226, 16, v194
v_mfma_f32_32x32x16_bf16 v[144:159], v[164:167], a[4:7], v[144:159]
ds_read_b128 v[44:47], v11 offset:1024
v_cvt_pk_bf16_f32 v131, v67, v131
v_lshlrev_b32_e64 v227, 16, v195
v_cvt_pk_bf16_f32 v132, v68, v132
v_lshlrev_b32_e64 v228, 16, v196
v_mfma_f32_32x32x16_bf16 v[176:191], v[164:167], a[20:23], v[176:191]
v_accvgpr_read_b32 v216, a227
v_cvt_pk_bf16_f32 v133, v69, v133
v_lshlrev_b32_e64 v229, 16, v197
v_accvgpr_read_b32 v217, a231
v_cvt_pk_bf16_f32 v134, v70, v134
v_mfma_f32_32x32x16_bf16 v[144:159], v[168:171], a[8:11], v[144:159]
v_lshlrev_b32_e64 v230, 16, v198
v_cvt_pk_bf16_f32 v135, v71, v135
v_lshlrev_b32_e64 v231, 16, v199
v_accvgpr_read_b32 v218, a235
v_cvt_pk_bf16_f32 v136, v72, v136
v_mfma_f32_32x32x16_bf16 v[176:191], v[168:171], a[24:27], v[176:191]
v_lshlrev_b32_e64 v232, 16, v200
v_accvgpr_read_b32 v219, a239
v_cvt_pk_bf16_f32 v137, v73, v137
v_lshlrev_b32_e64 v233, 16, v201
v_cvt_pk_bf16_f32 v138, v74, v138
v_mfma_f32_32x32x16_bf16 v[144:159], v[172:175], a[12:15], v[144:159]
v_lshlrev_b32_e64 v234, 16, v202
v_accvgpr_read_b32 v220, a243
v_cvt_pk_bf16_f32 v139, v75, v139
v_lshlrev_b32_e64 v235, 16, v203
v_accvgpr_read_b32 v221, a247
v_mfma_f32_32x32x16_bf16 v[176:191], v[172:175], a[28:31], v[176:191]
v_cvt_pk_bf16_f32 v140, v76, v140
v_lshlrev_b32_e64 v236, 16, v204
v_cvt_pk_bf16_f32 v141, v77, v141
v_lshlrev_b32_e64 v237, 16, v205
v_accvgpr_read_b32 v222, a251
v_cvt_pk_bf16_f32 v142, v78, v142
v_lshlrev_b32_e64 v238, 16, v206
v_accvgpr_read_b32 v223, a255
v_cvt_pk_bf16_f32 v143, v79, v143
v_lshlrev_b32_e64 v239, 16, v207
v_pk_mul_f32 v[24:25], v[144:145], v[96:97]
v_pk_mul_f32 v[26:27], v[146:147], v[98:99]
v_pk_mul_f32 v[144:145], v[144:145], v[80:81]
v_pk_mul_f32 v[146:147], v[146:147], v[82:83]
v_pk_fma_f32 v[144:145], v[176:177], v[96:97], v[144:145]
v_pk_fma_f32 v[146:147], v[178:179], v[98:99], v[146:147]
v_pk_fma_f32 v[176:177], v[176:177], v[80:81], v[24:25] neg_lo:[0,0,1] neg_hi:[0,0,1]
v_pk_fma_f32 v[178:179], v[178:179], v[82:83], v[26:27] neg_lo:[0,0,1] neg_hi:[0,0,1]
v_pk_mul_f32 v[24:25], v[148:149], v[100:101]
v_pk_mul_f32 v[26:27], v[150:151], v[102:103]
v_pk_mul_f32 v[148:149], v[148:149], v[84:85]
v_pk_mul_f32 v[150:151], v[150:151], v[86:87]
v_pk_fma_f32 v[148:149], v[180:181], v[100:101], v[148:149]
v_pk_fma_f32 v[150:151], v[182:183], v[102:103], v[150:151]
v_pk_fma_f32 v[180:181], v[180:181], v[84:85], v[24:25] neg_lo:[0,0,1] neg_hi:[0,0,1]
v_pk_fma_f32 v[182:183], v[182:183], v[86:87], v[26:27] neg_lo:[0,0,1] neg_hi:[0,0,1]
v_pk_mul_f32 v[24:25], v[152:153], v[104:105]
v_pk_mul_f32 v[26:27], v[154:155], v[106:107]
v_pk_mul_f32 v[152:153], v[152:153], v[88:89]
v_pk_mul_f32 v[154:155], v[154:155], v[90:91]
v_pk_fma_f32 v[152:153], v[184:185], v[104:105], v[152:153]
v_pk_fma_f32 v[154:155], v[186:187], v[106:107], v[154:155]
v_pk_fma_f32 v[184:185], v[184:185], v[88:89], v[24:25] neg_lo:[0,0,1] neg_hi:[0,0,1]
v_pk_fma_f32 v[186:187], v[186:187], v[90:91], v[26:27] neg_lo:[0,0,1] neg_hi:[0,0,1]
v_pk_mul_f32 v[24:25], v[156:157], v[108:109]
v_pk_mul_f32 v[26:27], v[158:159], v[110:111]
v_pk_mul_f32 v[156:157], v[156:157], v[92:93]
v_pk_mul_f32 v[158:159], v[158:159], v[94:95]
v_pk_fma_f32 v[156:157], v[188:189], v[108:109], v[156:157]
v_pk_fma_f32 v[158:159], v[190:191], v[110:111], v[158:159]
v_pk_fma_f32 v[188:189], v[188:189], v[92:93], v[24:25] neg_lo:[0,0,1] neg_hi:[0,0,1]
v_pk_fma_f32 v[190:191], v[190:191], v[94:95], v[26:27] neg_lo:[0,0,1] neg_hi:[0,0,1]
v_mfma_f32_32x32x16_bf16 v[64:79], a[32:35], v[128:131], 0
s_add_u32 s40, s44, 2097408
s_waitcnt lgkmcnt(1)
buffer_store_dwordx4 v[40:43], v12, s[24:27], s40 offen offset:0 sc1
v_mfma_f32_32x32x16_bf16 v[112:127], a[48:51], v[128:131], 0
v_cvt_pk_bf16_f32 v176, v144, v176
v_lshlrev_b32 v240, 16, v208
v_cvt_pk_bf16_f32 v177, v145, v177
v_lshlrev_b32_e64 v241, 16, v209
v_cvt_pk_bf16_f32 v178, v146, v178
v_mfma_f32_32x32x16_bf16 v[64:79], a[36:39], v[132:135], v[64:79]
v_lshlrev_b32_e64 v242, 16, v210
v_cvt_pk_bf16_f32 v179, v147, v179
v_lshlrev_b32_e64 v243, 16, v211
v_cvt_pk_bf16_f32 v180, v148, v180
v_lshlrev_b32_e64 v244, 16, v212
v_mfma_f32_32x32x16_bf16 v[112:127], a[52:55], v[132:135], v[112:127]
v_cvt_pk_bf16_f32 v181, v149, v181
v_lshlrev_b32 v245, 16, v213
v_mfma_f32_32x32x16_bf16 v[64:79], a[40:43], v[136:139], v[64:79]
s_waitcnt lgkmcnt(0)
buffer_store_dwordx4 v[44:47], v13, s[24:27], s40 offen offset:1024 sc1
v_cvt_pk_bf16_f32 v182, v150, v182
v_mfma_f32_32x32x16_bf16 v[112:127], a[56:59], v[136:139], v[112:127]
v_lshlrev_b32_e64 v246, 16, v214
v_cvt_pk_bf16_f32 v183, v151, v183
v_lshlrev_b32_e64 v247, 16, v215
v_cvt_pk_bf16_f32 v184, v152, v184
v_lshlrev_b32_e64 v248, 16, v216
v_mfma_f32_32x32x16_bf16 v[64:79], a[44:47], v[140:143], v[64:79]
v_cvt_pk_bf16_f32 v185, v153, v185
v_lshlrev_b32_e64 v249, 16, v217
v_cvt_pk_bf16_f32 v186, v154, v186
v_lshlrev_b32_e64 v250, 16, v218
ds_read_b128 v[48:51], v11 offset:2048
v_mfma_f32_32x32x16_bf16 v[112:127], a[60:63], v[140:143], v[112:127]
v_cvt_pk_bf16_f32 v187, v155, v187
v_lshlrev_b32_e64 v251, 16, v219
v_cvt_pk_bf16_f32 v188, v156, v188
v_lshlrev_b32_e64 v252, 16, v220
v_cvt_pk_bf16_f32 v189, v157, v189
v_lshlrev_b32_e64 v253, 16, v221
v_cvt_pk_bf16_f32 v190, v158, v190
v_lshlrev_b32_e64 v254, 16, v222
v_cvt_pk_bf16_f32 v191, v159, v191
v_lshlrev_b32 v255, 16, v223
v_pk_mul_f32 v[24:25], v[64:65], v[240:241]
v_pk_mul_f32 v[26:27], v[66:67], v[242:243]
v_pk_mul_f32 v[64:65], v[64:65], v[224:225]
v_pk_mul_f32 v[66:67], v[66:67], v[226:227]
v_pk_fma_f32 v[64:65], v[112:113], v[240:241], v[64:65] neg_lo:[1,0,0] neg_hi:[1,0,0]
v_pk_fma_f32 v[66:67], v[114:115], v[242:243], v[66:67] neg_lo:[1,0,0] neg_hi:[1,0,0]
v_pk_fma_f32 v[112:113], v[112:113], v[224:225], v[24:25]
v_pk_fma_f32 v[114:115], v[114:115], v[226:227], v[26:27]
v_pk_mul_f32 v[24:25], v[68:69], v[244:245]
v_pk_mul_f32 v[26:27], v[70:71], v[246:247]
v_pk_mul_f32 v[68:69], v[68:69], v[228:229]
v_pk_mul_f32 v[70:71], v[70:71], v[230:231]
v_pk_fma_f32 v[68:69], v[116:117], v[244:245], v[68:69] neg_lo:[1,0,0] neg_hi:[1,0,0]
v_pk_fma_f32 v[70:71], v[118:119], v[246:247], v[70:71] neg_lo:[1,0,0] neg_hi:[1,0,0]
v_pk_fma_f32 v[116:117], v[116:117], v[228:229], v[24:25]
v_pk_fma_f32 v[118:119], v[118:119], v[230:231], v[26:27]
v_pk_mul_f32 v[24:25], v[72:73], v[248:249]
v_pk_mul_f32 v[26:27], v[74:75], v[250:251]
v_pk_mul_f32 v[72:73], v[72:73], v[232:233]
v_pk_mul_f32 v[74:75], v[74:75], v[234:235]
v_pk_fma_f32 v[72:73], v[120:121], v[248:249], v[72:73] neg_lo:[1,0,0] neg_hi:[1,0,0]
v_pk_fma_f32 v[74:75], v[122:123], v[250:251], v[74:75] neg_lo:[1,0,0] neg_hi:[1,0,0]
v_pk_fma_f32 v[120:121], v[120:121], v[232:233], v[24:25]
v_pk_fma_f32 v[122:123], v[122:123], v[234:235], v[26:27]
v_pk_mul_f32 v[24:25], v[76:77], v[252:253]
v_pk_mul_f32 v[26:27], v[78:79], v[254:255]
v_pk_mul_f32 v[76:77], v[76:77], v[236:237]
v_pk_mul_f32 v[78:79], v[78:79], v[238:239]
v_pk_fma_f32 v[76:77], v[124:125], v[252:253], v[76:77] neg_lo:[1,0,0] neg_hi:[1,0,0]
v_pk_fma_f32 v[78:79], v[126:127], v[254:255], v[78:79] neg_lo:[1,0,0] neg_hi:[1,0,0]
v_pk_fma_f32 v[124:125], v[124:125], v[236:237], v[24:25]
v_pk_fma_f32 v[126:127], v[126:127], v[238:239], v[26:27]
v_mfma_f32_32x32x16_bf16 v[144:159], a[32:35], v[176:179], 0
s_waitcnt lgkmcnt(0)
buffer_store_dwordx4 v[48:51], v14, s[24:27], s40 offen offset:2048 sc1
v_cvt_pk_bf16_f32 v112, v64, v112
v_mfma_f32_32x32x16_bf16 v[160:175], a[48:51], v[176:179], 0
v_and_b32 v192, 0xffff0000, v192
v_and_b32 v193, 0xffff0000, v193
v_cvt_pk_bf16_f32 v113, v65, v113
v_and_b32 v194, 0xffff0000, v194
v_and_b32 v195, 0xffff0000, v195
v_mfma_f32_32x32x16_bf16 v[144:159], a[36:39], v[180:183], v[144:159]
v_cvt_pk_bf16_f32 v114, v66, v114
v_and_b32 v196, 0xffff0000, v196
v_and_b32 v197, 0xffff0000, v197
v_cvt_pk_bf16_f32 v115, v67, v115
v_and_b32 v198, 0xffff0000, v198
v_mfma_f32_32x32x16_bf16 v[160:175], a[52:55], v[180:183], v[160:175]
v_and_b32 v199, 0xffff0000, v199
v_cvt_pk_bf16_f32 v116, v68, v116
v_and_b32 v200, 0xffff0000, v200
v_and_b32 v201, 0xffff0000, v201
v_cvt_pk_bf16_f32 v117, v69, v117
v_mfma_f32_32x32x16_bf16 v[144:159], a[40:43], v[184:187], v[144:159]
v_and_b32 v202, 0xffff0000, v202
v_and_b32 v203, 0xffff0000, v203
v_cvt_pk_bf16_f32 v118, v70, v118
v_and_b32 v204, 0xffff0000, v204
v_and_b32 v205, 0xffff0000, v205
v_mfma_f32_32x32x16_bf16 v[160:175], a[56:59], v[184:187], v[160:175]
v_cvt_pk_bf16_f32 v119, v71, v119
v_and_b32 v206, 0xffff0000, v206
v_and_b32 v207, 0xffff0000, v207
ds_read_b128 v[52:55], v11 offset:3072
v_cvt_pk_bf16_f32 v120, v72, v120
v_mfma_f32_32x32x16_bf16 v[144:159], a[44:47], v[188:191], v[144:159]
v_and_b32 v208, 0xffff0000, v208
v_and_b32 v209, 0xffff0000, v209
v_cvt_pk_bf16_f32 v121, v73, v121
v_and_b32 v210, 0xffff0000, v210
v_and_b32 v211, 0xffff0000, v211
v_mfma_f32_32x32x16_bf16 v[160:175], a[60:63], v[188:191], v[160:175]
v_cvt_pk_bf16_f32 v122, v74, v122
v_and_b32 v212, 0xffff0000, v212
v_and_b32 v213, 0xffff0000, v213
v_cvt_pk_bf16_f32 v123, v75, v123
v_and_b32 v214, 0xffff0000, v214
v_and_b32 v215, 0xffff0000, v215
v_cvt_pk_bf16_f32 v124, v76, v124
v_and_b32 v216, 0xffff0000, v216
v_and_b32 v217, 0xffff0000, v217
v_cvt_pk_bf16_f32 v125, v77, v125
v_and_b32 v218, 0xffff0000, v218
v_and_b32 v219, 0xffff0000, v219
v_cvt_pk_bf16_f32 v126, v78, v126
v_and_b32 v220, 0xffff0000, v220
v_and_b32 v221, 0xffff0000, v221
v_cvt_pk_bf16_f32 v127, v79, v127
v_and_b32 v222, 0xffff0000, v222
v_and_b32 v223, 0xffff0000, v223
v_pk_mul_f32 v[24:25], v[144:145], v[208:209]
v_pk_mul_f32 v[26:27], v[146:147], v[210:211]
v_pk_mul_f32 v[144:145], v[144:145], v[192:193]
v_pk_mul_f32 v[146:147], v[146:147], v[194:195]
v_pk_fma_f32 v[144:145], v[160:161], v[208:209], v[144:145] neg_lo:[1,0,0] neg_hi:[1,0,0]
v_pk_fma_f32 v[146:147], v[162:163], v[210:211], v[146:147] neg_lo:[1,0,0] neg_hi:[1,0,0]
v_pk_fma_f32 v[160:161], v[160:161], v[192:193], v[24:25]
v_pk_fma_f32 v[162:163], v[162:163], v[194:195], v[26:27]
v_pk_mul_f32 v[24:25], v[148:149], v[212:213]
v_pk_mul_f32 v[26:27], v[150:151], v[214:215]
v_pk_mul_f32 v[148:149], v[148:149], v[196:197]
v_pk_mul_f32 v[150:151], v[150:151], v[198:199]
v_pk_fma_f32 v[148:149], v[164:165], v[212:213], v[148:149] neg_lo:[1,0,0] neg_hi:[1,0,0]
v_pk_fma_f32 v[150:151], v[166:167], v[214:215], v[150:151] neg_lo:[1,0,0] neg_hi:[1,0,0]
v_pk_fma_f32 v[164:165], v[164:165], v[196:197], v[24:25]
v_pk_fma_f32 v[166:167], v[166:167], v[198:199], v[26:27]
v_pk_mul_f32 v[24:25], v[152:153], v[216:217]
v_pk_mul_f32 v[26:27], v[154:155], v[218:219]
v_pk_mul_f32 v[152:153], v[152:153], v[200:201]
v_pk_mul_f32 v[154:155], v[154:155], v[202:203]
v_pk_fma_f32 v[152:153], v[168:169], v[216:217], v[152:153] neg_lo:[1,0,0] neg_hi:[1,0,0]
v_pk_fma_f32 v[154:155], v[170:171], v[218:219], v[154:155] neg_lo:[1,0,0] neg_hi:[1,0,0]
v_pk_fma_f32 v[168:169], v[168:169], v[200:201], v[24:25]
v_pk_fma_f32 v[170:171], v[170:171], v[202:203], v[26:27]
v_pk_mul_f32 v[24:25], v[156:157], v[220:221]
v_pk_mul_f32 v[156:157], v[156:157], v[204:205]
v_pk_fma_f32 v[156:157], v[172:173], v[220:221], v[156:157] neg_lo:[1,0,0] neg_hi:[1,0,0]
v_pk_fma_f32 v[172:173], v[172:173], v[204:205], v[24:25]
v_mfma_f32_32x32x16_bf16 v[64:79], v[112:115], a[64:67], 0
s_waitcnt lgkmcnt(0)
buffer_store_dwordx4 v[52:55], v15, s[24:27], s40 offen offset:3072 sc1
v_mul_f32 v24, v158, v222
v_mfma_f32_32x32x16_bf16 v[128:143], v[112:115], a[80:83], 0
v_mul_f32 v25, v159, v223
v_mul_f32 v158, v158, v206
v_mul_f32_e64 v159, v159, v207
ds_read_b128 v[40:43], v11 offset:4096
v_fma_f32 v158, -v174, v222, v158
v_mfma_f32_32x32x16_bf16 v[64:79], v[116:119], a[68:71], v[64:79]
v_fma_f32 v159, -v175, v223, v159
v_fma_f32 v174, v174, v206, v24
v_fma_f32 v175, v175, v207, v25
s_add_u32 m0, s47, 0xc000
s_mov_b32 s50, 131072
v_mfma_f32_32x32x16_bf16 v[128:143], v[116:119], a[84:87], v[128:143]
buffer_load_dwordx4 v6, s[20:23], s50 offen offset:0 lds
v_cvt_pk_bf16_f32 v160, v144, v160
v_cvt_pk_bf16_f32 v161, v145, v161
v_cvt_pk_bf16_f32 v162, v146, v162
v_mfma_f32_32x32x16_bf16 v[64:79], v[120:123], a[72:75], v[64:79]
v_cvt_pk_bf16_f32 v163, v147, v163
buffer_load_dwordx4 v7, s[20:23], s50 offen offset:1024 lds
v_cvt_pk_bf16_f32 v164, v148, v164
v_cvt_pk_bf16_f32 v165, v149, v165
v_mfma_f32_32x32x16_bf16 v[128:143], v[120:123], a[88:91], v[128:143]
v_cvt_pk_bf16_f32 v166, v150, v166
v_cvt_pk_bf16_f32 v167, v151, v167
buffer_load_dwordx4 v8, s[20:23], s50 offen offset:2048 lds
v_cvt_pk_bf16_f32 v168, v152, v168
v_mfma_f32_32x32x16_bf16 v[64:79], v[124:127], a[76:79], v[64:79]
v_cvt_pk_bf16_f32 v169, v153, v169
v_cvt_pk_bf16_f32 v170, v154, v170
v_cvt_pk_bf16_f32 v171, v155, v171
buffer_load_dwordx4 v9, s[20:23], s50 offen offset:3072 lds
v_mfma_f32_32x32x16_bf16 v[128:143], v[124:127], a[92:95], v[128:143]
v_cvt_pk_bf16_f32 v172, v156, v172
v_cvt_pk_bf16_f32 v173, v157, v173
v_cvt_pk_bf16_f32 v174, v158, v174
v_cvt_pk_bf16_f32 v175, v159, v175
s_nop 2
v_pk_mul_f32 v[24:25], v[64:65], v[96:97]
v_pk_mul_f32 v[26:27], v[66:67], v[98:99]
v_pk_mul_f32 v[64:65], v[64:65], v[80:81]
v_pk_mul_f32 v[66:67], v[66:67], v[82:83]
s_nop 0
v_pk_fma_f32 v[64:65], v[128:129], v[96:97], v[64:65] neg_lo:[1,0,0] neg_hi:[1,0,0]
v_pk_fma_f32 v[66:67], v[130:131], v[98:99], v[66:67] neg_lo:[1,0,0] neg_hi:[1,0,0]
v_pk_fma_f32 v[128:129], v[128:129], v[80:81], v[24:25]
v_pk_fma_f32 v[130:131], v[130:131], v[82:83], v[26:27]
v_pk_mul_f32 v[24:25], v[68:69], v[100:101]
v_pk_mul_f32 v[26:27], v[70:71], v[102:103]
v_pk_mul_f32 v[68:69], v[68:69], v[84:85]
v_pk_mul_f32 v[70:71], v[70:71], v[86:87]
v_pk_fma_f32 v[68:69], v[132:133], v[100:101], v[68:69] neg_lo:[1,0,0] neg_hi:[1,0,0]
v_pk_fma_f32 v[70:71], v[134:135], v[102:103], v[70:71] neg_lo:[1,0,0] neg_hi:[1,0,0]
v_pk_fma_f32 v[132:133], v[132:133], v[84:85], v[24:25]
v_pk_fma_f32 v[134:135], v[134:135], v[86:87], v[26:27]
v_pk_mul_f32 v[24:25], v[72:73], v[104:105]
v_pk_mul_f32 v[26:27], v[74:75], v[106:107]
v_pk_mul_f32 v[72:73], v[72:73], v[88:89]
v_pk_mul_f32 v[74:75], v[74:75], v[90:91]
v_pk_fma_f32 v[72:73], v[136:137], v[104:105], v[72:73] neg_lo:[1,0,0] neg_hi:[1,0,0]
v_pk_fma_f32 v[74:75], v[138:139], v[106:107], v[74:75] neg_lo:[1,0,0] neg_hi:[1,0,0]
v_pk_fma_f32 v[136:137], v[136:137], v[88:89], v[24:25]
v_pk_fma_f32 v[138:139], v[138:139], v[90:91], v[26:27]
v_mfma_f32_32x32x16_bf16 v[144:159], v[160:163], a[64:67], 0
s_add_u32 s40, s44, 2113792
s_waitcnt lgkmcnt(0)
buffer_store_dwordx4 v[40:43], v12, s[24:27], s40 offen offset:0 sc1
v_mfma_f32_32x32x16_bf16 v[176:191], v[160:163], a[80:83], 0
v_mul_f32 v24, v76, v108
v_mul_f32 v25, v77, v109
v_mul_f32 v76, v76, v92
v_mul_f32_e64 v77, v77, v93
v_fma_f32 v76, -v140, v108, v76
v_mfma_f32_32x32x16_bf16 v[144:159], v[164:167], a[68:71], v[144:159]
v_fma_f32 v77, -v141, v109, v77
v_fma_f32 v140, v140, v92, v24
v_fma_f32 v141, v141, v93, v25
v_mul_f32 v24, v78, v110
v_mul_f32 v25, v79, v111
v_mfma_f32_32x32x16_bf16 v[176:191], v[164:167], a[84:87], v[176:191]
v_mul_f32 v78, v78, v94
v_mul_f32 v79, v79, v95
v_fma_f32 v78, -v142, v110, v78
v_fma_f32 v79, -v143, v111, v79
v_fma_f32 v142, v142, v94, v24
v_mfma_f32_32x32x16_bf16 v[144:159], v[168:171], a[72:75], v[144:159]
v_fma_f32 v143, v143, v95, v25
ds_read_b128 v[44:47], v11 offset:5120
v_cvt_pk_bf16_f32 v128, v64, v128
v_cvt_pk_bf16_f32 v129, v65, v129
v_cvt_pk_bf16_f32 v130, v66, v130
v_mfma_f32_32x32x16_bf16 v[176:191], v[168:171], a[88:91], v[176:191]
v_cvt_pk_bf16_f32 v131, v67, v131
v_cvt_pk_bf16_f32 v132, v68, v132
v_cvt_pk_bf16_f32 v133, v69, v133
v_cvt_pk_bf16_f32 v134, v70, v134
v_cvt_pk_bf16_f32 v135, v71, v135
v_mfma_f32_32x32x16_bf16 v[144:159], v[172:175], a[76:79], v[144:159]
v_cvt_pk_bf16_f32 v136, v72, v136
v_cvt_pk_bf16_f32 v137, v73, v137
v_cvt_pk_bf16_f32 v138, v74, v138
v_cvt_pk_bf16_f32 v139, v75, v139
v_cvt_pk_bf16_f32 v140, v76, v140
v_mfma_f32_32x32x16_bf16 v[176:191], v[172:175], a[92:95], v[176:191]
v_cvt_pk_bf16_f32 v141, v77, v141
v_cvt_pk_bf16_f32 v142, v78, v142
v_cvt_pk_bf16_f32 v143, v79, v143
s_nop 2
v_pk_mul_f32 v[24:25], v[144:145], v[96:97]
v_pk_mul_f32 v[26:27], v[146:147], v[98:99]
v_pk_mul_f32 v[144:145], v[144:145], v[80:81]
v_pk_mul_f32 v[146:147], v[146:147], v[82:83]
s_nop 1
v_pk_fma_f32 v[144:145], v[176:177], v[96:97], v[144:145] neg_lo:[1,0,0] neg_hi:[1,0,0]
v_pk_fma_f32 v[146:147], v[178:179], v[98:99], v[146:147] neg_lo:[1,0,0] neg_hi:[1,0,0]
v_pk_fma_f32 v[176:177], v[176:177], v[80:81], v[24:25]
v_pk_fma_f32 v[178:179], v[178:179], v[82:83], v[26:27]
v_pk_mul_f32 v[24:25], v[148:149], v[100:101]
v_pk_mul_f32 v[26:27], v[150:151], v[102:103]
v_pk_mul_f32 v[148:149], v[148:149], v[84:85]
v_pk_mul_f32 v[150:151], v[150:151], v[86:87]
v_pk_fma_f32 v[148:149], v[180:181], v[100:101], v[148:149] neg_lo:[1,0,0] neg_hi:[1,0,0]
v_pk_fma_f32 v[150:151], v[182:183], v[102:103], v[150:151] neg_lo:[1,0,0] neg_hi:[1,0,0]
v_pk_fma_f32 v[180:181], v[180:181], v[84:85], v[24:25]
v_pk_fma_f32 v[182:183], v[182:183], v[86:87], v[26:27]
v_pk_mul_f32 v[24:25], v[152:153], v[104:105]
v_pk_mul_f32 v[26:27], v[154:155], v[106:107]
v_pk_mul_f32 v[152:153], v[152:153], v[88:89]
v_pk_mul_f32 v[154:155], v[154:155], v[90:91]
v_pk_fma_f32 v[152:153], v[184:185], v[104:105], v[152:153] neg_lo:[1,0,0] neg_hi:[1,0,0]
v_pk_fma_f32 v[154:155], v[186:187], v[106:107], v[154:155] neg_lo:[1,0,0] neg_hi:[1,0,0]
v_pk_fma_f32 v[184:185], v[184:185], v[88:89], v[24:25]
v_pk_fma_f32 v[186:187], v[186:187], v[90:91], v[26:27]
v_mfma_f32_32x32x16_bf16 v[64:79], a[96:99], v[128:131], 0
s_waitcnt lgkmcnt(0)
buffer_store_dwordx4 v[44:47], v13, s[24:27], s40 offen offset:1024 sc1
v_mul_f32 v24, v156, v108
v_mfma_f32_32x32x16_bf16 v[112:127], a[112:115], v[128:131], 0
v_mul_f32 v25, v157, v109
v_mul_f32 v156, v156, v92
v_mul_f32_e64 v157, v157, v93
v_fma_f32 v156, -v188, v108, v156
v_fma_f32 v157, -v189, v109, v157
v_mfma_f32_32x32x16_bf16 v[64:79], a[100:103], v[132:135], v[64:79]
v_fma_f32 v188, v188, v92, v24
v_fma_f32 v189, v189, v93, v25
v_mul_f32 v24, v158, v110
v_mul_f32 v25, v159, v111
v_mul_f32_e64 v158, v158, v94
v_mfma_f32_32x32x16_bf16 v[112:127], a[116:119], v[132:135], v[112:127]
v_mul_f32_e64 v159, v159, v95
v_fma_f32 v158, -v190, v110, v158
v_fma_f32 v159, -v191, v111, v159
v_fma_f32 v190, v190, v94, v24
v_fma_f32 v191, v191, v95, v25
v_mfma_f32_32x32x16_bf16 v[64:79], a[104:107], v[136:139], v[64:79]
ds_read_b128 v[48:51], v11 offset:6144
v_cvt_pk_bf16_f32 v176, v144, v176
v_cvt_pk_bf16_f32 v177, v145, v177
v_cvt_pk_bf16_f32 v178, v146, v178
v_cvt_pk_bf16_f32 v179, v147, v179
v_mfma_f32_32x32x16_bf16 v[112:127], a[120:123], v[136:139], v[112:127]
v_cvt_pk_bf16_f32 v180, v148, v180
v_cvt_pk_bf16_f32 v181, v149, v181
v_cvt_pk_bf16_f32 v182, v150, v182
v_cvt_pk_bf16_f32 v183, v151, v183
v_cvt_pk_bf16_f32 v184, v152, v184
v_mfma_f32_32x32x16_bf16 v[64:79], a[108:111], v[140:143], v[64:79]
v_cvt_pk_bf16_f32 v185, v153, v185
v_cvt_pk_bf16_f32 v186, v154, v186
v_cvt_pk_bf16_f32 v187, v155, v187
v_cvt_pk_bf16_f32 v188, v156, v188
v_cvt_pk_bf16_f32 v189, v157, v189
v_mfma_f32_32x32x16_bf16 v[112:127], a[124:127], v[140:143], v[112:127]
v_cvt_pk_bf16_f32 v190, v158, v190
v_cvt_pk_bf16_f32 v191, v159, v191
v_mfma_f32_32x32x16_bf16 v[144:159], a[96:99], v[176:179], 0
s_waitcnt lgkmcnt(0)
buffer_store_dwordx4 v[48:51], v14, s[24:27], s40 offen offset:2048 sc1
ds_read_b128 v[52:55], v11 offset:7168
v_mfma_f32_32x32x16_bf16 v[160:175], a[112:115], v[176:179], 0
s_nop 4
v_cvt_pk_bf16_f32 v112, v64, v112
v_cvt_pk_bf16_f32 v113, v65, v113
v_cvt_pk_bf16_f32 v114, v66, v114
v_cvt_pk_bf16_f32 v115, v67, v115
v_mfma_f32_32x32x16_bf16 v[144:159], a[100:103], v[180:183], v[144:159]
ds_write_b128 v4, v[112:115] offset:32768
v_cvt_pk_bf16_f32 v116, v68, v116
v_mfma_f32_32x32x16_bf16 v[160:175], a[116:119], v[180:183], v[160:175]
v_cvt_pk_bf16_f32 v117, v69, v117
v_cvt_pk_bf16_f32 v118, v70, v118
v_cvt_pk_bf16_f32 v119, v71, v119
v_mfma_f32_32x32x16_bf16 v[144:159], a[104:107], v[184:187], v[144:159]
ds_write_b128 v4, v[116:119] offset:33024
v_cvt_pk_bf16_f32 v120, v72, v120
v_mfma_f32_32x32x16_bf16 v[160:175], a[120:123], v[184:187], v[160:175]
v_cvt_pk_bf16_f32 v121, v73, v121
v_cvt_pk_bf16_f32 v122, v74, v122
v_cvt_pk_bf16_f32 v123, v75, v123
v_mfma_f32_32x32x16_bf16 v[144:159], a[108:111], v[188:191], v[144:159]
ds_write_b128 v4, v[120:123] offset:33280
v_cvt_pk_bf16_f32 v124, v76, v124
v_mfma_f32_32x32x16_bf16 v[160:175], a[124:127], v[188:191], v[160:175]
v_cvt_pk_bf16_f32 v125, v77, v125
v_cvt_pk_bf16_f32 v126, v78, v126
v_cvt_pk_bf16_f32 v127, v79, v127
ds_write_b128 v4, v[124:127] offset:33536
s_waitcnt lgkmcnt(4)
buffer_store_dwordx4 v[52:55], v15, s[24:27], s40 offen offset:3072 sc1
s_nop 5
v_cvt_pk_bf16_f32 v160, v144, v160
v_cvt_pk_bf16_f32 v161, v145, v161
v_cvt_pk_bf16_f32 v162, v146, v162
v_cvt_pk_bf16_f32 v163, v147, v163
ds_write_b128 v5, v[160:163] offset:32768
v_cvt_pk_bf16_f32 v164, v148, v164
v_cvt_pk_bf16_f32 v165, v149, v165
v_cvt_pk_bf16_f32 v166, v150, v166
v_cvt_pk_bf16_f32 v167, v151, v167
ds_write_b128 v5, v[164:167] offset:33024
v_cvt_pk_bf16_f32 v168, v152, v168
v_cvt_pk_bf16_f32 v169, v153, v169
v_cvt_pk_bf16_f32 v170, v154, v170
v_cvt_pk_bf16_f32 v171, v155, v171
ds_write_b128 v5, v[168:171] offset:33280
v_cvt_pk_bf16_f32 v172, v156, v172
v_cvt_pk_bf16_f32 v173, v157, v173
v_cvt_pk_bf16_f32 v174, v158, v174
v_cvt_pk_bf16_f32 v175, v159, v175
ds_write_b128 v5, v[172:175] offset:33536
s_waitcnt lgkmcnt(0)
s_barrier
ds_read_b128 v[224:227], v11 offset:32768
ds_read_b128 v[228:231], v11 offset:33792
ds_read_b128 v[232:235], v11 offset:34816
ds_read_b128 v[236:239], v11 offset:35840
ds_read_b128 v[240:243], v11 offset:36864
ds_read_b128 v[244:247], v11 offset:37888
ds_read_b128 v[248:251], v11 offset:38912
ds_read_b128 v[252:255], v11 offset:39936
s_add_u32 m0, s47, 0x14000
s_mov_b32 s50, 262144
buffer_load_dwordx4 v6, s[20:23], s50 offen offset:0 lds
buffer_load_dwordx4 v7, s[20:23], s50 offen offset:1024 lds
buffer_load_dwordx4 v8, s[20:23], s50 offen offset:2048 lds
buffer_load_dwordx4 v9, s[20:23], s50 offen offset:3072 lds
buffer_load_dword v23, v1, s[24:27], s59 offen offset:128 sc1
s_add_u32 s51, s44, 2097536
s_waitcnt lgkmcnt(7)
buffer_store_dwordx4 v[224:227], v12, s[24:27], s51 offen offset:0 sc1
s_waitcnt lgkmcnt(6)
buffer_store_dwordx4 v[228:231], v13, s[24:27], s51 offen offset:1024 sc1
s_waitcnt lgkmcnt(5)
buffer_store_dwordx4 v[232:235], v14, s[24:27], s51 offen offset:2048 sc1
s_waitcnt lgkmcnt(4)
buffer_store_dwordx4 v[236:239], v15, s[24:27], s51 offen offset:3072 sc1
s_add_u32 s51, s44, 2113920
s_waitcnt lgkmcnt(3)
buffer_store_dwordx4 v[240:243], v12, s[24:27], s51 offen offset:0 sc1
s_waitcnt lgkmcnt(2)
buffer_store_dwordx4 v[244:247], v13, s[24:27], s51 offen offset:1024 sc1
s_waitcnt lgkmcnt(1)
buffer_store_dwordx4 v[248:251], v14, s[24:27], s51 offen offset:2048 sc1
s_waitcnt lgkmcnt(0)
buffer_store_dwordx4 v[252:255], v15, s[24:27], s51 offen offset:3072 sc1
s_waitcnt vmcnt(8)
v_cmp_ne_u32 vcc, s53, v23
s_cbranch_vccnz L_spin13
L_back13:
s_barrier
s_add_u32 m0, s47, 0x0
s_mov_b32 s49, 0
buffer_load_dwordx4 v63, s[24:27], s49 offen offset:0 sc1 lds
buffer_load_dwordx4 v63, s[24:27], s49 offen offset:1024 sc1 lds
buffer_load_dwordx4 v63, s[24:27], s49 offen offset:2048 sc1 lds
buffer_load_dwordx4 v63, s[24:27], s49 offen offset:3072 sc1 lds
s_add_u32 m0, s47, 0x8000
s_mov_b32 s49, 4096
buffer_load_dwordx4 v63, s[24:27], s49 offen offset:0 sc1 lds
buffer_load_dwordx4 v63, s[24:27], s49 offen offset:1024 sc1 lds
buffer_load_dwordx4 v63, s[24:27], s49 offen offset:2048 sc1 lds
buffer_load_dwordx4 v63, s[24:27], s49 offen offset:3072 sc1 lds
s_waitcnt vmcnt(8)
buffer_store_dword v56, v57, s[24:27], s63 offen offset:384 sc1
s_waitcnt vmcnt(5)
s_barrier
ds_read_b64_tr_b16 a[0:1], v16 offset:0
ds_read_b64_tr_b16 a[2:3], v16 offset:4096
ds_read_b64_tr_b16 a[4:5], v17 offset:0
ds_read_b64_tr_b16 a[6:7], v17 offset:4096
ds_read_b128 v[64:67], v20 offset:0
ds_read_b128 v[68:71], v20 offset:1024
ds_read_b128 v[72:75], v20 offset:4096
ds_read_b128 v[76:79], v20 offset:5120
ds_read_b128 v[80:83], v20 offset:8192
ds_read_b128 v[84:87], v20 offset:9216
ds_read_b128 v[88:91], v20 offset:12288
ds_read_b128 v[92:95], v20 offset:13312
ds_read_b64_tr_b16 a[8:9], v16 offset:8192
ds_read_b64_tr_b16 a[10:11], v16 offset:12288
ds_read_b64_tr_b16 a[12:13], v17 offset:8192
ds_read_b64_tr_b16 a[14:15], v17 offset:12288
ds_read_b128 v[96:99], v20 offset:2048
ds_read_b128 v[100:103], v20 offset:3072
s_waitcnt lgkmcnt(13)
v_mfma_f32_16x16x32_bf16 v[128:131], a[0:3], v[64:67], 0
ds_read_b128 v[104:107], v20 offset:6144
s_add_u32 m0, s47, 0x10000
s_mov_b32 s49, 8192
v_mfma_f32_16x16x32_bf16 v[132:135], a[4:7], v[64:67], 0
buffer_load_dwordx4 v63, s[24:27], s49 offen offset:0 sc1 lds
s_waitcnt lgkmcnt(13)
v_mfma_f32_16x16x32_bf16 v[140:143], a[4:7], v[68:71], 0
buffer_load_dwordx4 v63, s[24:27], s49 offen offset:1024 sc1 lds
v_mfma_f32_16x16x32_bf16 v[136:139], a[0:3], v[68:71], 0
ds_read_b128 v[108:111], v20 offset:7168
s_waitcnt lgkmcnt(13)
v_mfma_f32_16x16x32_bf16 v[144:147], a[0:3], v[72:75], 0
buffer_load_dwordx4 v63, s[24:27], s49 offen offset:2048 sc1 lds
ds_read_b128 v[64:67], v20 offset:10240
v_mfma_f32_16x16x32_bf16 v[148:151], a[4:7], v[72:75], 0
v_add_u32 v2, 147456, v20
s_waitcnt lgkmcnt(3)
v_mfma_f32_16x16x32_bf16 v[156:159], a[4:7], v[76:79], 0
buffer_load_dwordx4 v63, s[24:27], s49 offen offset:3072 sc1 lds
ds_read_b128 v[68:71], v20 offset:11264
v_mfma_f32_16x16x32_bf16 v[152:155], a[0:3], v[76:79], 0
s_add_u32 m0, s47, 0x1c000
s_mov_b32 s50, 393216
ds_read_b128 a[240:243], v2 offset:8192
v_mfma_f32_16x16x32_bf16 v[160:163], a[0:3], v[80:83], 0
buffer_load_dwordx4 v6, s[20:23], s50 offen offset:0 lds
ds_read_b128 v[72:75], v20 offset:14336
v_mfma_f32_16x16x32_bf16 v[164:167], a[4:7], v[80:83], 0
ds_read_b128 a[244:247], v2 offset:9216
ds_read_b128 a[248:251], v2 offset:10240
v_mfma_f32_16x16x32_bf16 v[172:175], a[4:7], v[84:87], 0
buffer_load_dwordx4 v7, s[20:23], s50 offen offset:1024 lds
ds_read_b128 v[76:79], v20 offset:15360
v_mfma_f32_16x16x32_bf16 v[168:171], a[0:3], v[84:87], 0
ds_read_b128 a[252:255], v2 offset:11264
ds_read_b128 a[224:227], v2 offset:12288
v_mfma_f32_16x16x32_bf16 v[176:179], a[0:3], v[88:91], 0
buffer_load_dwordx4 v8, s[20:23], s50 offen offset:2048 lds
ds_read_b128 a[228:231], v2 offset:13312
v_mfma_f32_16x16x32_bf16 v[180:183], a[4:7], v[88:91], 0
ds_read_b128 a[232:235], v2 offset:14336
ds_read_b128 a[236:239], v2 offset:15360
v_mfma_f32_16x16x32_bf16 v[188:191], a[4:7], v[92:95], 0
buffer_load_dwordx4 v9, s[20:23], s50 offen offset:3072 lds
s_add_u32 m0, s47, 0x18000
v_mfma_f32_16x16x32_bf16 v[184:187], a[0:3], v[92:95], 0
s_mov_b32 s49, 12288
ds_read_b128 v[192:195], v2 offset:0
ds_read_b128 v[196:199], v2 offset:1024
v_mfma_f32_16x16x32_bf16 v[128:131], a[8:11], v[96:99], v[128:131]
buffer_load_dwordx4 v63, s[24:27], s49 offen offset:0 sc1 lds
ds_read_b128 v[200:203], v2 offset:2048
v_mfma_f32_16x16x32_bf16 v[132:135], a[12:15], v[96:99], v[132:135]
ds_read_b128 v[204:207], v2 offset:3072
ds_read_b128 v[208:211], v2 offset:4096
v_mfma_f32_16x16x32_bf16 v[140:143], a[12:15], v[100:103], v[140:143]
s_waitcnt vmcnt(10) lgkmcnt(0)
s_barrier
v_mfma_f32_16x16x32_bf16 v[136:139], a[8:11], v[100:103], v[136:139]
ds_read_b64_tr_b16 a[16:17], v16 offset:32768
ds_read_b64_tr_b16 a[18:19], v16 offset:36864
v_mfma_f32_16x16x32_bf16 v[144:147], a[8:11], v[104:107], v[144:147]
buffer_load_dwordx4 v63, s[24:27], s49 offen offset:1024 sc1 lds
ds_read_b64_tr_b16 a[20:21], v17 offset:32768
v_mfma_f32_16x16x32_bf16 v[148:151], a[12:15], v[104:107], v[148:151]
ds_read_b64_tr_b16 a[22:23], v17 offset:36864
ds_read_b128 v[212:215], v2 offset:5120
v_mfma_f32_16x16x32_bf16 v[156:159], a[12:15], v[108:111], v[156:159]
buffer_load_dwordx4 v63, s[24:27], s49 offen offset:2048 sc1 lds
ds_read_b128 v[80:83], v20 offset:32768
v_mfma_f32_16x16x32_bf16 v[152:155], a[8:11], v[108:111], v[152:155]
ds_read_b128 v[84:87], v20 offset:33792
ds_read_b128 v[216:219], v2 offset:6144
ds_read_b128 v[220:223], v2 offset:7168
v_mfma_f32_16x16x32_bf16 v[160:163], a[8:11], v[64:67], v[160:163]
buffer_load_dwordx4 v63, s[24:27], s49 offen offset:3072 sc1 lds
ds_read_b128 v[88:91], v20 offset:36864
v_mfma_f32_16x16x32_bf16 v[164:167], a[12:15], v[64:67], v[164:167]
ds_read_b128 v[92:95], v20 offset:37888
s_add_u32 m0, s47, 0x4000
v_mfma_f32_16x16x32_bf16 v[172:175], a[12:15], v[68:71], v[172:175]
ds_read_b128 v[96:99], v20 offset:40960
s_mov_b32 s50, 524288
v_min_u32 v4, 7, v0
v_mfma_f32_16x16x32_bf16 v[168:171], a[8:11], v[68:71], v[168:171]
buffer_load_dwordx4 v6, s[20:23], s50 offen offset:0 lds
ds_read_b128 v[100:103], v20 offset:41984
v_mfma_f32_16x16x32_bf16 v[176:179], a[8:11], v[72:75], v[176:179]
buffer_load_dwordx4 v7, s[20:23], s50 offen offset:1024 lds
v_mfma_f32_16x16x32_bf16 v[180:183], a[12:15], v[72:75], v[180:183]
ds_read_b128 v[104:107], v20 offset:45056
v_lshlrev_b32_e64 v4, 9, v4
v_mfma_f32_16x16x32_bf16 v[188:191], a[12:15], v[76:79], v[188:191]
buffer_load_dwordx4 v8, s[20:23], s50 offen offset:2048 lds
ds_read_b128 v[108:111], v20 offset:46080
v_mfma_f32_16x16x32_bf16 v[184:187], a[8:11], v[76:79], v[184:187]
ds_read_b64_tr_b16 a[24:25], v16 offset:40960
ds_read_b64_tr_b16 a[26:27], v16 offset:45056
s_waitcnt lgkmcnt(6)
v_mfma_f32_16x16x32_bf16 v[128:131], a[16:19], v[80:83], v[128:131]
buffer_load_dwordx4 v9, s[20:23], s50 offen offset:3072 lds
ds_read_b64_tr_b16 a[28:29], v17 offset:40960
v_mfma_f32_16x16x32_bf16 v[132:135], a[20:23], v[80:83], v[132:135]
ds_read_b64_tr_b16 a[30:31], v17 offset:45056
s_add_u32 m0, s47, 0x0
v_mfma_f32_16x16x32_bf16 v[140:143], a[20:23], v[84:87], v[140:143]
ds_read_b128 v[64:67], v20 offset:34816
s_mov_b32 s49, 16384
v_mfma_f32_16x16x32_bf16 v[136:139], a[16:19], v[84:87], v[136:139]
ds_read_b128 v[68:71], v20 offset:35840
v_mfma_f32_16x16x32_bf16 v[144:147], a[16:19], v[88:91], v[144:147]
buffer_load_dwordx4 v63, s[24:27], s49 offen offset:0 sc1 lds
ds_read_b128 v[72:75], v20 offset:38912
v_mfma_f32_16x16x32_bf16 v[148:151], a[20:23], v[88:91], v[148:151]
ds_read_b128 v[76:79], v20 offset:39936
v_mfma_f32_16x16x32_bf16 v[156:159], a[20:23], v[92:95], v[156:159]
ds_read_b128 v[80:83], v20 offset:43008
v_mfma_f32_16x16x32_bf16 v[152:155], a[16:19], v[92:95], v[152:155]
ds_read_b128 v[84:87], v20 offset:44032
s_waitcnt lgkmcnt(6)
v_mfma_f32_16x16x32_bf16 v[160:163], a[16:19], v[96:99], v[160:163]
buffer_load_dwordx4 v63, s[24:27], s49 offen offset:1024 sc1 lds
ds_read_b128 v[88:91], v20 offset:47104
v_mfma_f32_16x16x32_bf16 v[164:167], a[20:23], v[96:99], v[164:167]
v_mfma_f32_16x16x32_bf16 v[172:175], a[20:23], v[100:103], v[172:175]
ds_read_b128 v[92:95], v20 offset:48128
v_mfma_f32_16x16x32_bf16 v[168:171], a[16:19], v[100:103], v[168:171]
v_mfma_f32_16x16x32_bf16 v[176:179], a[16:19], v[104:107], v[176:179]
buffer_load_dwordx4 v63, s[24:27], s49 offen offset:2048 sc1 lds
v_mfma_f32_16x16x32_bf16 v[180:183], a[20:23], v[104:107], v[180:183]
v_mfma_f32_16x16x32_bf16 v[188:191], a[20:23], v[108:111], v[188:191]
v_mfma_f32_16x16x32_bf16 v[184:187], a[16:19], v[108:111], v[184:187]
s_waitcnt lgkmcnt(1)
v_mfma_f32_16x16x32_bf16 v[128:131], a[24:27], v[64:67], v[128:131]
buffer_load_dwordx4 v63, s[24:27], s49 offen offset:3072 sc1 lds
s_add_u32 m0, s47, 0xc000
v_mfma_f32_16x16x32_bf16 v[132:135], a[28:31], v[64:67], v[132:135]
s_mov_b32 s50, 655360
v_mfma_f32_16x16x32_bf16 v[140:143], a[28:31], v[68:71], v[140:143]
s_waitcnt vmcnt(16) lgkmcnt(0)
s_barrier
v_mfma_f32_16x16x32_bf16 v[136:139], a[24:27], v[68:71], v[136:139]
ds_read_b64_tr_b16 a[32:33], v18 offset:0
ds_read_b64_tr_b16 a[34:35], v18 offset:4096
v_mfma_f32_16x16x32_bf16 v[144:147], a[24:27], v[72:75], v[144:147]
buffer_load_dwordx4 v6, s[20:23], s50 offen offset:0 lds
ds_read_b64_tr_b16 a[36:37], v19 offset:0
v_mfma_f32_16x16x32_bf16 v[148:151], a[28:31], v[72:75], v[148:151]
ds_read_b64_tr_b16 a[38:39], v19 offset:4096
v_mfma_f32_16x16x32_bf16 v[156:159], a[28:31], v[76:79], v[156:159]
ds_read_b128 v[96:99], v21 offset:0
v_mfma_f32_16x16x32_bf16 v[152:155], a[24:27], v[76:79], v[152:155]
ds_read_b128 v[100:103], v21 offset:1024
v_mfma_f32_16x16x32_bf16 v[160:163], a[24:27], v[80:83], v[160:163]
buffer_load_dwordx4 v7, s[20:23], s50 offen offset:1024 lds
ds_read_b128 v[104:107], v21 offset:4096
v_mfma_f32_16x16x32_bf16 v[164:167], a[28:31], v[80:83], v[164:167]
ds_read_b128 v[108:111], v21 offset:5120
v_mfma_f32_16x16x32_bf16 v[172:175], a[28:31], v[84:87], v[172:175]
ds_read_b128 v[64:67], v21 offset:8192
v_mfma_f32_16x16x32_bf16 v[168:171], a[24:27], v[84:87], v[168:171]
ds_read_b128 v[68:71], v21 offset:9216
v_mfma_f32_16x16x32_bf16 v[176:179], a[24:27], v[88:91], v[176:179]
buffer_load_dwordx4 v8, s[20:23], s50 offen offset:2048 lds
ds_read_b128 v[72:75], v21 offset:12288
v_mfma_f32_16x16x32_bf16 v[180:183], a[28:31], v[88:91], v[180:183]
ds_read_b128 v[76:79], v21 offset:13312
v_mfma_f32_16x16x32_bf16 v[188:191], a[28:31], v[92:95], v[188:191]
ds_read_b64_tr_b16 a[40:41], v18 offset:8192
ds_read_b64_tr_b16 a[42:43], v18 offset:12288
v_mfma_f32_16x16x32_bf16 v[184:187], a[24:27], v[92:95], v[184:187]
ds_read_b64_tr_b16 a[44:45], v19 offset:8192
ds_read_b64_tr_b16 a[46:47], v19 offset:12288
s_waitcnt lgkmcnt(8)
v_mfma_f32_16x16x32_bf16 v[128:131], a[32:35], v[96:99], v[128:131]
buffer_load_dwordx4 v9, s[20:23], s50 offen offset:3072 lds
ds_read_b128 v[80:83], v21 offset:2048
v_mfma_f32_16x16x32_bf16 v[132:135], a[36:39], v[96:99], v[132:135]
ds_read_b128 v[84:87], v21 offset:3072
s_add_u32 m0, s47, 0x8000
v_mfma_f32_16x16x32_bf16 v[140:143], a[36:39], v[100:103], v[140:143]
ds_read_b128 v[88:91], v21 offset:6144
s_mov_b32 s49, 20480
v_mfma_f32_16x16x32_bf16 v[136:139], a[32:35], v[100:103], v[136:139]
ds_read_b128 v[92:95], v21 offset:7168
v_mfma_f32_16x16x32_bf16 v[144:147], a[32:35], v[104:107], v[144:147]
buffer_load_dwordx4 v63, s[24:27], s49 offen offset:0 sc1 lds
ds_read_b128 v[96:99], v21 offset:10240
v_mfma_f32_16x16x32_bf16 v[148:151], a[36:39], v[104:107], v[148:151]
v_mfma_f32_16x16x32_bf16 v[156:159], a[36:39], v[108:111], v[156:159]
ds_read_b128 v[100:103], v21 offset:11264
v_mfma_f32_16x16x32_bf16 v[152:155], a[32:35], v[108:111], v[152:155]
s_waitcnt lgkmcnt(4)
v_mfma_f32_16x16x32_bf16 v[160:163], a[32:35], v[64:67], v[160:163]
buffer_load_dwordx4 v63, s[24:27], s49 offen offset:1024 sc1 lds
ds_read_b128 v[104:107], v21 offset:14336
v_mfma_f32_16x16x32_bf16 v[164:167], a[36:39], v[64:67], v[164:167]
v_mfma_f32_16x16x32_bf16 v[172:175], a[36:39], v[68:71], v[172:175]
ds_read_b128 v[108:111], v21 offset:15360
v_mfma_f32_16x16x32_bf16 v[168:171], a[32:35], v[68:71], v[168:171]
v_mfma_f32_16x16x32_bf16 v[176:179], a[32:35], v[72:75], v[176:179]
buffer_load_dwordx4 v63, s[24:27], s49 offen offset:2048 sc1 lds
v_mfma_f32_16x16x32_bf16 v[180:183], a[36:39], v[72:75], v[180:183]
v_mfma_f32_16x16x32_bf16 v[188:191], a[36:39], v[76:79], v[188:191]
v_mfma_f32_16x16x32_bf16 v[184:187], a[32:35], v[76:79], v[184:187]
v_mfma_f32_16x16x32_bf16 v[128:131], a[40:43], v[80:83], v[128:131]
buffer_load_dwordx4 v63, s[24:27], s49 offen offset:3072 sc1 lds
s_add_u32 m0, s47, 0x14000
v_mfma_f32_16x16x32_bf16 v[132:135], a[44:47], v[80:83], v[132:135]
s_mov_b32 s50, 786432
v_mfma_f32_16x16x32_bf16 v[140:143], a[44:47], v[84:87], v[140:143]
s_waitcnt vmcnt(16) lgkmcnt(0)
s_barrier
v_mfma_f32_16x16x32_bf16 v[136:139], a[40:43], v[84:87], v[136:139]
ds_read_b64_tr_b16 a[48:49], v18 offset:32768
ds_read_b64_tr_b16 a[50:51], v18 offset:36864
v_mfma_f32_16x16x32_bf16 v[144:147], a[40:43], v[88:91], v[144:147]
buffer_load_dword v5, v4, s[24:27], s80 offen sc1
ds_read_b64_tr_b16 a[52:53], v19 offset:32768
v_mfma_f32_16x16x32_bf16 v[148:151], a[44:47], v[88:91], v[148:151]
ds_read_b64_tr_b16 a[54:55], v19 offset:36864
v_mfma_f32_16x16x32_bf16 v[156:159], a[44:47], v[92:95], v[156:159]
buffer_load_dwordx4 v6, s[20:23], s50 offen offset:0 lds
ds_read_b128 v[64:67], v21 offset:32768
v_mfma_f32_16x16x32_bf16 v[152:155], a[40:43], v[92:95], v[152:155]
ds_read_b128 v[68:71], v21 offset:33792
v_mfma_f32_16x16x32_bf16 v[160:163], a[40:43], v[96:99], v[160:163]
buffer_load_dwordx4 v7, s[20:23], s50 offen offset:1024 lds
ds_read_b128 v[72:75], v21 offset:36864
v_mfma_f32_16x16x32_bf16 v[164:167], a[44:47], v[96:99], v[164:167]
ds_read_b128 v[76:79], v21 offset:37888
v_mfma_f32_16x16x32_bf16 v[172:175], a[44:47], v[100:103], v[172:175]
ds_read_b128 v[80:83], v21 offset:40960
v_mfma_f32_16x16x32_bf16 v[168:171], a[40:43], v[100:103], v[168:171]
ds_read_b128 v[84:87], v21 offset:41984
v_mfma_f32_16x16x32_bf16 v[176:179], a[40:43], v[104:107], v[176:179]
buffer_load_dwordx4 v8, s[20:23], s50 offen offset:2048 lds
ds_read_b128 v[88:91], v21 offset:45056
v_mfma_f32_16x16x32_bf16 v[180:183], a[44:47], v[104:107], v[180:183]
ds_read_b128 v[92:95], v21 offset:46080
v_mfma_f32_16x16x32_bf16 v[188:191], a[44:47], v[108:111], v[188:191]
ds_read_b64_tr_b16 a[56:57], v18 offset:40960
ds_read_b64_tr_b16 a[58:59], v18 offset:45056
v_mfma_f32_16x16x32_bf16 v[184:187], a[40:43], v[108:111], v[184:187]
ds_read_b64_tr_b16 a[60:61], v19 offset:40960
ds_read_b64_tr_b16 a[62:63], v19 offset:45056
s_waitcnt lgkmcnt(8)
v_mfma_f32_16x16x32_bf16 v[128:131], a[48:51], v[64:67], v[128:131]
buffer_load_dwordx4 v9, s[20:23], s50 offen offset:3072 lds
ds_read_b128 v[96:99], v21 offset:34816
v_mfma_f32_16x16x32_bf16 v[132:135], a[52:55], v[64:67], v[132:135]
ds_read_b128 v[100:103], v21 offset:35840
s_add_u32 m0, s47, 0x10000
v_mfma_f32_16x16x32_bf16 v[140:143], a[52:55], v[68:71], v[140:143]
ds_read_b128 v[104:107], v21 offset:38912
s_mov_b32 s49, 24576
v_mfma_f32_16x16x32_bf16 v[136:139], a[48:51], v[68:71], v[136:139]
ds_read_b128 v[108:111], v21 offset:39936
v_mfma_f32_16x16x32_bf16 v[144:147], a[48:51], v[72:75], v[144:147]
buffer_load_dwordx4 v63, s[24:27], s49 offen offset:0 sc1 lds
ds_read_b128 v[64:67], v21 offset:43008
v_mfma_f32_16x16x32_bf16 v[148:151], a[52:55], v[72:75], v[148:151]
v_mfma_f32_16x16x32_bf16 v[156:159], a[52:55], v[76:79], v[156:159]
ds_read_b128 v[68:71], v21 offset:44032
v_mfma_f32_16x16x32_bf16 v[152:155], a[48:51], v[76:79], v[152:155]
s_waitcnt lgkmcnt(4)
v_mfma_f32_16x16x32_bf16 v[160:163], a[48:51], v[80:83], v[160:163]
buffer_load_dwordx4 v63, s[24:27], s49 offen offset:1024 sc1 lds
ds_read_b128 v[72:75], v21 offset:47104
v_mfma_f32_16x16x32_bf16 v[164:167], a[52:55], v[80:83], v[164:167]
v_mfma_f32_16x16x32_bf16 v[172:175], a[52:55], v[84:87], v[172:175]
ds_read_b128 v[76:79], v21 offset:48128
v_mfma_f32_16x16x32_bf16 v[168:171], a[48:51], v[84:87], v[168:171]
v_mfma_f32_16x16x32_bf16 v[176:179], a[48:51], v[88:91], v[176:179]
buffer_load_dwordx4 v63, s[24:27], s49 offen offset:2048 sc1 lds
v_mfma_f32_16x16x32_bf16 v[180:183], a[52:55], v[88:91], v[180:183]
v_mfma_f32_16x16x32_bf16 v[188:191], a[52:55], v[92:95], v[188:191]
v_mfma_f32_16x16x32_bf16 v[184:187], a[48:51], v[92:95], v[184:187]
v_mfma_f32_16x16x32_bf16 v[128:131], a[56:59], v[96:99], v[128:131]
buffer_load_dwordx4 v63, s[24:27], s49 offen offset:3072 sc1 lds
s_add_u32 m0, s47, 0x1c000
v_mfma_f32_16x16x32_bf16 v[132:135], a[60:63], v[96:99], v[132:135]
s_mov_b32 s50, 917504
v_mfma_f32_16x16x32_bf16 v[140:143], a[60:63], v[100:103], v[140:143]
s_waitcnt vmcnt(17) lgkmcnt(0)
s_barrier
v_mfma_f32_16x16x32_bf16 v[136:139], a[56:59], v[100:103], v[136:139]
ds_read_b64_tr_b16 a[64:65], v16 offset:0
ds_read_b64_tr_b16 a[66:67], v16 offset:4096
v_mfma_f32_16x16x32_bf16 v[144:147], a[56:59], v[104:107], v[144:147]
buffer_load_dwordx4 v6, s[20:23], s50 offen offset:0 lds
ds_read_b64_tr_b16 a[68:69], v17 offset:0
v_mfma_f32_16x16x32_bf16 v[148:151], a[60:63], v[104:107], v[148:151]
ds_read_b64_tr_b16 a[70:71], v17 offset:4096
v_mfma_f32_16x16x32_bf16 v[156:159], a[60:63], v[108:111], v[156:159]
ds_read_b128 v[80:83], v20 offset:0
v_mfma_f32_16x16x32_bf16 v[152:155], a[56:59], v[108:111], v[152:155]
ds_read_b128 v[84:87], v20 offset:1024
v_mfma_f32_16x16x32_bf16 v[160:163], a[56:59], v[64:67], v[160:163]
buffer_load_dwordx4 v7, s[20:23], s50 offen offset:1024 lds
ds_read_b128 v[88:91], v20 offset:4096
v_mfma_f32_16x16x32_bf16 v[164:167], a[60:63], v[64:67], v[164:167]
ds_read_b128 v[92:95], v20 offset:5120
v_mfma_f32_16x16x32_bf16 v[172:175], a[60:63], v[68:71], v[172:175]
ds_read_b128 v[96:99], v20 offset:8192
v_mfma_f32_16x16x32_bf16 v[168:171], a[56:59], v[68:71], v[168:171]
ds_read_b128 v[100:103], v20 offset:9216
v_mfma_f32_16x16x32_bf16 v[176:179], a[56:59], v[72:75], v[176:179]
buffer_load_dwordx4 v8, s[20:23], s50 offen offset:2048 lds
ds_read_b128 v[104:107], v20 offset:12288
v_mfma_f32_16x16x32_bf16 v[180:183], a[60:63], v[72:75], v[180:183]
ds_read_b128 v[108:111], v20 offset:13312
s_waitcnt vmcnt(11)
v_cmp_ne_u32 vcc, s53, v5
s_cbranch_vccnz L_spin14
L_back14:
v_mfma_f32_16x16x32_bf16 v[188:191], a[60:63], v[76:79], v[188:191]
ds_read_b64_tr_b16 a[72:73], v16 offset:8192
ds_read_b64_tr_b16 a[74:75], v16 offset:12288
v_mfma_f32_16x16x32_bf16 v[184:187], a[56:59], v[76:79], v[184:187]
buffer_load_dwordx4 v9, s[20:23], s50 offen offset:3072 lds
s_waitcnt lgkmcnt(6)
v_mfma_f32_16x16x32_bf16 v[128:131], a[64:67], v[80:83], v[128:131]
ds_read_b64_tr_b16 a[76:77], v17 offset:8192
ds_read_b64_tr_b16 a[78:79], v17 offset:12288
v_mfma_f32_16x16x32_bf16 v[132:135], a[68:71], v[80:83], v[132:135]
ds_read_b128 v[64:67], v20 offset:2048
s_add_u32 m0, s47, 0x18000
v_mfma_f32_16x16x32_bf16 v[140:143], a[68:71], v[84:87], v[140:143]
ds_read_b128 v[68:71], v20 offset:3072
s_mov_b32 s49, 28672
v_mfma_f32_16x16x32_bf16 v[136:139], a[64:67], v[84:87], v[136:139]
buffer_load_dwordx4 v63, s[24:27], s49 offen offset:0 sc1 lds
v_mfma_f32_16x16x32_bf16 v[144:147], a[64:67], v[88:91], v[144:147]
buffer_load_dwordx4 v63, s[24:27], s49 offen offset:1024 sc1 lds
v_mfma_f32_16x16x32_bf16 v[148:151], a[68:71], v[88:91], v[148:151]
ds_read_b128 v[72:75], v20 offset:6144
v_lshrrev_b32 v2, 4, v0
v_mfma_f32_16x16x32_bf16 v[156:159], a[68:71], v[92:95], v[156:159]
buffer_load_dwordx4 v63, s[24:27], s49 offen offset:2048 sc1 lds
ds_read_b128 v[76:79], v20 offset:7168
v_mfma_f32_16x16x32_bf16 v[152:155], a[64:67], v[92:95], v[152:155]
ds_read_b128 v[80:83], v20 offset:10240
v_lshl_add_u32 v2, s36, 2, v2
s_waitcnt lgkmcnt(4)
v_mfma_f32_16x16x32_bf16 v[160:163], a[64:67], v[96:99], v[160:163]
buffer_load_dwordx4 v63, s[24:27], s49 offen offset:3072 sc1 lds
ds_read_b128 v[84:87], v20 offset:11264
v_mfma_f32_16x16x32_bf16 v[164:167], a[68:71], v[96:99], v[164:167]
ds_read_b128 v[88:91], v20 offset:14336
s_add_u32 m0, s47, 147456
v_mfma_f32_16x16x32_bf16 v[172:175], a[68:71], v[100:103], v[172:175]
buffer_load_dwordx4 v62, s[24:27], s81 offen offset:0 sc1 lds
ds_read_b128 v[92:95], v20 offset:15360
v_mfma_f32_16x16x32_bf16 v[168:171], a[64:67], v[100:103], v[168:171]
s_add_u32 s81, s81, 261120
v_xor_b32_e64 v22, v2, v0
v_mfma_f32_16x16x32_bf16 v[176:179], a[64:67], v[104:107], v[176:179]
buffer_load_dwordx4 v62, s[24:27], s81 offen offset:1024 sc1 lds
s_add_u32 s81, s81, 261120
v_mfma_f32_16x16x32_bf16 v[180:183], a[68:71], v[104:107], v[180:183]
v_lshlrev_b32 v2, 11, v2
v_and_b32 v22, 15, v22
v_mfma_f32_16x16x32_bf16 v[188:191], a[68:71], v[108:111], v[188:191]
buffer_load_dwordx4 v62, s[24:27], s81 offen offset:2048 sc1 lds
s_add_u32 s81, s81, 261120
v_mfma_f32_16x16x32_bf16 v[184:187], a[64:67], v[108:111], v[184:187]
v_lshl_add_u32 v22, v22, 4, v2
v_mfma_f32_16x16x32_bf16 v[128:131], a[72:75], v[64:67], v[128:131]
buffer_load_dwordx4 v62, s[24:27], s81 offen offset:3072 sc1 lds
s_add_u32 m0, s47, 0x4000
v_mfma_f32_16x16x32_bf16 v[132:135], a[76:79], v[64:67], v[132:135]
s_mov_b32 s50, 1048576
s_waitcnt lgkmcnt(0)
v_mfma_f32_16x16x32_bf16 v[140:143], a[76:79], v[68:71], v[140:143]
s_barrier
v_mfma_f32_16x16x32_bf16 v[136:139], a[72:75], v[68:71], v[136:139]
ds_read_b64_tr_b16 a[80:81], v16 offset:32768
ds_read_b64_tr_b16 a[82:83], v16 offset:36864
v_mfma_f32_16x16x32_bf16 v[144:147], a[72:75], v[72:75], v[144:147]
buffer_load_dwordx4 v6, s[20:23], s50 offen offset:0 lds
ds_read_b64_tr_b16 a[84:85], v17 offset:32768
v_mfma_f32_16x16x32_bf16 v[148:151], a[76:79], v[72:75], v[148:151]
ds_read_b64_tr_b16 a[86:87], v17 offset:36864
v_mfma_f32_16x16x32_bf16 v[156:159], a[76:79], v[76:79], v[156:159]
buffer_load_dwordx4 v7, s[20:23], s50 offen offset:1024 lds
ds_read_b128 v[96:99], v20 offset:32768
v_mfma_f32_16x16x32_bf16 v[152:155], a[72:75], v[76:79], v[152:155]
ds_read_b128 v[100:103], v20 offset:33792
v_mfma_f32_16x16x32_bf16 v[160:163], a[72:75], v[80:83], v[160:163]
buffer_load_dwordx4 v8, s[20:23], s50 offen offset:2048 lds
ds_read_b128 v[104:107], v20 offset:36864
v_mfma_f32_16x16x32_bf16 v[164:167], a[76:79], v[80:83], v[164:167]
ds_read_b128 v[108:111], v20 offset:37888
v_mfma_f32_16x16x32_bf16 v[172:175], a[76:79], v[84:87], v[172:175]
buffer_load_dwordx4 v9, s[20:23], s50 offen offset:3072 lds
ds_read_b128 v[64:67], v20 offset:40960
v_mfma_f32_16x16x32_bf16 v[168:171], a[72:75], v[84:87], v[168:171]
ds_read_b128 v[68:71], v20 offset:41984
s_add_u32 m0, s47, 0x0
v_mfma_f32_16x16x32_bf16 v[176:179], a[72:75], v[88:91], v[176:179]
ds_read_b128 v[72:75], v20 offset:45056
s_mov_b32 s49, 32768
v_mfma_f32_16x16x32_bf16 v[180:183], a[76:79], v[88:91], v[180:183]
buffer_load_dwordx4 v63, s[24:27], s49 offen offset:0 sc1 lds
v_mfma_f32_16x16x32_bf16 v[188:191], a[76:79], v[92:95], v[188:191]
buffer_load_dwordx4 v63, s[24:27], s49 offen offset:1024 sc1 lds
ds_read_b128 v[76:79], v20 offset:46080
v_mfma_f32_16x16x32_bf16 v[184:187], a[72:75], v[92:95], v[184:187]
ds_read_b64_tr_b16 a[88:89], v16 offset:40960
ds_read_b64_tr_b16 a[90:91], v16 offset:45056
s_waitcnt lgkmcnt(6)
v_mfma_f32_16x16x32_bf16 v[128:131], a[80:83], v[96:99], v[128:131]
buffer_load_dwordx4 v63, s[24:27], s49 offen offset:2048 sc1 lds
ds_read_b64_tr_b16 a[92:93], v17 offset:40960
v_mfma_f32_16x16x32_bf16 v[132:135], a[84:87], v[96:99], v[132:135]
ds_read_b64_tr_b16 a[94:95], v17 offset:45056
v_mfma_f32_16x16x32_bf16 v[140:143], a[84:87], v[100:103], v[140:143]
buffer_load_dwordx4 v63, s[24:27], s49 offen offset:3072 sc1 lds
ds_read_b128 v[80:83], v20 offset:34816
v_mfma_f32_16x16x32_bf16 v[136:139], a[80:83], v[100:103], v[136:139]
ds_read_b128 v[84:87], v20 offset:35840
s_add_u32 m0, s47, 131072
v_mfma_f32_16x16x32_bf16 v[144:147], a[80:83], v[104:107], v[144:147]
buffer_load_dwordx4 v22, s[16:19], s74 offen offset:0 lds
ds_read_b128 v[88:91], v20 offset:38912
v_mfma_f32_16x16x32_bf16 v[148:151], a[84:87], v[104:107], v[148:151]
ds_read_b128 v[92:95], v20 offset:39936
s_add_u32 s74, s74, 31744
v_mfma_f32_16x16x32_bf16 v[156:159], a[84:87], v[108:111], v[156:159]
ds_read_b128 v[96:99], v20 offset:43008
v_mfma_f32_16x16x32_bf16 v[152:155], a[80:83], v[108:111], v[152:155]
ds_read_b128 v[100:103], v20 offset:44032
s_waitcnt lgkmcnt(6)
v_mfma_f32_16x16x32_bf16 v[160:163], a[80:83], v[64:67], v[160:163]
buffer_load_dwordx4 v22, s[16:19], s74 offen offset:1024 lds
ds_read_b128 v[104:107], v20 offset:47104
v_mfma_f32_16x16x32_bf16 v[164:167], a[84:87], v[64:67], v[164:167]
s_add_u32 s74, s74, 31744
v_mfma_f32_16x16x32_bf16 v[172:175], a[84:87], v[68:71], v[172:175]
ds_read_b128 v[108:111], v20 offset:48128
v_mfma_f32_16x16x32_bf16 v[168:171], a[80:83], v[68:71], v[168:171]
v_mfma_f32_16x16x32_bf16 v[176:179], a[80:83], v[72:75], v[176:179]
buffer_load_dwordx4 v22, s[16:19], s74 offen offset:2048 lds
s_add_u32 s74, s74, 31744
v_mfma_f32_16x16x32_bf16 v[180:183], a[84:87], v[72:75], v[180:183]
v_mfma_f32_16x16x32_bf16 v[188:191], a[84:87], v[76:79], v[188:191]
v_mfma_f32_16x16x32_bf16 v[184:187], a[80:83], v[76:79], v[184:187]
s_waitcnt lgkmcnt(1)
v_mfma_f32_16x16x32_bf16 v[128:131], a[88:91], v[80:83], v[128:131]
buffer_load_dwordx4 v22, s[16:19], s74 offen offset:3072 lds
s_add_u32 m0, s47, 0xc000
v_mfma_f32_16x16x32_bf16 v[132:135], a[92:95], v[80:83], v[132:135]
s_mov_b32 s50, 1179648
v_mfma_f32_16x16x32_bf16 v[140:143], a[92:95], v[84:87], v[140:143]
s_waitcnt vmcnt(24) lgkmcnt(0)
s_barrier
v_mfma_f32_16x16x32_bf16 v[136:139], a[88:91], v[84:87], v[136:139]
ds_read_b64_tr_b16 a[96:97], v18 offset:0
ds_read_b64_tr_b16 a[98:99], v18 offset:4096
v_mfma_f32_16x16x32_bf16 v[144:147], a[88:91], v[88:91], v[144:147]
buffer_load_dwordx4 v6, s[20:23], s50 offen offset:0 lds
ds_read_b64_tr_b16 a[100:101], v19 offset:0
v_mfma_f32_16x16x32_bf16 v[148:151], a[92:95], v[88:91], v[148:151]
ds_read_b64_tr_b16 a[102:103], v19 offset:4096
v_mfma_f32_16x16x32_bf16 v[156:159], a[92:95], v[92:95], v[156:159]
ds_read_b128 v[64:67], v21 offset:0
v_mfma_f32_16x16x32_bf16 v[152:155], a[88:91], v[92:95], v[152:155]
ds_read_b128 v[68:71], v21 offset:1024
v_mfma_f32_16x16x32_bf16 v[160:163], a[88:91], v[96:99], v[160:163]
buffer_load_dwordx4 v7, s[20:23], s50 offen offset:1024 lds
ds_read_b128 v[72:75], v21 offset:4096
v_mfma_f32_16x16x32_bf16 v[164:167], a[92:95], v[96:99], v[164:167]
ds_read_b128 v[76:79], v21 offset:5120
v_mfma_f32_16x16x32_bf16 v[172:175], a[92:95], v[100:103], v[172:175]
ds_read_b128 v[80:83], v21 offset:8192
v_mfma_f32_16x16x32_bf16 v[168:171], a[88:91], v[100:103], v[168:171]
ds_read_b128 v[84:87], v21 offset:9216
v_mfma_f32_16x16x32_bf16 v[176:179], a[88:91], v[104:107], v[176:179]
buffer_load_dwordx4 v8, s[20:23], s50 offen offset:2048 lds
ds_read_b128 v[88:91], v21 offset:12288
v_mfma_f32_16x16x32_bf16 v[180:183], a[92:95], v[104:107], v[180:183]
ds_read_b128 v[92:95], v21 offset:13312
v_mfma_f32_16x16x32_bf16 v[188:191], a[92:95], v[108:111], v[188:191]
ds_read_b64_tr_b16 a[104:105], v18 offset:8192
ds_read_b64_tr_b16 a[106:107], v18 offset:12288
v_mfma_f32_16x16x32_bf16 v[184:187], a[88:91], v[108:111], v[184:187]
ds_read_b64_tr_b16 a[108:109], v19 offset:8192
ds_read_b64_tr_b16 a[110:111], v19 offset:12288
s_waitcnt lgkmcnt(8)
v_mfma_f32_16x16x32_bf16 v[128:131], a[96:99], v[64:67], v[128:131]
buffer_load_dwordx4 v9, s[20:23], s50 offen offset:3072 lds
ds_read_b128 v[96:99], v21 offset:2048
v_mfma_f32_16x16x32_bf16 v[132:135], a[100:103], v[64:67], v[132:135]
ds_read_b128 v[100:103], v21 offset:3072
s_add_u32 m0, s47, 0x8000
v_mfma_f32_16x16x32_bf16 v[140:143], a[100:103], v[68:71], v[140:143]
ds_read_b128 v[104:107], v21 offset:6144
s_mov_b32 s49, 36864
v_mfma_f32_16x16x32_bf16 v[136:139], a[96:99], v[68:71], v[136:139]
ds_read_b128 v[108:111], v21 offset:7168
v_mfma_f32_16x16x32_bf16 v[144:147], a[96:99], v[72:75], v[144:147]
buffer_load_dwordx4 v63, s[24:27], s49 offen offset:0 sc1 lds
ds_read_b128 v[64:67], v21 offset:10240
v_mfma_f32_16x16x32_bf16 v[148:151], a[100:103], v[72:75], v[148:151]
v_mfma_f32_16x16x32_bf16 v[156:159], a[100:103], v[76:79], v[156:159]
ds_read_b128 v[68:71], v21 offset:11264
v_mfma_f32_16x16x32_bf16 v[152:155], a[96:99], v[76:79], v[152:155]
s_waitcnt lgkmcnt(4)
v_mfma_f32_16x16x32_bf16 v[160:163], a[96:99], v[80:83], v[160:163]
buffer_load_dwordx4 v63, s[24:27], s49 offen offset:1024 sc1 lds
ds_read_b128 v[72:75], v21 offset:14336
v_mfma_f32_16x16x32_bf16 v[164:167], a[100:103], v[80:83], v[164:167]
v_mfma_f32_16x16x32_bf16 v[172:175], a[100:103], v[84:87], v[172:175]
ds_read_b128 v[76:79], v21 offset:15360
v_mfma_f32_16x16x32_bf16 v[168:171], a[96:99], v[84:87], v[168:171]
v_mfma_f32_16x16x32_bf16 v[176:179], a[96:99], v[88:91], v[176:179]
buffer_load_dwordx4 v63, s[24:27], s49 offen offset:2048 sc1 lds
v_mfma_f32_16x16x32_bf16 v[180:183], a[100:103], v[88:91], v[180:183]
v_mfma_f32_16x16x32_bf16 v[188:191], a[100:103], v[92:95], v[188:191]
v_mfma_f32_16x16x32_bf16 v[184:187], a[96:99], v[92:95], v[184:187]
v_mfma_f32_16x16x32_bf16 v[128:131], a[104:107], v[96:99], v[128:131]
buffer_load_dwordx4 v63, s[24:27], s49 offen offset:3072 sc1 lds
s_add_u32 m0, s47, 0x14000
v_mfma_f32_16x16x32_bf16 v[132:135], a[108:111], v[96:99], v[132:135]
s_mov_b32 s50, 1310720
v_mfma_f32_16x16x32_bf16 v[140:143], a[108:111], v[100:103], v[140:143]
s_waitcnt vmcnt(20) lgkmcnt(0)
s_barrier
v_mfma_f32_16x16x32_bf16 v[136:139], a[104:107], v[100:103], v[136:139]
ds_read_b64_tr_b16 a[112:113], v18 offset:32768
ds_read_b64_tr_b16 a[114:115], v18 offset:36864
v_mfma_f32_16x16x32_bf16 v[144:147], a[104:107], v[104:107], v[144:147]
buffer_load_dwordx4 v6, s[20:23], s50 offen offset:0 lds
ds_read_b64_tr_b16 a[116:117], v19 offset:32768
v_mfma_f32_16x16x32_bf16 v[148:151], a[108:111], v[104:107], v[148:151]
ds_read_b64_tr_b16 a[118:119], v19 offset:36864
ds_read2st64_b32 v[48:49], v59 offset0:0 offset1:4
v_mfma_f32_16x16x32_bf16 v[156:159], a[108:111], v[108:111], v[156:159]
ds_read_b128 v[80:83], v21 offset:32768
ds_read2st64_b32 v[50:51], v59 offset0:16 offset1:20
ds_read2st64_b32 v[52:53], v59 offset0:32 offset1:36
v_mfma_f32_16x16x32_bf16 v[152:155], a[104:107], v[108:111], v[152:155]
ds_read_b128 v[84:87], v21 offset:33792
ds_read2st64_b32 v[54:55], v59 offset0:48 offset1:52
ds_read_b32 v40, v61 offset:512
v_mfma_f32_16x16x32_bf16 v[160:163], a[104:107], v[64:67], v[160:163]
buffer_load_dwordx4 v7, s[20:23], s50 offen offset:1024 lds
ds_read_b128 v[88:91], v21 offset:36864
v_mfma_f32_16x16x32_bf16 v[164:167], a[108:111], v[64:67], v[164:167]
ds_read_b128 v[92:95], v21 offset:37888
ds_read_b32 v41, v60 offset:1536
v_mfma_f32_16x16x32_bf16 v[172:175], a[108:111], v[68:71], v[172:175]
ds_read_b128 v[96:99], v21 offset:40960
ds_read_b32 v42, v60 offset:4608
ds_read_b32 v43, v60 offset:5632
v_mfma_f32_16x16x32_bf16 v[168:171], a[104:107], v[68:71], v[168:171]
ds_read_b128 v[100:103], v21 offset:41984
ds_read_b32 v44, v60 offset:8704
v_mfma_f32_16x16x32_bf16 v[176:179], a[104:107], v[72:75], v[176:179]
buffer_load_dwordx4 v8, s[20:23], s50 offen offset:2048 lds
ds_read_b128 v[104:107], v21 offset:45056
v_mfma_f32_16x16x32_bf16 v[180:183], a[108:111], v[72:75], v[180:183]
ds_read_b128 v[108:111], v21 offset:46080
ds_read_b32 v45, v60 offset:9728
v_mfma_f32_16x16x32_bf16 v[188:191], a[108:111], v[76:79], v[188:191]
ds_read_b64_tr_b16 a[120:121], v18 offset:40960
ds_read_b64_tr_b16 a[122:123], v18 offset:45056
ds_read_b32 v46, v60 offset:12800
v_mfma_f32_16x16x32_bf16 v[184:187], a[104:107], v[76:79], v[184:187]
ds_read_b64_tr_b16 a[124:125], v19 offset:40960
ds_read_b64_tr_b16 a[126:127], v19 offset:45056
s_waitcnt lgkmcnt(14)
v_mfma_f32_16x16x32_bf16 v[128:131], a[112:115], v[80:83], v[128:131]
buffer_load_dwordx4 v9, s[20:23], s50 offen offset:3072 lds
ds_read_b128 v[64:67], v21 offset:34816
v_mfma_f32_16x16x32_bf16 v[132:135], a[116:119], v[80:83], v[132:135]
ds_read_b128 v[68:71], v21 offset:35840
s_add_u32 m0, s47, 0x10000
v_mfma_f32_16x16x32_bf16 v[140:143], a[116:119], v[84:87], v[140:143]
ds_read_b128 v[72:75], v21 offset:38912
s_mov_b32 s49, 40960
ds_read_b32 v47, v60 offset:13824
v_mfma_f32_16x16x32_bf16 v[136:139], a[112:115], v[84:87], v[136:139]
ds_read_b128 v[76:79], v21 offset:39936
v_lshlrev_b32 v61, 31, v0
v_mfma_f32_16x16x32_bf16 v[144:147], a[112:115], v[88:91], v[144:147]
buffer_load_dwordx4 v63, s[24:27], s49 offen offset:0 sc1 lds
ds_read_b128 v[80:83], v21 offset:43008
v_mfma_f32_16x16x32_bf16 v[148:151], a[116:119], v[88:91], v[148:151]
v_or_b32 v61, 0.5, v61
v_cmp_gt_u32 s[66:67], 32, v0
v_mfma_f32_16x16x32_bf16 v[156:159], a[116:119], v[92:95], v[156:159]
ds_read_b128 v[84:87], v21 offset:44032
v_readlane_b32 s64, v48, 0
v_writelane_b32 v48, 0, 0
v_mfma_f32_16x16x32_bf16 v[152:155], a[112:115], v[92:95], v[152:155]
v_readlane_b32 s65, v40, 0
v_writelane_b32 v40, 0, 0
s_waitcnt lgkmcnt(5)
v_mfma_f32_16x16x32_bf16 v[160:163], a[112:115], v[96:99], v[160:163]
buffer_load_dwordx4 v63, s[24:27], s49 offen offset:1024 sc1 lds
ds_read_b128 v[88:91], v21 offset:47104
v_mfma_f32_16x16x32_bf16 v[164:167], a[116:119], v[96:99], v[164:167]
v_cndmask_b32 v60, 0, v61, s[66:67]
s_lshl_b32 s64, s64, 16
v_mfma_f32_16x16x32_bf16 v[172:175], a[116:119], v[100:103], v[172:175]
ds_read_b128 v[92:95], v21 offset:48128
s_lshl_b32 s65, s65, 16
v_mfma_f32_16x16x32_bf16 v[168:171], a[112:115], v[100:103], v[168:171]
v_mfma_f32_32x32x16_bf16 v[224:239], v[48:51], a[224:227], 0
buffer_load_dwordx4 v63, s[24:27], s49 offen offset:2048 sc1 lds
v_mfma_f32_32x32x16_bf16 v[112:127], v[48:51], a[232:235], 0
buffer_load_dwordx4 v63, s[24:27], s49 offen offset:3072 sc1 lds
s_add_u32 m0, s47, 0x1c000
s_mov_b32 s50, 1441792
v_mfma_f32_32x32x16_bf16 v[224:239], v[52:55], a[228:231], v[224:239]
v_mfma_f32_32x32x16_bf16 v[112:127], v[52:55], a[236:239], v[112:127]
v_mfma_f32_16x16x32_bf16 v[176:179], a[112:115], v[104:107], v[176:179]
v_mfma_f32_16x16x32_bf16 v[180:183], a[116:119], v[104:107], v[180:183]
v_mfma_f32_16x16x32_bf16 v[188:191], a[116:119], v[108:111], v[188:191]
v_mfma_f32_16x16x32_bf16 v[184:187], a[112:115], v[108:111], v[184:187]
v_mfma_f32_16x16x32_bf16 v[128:131], a[120:123], v[64:67], v[128:131]
v_mfma_f32_16x16x32_bf16 v[132:135], a[124:127], v[64:67], v[132:135]
v_mfma_f32_16x16x32_bf16 v[140:143], a[124:127], v[68:71], v[140:143]
s_waitcnt vmcnt(20) lgkmcnt(0)
s_barrier
v_mfma_f32_16x16x32_bf16 v[136:139], a[120:123], v[68:71], v[136:139]
ds_read_b64_tr_b16 a[128:129], v16 offset:0
ds_read_b64_tr_b16 a[130:131], v16 offset:4096
v_mfma_f32_16x16x32_bf16 v[144:147], a[120:123], v[72:75], v[144:147]
buffer_load_dwordx4 v6, s[20:23], s50 offen offset:0 lds
ds_read_b64_tr_b16 a[132:133], v17 offset:0
v_mfma_f32_16x16x32_bf16 v[148:151], a[124:127], v[72:75], v[148:151]
ds_read_b64_tr_b16 a[134:135], v17 offset:4096
v_mul_f32_e64 v2, v224, v208
v_mfma_f32_16x16x32_bf16 v[156:159], a[124:127], v[76:79], v[156:159]
ds_read_b128 v[96:99], v20 offset:0
v_mul_f32 v3, v225, v209
v_mul_f32 v224, v224, v192
v_mfma_f32_16x16x32_bf16 v[152:155], a[120:123], v[76:79], v[152:155]
ds_read_b128 v[100:103], v20 offset:1024
v_mul_f32_e64 v225, v225, v193
v_fma_f32 v224, -v112, v208, v224
v_mfma_f32_16x16x32_bf16 v[160:163], a[120:123], v[80:83], v[160:163]
buffer_load_dwordx4 v7, s[20:23], s50 offen offset:1024 lds
ds_read_b128 v[104:107], v20 offset:4096
v_mfma_f32_16x16x32_bf16 v[164:167], a[124:127], v[80:83], v[164:167]
ds_read_b128 v[108:111], v20 offset:5120
v_fma_f32 v225, -v113, v209, v225
v_mfma_f32_16x16x32_bf16 v[172:175], a[124:127], v[84:87], v[172:175]
ds_read_b128 v[64:67], v20 offset:8192
v_fma_f32 v112, v112, v192, v2
v_fma_f32 v113, v113, v193, v3
v_mfma_f32_16x16x32_bf16 v[168:171], a[120:123], v[84:87], v[168:171]
ds_read_b128 v[68:71], v20 offset:9216
v_mul_f32_e64 v2, v226, v210
v_mfma_f32_16x16x32_bf16 v[176:179], a[120:123], v[88:91], v[176:179]
buffer_load_dwordx4 v8, s[20:23], s50 offen offset:2048 lds
ds_read_b128 v[72:75], v20 offset:12288
v_mfma_f32_16x16x32_bf16 v[180:183], a[124:127], v[88:91], v[180:183]
ds_read_b128 v[76:79], v20 offset:13312
v_mul_f32_e64 v3, v227, v211
v_mfma_f32_16x16x32_bf16 v[188:191], a[124:127], v[92:95], v[188:191]
ds_read_b64_tr_b16 a[136:137], v16 offset:8192
ds_read_b64_tr_b16 a[138:139], v16 offset:12288
v_mul_f32 v226, v226, v194
v_mfma_f32_16x16x32_bf16 v[184:187], a[120:123], v[92:95], v[184:187]
ds_read_b64_tr_b16 a[140:141], v17 offset:8192
ds_read_b64_tr_b16 a[142:143], v17 offset:12288
s_waitcnt lgkmcnt(8)
v_mfma_f32_16x16x32_bf16 v[128:131], a[128:131], v[96:99], v[128:131]
buffer_load_dwordx4 v9, s[20:23], s50 offen offset:3072 lds
ds_read_b128 v[80:83], v20 offset:2048
v_mfma_f32_16x16x32_bf16 v[132:135], a[132:135], v[96:99], v[132:135]
ds_read_b128 v[84:87], v20 offset:3072
s_add_u32 m0, s47, 0x18000
v_mfma_f32_16x16x32_bf16 v[140:143], a[132:135], v[100:103], v[140:143]
ds_read_b128 v[88:91], v20 offset:6144
s_mov_b32 s49, 45056
v_mul_f32_e64 v227, v227, v195
v_mfma_f32_16x16x32_bf16 v[136:139], a[128:131], v[100:103], v[136:139]
ds_read_b128 v[92:95], v20 offset:7168
v_fma_f32 v226, -v114, v210, v226
v_mfma_f32_16x16x32_bf16 v[144:147], a[128:131], v[104:107], v[144:147]
buffer_load_dwordx4 v63, s[24:27], s49 offen offset:0 sc1 lds
ds_read_b128 v[96:99], v20 offset:10240
v_mfma_f32_16x16x32_bf16 v[148:151], a[132:135], v[104:107], v[148:151]
v_fma_f32 v227, -v115, v211, v227
v_fma_f32 v114, v114, v194, v2
v_mfma_f32_16x16x32_bf16 v[156:159], a[132:135], v[108:111], v[156:159]
ds_read_b128 v[100:103], v20 offset:11264
v_fma_f32 v115, v115, v195, v3
v_mul_f32_e64 v2, v228, v212
v_mfma_f32_16x16x32_bf16 v[152:155], a[128:131], v[108:111], v[152:155]
v_mul_f32_e64 v3, v229, v213
v_mul_f32 v228, v228, v196
s_waitcnt lgkmcnt(4)
v_mfma_f32_16x16x32_bf16 v[160:163], a[128:131], v[64:67], v[160:163]
buffer_load_dwordx4 v63, s[24:27], s49 offen offset:1024 sc1 lds
ds_read_b128 v[104:107], v20 offset:14336
v_mfma_f32_16x16x32_bf16 v[164:167], a[132:135], v[64:67], v[164:167]
v_mul_f32_e64 v229, v229, v197
v_fma_f32 v228, -v116, v212, v228
v_mfma_f32_16x16x32_bf16 v[172:175], a[132:135], v[68:71], v[172:175]
ds_read_b128 v[108:111], v20 offset:15360
v_fma_f32 v229, -v117, v213, v229
v_fma_f32 v116, v116, v196, v2
v_mfma_f32_16x16x32_bf16 v[168:171], a[128:131], v[68:71], v[168:171]
v_fma_f32 v117, v117, v197, v3
v_mul_f32_e64 v2, v230, v214
v_mfma_f32_16x16x32_bf16 v[176:179], a[128:131], v[72:75], v[176:179]
buffer_load_dwordx4 v63, s[24:27], s49 offen offset:2048 sc1 lds
v_mul_f32_e64 v3, v231, v215
v_mfma_f32_16x16x32_bf16 v[180:183], a[132:135], v[72:75], v[180:183]
v_mul_f32 v230, v230, v198
v_mul_f32 v231, v231, v199
v_mfma_f32_16x16x32_bf16 v[188:191], a[132:135], v[76:79], v[188:191]
v_fma_f32 v230, -v118, v214, v230
v_fma_f32 v231, -v119, v215, v231
v_fma_f32 v118, v118, v198, v2
v_mfma_f32_16x16x32_bf16 v[184:187], a[128:131], v[76:79], v[184:187]
v_fma_f32 v119, v119, v199, v3
v_mul_f32 v2, v232, v216
v_mul_f32 v3, v233, v217
v_mfma_f32_16x16x32_bf16 v[128:131], a[136:139], v[80:83], v[128:131]
buffer_load_dwordx4 v63, s[24:27], s49 offen offset:3072 sc1 lds
s_add_u32 m0, s47, 0x4000
v_mfma_f32_16x16x32_bf16 v[132:135], a[140:143], v[80:83], v[132:135]
s_mov_b32 s50, 1572864
v_mul_f32_e64 v232, v232, v200
v_mfma_f32_16x16x32_bf16 v[140:143], a[140:143], v[84:87], v[140:143]
s_waitcnt vmcnt(16) lgkmcnt(0)
s_barrier
v_mfma_f32_16x16x32_bf16 v[136:139], a[136:139], v[84:87], v[136:139]
ds_read_b64_tr_b16 a[144:145], v16 offset:32768
ds_read_b64_tr_b16 a[146:147], v16 offset:36864
v_mfma_f32_16x16x32_bf16 v[144:147], a[136:139], v[88:91], v[144:147]
buffer_load_dwordx4 v6, s[20:23], s50 offen offset:0 lds
ds_read_b64_tr_b16 a[148:149], v17 offset:32768
v_mfma_f32_16x16x32_bf16 v[148:151], a[140:143], v[88:91], v[148:151]
ds_read_b64_tr_b16 a[150:151], v17 offset:36864
v_mul_f32_e64 v233, v233, v201
v_mfma_f32_16x16x32_bf16 v[156:159], a[140:143], v[92:95], v[156:159]
ds_read_b128 v[64:67], v20 offset:32768
v_fma_f32 v232, -v120, v216, v232
v_fma_f32 v233, -v121, v217, v233
v_mfma_f32_16x16x32_bf16 v[152:155], a[136:139], v[92:95], v[152:155]
ds_read_b128 v[68:71], v20 offset:33792
v_fma_f32 v120, v120, v200, v2
v_fma_f32 v121, v121, v201, v3
v_mfma_f32_16x16x32_bf16 v[160:163], a[136:139], v[96:99], v[160:163]
buffer_load_dwordx4 v7, s[20:23], s50 offen offset:1024 lds
ds_read_b128 v[72:75], v20 offset:36864
v_mfma_f32_16x16x32_bf16 v[164:167], a[140:143], v[96:99], v[164:167]
ds_read_b128 v[76:79], v20 offset:37888
v_mul_f32_e64 v2, v234, v218
v_mfma_f32_16x16x32_bf16 v[172:175], a[140:143], v[100:103], v[172:175]
ds_read_b128 v[80:83], v20 offset:40960
v_mul_f32 v3, v235, v219
v_mul_f32 v234, v234, v202
v_mfma_f32_16x16x32_bf16 v[168:171], a[136:139], v[100:103], v[168:171]
ds_read_b128 v[84:87], v20 offset:41984
v_mul_f32_e64 v235, v235, v203
v_mfma_f32_16x16x32_bf16 v[176:179], a[136:139], v[104:107], v[176:179]
buffer_load_dwordx4 v8, s[20:23], s50 offen offset:2048 lds
ds_read_b128 v[88:91], v20 offset:45056
v_mfma_f32_16x16x32_bf16 v[180:183], a[140:143], v[104:107], v[180:183]
ds_read_b128 v[92:95], v20 offset:46080
v_fma_f32 v234, -v122, v218, v234
v_mfma_f32_16x16x32_bf16 v[188:191], a[140:143], v[108:111], v[188:191]
ds_read_b64_tr_b16 a[152:153], v16 offset:40960
ds_read_b64_tr_b16 a[154:155], v16 offset:45056
v_fma_f32 v235, -v123, v219, v235
v_mfma_f32_16x16x32_bf16 v[184:187], a[136:139], v[108:111], v[184:187]
ds_read_b64_tr_b16 a[156:157], v17 offset:40960
ds_read_b64_tr_b16 a[158:159], v17 offset:45056
s_waitcnt lgkmcnt(8)
v_mfma_f32_16x16x32_bf16 v[128:131], a[144:147], v[64:67], v[128:131]
buffer_load_dwordx4 v9, s[20:23], s50 offen offset:3072 lds
ds_read_b128 v[96:99], v20 offset:34816
v_mfma_f32_16x16x32_bf16 v[132:135], a[148:151], v[64:67], v[132:135]
ds_read_b128 v[100:103], v20 offset:35840
s_add_u32 m0, s47, 0x0
v_mfma_f32_16x16x32_bf16 v[140:143], a[148:151], v[68:71], v[140:143]
ds_read_b128 v[104:107], v20 offset:38912
s_mov_b32 s49, 49152
v_fma_f32 v122, v122, v202, v2
v_mfma_f32_16x16x32_bf16 v[136:139], a[144:147], v[68:71], v[136:139]
ds_read_b128 v[108:111], v20 offset:39936
v_fma_f32 v123, v123, v203, v3
v_mfma_f32_16x16x32_bf16 v[144:147], a[144:147], v[72:75], v[144:147]
buffer_load_dwordx4 v63, s[24:27], s49 offen offset:0 sc1 lds
ds_read_b128 v[64:67], v20 offset:43008
v_mfma_f32_16x16x32_bf16 v[148:151], a[148:151], v[72:75], v[148:151]
v_mul_f32 v2, v236, v220
v_mul_f32 v3, v237, v221
v_mfma_f32_16x16x32_bf16 v[156:159], a[148:151], v[76:79], v[156:159]
ds_read_b128 v[68:71], v20 offset:44032
v_mul_f32_e64 v236, v236, v204
v_mul_f32 v237, v237, v205
v_mfma_f32_16x16x32_bf16 v[152:155], a[144:147], v[76:79], v[152:155]
v_fma_f32 v236, -v124, v220, v236
v_fma_f32 v237, -v125, v221, v237
s_waitcnt lgkmcnt(4)
v_mfma_f32_16x16x32_bf16 v[160:163], a[144:147], v[80:83], v[160:163]
buffer_load_dwordx4 v63, s[24:27], s49 offen offset:1024 sc1 lds
ds_read_b128 v[72:75], v20 offset:47104
v_mfma_f32_16x16x32_bf16 v[164:167], a[148:151], v[80:83], v[164:167]
v_fma_f32 v124, v124, v204, v2
v_fma_f32 v125, v125, v205, v3
v_mfma_f32_16x16x32_bf16 v[172:175], a[148:151], v[84:87], v[172:175]
ds_read_b128 v[76:79], v20 offset:48128
v_mul_f32 v2, v238, v222
v_mul_f32 v3, v239, v223
v_mfma_f32_16x16x32_bf16 v[168:171], a[144:147], v[84:87], v[168:171]
v_mul_f32 v238, v238, v206
v_mul_f32 v239, v239, v207
v_mfma_f32_16x16x32_bf16 v[176:179], a[144:147], v[88:91], v[176:179]
buffer_load_dwordx4 v63, s[24:27], s49 offen offset:2048 sc1 lds
v_fma_f32 v238, -v126, v222, v238
v_mfma_f32_16x16x32_bf16 v[180:183], a[148:151], v[88:91], v[180:183]
v_fma_f32 v239, -v127, v223, v239
v_fma_f32 v126, v126, v206, v2
v_mfma_f32_16x16x32_bf16 v[188:191], a[148:151], v[92:95], v[188:191]
v_fma_f32 v127, v127, v207, v3
v_fmac_f32_e64 v224, s64, v60
v_cvt_pk_bf16_f32 v112, v224, v112
v_mfma_f32_16x16x32_bf16 v[184:187], a[144:147], v[92:95], v[184:187]
v_cvt_pk_bf16_f32 v113, v225, v113
v_cvt_pk_bf16_f32 v114, v226, v114
v_cvt_pk_bf16_f32 v115, v227, v115
v_mfma_f32_16x16x32_bf16 v[128:131], a[152:155], v[96:99], v[128:131]
buffer_load_dwordx4 v63, s[24:27], s49 offen offset:3072 sc1 lds
s_add_u32 m0, s47, 0xc000
v_mfma_f32_16x16x32_bf16 v[132:135], a[156:159], v[96:99], v[132:135]
s_mov_b32 s50, 1703936
v_cvt_pk_bf16_f32 v116, v228, v116
v_mfma_f32_16x16x32_bf16 v[140:143], a[156:159], v[100:103], v[140:143]
s_waitcnt vmcnt(16) lgkmcnt(0)
s_barrier
v_mfma_f32_16x16x32_bf16 v[136:139], a[152:155], v[100:103], v[136:139]
ds_read_b64_tr_b16 a[160:161], v18 offset:0
ds_read_b64_tr_b16 a[162:163], v18 offset:4096
v_mfma_f32_16x16x32_bf16 v[144:147], a[152:155], v[104:107], v[144:147]
buffer_load_dwordx4 v6, s[20:23], s50 offen offset:0 lds
ds_read_b64_tr_b16 a[164:165], v19 offset:0
v_mfma_f32_16x16x32_bf16 v[148:151], a[156:159], v[104:107], v[148:151]
ds_read_b64_tr_b16 a[166:167], v19 offset:4096
v_cvt_pk_bf16_f32 v117, v229, v117
v_mfma_f32_16x16x32_bf16 v[156:159], a[156:159], v[108:111], v[156:159]
ds_read_b128 v[80:83], v21 offset:0
v_cvt_pk_bf16_f32 v118, v230, v118
v_cvt_pk_bf16_f32 v119, v231, v119
v_mfma_f32_16x16x32_bf16 v[152:155], a[152:155], v[108:111], v[152:155]
ds_read_b128 v[84:87], v21 offset:1024
v_cvt_pk_bf16_f32 v120, v232, v120
v_cvt_pk_bf16_f32 v121, v233, v121
v_mfma_f32_16x16x32_bf16 v[160:163], a[152:155], v[64:67], v[160:163]
buffer_load_dwordx4 v7, s[20:23], s50 offen offset:1024 lds
ds_read_b128 v[88:91], v21 offset:4096
v_mfma_f32_16x16x32_bf16 v[164:167], a[156:159], v[64:67], v[164:167]
ds_read_b128 v[92:95], v21 offset:5120
v_cvt_pk_bf16_f32 v122, v234, v122
v_mfma_f32_16x16x32_bf16 v[172:175], a[156:159], v[68:71], v[172:175]
ds_read_b128 v[96:99], v21 offset:8192
v_cvt_pk_bf16_f32 v123, v235, v123
v_cvt_pk_bf16_f32 v124, v236, v124
v_mfma_f32_16x16x32_bf16 v[168:171], a[152:155], v[68:71], v[168:171]
ds_read_b128 v[100:103], v21 offset:9216
v_cvt_pk_bf16_f32 v125, v237, v125
v_mfma_f32_16x16x32_bf16 v[176:179], a[152:155], v[72:75], v[176:179]
buffer_load_dwordx4 v8, s[20:23], s50 offen offset:2048 lds
ds_read_b128 v[104:107], v21 offset:12288
v_mfma_f32_16x16x32_bf16 v[180:183], a[156:159], v[72:75], v[180:183]
ds_read_b128 v[108:111], v21 offset:13312
v_cvt_pk_bf16_f32 v126, v238, v126
v_mfma_f32_16x16x32_bf16 v[188:191], a[156:159], v[76:79], v[188:191]
ds_read_b64_tr_b16 a[168:169], v18 offset:8192
ds_read_b64_tr_b16 a[170:171], v18 offset:12288
v_cvt_pk_bf16_f32 v127, v239, v127
v_mfma_f32_16x16x32_bf16 v[184:187], a[152:155], v[76:79], v[184:187]
ds_read_b64_tr_b16 a[172:173], v19 offset:8192
ds_read_b64_tr_b16 a[174:175], v19 offset:12288
v_mfma_f32_32x32x16_bf16 v[224:239], v[112:115], a[240:243], 0
buffer_load_dwordx4 v9, s[20:23], s50 offen offset:3072 lds
ds_read_b128 v[64:67], v21 offset:2048
ds_read_b128 v[68:71], v21 offset:3072
s_add_u32 m0, s47, 0x8000
v_mfma_f32_32x32x16_bf16 v[224:239], v[116:119], a[244:247], v[224:239]
s_mov_b32 s49, 53248
v_mfma_f32_32x32x16_bf16 v[224:239], v[120:123], a[248:251], v[224:239]
buffer_load_dwordx4 v63, s[24:27], s49 offen offset:0 sc1 lds
v_mfma_f32_32x32x16_bf16 v[224:239], v[124:127], a[252:255], v[224:239]
buffer_load_dwordx4 v63, s[24:27], s49 offen offset:1024 sc1 lds
v_mfma_f32_32x32x16_bf16 v[24:39], v[40:43], a[224:227], 0
buffer_load_dwordx4 v63, s[24:27], s49 offen offset:2048 sc1 lds
v_mfma_f32_32x32x16_bf16 v[112:127], v[40:43], a[232:235], 0
buffer_load_dwordx4 v63, s[24:27], s49 offen offset:3072 sc1 lds
v_mfma_f32_32x32x16_bf16 v[24:39], v[44:47], a[228:231], v[24:39]
v_mfma_f32_32x32x16_bf16 v[112:127], v[44:47], a[236:239], v[112:127]
s_waitcnt lgkmcnt(10)
v_mfma_f32_16x16x32_bf16 v[128:131], a[160:163], v[80:83], v[128:131]
ds_read_b128 v[72:75], v21 offset:6144
v_mfma_f32_16x16x32_bf16 v[132:135], a[164:167], v[80:83], v[132:135]
v_mfma_f32_16x16x32_bf16 v[140:143], a[164:167], v[84:87], v[140:143]
ds_read_b128 v[76:79], v21 offset:7168
v_mfma_f32_16x16x32_bf16 v[136:139], a[160:163], v[84:87], v[136:139]
v_mfma_f32_16x16x32_bf16 v[144:147], a[160:163], v[88:91], v[144:147]
buffer_load_dword v23, v1, s[24:27], s59 offen offset:256 sc1
ds_read_b128 v[80:83], v21 offset:10240
v_mfma_f32_16x16x32_bf16 v[148:151], a[164:167], v[88:91], v[148:151]
v_mul_f32 v2, v24, v208
v_mul_f32_e64 v3, v25, v209
v_mfma_f32_16x16x32_bf16 v[156:159], a[164:167], v[92:95], v[156:159]
ds_read_b128 v[84:87], v21 offset:11264
v_mul_f32_e64 v24, v24, v192
v_mul_f32 v25, v25, v193
v_mfma_f32_16x16x32_bf16 v[152:155], a[160:163], v[92:95], v[152:155]
v_fma_f32 v24, -v112, v208, v24
v_fma_f32 v25, -v113, v209, v25
s_waitcnt lgkmcnt(3)
v_mfma_f32_16x16x32_bf16 v[160:163], a[160:163], v[96:99], v[160:163]
ds_read_b128 v[88:91], v21 offset:14336
v_fma_f32 v112, v112, v192, v2
v_fma_f32 v113, v113, v193, v3
v_mfma_f32_16x16x32_bf16 v[164:167], a[164:167], v[96:99], v[164:167]
v_mul_f32 v2, v26, v210
v_mul_f32 v3, v27, v211
v_mfma_f32_16x16x32_bf16 v[172:175], a[164:167], v[100:103], v[172:175]
ds_read_b128 v[92:95], v21 offset:15360
v_mul_f32 v26, v26, v194
v_mul_f32 v27, v27, v195
v_mfma_f32_16x16x32_bf16 v[168:171], a[160:163], v[100:103], v[168:171]
v_fma_f32 v26, -v114, v210, v26
v_fma_f32 v27, -v115, v211, v27
v_mfma_f32_16x16x32_bf16 v[176:179], a[160:163], v[104:107], v[176:179]
v_fma_f32 v114, v114, v194, v2
v_fma_f32 v115, v115, v195, v3
v_mul_f32_e64 v2, v28, v212
v_mfma_f32_16x16x32_bf16 v[180:183], a[164:167], v[104:107], v[180:183]
v_mul_f32 v3, v29, v213
v_mul_f32 v28, v28, v196
v_mfma_f32_16x16x32_bf16 v[188:191], a[164:167], v[108:111], v[188:191]
v_mul_f32_e64 v29, v29, v197
v_fma_f32 v28, -v116, v212, v28
v_fma_f32 v29, -v117, v213, v29
v_mfma_f32_16x16x32_bf16 v[184:187], a[160:163], v[108:111], v[184:187]
v_fma_f32 v116, v116, v196, v2
v_fma_f32 v117, v117, v197, v3
v_mul_f32_e64 v2, v30, v214
v_mfma_f32_16x16x32_bf16 v[128:131], a[168:171], v[64:67], v[128:131]
v_mul_f32 v3, v31, v215
v_mul_f32 v30, v30, v198
v_mul_f32_e64 v31, v31, v199
v_mfma_f32_16x16x32_bf16 v[132:135], a[172:175], v[64:67], v[132:135]
v_fma_f32 v30, -v118, v214, v30
v_fma_f32 v31, -v119, v215, v31
v_mfma_f32_16x16x32_bf16 v[140:143], a[172:175], v[68:71], v[140:143]
s_waitcnt vmcnt(17) lgkmcnt(0)
s_barrier
v_mfma_f32_16x16x32_bf16 v[136:139], a[168:171], v[68:71], v[136:139]
ds_read_b64_tr_b16 a[176:177], v18 offset:32768
ds_read_b64_tr_b16 a[178:179], v18 offset:36864
v_mfma_f32_16x16x32_bf16 v[144:147], a[168:171], v[72:75], v[144:147]
ds_read_b64_tr_b16 a[180:181], v19 offset:32768
ds_read_b64_tr_b16 a[182:183], v19 offset:36864
v_fma_f32 v118, v118, v198, v2
v_mfma_f32_16x16x32_bf16 v[148:151], a[172:175], v[72:75], v[148:151]
ds_read_b128 v[96:99], v21 offset:32768
v_fma_f32 v119, v119, v199, v3
v_mfma_f32_16x16x32_bf16 v[156:159], a[172:175], v[76:79], v[156:159]
ds_read_b128 v[100:103], v21 offset:33792
v_mul_f32 v2, v32, v216
v_mul_f32 v3, v33, v217
v_mfma_f32_16x16x32_bf16 v[152:155], a[168:171], v[76:79], v[152:155]
ds_read_b128 v[104:107], v21 offset:36864
v_mul_f32 v32, v32, v200
v_mul_f32 v33, v33, v201
v_mfma_f32_16x16x32_bf16 v[160:163], a[168:171], v[80:83], v[160:163]
ds_read_b128 v[108:111], v21 offset:37888
v_fma_f32 v32, -v120, v216, v32
v_fma_f32 v33, -v121, v217, v33
v_mfma_f32_16x16x32_bf16 v[164:167], a[172:175], v[80:83], v[164:167]
ds_read_b128 v[64:67], v21 offset:40960
v_fma_f32 v120, v120, v200, v2
v_mfma_f32_16x16x32_bf16 v[172:175], a[172:175], v[84:87], v[172:175]
ds_read_b128 v[68:71], v21 offset:41984
v_fma_f32 v121, v121, v201, v3
v_mul_f32_e64 v2, v34, v218
v_mfma_f32_16x16x32_bf16 v[168:171], a[168:171], v[84:87], v[168:171]
ds_read_b128 v[72:75], v21 offset:45056
v_mul_f32_e64 v3, v35, v219
v_mfma_f32_16x16x32_bf16 v[176:179], a[168:171], v[88:91], v[176:179]
ds_read_b128 v[76:79], v21 offset:46080
v_mul_f32 v34, v34, v202
v_mul_f32 v35, v35, v203
v_mfma_f32_16x16x32_bf16 v[180:183], a[172:175], v[88:91], v[180:183]
ds_read_b64_tr_b16 a[184:185], v18 offset:40960
ds_read_b64_tr_b16 a[186:187], v18 offset:45056
v_mfma_f32_16x16x32_bf16 v[188:191], a[172:175], v[92:95], v[188:191]
ds_read_b64_tr_b16 a[188:189], v19 offset:40960
ds_read_b64_tr_b16 a[190:191], v19 offset:45056
v_fma_f32 v34, -v122, v218, v34
v_mfma_f32_16x16x32_bf16 v[184:187], a[168:171], v[92:95], v[184:187]
ds_read_b128 v[80:83], v21 offset:34816
v_fma_f32 v35, -v123, v219, v35
s_waitcnt lgkmcnt(8)
v_mfma_f32_16x16x32_bf16 v[128:131], a[176:179], v[96:99], v[128:131]
ds_read_b128 v[84:87], v21 offset:35840
v_fma_f32 v122, v122, v202, v2
v_fma_f32 v123, v123, v203, v3
v_mfma_f32_16x16x32_bf16 v[132:135], a[180:183], v[96:99], v[132:135]
ds_read_b128 v[88:91], v21 offset:38912
v_mul_f32 v2, v36, v220
v_mfma_f32_16x16x32_bf16 v[140:143], a[180:183], v[100:103], v[140:143]
ds_read_b128 v[92:95], v21 offset:39936
v_mul_f32 v3, v37, v221
v_mul_f32 v36, v36, v204
v_mfma_f32_16x16x32_bf16 v[136:139], a[176:179], v[100:103], v[136:139]
v_mul_f32_e64 v37, v37, v205
v_fma_f32 v36, -v124, v220, v36
v_mfma_f32_16x16x32_bf16 v[144:147], a[176:179], v[104:107], v[144:147]
ds_read_b128 v[96:99], v21 offset:43008
v_fma_f32 v37, -v125, v221, v37
v_fma_f32 v124, v124, v204, v2
v_mfma_f32_16x16x32_bf16 v[148:151], a[180:183], v[104:107], v[148:151]
v_fma_f32 v125, v125, v205, v3
v_mul_f32_e64 v2, v38, v222
v_mfma_f32_16x16x32_bf16 v[156:159], a[180:183], v[108:111], v[156:159]
ds_read_b128 v[100:103], v21 offset:44032
v_mul_f32 v3, v39, v223
v_mul_f32 v38, v38, v206
v_mfma_f32_16x16x32_bf16 v[152:155], a[176:179], v[108:111], v[152:155]
v_mul_f32_e64 v39, v39, v207
v_fma_f32 v38, -v126, v222, v38
v_fma_f32 v39, -v127, v223, v39
v_mfma_f32_16x16x32_bf16 v[160:163], a[176:179], v[64:67], v[160:163]
ds_read_b128 v[104:107], v21 offset:47104
s_add_u32 m0, s48, 0x10000
s_add_u32 s49, s55, 229376
v_mfma_f32_16x16x32_bf16 v[164:167], a[180:183], v[64:67], v[164:167]
v_fma_f32 v126, v126, v206, v2
s_waitcnt lgkmcnt(3)
v_mfma_f32_16x16x32_bf16 v[172:175], a[180:183], v[68:71], v[172:175]
ds_read_b128 v[108:111], v21 offset:48128
v_fma_f32 v127, v127, v207, v3
v_fmac_f32_e64 v24, s65, v60
v_mfma_f32_16x16x32_bf16 v[168:171], a[176:179], v[68:71], v[168:171]
v_cvt_pk_bf16_f32 v112, v24, v112
v_cvt_pk_bf16_f32 v113, v25, v113
v_mfma_f32_16x16x32_bf16 v[176:179], a[176:179], v[72:75], v[176:179]
s_waitcnt vmcnt(0)
v_cmp_ne_u32 vcc, s53, v23
s_cbranch_vccnz L_spin15
L_back15:
v_mfma_f32_16x16x32_bf16 v[180:183], a[180:183], v[72:75], v[180:183]
v_cvt_pk_bf16_f32 v114, v26, v114
v_cvt_pk_bf16_f32 v115, v27, v115
v_mfma_f32_16x16x32_bf16 v[188:191], a[180:183], v[76:79], v[188:191]
v_cvt_pk_bf16_f32 v116, v28, v116
v_cvt_pk_bf16_f32 v117, v29, v117
v_mfma_f32_16x16x32_bf16 v[184:187], a[176:179], v[76:79], v[184:187]
v_cvt_pk_bf16_f32 v118, v30, v118
v_cvt_pk_bf16_f32 v119, v31, v119
v_mfma_f32_16x16x32_bf16 v[128:131], a[184:187], v[80:83], v[128:131]
v_cvt_pk_bf16_f32 v120, v32, v120
v_cvt_pk_bf16_f32 v121, v33, v121
v_cvt_pk_bf16_f32 v122, v34, v122
v_mfma_f32_16x16x32_bf16 v[132:135], a[188:191], v[80:83], v[132:135]
v_cvt_pk_bf16_f32 v123, v35, v123
v_cvt_pk_bf16_f32 v124, v36, v124
v_mfma_f32_16x16x32_bf16 v[140:143], a[188:191], v[84:87], v[140:143]
s_waitcnt lgkmcnt(0)
s_barrier
v_mfma_f32_16x16x32_bf16 v[136:139], a[184:187], v[84:87], v[136:139]
ds_read_b64_tr_b16 a[192:193], v16 offset:0
ds_read_b64_tr_b16 a[194:195], v16 offset:4096
v_mfma_f32_16x16x32_bf16 v[144:147], a[184:187], v[88:91], v[144:147]
buffer_load_dwordx4 v20, s[24:27], s49 offen offset:0 sc1 lds
ds_read_b64_tr_b16 a[196:197], v17 offset:0
v_mfma_f32_16x16x32_bf16 v[148:151], a[188:191], v[88:91], v[148:151]
ds_read_b64_tr_b16 a[198:199], v17 offset:4096
v_cvt_pk_bf16_f32 v125, v37, v125
v_mfma_f32_16x16x32_bf16 v[156:159], a[188:191], v[92:95], v[156:159]
buffer_load_dwordx4 v20, s[24:27], s49 offen offset:1024 sc1 lds
ds_read_b128 v[64:67], v20 offset:0
v_mfma_f32_16x16x32_bf16 v[152:155], a[184:187], v[92:95], v[152:155]
ds_read_b128 v[68:71], v20 offset:1024
v_cvt_pk_bf16_f32 v126, v38, v126
v_cvt_pk_bf16_f32 v127, v39, v127
v_mfma_f32_32x32x16_bf16 v[24:39], v[112:115], a[240:243], 0
buffer_load_dwordx4 v20, s[24:27], s49 offen offset:2048 sc1 lds
ds_read_b128 v[72:75], v20 offset:4096
ds_read_b128 v[76:79], v20 offset:5120
v_mfma_f32_32x32x16_bf16 v[24:39], v[116:119], a[244:247], v[24:39]
buffer_load_dwordx4 v20, s[24:27], s49 offen offset:3072 sc1 lds
ds_read_b128 v[80:83], v20 offset:8192
ds_read_b128 v[84:87], v20 offset:9216
s_add_u32 m0, s48, 0x11000
s_add_u32 s49, s55, 233472
v_mfma_f32_32x32x16_bf16 v[24:39], v[120:123], a[248:251], v[24:39]
buffer_load_dwordx4 v20, s[24:27], s49 offen offset:0 sc1 lds
v_mfma_f32_32x32x16_bf16 v[24:39], v[124:127], a[252:255], v[24:39]
buffer_load_dwordx4 v20, s[24:27], s49 offen offset:1024 sc1 lds
v_mfma_f32_16x16x32_bf16 v[160:163], a[184:187], v[96:99], v[160:163]
buffer_load_dwordx4 v20, s[24:27], s49 offen offset:2048 sc1 lds
ds_read_b128 v[88:91], v20 offset:12288
v_mfma_f32_16x16x32_bf16 v[164:167], a[188:191], v[96:99], v[164:167]
v_mfma_f32_16x16x32_bf16 v[172:175], a[188:191], v[100:103], v[172:175]
buffer_load_dwordx4 v20, s[24:27], s49 offen offset:3072 sc1 lds
ds_read_b128 v[92:95], v20 offset:13312
v_mfma_f32_16x16x32_bf16 v[168:171], a[184:187], v[100:103], v[168:171]
s_add_u32 m0, s5, 0x18000
s_add_u32 s49, s56, 229376
v_mfma_f32_16x16x32_bf16 v[176:179], a[184:187], v[104:107], v[176:179]
buffer_load_dwordx4 v20, s[24:27], s49 offen offset:0 sc1 lds
ds_read_b64_tr_b16 a[200:201], v16 offset:8192
v_mfma_f32_16x16x32_bf16 v[180:183], a[188:191], v[104:107], v[180:183]
ds_read_b64_tr_b16 a[202:203], v16 offset:12288
ds_read_b64_tr_b16 a[204:205], v17 offset:8192
v_mfma_f32_16x16x32_bf16 v[188:191], a[188:191], v[108:111], v[188:191]
ds_read_b64_tr_b16 a[206:207], v17 offset:12288
v_add_f32 v48, v224, v24
v_add_f32 v49, v225, v25
v_mfma_f32_16x16x32_bf16 v[184:187], a[184:187], v[108:111], v[184:187]
ds_read_b128 v[96:99], v20 offset:2048
v_add_f32 v50, v226, v26
s_waitcnt lgkmcnt(6)
v_mfma_f32_16x16x32_bf16 v[128:131], a[192:195], v[64:67], v[128:131]
buffer_load_dwordx4 v20, s[24:27], s49 offen offset:1024 sc1 lds
ds_read_b128 v[100:103], v20 offset:3072
v_mfma_f32_16x16x32_bf16 v[132:135], a[196:199], v[64:67], v[132:135]
ds_read_b128 v[104:107], v20 offset:6144
s_add_u32 s49, s57, 229376
v_mfma_f32_16x16x32_bf16 v[140:143], a[196:199], v[68:71], v[140:143]
ds_read_b128 v[108:111], v20 offset:7168
v_add_f32 v51, v227, v27
v_add_f32 v52, v228, v28
v_mfma_f32_16x16x32_bf16 v[136:139], a[192:195], v[68:71], v[136:139]
v_add_f32 v53, v229, v29
v_add_f32 v54, v230, v30
v_mfma_f32_16x16x32_bf16 v[144:147], a[192:195], v[72:75], v[144:147]
buffer_load_dwordx4 v20, s[24:27], s49 offen offset:2048 sc1 lds
ds_read_b128 v[64:67], v20 offset:10240
v_mfma_f32_16x16x32_bf16 v[148:151], a[196:199], v[72:75], v[148:151]
v_add_f32_e64 v55, v231, v31
v_cvt_pk_bf16_f32 v112, v48, v49
v_mfma_f32_16x16x32_bf16 v[156:159], a[196:199], v[76:79], v[156:159]
ds_read_b128 v[68:71], v20 offset:11264
v_cvt_pk_bf16_f32 v113, v50, v51
v_cvt_pk_bf16_f32 v114, v52, v53
v_mfma_f32_16x16x32_bf16 v[152:155], a[192:195], v[76:79], v[152:155]
v_cvt_pk_bf16_f32 v115, v54, v55
v_add_f32 v48, v232, v32
v_add_f32 v49, v233, v33
v_mfma_f32_16x16x32_bf16 v[160:163], a[192:195], v[80:83], v[160:163]
buffer_load_dwordx4 v20, s[24:27], s49 offen offset:3072 sc1 lds
ds_read_b128 v[72:75], v20 offset:14336
v_mfma_f32_16x16x32_bf16 v[164:167], a[196:199], v[80:83], v[164:167]
s_add_u32 m0, s5, 0x19000
s_add_u32 s49, s58, 229376
v_mfma_f32_16x16x32_bf16 v[172:175], a[196:199], v[84:87], v[172:175]
buffer_store_dwordx4 v[112:115], v62, s[24:27], s82 offen sc1
ds_read_b128 v[76:79], v20 offset:15360
v_add_f32_e64 v50, v234, v34
v_mfma_f32_16x16x32_bf16 v[168:171], a[192:195], v[84:87], v[168:171]
v_add_f32 v51, v235, v35
v_add_f32 v52, v236, v36
v_mfma_f32_16x16x32_bf16 v[176:179], a[192:195], v[88:91], v[176:179]
buffer_load_dwordx4 v20, s[24:27], s49 offen offset:0 sc1 lds
v_add_f32_e64 v53, v237, v37
v_mfma_f32_16x16x32_bf16 v[180:183], a[196:199], v[88:91], v[180:183]
v_add_f32 v54, v238, v38
s_waitcnt lgkmcnt(2)
v_mfma_f32_16x16x32_bf16 v[188:191], a[196:199], v[92:95], v[188:191]
v_add_f32_e64 v55, v239, v39
v_cvt_pk_bf16_f32 v116, v48, v49
v_cvt_pk_bf16_f32 v117, v50, v51
v_mfma_f32_16x16x32_bf16 v[184:187], a[192:195], v[92:95], v[184:187]
v_cvt_pk_bf16_f32 v118, v52, v53
v_cvt_pk_bf16_f32 v119, v54, v55
v_sub_f32 v48, v224, v24
v_mfma_f32_16x16x32_bf16 v[128:131], a[200:203], v[96:99], v[128:131]
buffer_load_dwordx4 v20, s[24:27], s49 offen offset:1024 sc1 lds
s_add_u32 m0, s48, 0x0
v_mfma_f32_16x16x32_bf16 v[132:135], a[204:207], v[96:99], v[132:135]
s_add_u32 s49, s55, 286720
v_sub_f32_e64 v49, v225, v25
v_mfma_f32_16x16x32_bf16 v[140:143], a[204:207], v[100:103], v[140:143]
s_waitcnt lgkmcnt(0)
s_barrier
v_mfma_f32_16x16x32_bf16 v[136:139], a[200:203], v[100:103], v[136:139]
ds_read_b64_tr_b16 a[208:209], v16 offset:32768
ds_read_b64_tr_b16 a[210:211], v16 offset:36864
v_mfma_f32_16x16x32_bf16 v[144:147], a[200:203], v[104:107], v[144:147]
buffer_load_dwordx4 v20, s[24:27], s49 offen offset:0 sc1 lds
ds_read_b64_tr_b16 a[212:213], v17 offset:32768
v_mfma_f32_16x16x32_bf16 v[148:151], a[204:207], v[104:107], v[148:151]
ds_read_b64_tr_b16 a[214:215], v17 offset:36864
v_sub_f32_e64 v50, v226, v26
v_mfma_f32_16x16x32_bf16 v[156:159], a[204:207], v[108:111], v[156:159]
ds_read_b128 v[80:83], v20 offset:32768
v_sub_f32 v51, v227, v27
v_sub_f32 v52, v228, v28
v_mfma_f32_16x16x32_bf16 v[152:155], a[200:203], v[108:111], v[152:155]
ds_read_b128 v[84:87], v20 offset:33792
v_sub_f32 v53, v229, v29
v_sub_f32 v54, v230, v30
v_mfma_f32_16x16x32_bf16 v[160:163], a[200:203], v[64:67], v[160:163]
buffer_load_dwordx4 v20, s[24:27], s49 offen offset:1024 sc1 lds
ds_read_b128 v[88:91], v20 offset:36864
v_mfma_f32_16x16x32_bf16 v[164:167], a[204:207], v[64:67], v[164:167]
ds_read_b128 v[92:95], v20 offset:37888
v_sub_f32_e64 v55, v231, v31
v_mfma_f32_16x16x32_bf16 v[172:175], a[204:207], v[68:71], v[172:175]
ds_read_b128 v[96:99], v20 offset:40960
v_cvt_pk_bf16_f32 v120, v48, v49
v_cvt_pk_bf16_f32 v121, v50, v51
v_mfma_f32_16x16x32_bf16 v[168:171], a[200:203], v[68:71], v[168:171]
ds_read_b128 v[100:103], v20 offset:41984
v_cvt_pk_bf16_f32 v122, v52, v53
v_mfma_f32_16x16x32_bf16 v[176:179], a[200:203], v[72:75], v[176:179]
buffer_load_dwordx4 v20, s[24:27], s49 offen offset:2048 sc1 lds
ds_read_b128 v[104:107], v20 offset:45056
v_mfma_f32_16x16x32_bf16 v[180:183], a[204:207], v[72:75], v[180:183]
ds_read_b128 v[108:111], v20 offset:46080
v_cvt_pk_bf16_f32 v123, v54, v55
v_mfma_f32_16x16x32_bf16 v[188:191], a[204:207], v[76:79], v[188:191]
ds_read_b64_tr_b16 a[216:217], v16 offset:40960
ds_read_b64_tr_b16 a[218:219], v16 offset:45056
v_sub_f32 v48, v232, v32
v_mfma_f32_16x16x32_bf16 v[184:187], a[200:203], v[76:79], v[184:187]
ds_read_b64_tr_b16 a[220:221], v17 offset:40960
ds_read_b64_tr_b16 a[222:223], v17 offset:45056
s_waitcnt lgkmcnt(8)
v_mfma_f32_16x16x32_bf16 v[128:131], a[208:211], v[80:83], v[128:131]
buffer_load_dwordx4 v20, s[24:27], s49 offen offset:3072 sc1 lds
ds_read_b128 v[64:67], v20 offset:34816
v_mfma_f32_16x16x32_bf16 v[132:135], a[212:215], v[80:83], v[132:135]
ds_read_b128 v[68:71], v20 offset:35840
s_add_u32 m0, s48, 0x1000
v_mfma_f32_16x16x32_bf16 v[140:143], a[212:215], v[84:87], v[140:143]
ds_read_b128 v[72:75], v20 offset:38912
s_add_u32 s49, s55, 290816
v_sub_f32_e64 v49, v233, v33
v_mfma_f32_16x16x32_bf16 v[136:139], a[208:211], v[84:87], v[136:139]
ds_read_b128 v[76:79], v20 offset:39936
v_sub_f32_e64 v50, v234, v34
v_mfma_f32_16x16x32_bf16 v[144:147], a[208:211], v[88:91], v[144:147]
buffer_load_dwordx4 v20, s[24:27], s49 offen offset:0 sc1 lds
ds_read_b128 v[80:83], v20 offset:43008
v_mfma_f32_16x16x32_bf16 v[148:151], a[212:215], v[88:91], v[148:151]
v_sub_f32 v51, v235, v35
v_sub_f32 v52, v236, v36
v_mfma_f32_16x16x32_bf16 v[156:159], a[212:215], v[92:95], v[156:159]
ds_read_b128 v[84:87], v20 offset:44032
v_sub_f32 v53, v237, v37
v_sub_f32 v54, v238, v38
v_mfma_f32_16x16x32_bf16 v[152:155], a[208:211], v[92:95], v[152:155]
v_sub_f32 v55, v239, v39
v_cvt_pk_bf16_f32 v124, v48, v49
s_waitcnt lgkmcnt(4)
v_mfma_f32_16x16x32_bf16 v[160:163], a[208:211], v[96:99], v[160:163]
buffer_load_dwordx4 v20, s[24:27], s49 offen offset:1024 sc1 lds
ds_read_b128 v[88:91], v20 offset:47104
v_mfma_f32_16x16x32_bf16 v[164:167], a[212:215], v[96:99], v[164:167]
v_cvt_pk_bf16_f32 v125, v50, v51
v_cvt_pk_bf16_f32 v126, v52, v53
v_mfma_f32_16x16x32_bf16 v[172:175], a[212:215], v[100:103], v[172:175]
ds_read_b128 v[92:95], v20 offset:48128
v_cvt_pk_bf16_f32 v127, v54, v55
s_add_u32 s82, s82, 0x40000
v_mfma_f32_16x16x32_bf16 v[168:171], a[208:211], v[100:103], v[168:171]
buffer_store_dwordx4 v[116:119], v62, s[24:27], s82 offen sc1
s_add_u32 s82, s82, 0x40000
v_mfma_f32_16x16x32_bf16 v[176:179], a[208:211], v[104:107], v[176:179]
buffer_load_dwordx4 v20, s[24:27], s49 offen offset:2048 sc1 lds
v_lshlrev_b32_e64 v63, 3, v0
v_mfma_f32_16x16x32_bf16 v[180:183], a[212:215], v[104:107], v[180:183]
v_mov_b32_e64 v9, v56
s_mov_b32 s72, 0xffff
v_mfma_f32_16x16x32_bf16 v[188:191], a[212:215], v[108:111], v[188:191]
buffer_store_dwordx4 v[120:123], v62, s[24:27], s82 offen sc1
s_add_u32 s82, s82, 0x40000
v_lshrrev_b32_e64 v40, 4, v0
v_mfma_f32_16x16x32_bf16 v[184:187], a[208:211], v[108:111], v[184:187]
v_lshlrev_b32_e64 v3, 4, v40
v_mfma_f32_16x16x32_bf16 v[128:131], a[216:219], v[64:67], v[128:131]
buffer_load_dwordx4 v20, s[24:27], s49 offen offset:3072 sc1 lds
s_add_u32 m0, s5, 0x8000
v_mfma_f32_16x16x32_bf16 v[132:135], a[220:223], v[64:67], v[132:135]
s_add_u32 s49, s56, 286720
v_mfma_f32_16x16x32_bf16 v[140:143], a[220:223], v[68:71], v[140:143]
s_waitcnt vmcnt(17) lgkmcnt(0)
s_barrier
v_mfma_f32_16x16x32_bf16 v[136:139], a[216:219], v[68:71], v[136:139]
ds_read_b128 v[96:99], v21 offset:0
v_mfma_f32_16x16x32_bf16 v[144:147], a[216:219], v[72:75], v[144:147]
buffer_load_dwordx4 v20, s[24:27], s49 offen offset:0 sc1 lds
ds_read_b128 v[100:103], v21 offset:1024
v_mfma_f32_16x16x32_bf16 v[148:151], a[220:223], v[72:75], v[148:151]
ds_read_b128 v[104:107], v21 offset:2048
v_mfma_f32_16x16x32_bf16 v[156:159], a[220:223], v[76:79], v[156:159]
buffer_store_dwordx4 v[124:127], v62, s[24:27], s82 offen sc1
ds_read_b128 v[108:111], v21 offset:3072
v_mfma_f32_16x16x32_bf16 v[152:155], a[216:219], v[76:79], v[152:155]
ds_read_b128 v[64:67], v21 offset:4096
v_mfma_f32_16x16x32_bf16 v[160:163], a[216:219], v[80:83], v[160:163]
buffer_load_dwordx4 v20, s[24:27], s49 offen offset:1024 sc1 lds
ds_read_b128 v[68:71], v21 offset:5120
v_mfma_f32_16x16x32_bf16 v[164:167], a[220:223], v[80:83], v[164:167]
ds_read_b128 v[72:75], v21 offset:6144
s_add_u32 s49, s57, 286720
v_mfma_f32_16x16x32_bf16 v[172:175], a[220:223], v[84:87], v[172:175]
buffer_load_dwordx4 v[224:227], v3, s[28:31], s78 offen
ds_read_b128 v[76:79], v21 offset:7168
v_mfma_f32_16x16x32_bf16 v[168:171], a[216:219], v[84:87], v[168:171]
v_cvt_pk_bf16_f32 v48, v128, v129
v_cvt_pk_bf16_f32 v49, v130, v131
v_mfma_f32_16x16x32_bf16 v[176:179], a[216:219], v[88:91], v[176:179]
buffer_load_dwordx4 v20, s[24:27], s49 offen offset:2048 sc1 lds
ds_read_b128 v[80:83], v21 offset:8192
v_mfma_f32_16x16x32_bf16 v[180:183], a[220:223], v[88:91], v[180:183]
v_cvt_pk_bf16_f32 v50, v132, v133
v_cvt_pk_bf16_f32 v51, v134, v135
v_mfma_f32_16x16x32_bf16 v[188:191], a[220:223], v[92:95], v[188:191]
ds_read_b128 v[84:87], v21 offset:9216
v_cvt_pk_bf16_f32 v52, v136, v137
v_cvt_pk_bf16_f32 v53, v138, v139
v_mfma_f32_16x16x32_bf16 v[184:187], a[216:219], v[92:95], v[184:187]
v_cvt_pk_bf16_f32 v54, v140, v141
v_cvt_pk_bf16_f32 v55, v142, v143
s_waitcnt lgkmcnt(3)
v_mfma_f32_16x16x32_bf16 v[240:243], a[0:3], v[96:99], 0
ds_read_b128 v[88:91], v21 offset:10240
v_cvt_pk_bf16_f32 v6, v135, v143
v_bfi_b32 v51, s72, v51, v56
v_mfma_f32_16x16x32_bf16 v[244:247], a[4:7], v[96:99], 0
v_bfi_b32 v55, s72, v55, v56
v_bfe_u32 v41, v0, 2, 2
v_mfma_f32_16x16x32_bf16 v[252:255], a[4:7], v[100:103], 0
buffer_load_dwordx4 v20, s[24:27], s49 offen offset:3072 sc1 lds
ds_read_b128 v[92:95], v21 offset:11264
v_mfma_f32_16x16x32_bf16 v[248:251], a[0:3], v[100:103], 0
s_add_u32 m0, s5, 0x9000
s_add_u32 s49, s58, 286720
v_mfma_f32_16x16x32_bf16 v[240:243], a[8:11], v[104:107], v[240:243]
ds_read_b128 v[96:99], v21 offset:12288
v_and_b32 v42, 3, v0
v_lshl_add_u32 v41, v41, 4, v42
v_mfma_f32_16x16x32_bf16 v[244:247], a[12:15], v[104:107], v[244:247]
v_lshlrev_b32_e64 v41, 8, v41
v_add_u32 v41, 131072, v41
v_mfma_f32_16x16x32_bf16 v[252:255], a[12:15], v[108:111], v[252:255]
ds_read_b128 v[100:103], v21 offset:13312
v_and_b32_e64 v42, 15, v0
v_lshl_add_u32 v43, s36, 2, v40
v_mfma_f32_16x16x32_bf16 v[248:251], a[8:11], v[108:111], v[248:251]
v_xor_b32_e64 v43, v43, v42
v_lshl_add_u32 v4, v43, 4, v41
v_mfma_f32_16x16x32_bf16 v[240:243], a[16:19], v[64:67], v[240:243]
buffer_load_dwordx4 v20, s[24:27], s49 offen offset:0 sc1 lds
ds_read_b128 v[104:107], v21 offset:14336
v_mfma_f32_16x16x32_bf16 v[244:247], a[20:23], v[64:67], v[244:247]
ds_read_b128 v[24:27], v4 offset:0
ds_read_b128 v[28:31], v4 offset:1024
v_mfma_f32_16x16x32_bf16 v[252:255], a[20:23], v[68:71], v[252:255]
ds_read_b128 v[108:111], v21 offset:15360
ds_read_b128 v[32:35], v4 offset:2048
ds_read_b128 v[36:39], v4 offset:3072
v_mfma_f32_16x16x32_bf16 v[248:251], a[16:19], v[68:71], v[248:251]
v_lshl_add_u32 v43, v40, 2, s36
v_xor_b32_e64 v43, v43, v42
v_mfma_f32_16x16x32_bf16 v[240:243], a[24:27], v[72:75], v[240:243]
ds_read_b128 v[64:67], v21 offset:16384
v_lshl_add_u32 v60, v43, 4, v41
v_lshl_add_u32 v2, v42, 11, v3
v_mfma_f32_16x16x32_bf16 v[244:247], a[28:31], v[72:75], v[244:247]
v_min_u32 v42, 15, v0
s_waitcnt lgkmcnt(7)
v_mfma_f32_16x16x32_bf16 v[252:255], a[28:31], v[76:79], v[252:255]
buffer_load_dwordx4 v20, s[24:27], s49 offen offset:1024 sc1 lds
ds_read_b128 v[68:71], v21 offset:17408
v_mfma_f32_16x16x32_bf16 v[248:251], a[24:27], v[76:79], v[248:251]
v_and_b32 v43, 12, v42
v_mul_u32_u24 v43, 3, v43
v_mfma_f32_16x16x32_bf16 v[240:243], a[32:35], v[80:83], v[240:243]
buffer_store_dwordx4 v[48:51], v20, s[24:27], s68 offen offset:0 sc1
ds_read_b128 v[72:75], v21 offset:18432
v_add_u32_e64 v42, v42, v43
v_mfma_f32_16x16x32_bf16 v[244:247], a[36:39], v[80:83], v[244:247]
v_lshl_add_u32 v42, s36, 2, v42
v_lshlrev_b32_e64 v62, 7, v42
v_mfma_f32_16x16x32_bf16 v[252:255], a[36:39], v[84:87], v[252:255]
ds_read_b128 v[76:79], v21 offset:19456
v_lshrrev_b32_e64 v42, 4, v0
v_lshl_add_u32 v42, s36, 2, v42
v_mfma_f32_16x16x32_bf16 v[248:251], a[32:35], v[84:87], v[248:251]
v_xor_b32 v22, v42, v0
v_lshlrev_b32 v42, 12, v42
v_mfma_f32_16x16x32_bf16 v[240:243], a[40:43], v[88:91], v[240:243]
ds_read_b128 v[80:83], v21 offset:20480
v_bfe_u32 v43, v22, 2, 2
v_lshl_add_u32 v42, v43, 17, v42
v_mfma_f32_16x16x32_bf16 v[244:247], a[44:47], v[88:91], v[244:247]
v_and_b32_e64 v22, 3, v22
v_lshl_add_u32 v22, v22, 4, v42
v_mfma_f32_16x16x32_bf16 v[252:255], a[44:47], v[92:95], v[252:255]
buffer_store_dwordx4 v[52:55], v20, s[24:27], s68 offen offset:1024 sc1
ds_read_b128 v[84:87], v21 offset:21504
v_cvt_pk_bf16_f32 v48, v144, v145
v_mfma_f32_16x16x32_bf16 v[248:251], a[40:43], v[92:95], v[248:251]
v_cvt_pk_bf16_f32 v49, v146, v147
v_cvt_pk_bf16_f32 v50, v148, v149
v_mfma_f32_16x16x32_bf16 v[240:243], a[48:51], v[96:99], v[240:243]
ds_read_b128 v[88:91], v21 offset:22528
v_cvt_pk_bf16_f32 v51, v150, v151
v_cvt_pk_bf16_f32 v52, v152, v153
v_mfma_f32_16x16x32_bf16 v[244:247], a[52:55], v[96:99], v[244:247]
v_cvt_pk_bf16_f32 v53, v154, v155
v_cvt_pk_bf16_f32 v54, v156, v157
v_mfma_f32_16x16x32_bf16 v[252:255], a[52:55], v[100:103], v[252:255]
ds_read_b128 v[92:95], v21 offset:23552
v_cvt_pk_bf16_f32 v55, v158, v159
v_cvt_pk_bf16_f32 v7, v151, v159
v_mfma_f32_16x16x32_bf16 v[248:251], a[48:51], v[100:103], v[248:251]
v_bfi_b32 v51, s72, v51, v56
s_waitcnt lgkmcnt(3)
v_mfma_f32_16x16x32_bf16 v[240:243], a[56:59], v[104:107], v[240:243]
ds_read_b128 v[96:99], v21 offset:24576
v_bfi_b32 v55, s72, v55, v56
v_permlane32_swap_b32 v24, v26
v_mfma_f32_16x16x32_bf16 v[244:247], a[60:63], v[104:107], v[244:247]
buffer_store_dwordx4 v[48:51], v20, s[24:27], s68 offen offset:2048 sc1
v_permlane32_swap_b32_e64 v25, v27
v_mfma_f32_16x16x32_bf16 v[252:255], a[60:63], v[108:111], v[252:255]
ds_read_b128 v[100:103], v21 offset:25600
v_permlane32_swap_b32 v28, v30
v_permlane32_swap_b32 v29, v31
v_mfma_f32_16x16x32_bf16 v[248:251], a[56:59], v[108:111], v[248:251]
v_permlane32_swap_b32 v32, v34
v_permlane32_swap_b32 v33, v35
v_mfma_f32_16x16x32_bf16 v[240:243], a[64:67], v[64:67], v[240:243]
ds_read_b128 v[104:107], v21 offset:26624
v_permlane32_swap_b32 v36, v38
v_permlane32_swap_b32 v37, v39
v_mfma_f32_16x16x32_bf16 v[244:247], a[68:71], v[64:67], v[244:247]
v_lshlrev_b32_e64 v192, 16, v24
v_and_b32 v193, 0xffff0000, v24
v_mfma_f32_16x16x32_bf16 v[252:255], a[68:71], v[68:71], v[252:255]
buffer_store_dwordx4 v[52:55], v20, s[24:27], s68 offen offset:3072 sc1
ds_read_b128 v[108:111], v21 offset:27648
s_add_u32 s68, s68, 4096
v_mfma_f32_16x16x32_bf16 v[248:251], a[64:67], v[68:71], v[248:251]
v_lshlrev_b32_e64 v194, 16, v25
v_and_b32 v195, 0xffff0000, v25
v_mfma_f32_16x16x32_bf16 v[240:243], a[72:75], v[72:75], v[240:243]
ds_read_b128 v[64:67], v21 offset:28672
v_lshlrev_b32_e64 v196, 16, v26
v_and_b32 v197, 0xffff0000, v26
v_mfma_f32_16x16x32_bf16 v[244:247], a[76:79], v[72:75], v[244:247]
v_lshlrev_b32_e64 v198, 16, v27
v_and_b32 v199, 0xffff0000, v27
v_mfma_f32_16x16x32_bf16 v[252:255], a[76:79], v[76:79], v[252:255]
ds_read_b128 v[68:71], v21 offset:29696
v_lshlrev_b32_e64 v200, 16, v28
v_and_b32 v201, 0xffff0000, v28
v_mfma_f32_16x16x32_bf16 v[248:251], a[72:75], v[76:79], v[248:251]
v_lshlrev_b32 v202, 16, v29
v_and_b32 v203, 0xffff0000, v29
v_mfma_f32_16x16x32_bf16 v[240:243], a[80:83], v[80:83], v[240:243]
buffer_store_dwordx4 v[6:9], v20, s[24:27], s68 offen sc1
ds_read_b128 v[72:75], v21 offset:30720
v_cvt_pk_bf16_f32 v48, v160, v161
v_mfma_f32_16x16x32_bf16 v[244:247], a[84:87], v[80:83], v[244:247]
v_cvt_pk_bf16_f32 v49, v162, v163
s_waitcnt lgkmcnt(3)
v_mfma_f32_16x16x32_bf16 v[252:255], a[84:87], v[84:87], v[252:255]
ds_read_b128 v[76:79], v21 offset:31744
v_cvt_pk_bf16_f32 v50, v164, v165
v_cvt_pk_bf16_f32 v51, v166, v167
v_mfma_f32_16x16x32_bf16 v[248:251], a[80:83], v[84:87], v[248:251]
v_cvt_pk_bf16_f32 v52, v168, v169
v_cvt_pk_bf16_f32 v53, v170, v171
v_mfma_f32_16x16x32_bf16 v[240:243], a[88:91], v[88:91], v[240:243]
v_cvt_pk_bf16_f32 v54, v172, v173
v_cvt_pk_bf16_f32 v55, v174, v175
v_cvt_pk_bf16_f32 v6, v167, v175
v_mfma_f32_16x16x32_bf16 v[244:247], a[92:95], v[88:91], v[244:247]
v_bfi_b32 v51, s72, v51, v56
v_bfi_b32 v55, s72, v55, v56
v_mfma_f32_16x16x32_bf16 v[252:255], a[92:95], v[92:95], v[252:255]
buffer_store_dwordx4 v[48:51], v20, s[24:27], s69 offen offset:0 sc1
v_lshlrev_b32_e64 v204, 16, v30
v_and_b32 v205, 0xffff0000, v30
v_mfma_f32_16x16x32_bf16 v[248:251], a[88:91], v[92:95], v[248:251]
v_lshlrev_b32_e64 v206, 16, v31
v_and_b32 v207, 0xffff0000, v31
v_mfma_f32_16x16x32_bf16 v[240:243], a[96:99], v[96:99], v[240:243]
v_lshlrev_b32_e64 v208, 16, v32
v_and_b32 v209, 0xffff0000, v32
v_lshlrev_b32_e64 v210, 16, v33
v_mfma_f32_16x16x32_bf16 v[244:247], a[100:103], v[96:99], v[244:247]
v_and_b32 v211, 0xffff0000, v33
v_lshlrev_b32_e64 v212, 16, v34
v_mfma_f32_16x16x32_bf16 v[252:255], a[100:103], v[100:103], v[252:255]
s_waitcnt vmcnt(24) lgkmcnt(0)
s_barrier
ds_read_b128 v[80:83], v21 offset:32768
v_mfma_f32_16x16x32_bf16 v[248:251], a[96:99], v[100:103], v[248:251]
ds_read_b128 v[84:87], v21 offset:33792
v_and_b32 v213, 0xffff0000, v34
v_mfma_f32_16x16x32_bf16 v[240:243], a[104:107], v[104:107], v[240:243]
buffer_store_dwordx4 v[52:55], v20, s[24:27], s69 offen offset:1024 sc1
ds_read_b128 v[88:91], v21 offset:34816
v_cvt_pk_bf16_f32 v48, v176, v177
v_mfma_f32_16x16x32_bf16 v[244:247], a[108:111], v[104:107], v[244:247]
ds_read_b128 v[92:95], v21 offset:35840
v_cvt_pk_bf16_f32 v49, v178, v179
v_mfma_f32_16x16x32_bf16 v[252:255], a[108:111], v[108:111], v[252:255]
ds_read_b128 v[96:99], v21 offset:36864
v_cvt_pk_bf16_f32 v50, v180, v181
v_cvt_pk_bf16_f32 v51, v182, v183
v_mfma_f32_16x16x32_bf16 v[248:251], a[104:107], v[108:111], v[248:251]
ds_read_b128 v[100:103], v21 offset:37888
v_cvt_pk_bf16_f32 v52, v184, v185
v_mfma_f32_16x16x32_bf16 v[240:243], a[112:115], v[64:67], v[240:243]
ds_read_b128 v[104:107], v21 offset:38912
v_cvt_pk_bf16_f32 v53, v186, v187
v_cvt_pk_bf16_f32 v54, v188, v189
v_mfma_f32_16x16x32_bf16 v[244:247], a[116:119], v[64:67], v[244:247]
v_cvt_pk_bf16_f32 v55, v190, v191
v_cvt_pk_bf16_f32 v7, v183, v191
v_mfma_f32_16x16x32_bf16 v[252:255], a[116:119], v[68:71], v[252:255]
ds_read_b128 v[108:111], v21 offset:39936
s_waitcnt vmcnt(13)
v_bfi_b32 v51, s72, v51, v56
v_mfma_f32_16x16x32_bf16 v[248:251], a[112:115], v[68:71], v[248:251]
buffer_store_dword v56, v57, s[24:27], s83 offen offset:0 sc1
v_mfma_f32_16x16x32_bf16 v[240:243], a[120:123], v[72:75], v[240:243]
ds_read_b128 v[64:67], v21 offset:40960
v_bfi_b32 v55, s72, v55, v56
v_lshlrev_b32 v214, 16, v35
v_mfma_f32_16x16x32_bf16 v[244:247], a[124:127], v[72:75], v[244:247]
buffer_store_dwordx4 v[48:51], v20, s[24:27], s69 offen offset:2048 sc1
v_and_b32 v215, 0xffff0000, v35
v_mfma_f32_16x16x32_bf16 v[252:255], a[124:127], v[76:79], v[252:255]
ds_read_b128 v[68:71], v21 offset:41984
v_lshlrev_b32_e64 v216, 16, v36
v_and_b32 v217, 0xffff0000, v36
v_mfma_f32_16x16x32_bf16 v[248:251], a[120:123], v[76:79], v[248:251]
v_lshlrev_b32 v218, 16, v37
s_waitcnt lgkmcnt(3)
v_mfma_f32_16x16x32_bf16 v[240:243], a[128:131], v[80:83], v[240:243]
ds_read_b128 v[72:75], v21 offset:43008
v_and_b32 v219, 0xffff0000, v37
v_lshlrev_b32_e64 v220, 16, v38
v_mfma_f32_16x16x32_bf16 v[244:247], a[132:135], v[80:83], v[244:247]
v_and_b32 v221, 0xffff0000, v38
v_lshlrev_b32_e64 v222, 16, v39
v_mfma_f32_16x16x32_bf16 v[252:255], a[132:135], v[84:87], v[252:255]
buffer_store_dwordx4 v[52:55], v20, s[24:27], s69 offen offset:3072 sc1
ds_read_b128 v[76:79], v21 offset:44032
s_add_u32 s69, s69, 4096
v_mfma_f32_16x16x32_bf16 v[248:251], a[128:131], v[84:87], v[248:251]
v_and_b32 v223, 0xffff0000, v39
v_mfma_f32_16x16x32_bf16 v[240:243], a[136:139], v[88:91], v[240:243]
ds_read_b128 v[80:83], v21 offset:45056
s_waitcnt vmcnt(14)
v_permlane32_swap_b32 v224, v226
v_mfma_f32_16x16x32_bf16 v[244:247], a[140:143], v[88:91], v[244:247]
v_permlane32_swap_b32 v225, v227
v_lshlrev_b32 v44, 16, v224
v_mfma_f32_16x16x32_bf16 v[252:255], a[140:143], v[92:95], v[252:255]
ds_read_b128 v[84:87], v21 offset:46080
v_and_b32 v45, 0xffff0000, v224
v_add_f32_e64 v192, v192, v44
v_mfma_f32_16x16x32_bf16 v[248:251], a[136:139], v[92:95], v[248:251]
v_add_f32 v193, v193, v45
v_add_f32 v200, v200, v44
v_mfma_f32_16x16x32_bf16 v[240:243], a[144:147], v[96:99], v[240:243]
buffer_store_dwordx4 v[6:9], v20, s[24:27], s69 offen sc1
ds_read_b128 v[88:91], v21 offset:47104
v_add_f32_e64 v201, v201, v45
v_mfma_f32_16x16x32_bf16 v[244:247], a[148:151], v[96:99], v[244:247]
v_add_f32 v208, v208, v44
v_add_f32 v209, v209, v45
v_mfma_f32_16x16x32_bf16 v[252:255], a[148:151], v[100:103], v[252:255]
ds_read_b128 v[92:95], v21 offset:48128
v_add_f32 v216, v216, v44
v_add_f32 v217, v217, v45
v_mfma_f32_16x16x32_bf16 v[248:251], a[144:147], v[100:103], v[248:251]
v_lshlrev_b32_e64 v46, 16, v225
v_and_b32 v47, 0xffff0000, v225
v_mfma_f32_16x16x32_bf16 v[240:243], a[152:155], v[104:107], v[240:243]
ds_read_b128 v[96:99], v21 offset:49152
v_add_f32 v194, v194, v46
v_add_f32 v195, v195, v47
v_mfma_f32_16x16x32_bf16 v[244:247], a[156:159], v[104:107], v[244:247]
v_add_f32 v202, v202, v46
s_waitcnt lgkmcnt(3)
v_mfma_f32_16x16x32_bf16 v[252:255], a[156:159], v[108:111], v[252:255]
ds_read_b128 v[100:103], v21 offset:50176
v_add_f32 v203, v203, v47
v_add_f32 v210, v210, v46
v_mfma_f32_16x16x32_bf16 v[248:251], a[152:155], v[108:111], v[248:251]
v_add_f32 v211, v211, v47
v_add_f32 v218, v218, v46
v_mfma_f32_16x16x32_bf16 v[240:243], a[160:163], v[64:67], v[240:243]
ds_read_b128 v[104:107], v21 offset:51200
v_add_f32 v219, v219, v47
v_lshlrev_b32 v44, 16, v226
v_mfma_f32_16x16x32_bf16 v[244:247], a[164:167], v[64:67], v[244:247]
v_and_b32 v45, 0xffff0000, v226
v_add_f32_e64 v196, v196, v44
v_mfma_f32_16x16x32_bf16 v[252:255], a[164:167], v[68:71], v[252:255]
ds_read_b128 v[108:111], v21 offset:52224
v_add_f32 v197, v197, v45
v_add_f32 v204, v204, v44
v_mfma_f32_16x16x32_bf16 v[248:251], a[160:163], v[68:71], v[248:251]
v_add_f32 v205, v205, v45
v_add_f32 v212, v212, v44
v_mfma_f32_16x16x32_bf16 v[240:243], a[168:171], v[72:75], v[240:243]
ds_read_b128 v[64:67], v21 offset:53248
v_add_f32 v213, v213, v45
v_add_f32 v220, v220, v44
v_mfma_f32_16x16x32_bf16 v[244:247], a[172:175], v[72:75], v[244:247]
v_add_f32 v221, v221, v45
v_lshlrev_b32 v46, 16, v227
v_mfma_f32_16x16x32_bf16 v[252:255], a[172:175], v[76:79], v[252:255]
ds_read_b128 v[68:71], v21 offset:54272
v_and_b32 v47, 0xffff0000, v227
v_add_f32_e64 v198, v198, v46
v_mfma_f32_16x16x32_bf16 v[248:251], a[168:171], v[76:79], v[248:251]
v_add_f32 v199, v199, v47
v_add_f32 v206, v206, v46
v_mfma_f32_16x16x32_bf16 v[240:243], a[176:179], v[80:83], v[240:243]
ds_read_b128 v[72:75], v21 offset:55296
v_add_f32 v207, v207, v47
v_add_f32 v214, v214, v46
v_mfma_f32_16x16x32_bf16 v[244:247], a[180:183], v[80:83], v[244:247]
v_add_f32 v215, v215, v47
v_add_f32 v222, v222, v46
v_mfma_f32_16x16x32_bf16 v[252:255], a[180:183], v[84:87], v[252:255]
ds_read_b128 v[76:79], v21 offset:56320
v_add_f32 v223, v223, v47
v_mfma_f32_16x16x32_bf16 v[248:251], a[176:179], v[84:87], v[248:251]
s_add_u32 s45, s71, 4096
s_waitcnt lgkmcnt(3)
v_mfma_f32_16x16x32_bf16 v[240:243], a[184:187], v[88:91], v[240:243]
s_add_u32 s46, s71, 8192
s_add_u32 s62, s71, 12288
v_mfma_f32_16x16x32_bf16 v[244:247], a[188:191], v[88:91], v[244:247]
v_mfma_f32_16x16x32_bf16 v[252:255], a[188:191], v[92:95], v[252:255]
v_mfma_f32_16x16x32_bf16 v[248:251], a[184:187], v[92:95], v[248:251]
v_mfma_f32_16x16x32_bf16 v[240:243], a[192:195], v[96:99], v[240:243]
v_mfma_f32_16x16x32_bf16 v[244:247], a[196:199], v[96:99], v[244:247]
v_mfma_f32_16x16x32_bf16 v[252:255], a[196:199], v[100:103], v[252:255]
s_waitcnt lgkmcnt(0)
s_barrier
ds_read_b128 v[80:83], v20 offset:0
v_mfma_f32_16x16x32_bf16 v[248:251], a[192:195], v[100:103], v[248:251]
ds_read_b128 v[84:87], v20 offset:1024
v_mfma_f32_16x16x32_bf16 v[240:243], a[200:203], v[104:107], v[240:243]
ds_read_b128 v[88:91], v20 offset:2048
v_mfma_f32_16x16x32_bf16 v[244:247], a[204:207], v[104:107], v[244:247]
ds_read_b128 v[92:95], v20 offset:3072
v_mfma_f32_16x16x32_bf16 v[252:255], a[204:207], v[108:111], v[252:255]
ds_read_b128 v[96:99], v20 offset:4096
v_mfma_f32_16x16x32_bf16 v[248:251], a[200:203], v[108:111], v[248:251]
ds_read_b128 v[100:103], v20 offset:5120
v_mfma_f32_16x16x32_bf16 v[240:243], a[208:211], v[64:67], v[240:243]
ds_read_b128 v[104:107], v20 offset:6144
v_mfma_f32_16x16x32_bf16 v[244:247], a[212:215], v[64:67], v[244:247]
v_mfma_f32_16x16x32_bf16 v[252:255], a[212:215], v[68:71], v[252:255]
ds_read_b128 v[108:111], v20 offset:7168
v_mfma_f32_16x16x32_bf16 v[248:251], a[208:211], v[68:71], v[248:251]
v_mfma_f32_16x16x32_bf16 v[240:243], a[216:219], v[72:75], v[240:243]
ds_read_b128 v[64:67], v20 offset:8192
v_mfma_f32_16x16x32_bf16 v[244:247], a[220:223], v[72:75], v[244:247]
v_mfma_f32_16x16x32_bf16 v[252:255], a[220:223], v[76:79], v[252:255]
ds_read_b128 v[68:71], v20 offset:9216
v_mfma_f32_16x16x32_bf16 v[248:251], a[216:219], v[76:79], v[248:251]
s_waitcnt lgkmcnt(3)
v_mfma_f32_16x16x32_bf16 v[128:131], a[0:3], v[80:83], 0
ds_read_b128 v[72:75], v20 offset:10240
v_mfma_f32_16x16x32_bf16 v[132:135], a[4:7], v[80:83], 0
v_mfma_f32_16x16x32_bf16 v[140:143], a[4:7], v[84:87], 0
ds_read_b128 v[76:79], v20 offset:11264
v_mfma_f32_16x16x32_bf16 v[136:139], a[0:3], v[84:87], 0
v_mfma_f32_16x16x32_bf16 v[128:131], a[8:11], v[88:91], v[128:131]
buffer_load_dword v23, v1, s[24:27], s59 offen offset:512 sc1
ds_read_b128 v[80:83], v20 offset:12288
v_mfma_f32_16x16x32_bf16 v[132:135], a[12:15], v[88:91], v[132:135]
v_cvt_pk_bf16_f32 v48, v240, v241
v_cvt_pk_bf16_f32 v49, v242, v243
v_mfma_f32_16x16x32_bf16 v[140:143], a[12:15], v[92:95], v[140:143]
ds_read_b128 v[84:87], v20 offset:13312
v_cvt_pk_bf16_f32 v50, v244, v245
v_cvt_pk_bf16_f32 v51, v246, v247
v_mfma_f32_16x16x32_bf16 v[136:139], a[8:11], v[92:95], v[136:139]
v_cvt_pk_bf16_f32 v52, v248, v249
v_cvt_pk_bf16_f32 v53, v250, v251
v_mfma_f32_16x16x32_bf16 v[128:131], a[16:19], v[96:99], v[128:131]
ds_read_b128 v[88:91], v20 offset:14336
v_cvt_pk_bf16_f32 v54, v252, v253
v_cvt_pk_bf16_f32 v55, v254, v255
v_mfma_f32_16x16x32_bf16 v[132:135], a[20:23], v[96:99], v[132:135]
v_cvt_pk_bf16_f32 v8, v247, v255
v_bfi_b32 v51, s72, v51, v56
v_mfma_f32_16x16x32_bf16 v[140:143], a[20:23], v[100:103], v[140:143]
ds_read_b128 v[92:95], v20 offset:15360
v_bfi_b32 v55, s72, v55, v56
v_mfma_f32_16x16x32_bf16 v[136:139], a[16:19], v[100:103], v[136:139]
buffer_store_dwordx4 v[48:51], v20, s[24:27], s70 offen offset:0 sc1
v_mfma_f32_16x16x32_bf16 v[128:131], a[24:27], v[104:107], v[128:131]
ds_read_b128 v[96:99], v20 offset:16384
v_mfma_f32_16x16x32_bf16 v[132:135], a[28:31], v[104:107], v[132:135]
s_waitcnt lgkmcnt(3)
v_mfma_f32_16x16x32_bf16 v[140:143], a[28:31], v[108:111], v[140:143]
ds_read_b128 v[100:103], v20 offset:17408
v_mfma_f32_16x16x32_bf16 v[136:139], a[24:27], v[108:111], v[136:139]
v_mfma_f32_16x16x32_bf16 v[128:131], a[32:35], v[64:67], v[128:131]
buffer_store_dwordx4 v[52:55], v20, s[24:27], s70 offen offset:1024 sc1
ds_read_b128 v[104:107], v20 offset:18432
v_mfma_f32_16x16x32_bf16 v[132:135], a[36:39], v[64:67], v[132:135]
v_mfma_f32_16x16x32_bf16 v[140:143], a[36:39], v[68:71], v[140:143]
ds_read_b128 v[108:111], v20 offset:19456
v_mfma_f32_16x16x32_bf16 v[136:139], a[32:35], v[68:71], v[136:139]
v_mfma_f32_16x16x32_bf16 v[128:131], a[40:43], v[72:75], v[128:131]
ds_read_b128 v[64:67], v20 offset:20480
v_mfma_f32_16x16x32_bf16 v[132:135], a[44:47], v[72:75], v[132:135]
v_mfma_f32_16x16x32_bf16 v[140:143], a[44:47], v[76:79], v[140:143]
buffer_store_dwordx2 v[8:9], v63, s[24:27], s70 offen offset:2048 sc1
ds_read_b128 v[68:71], v20 offset:21504
v_mfma_f32_16x16x32_bf16 v[136:139], a[40:43], v[76:79], v[136:139]
s_add_u32 s70, s70, 1024
v_mfma_f32_16x16x32_bf16 v[128:131], a[48:51], v[80:83], v[128:131]
ds_read_b128 v[72:75], v20 offset:22528
v_mfma_f32_16x16x32_bf16 v[132:135], a[52:55], v[80:83], v[132:135]
v_mfma_f32_16x16x32_bf16 v[140:143], a[52:55], v[84:87], v[140:143]
ds_read_b128 v[76:79], v20 offset:23552
v_mfma_f32_16x16x32_bf16 v[136:139], a[48:51], v[84:87], v[136:139]
s_waitcnt lgkmcnt(3)
v_mfma_f32_16x16x32_bf16 v[128:131], a[56:59], v[88:91], v[128:131]
ds_read_b128 v[80:83], v20 offset:24576
v_mfma_f32_16x16x32_bf16 v[132:135], a[60:63], v[88:91], v[132:135]
v_mfma_f32_16x16x32_bf16 v[140:143], a[60:63], v[92:95], v[140:143]
ds_read_b128 v[84:87], v20 offset:25600
v_mfma_f32_16x16x32_bf16 v[136:139], a[56:59], v[92:95], v[136:139]
v_mfma_f32_16x16x32_bf16 v[128:131], a[64:67], v[96:99], v[128:131]
ds_read_b128 v[88:91], v20 offset:26624
v_mfma_f32_16x16x32_bf16 v[132:135], a[68:71], v[96:99], v[132:135]
v_mfma_f32_16x16x32_bf16 v[140:143], a[68:71], v[100:103], v[140:143]
ds_read_b128 v[92:95], v20 offset:27648
v_mfma_f32_16x16x32_bf16 v[136:139], a[64:67], v[100:103], v[136:139]
v_mfma_f32_16x16x32_bf16 v[128:131], a[72:75], v[104:107], v[128:131]
ds_read_b128 v[96:99], v20 offset:28672
v_mfma_f32_16x16x32_bf16 v[132:135], a[76:79], v[104:107], v[132:135]
v_mfma_f32_16x16x32_bf16 v[140:143], a[76:79], v[108:111], v[140:143]
ds_read_b128 v[100:103], v20 offset:29696
v_mfma_f32_16x16x32_bf16 v[136:139], a[72:75], v[108:111], v[136:139]
v_mfma_f32_16x16x32_bf16 v[128:131], a[80:83], v[64:67], v[128:131]
ds_read_b128 v[104:107], v20 offset:30720
s_add_u32 m0, s48, 0x10000
s_add_u32 s49, s55, 344064
v_mfma_f32_16x16x32_bf16 v[132:135], a[84:87], v[64:67], v[132:135]
s_waitcnt lgkmcnt(3)
v_mfma_f32_16x16x32_bf16 v[140:143], a[84:87], v[68:71], v[140:143]
ds_read_b128 v[108:111], v20 offset:31744
v_mfma_f32_16x16x32_bf16 v[136:139], a[80:83], v[68:71], v[136:139]
v_mfma_f32_16x16x32_bf16 v[128:131], a[88:91], v[72:75], v[128:131]
s_waitcnt vmcnt(3)
v_cmp_ne_u32 vcc, s53, v23
s_cbranch_vccnz L_spin16
L_back16:
v_mfma_f32_16x16x32_bf16 v[132:135], a[92:95], v[72:75], v[132:135]
v_mfma_f32_16x16x32_bf16 v[140:143], a[92:95], v[76:79], v[140:143]
v_mfma_f32_16x16x32_bf16 v[136:139], a[88:91], v[76:79], v[136:139]
v_mfma_f32_16x16x32_bf16 v[128:131], a[96:99], v[80:83], v[128:131]
v_mfma_f32_16x16x32_bf16 v[132:135], a[100:103], v[80:83], v[132:135]
v_mfma_f32_16x16x32_bf16 v[140:143], a[100:103], v[84:87], v[140:143]
s_waitcnt lgkmcnt(0)
s_barrier
ds_read_b128 v[64:67], v20 offset:32768
v_mfma_f32_16x16x32_bf16 v[136:139], a[96:99], v[84:87], v[136:139]
ds_read_b128 v[68:71], v20 offset:33792
v_mfma_f32_16x16x32_bf16 v[128:131], a[104:107], v[88:91], v[128:131]
buffer_load_dwordx4 v20, s[24:27], s49 offen offset:0 sc1 lds
ds_read_b128 v[72:75], v20 offset:34816
v_mfma_f32_16x16x32_bf16 v[132:135], a[108:111], v[88:91], v[132:135]
ds_read_b128 v[76:79], v20 offset:35840
v_mfma_f32_16x16x32_bf16 v[140:143], a[108:111], v[92:95], v[140:143]
buffer_load_dwordx4 v20, s[24:27], s49 offen offset:1024 sc1 lds
ds_read_b128 v[80:83], v20 offset:36864
v_mfma_f32_16x16x32_bf16 v[136:139], a[104:107], v[92:95], v[136:139]
ds_read_b128 v[84:87], v20 offset:37888
v_mfma_f32_16x16x32_bf16 v[128:131], a[112:115], v[96:99], v[128:131]
buffer_load_dwordx4 v20, s[24:27], s49 offen offset:2048 sc1 lds
ds_read_b128 v[88:91], v20 offset:38912
v_mfma_f32_16x16x32_bf16 v[132:135], a[116:119], v[96:99], v[132:135]
v_mfma_f32_16x16x32_bf16 v[140:143], a[116:119], v[100:103], v[140:143]
buffer_load_dwordx4 v20, s[24:27], s49 offen offset:3072 sc1 lds
ds_read_b128 v[92:95], v20 offset:39936
v_mfma_f32_16x16x32_bf16 v[136:139], a[112:115], v[100:103], v[136:139]
s_add_u32 m0, s48, 0x11000
s_add_u32 s49, s55, 348160
v_mfma_f32_16x16x32_bf16 v[128:131], a[120:123], v[104:107], v[128:131]
buffer_load_dwordx4 v20, s[24:27], s49 offen offset:0 sc1 lds
ds_read_b128 v[96:99], v20 offset:40960
v_mfma_f32_16x16x32_bf16 v[132:135], a[124:127], v[104:107], v[132:135]
v_mfma_f32_16x16x32_bf16 v[140:143], a[124:127], v[108:111], v[140:143]
buffer_load_dwordx4 v20, s[24:27], s49 offen offset:1024 sc1 lds
ds_read_b128 v[100:103], v20 offset:41984
v_mfma_f32_16x16x32_bf16 v[136:139], a[120:123], v[108:111], v[136:139]
s_waitcnt lgkmcnt(3)
v_mfma_f32_16x16x32_bf16 v[128:131], a[128:131], v[64:67], v[128:131]
buffer_load_dwordx4 v20, s[24:27], s49 offen offset:2048 sc1 lds
ds_read_b128 v[104:107], v20 offset:43008
v_mfma_f32_16x16x32_bf16 v[132:135], a[132:135], v[64:67], v[132:135]
v_mfma_f32_16x16x32_bf16 v[140:143], a[132:135], v[68:71], v[140:143]
buffer_load_dwordx4 v20, s[24:27], s49 offen offset:3072 sc1 lds
ds_read_b128 v[108:111], v20 offset:44032
v_mfma_f32_16x16x32_bf16 v[136:139], a[128:131], v[68:71], v[136:139]
s_add_u32 m0, s5, 0x18000
s_add_u32 s49, s56, 344064
v_mfma_f32_16x16x32_bf16 v[128:131], a[136:139], v[72:75], v[128:131]
buffer_load_dwordx4 v20, s[24:27], s49 offen offset:0 sc1 lds
ds_read_b128 v[64:67], v20 offset:45056
v_mfma_f32_16x16x32_bf16 v[132:135], a[140:143], v[72:75], v[132:135]
v_mfma_f32_16x16x32_bf16 v[140:143], a[140:143], v[76:79], v[140:143]
buffer_load_dwordx4 v20, s[24:27], s49 offen offset:1024 sc1 lds
ds_read_b128 v[68:71], v20 offset:46080
v_mfma_f32_16x16x32_bf16 v[136:139], a[136:139], v[76:79], v[136:139]
s_add_u32 s49, s57, 344064
v_mfma_f32_16x16x32_bf16 v[128:131], a[144:147], v[80:83], v[128:131]
buffer_load_dwordx4 v20, s[24:27], s49 offen offset:2048 sc1 lds
ds_read_b128 v[72:75], v20 offset:47104
v_mfma_f32_16x16x32_bf16 v[132:135], a[148:151], v[80:83], v[132:135]
v_mfma_f32_16x16x32_bf16 v[140:143], a[148:151], v[84:87], v[140:143]
buffer_load_dwordx4 v20, s[24:27], s49 offen offset:3072 sc1 lds
ds_read_b128 v[76:79], v20 offset:48128
v_mfma_f32_16x16x32_bf16 v[136:139], a[144:147], v[84:87], v[136:139]
s_add_u32 m0, s5, 0x19000
s_add_u32 s49, s58, 344064
v_mfma_f32_16x16x32_bf16 v[128:131], a[152:155], v[88:91], v[128:131]
buffer_load_dwordx4 v20, s[24:27], s49 offen offset:0 sc1 lds
ds_read_b128 v[80:83], v20 offset:49152
v_mfma_f32_16x16x32_bf16 v[132:135], a[156:159], v[88:91], v[132:135]
s_waitcnt lgkmcnt(3)
v_mfma_f32_16x16x32_bf16 v[140:143], a[156:159], v[92:95], v[140:143]
buffer_load_dwordx4 v20, s[24:27], s49 offen offset:1024 sc1 lds
ds_read_b128 v[84:87], v20 offset:50176
v_mfma_f32_16x16x32_bf16 v[136:139], a[152:155], v[92:95], v[136:139]
s_add_u32 m0, s48, 0x0
s_add_u32 s49, s55, 401408
v_mfma_f32_16x16x32_bf16 v[128:131], a[160:163], v[96:99], v[128:131]
buffer_load_dwordx4 v20, s[24:27], s49 offen offset:0 sc1 lds
ds_read_b128 v[88:91], v20 offset:51200
v_mfma_f32_16x16x32_bf16 v[132:135], a[164:167], v[96:99], v[132:135]
v_mfma_f32_16x16x32_bf16 v[140:143], a[164:167], v[100:103], v[140:143]
buffer_load_dwordx4 v20, s[24:27], s49 offen offset:1024 sc1 lds
ds_read_b128 v[92:95], v20 offset:52224
v_mfma_f32_16x16x32_bf16 v[136:139], a[160:163], v[100:103], v[136:139]
v_mfma_f32_16x16x32_bf16 v[128:131], a[168:171], v[104:107], v[128:131]
buffer_load_dwordx4 v20, s[24:27], s49 offen offset:2048 sc1 lds
ds_read_b128 v[96:99], v20 offset:53248
v_mfma_f32_16x16x32_bf16 v[132:135], a[172:175], v[104:107], v[132:135]
v_mfma_f32_16x16x32_bf16 v[140:143], a[172:175], v[108:111], v[140:143]
buffer_load_dwordx4 v20, s[24:27], s49 offen offset:3072 sc1 lds
ds_read_b128 v[100:103], v20 offset:54272
v_mfma_f32_16x16x32_bf16 v[136:139], a[168:171], v[108:111], v[136:139]
s_add_u32 m0, s48, 0x1000
s_add_u32 s49, s55, 405504
v_mfma_f32_16x16x32_bf16 v[128:131], a[176:179], v[64:67], v[128:131]
buffer_load_dwordx4 v20, s[24:27], s49 offen offset:0 sc1 lds
ds_read_b128 v[104:107], v20 offset:55296
v_mfma_f32_16x16x32_bf16 v[132:135], a[180:183], v[64:67], v[132:135]
v_mfma_f32_16x16x32_bf16 v[140:143], a[180:183], v[68:71], v[140:143]
buffer_load_dwordx4 v20, s[24:27], s49 offen offset:1024 sc1 lds
ds_read_b128 v[108:111], v20 offset:56320
v_mfma_f32_16x16x32_bf16 v[136:139], a[176:179], v[68:71], v[136:139]
s_waitcnt lgkmcnt(3)
v_mfma_f32_16x16x32_bf16 v[128:131], a[184:187], v[72:75], v[128:131]
buffer_load_dwordx4 v20, s[24:27], s49 offen offset:2048 sc1 lds
v_mfma_f32_16x16x32_bf16 v[132:135], a[188:191], v[72:75], v[132:135]
v_mfma_f32_16x16x32_bf16 v[140:143], a[188:191], v[76:79], v[140:143]
buffer_load_dwordx4 v20, s[24:27], s49 offen offset:3072 sc1 lds
s_add_u32 m0, s5, 0x8000
v_mfma_f32_16x16x32_bf16 v[136:139], a[184:187], v[76:79], v[136:139]
s_add_u32 s49, s56, 401408
v_mfma_f32_16x16x32_bf16 v[128:131], a[192:195], v[80:83], v[128:131]
v_mfma_f32_16x16x32_bf16 v[132:135], a[196:199], v[80:83], v[132:135]
v_mfma_f32_16x16x32_bf16 v[140:143], a[196:199], v[84:87], v[140:143]
s_waitcnt vmcnt(14) lgkmcnt(0)
s_barrier
ds_read_b128 v[64:67], v21 offset:0
v_mfma_f32_16x16x32_bf16 v[136:139], a[192:195], v[84:87], v[136:139]
ds_read_b128 v[68:71], v21 offset:1024
v_mfma_f32_16x16x32_bf16 v[128:131], a[200:203], v[88:91], v[128:131]
buffer_load_dwordx4 v20, s[24:27], s49 offen offset:0 sc1 lds
ds_read_b128 v[72:75], v21 offset:2048
v_mfma_f32_16x16x32_bf16 v[132:135], a[204:207], v[88:91], v[132:135]
ds_read_b128 v[76:79], v21 offset:3072
v_mfma_f32_16x16x32_bf16 v[140:143], a[204:207], v[92:95], v[140:143]
buffer_load_dwordx4 v20, s[24:27], s49 offen offset:1024 sc1 lds
ds_read_b128 v[80:83], v21 offset:4096
v_mfma_f32_16x16x32_bf16 v[136:139], a[200:203], v[92:95], v[136:139]
ds_read_b128 v[84:87], v21 offset:5120
s_add_u32 s49, s57, 401408
v_mfma_f32_16x16x32_bf16 v[128:131], a[208:211], v[96:99], v[128:131]
buffer_load_dwordx4 v20, s[24:27], s49 offen offset:2048 sc1 lds
ds_read_b128 v[88:91], v21 offset:6144
v_mfma_f32_16x16x32_bf16 v[132:135], a[212:215], v[96:99], v[132:135]
v_mfma_f32_16x16x32_bf16 v[140:143], a[212:215], v[100:103], v[140:143]
buffer_load_dwordx4 v20, s[24:27], s49 offen offset:3072 sc1 lds
ds_read_b128 v[92:95], v21 offset:7168
v_mfma_f32_16x16x32_bf16 v[136:139], a[208:211], v[100:103], v[136:139]
s_add_u32 m0, s5, 0x9000
s_add_u32 s49, s58, 401408
v_mfma_f32_16x16x32_bf16 v[128:131], a[216:219], v[104:107], v[128:131]
buffer_load_dwordx4 v20, s[24:27], s49 offen offset:0 sc1 lds
ds_read_b128 v[96:99], v21 offset:8192
v_mfma_f32_16x16x32_bf16 v[132:135], a[220:223], v[104:107], v[132:135]
v_mfma_f32_16x16x32_bf16 v[140:143], a[220:223], v[108:111], v[140:143]
buffer_load_dwordx4 v20, s[24:27], s49 offen offset:1024 sc1 lds
ds_read_b128 v[100:103], v21 offset:9216
v_mfma_f32_16x16x32_bf16 v[136:139], a[216:219], v[108:111], v[136:139]
s_waitcnt lgkmcnt(3)
v_mfma_f32_16x16x32_bf16 v[144:147], a[0:3], v[64:67], 0
ds_read_b128 v[104:107], v21 offset:10240
v_mfma_f32_16x16x32_bf16 v[148:151], a[4:7], v[64:67], 0
v_mfma_f32_16x16x32_bf16 v[156:159], a[4:7], v[68:71], 0
buffer_load_dword v3, v62, s[24:27], s79 offen sc1
ds_read_b128 v[108:111], v21 offset:11264
v_mfma_f32_16x16x32_bf16 v[152:155], a[0:3], v[68:71], 0
v_mfma_f32_16x16x32_bf16 v[144:147], a[8:11], v[72:75], v[144:147]
buffer_load_dwordx4 v[112:115], v20, s[24:27], s71 offen offset:0 sc1
ds_read_b128 v[64:67], v21 offset:12288
v_mfma_f32_16x16x32_bf16 v[148:151], a[12:15], v[72:75], v[148:151]
v_cvt_pk_bf16_f32 v48, v128, v129
v_cvt_pk_bf16_f32 v49, v130, v131
v_mfma_f32_16x16x32_bf16 v[156:159], a[12:15], v[76:79], v[156:159]
buffer_load_dwordx4 v[116:119], v20, s[24:27], s71 offen offset:1024 sc1
ds_read_b128 v[68:71], v21 offset:13312
v_mfma_f32_16x16x32_bf16 v[152:155], a[8:11], v[76:79], v[152:155]
v_cvt_pk_bf16_f32 v50, v132, v133
v_cvt_pk_bf16_f32 v51, v134, v135
v_mfma_f32_16x16x32_bf16 v[144:147], a[16:19], v[80:83], v[144:147]
buffer_load_dwordx4 v[120:123], v20, s[24:27], s71 offen offset:2048 sc1
ds_read_b128 v[72:75], v21 offset:14336
v_mfma_f32_16x16x32_bf16 v[148:151], a[20:23], v[80:83], v[148:151]
v_cvt_pk_bf16_f32 v52, v136, v137
v_cvt_pk_bf16_f32 v53, v138, v139
v_mfma_f32_16x16x32_bf16 v[156:159], a[20:23], v[84:87], v[156:159]
buffer_load_dwordx4 v[124:127], v20, s[24:27], s71 offen offset:3072 sc1
ds_read_b128 v[76:79], v21 offset:15360
v_mfma_f32_16x16x32_bf16 v[152:155], a[16:19], v[84:87], v[152:155]
v_cvt_pk_bf16_f32 v54, v140, v141
v_cvt_pk_bf16_f32 v55, v142, v143
v_mfma_f32_16x16x32_bf16 v[144:147], a[24:27], v[88:91], v[144:147]
buffer_load_dwordx4 v[188:191], v20, s[24:27], s45 offen offset:0 sc1
ds_read_b128 v[80:83], v21 offset:16384
v_mfma_f32_16x16x32_bf16 v[148:151], a[28:31], v[88:91], v[148:151]
v_cvt_pk_bf16_f32 v8, v135, v143
s_waitcnt lgkmcnt(3)
v_mfma_f32_16x16x32_bf16 v[156:159], a[28:31], v[92:95], v[156:159]
ds_read_b128 v[84:87], v21 offset:17408
v_bfi_b32 v51, s72, v51, v56
v_bfi_b32 v55, s72, v55, v56
v_mfma_f32_16x16x32_bf16 v[152:155], a[24:27], v[92:95], v[152:155]
v_mfma_f32_16x16x32_bf16 v[144:147], a[32:35], v[96:99], v[144:147]
buffer_load_dwordx4 v[24:27], v20, s[24:27], s45 offen offset:1024 sc1
ds_read_b128 v[88:91], v21 offset:18432
v_mfma_f32_16x16x32_bf16 v[148:151], a[36:39], v[96:99], v[148:151]
v_mfma_f32_16x16x32_bf16 v[156:159], a[36:39], v[100:103], v[156:159]
buffer_load_dwordx4 v[28:31], v20, s[24:27], s45 offen offset:2048 sc1
ds_read_b128 v[92:95], v21 offset:19456
v_mfma_f32_16x16x32_bf16 v[152:155], a[32:35], v[100:103], v[152:155]
v_mfma_f32_16x16x32_bf16 v[144:147], a[40:43], v[104:107], v[144:147]
buffer_load_dwordx4 v[32:35], v20, s[24:27], s45 offen offset:3072 sc1
ds_read_b128 v[96:99], v21 offset:20480
v_mfma_f32_16x16x32_bf16 v[148:151], a[44:47], v[104:107], v[148:151]
v_mfma_f32_16x16x32_bf16 v[156:159], a[44:47], v[108:111], v[156:159]
buffer_load_dwordx4 v[36:39], v20, s[24:27], s46 offen offset:0 sc1
ds_read_b128 v[100:103], v21 offset:21504
v_mfma_f32_16x16x32_bf16 v[152:155], a[40:43], v[108:111], v[152:155]
v_mfma_f32_16x16x32_bf16 v[144:147], a[48:51], v[64:67], v[144:147]
buffer_load_dwordx4 v[40:43], v20, s[24:27], s46 offen offset:1024 sc1
ds_read_b128 v[104:107], v21 offset:22528
v_mfma_f32_16x16x32_bf16 v[148:151], a[52:55], v[64:67], v[148:151]
v_mfma_f32_16x16x32_bf16 v[156:159], a[52:55], v[68:71], v[156:159]
ds_read_b128 v[108:111], v21 offset:23552
v_mfma_f32_16x16x32_bf16 v[152:155], a[48:51], v[68:71], v[152:155]
s_waitcnt lgkmcnt(3)
v_mfma_f32_16x16x32_bf16 v[144:147], a[56:59], v[72:75], v[144:147]
buffer_store_dwordx4 v[48:51], v20, s[24:27], s70 offen offset:2048 sc1
ds_read_b128 v[64:67], v21 offset:24576
v_mfma_f32_16x16x32_bf16 v[148:151], a[60:63], v[72:75], v[148:151]
v_mfma_f32_16x16x32_bf16 v[156:159], a[60:63], v[76:79], v[156:159]
ds_read_b128 v[68:71], v21 offset:25600
v_mfma_f32_16x16x32_bf16 v[152:155], a[56:59], v[76:79], v[152:155]
v_mfma_f32_16x16x32_bf16 v[144:147], a[64:67], v[80:83], v[144:147]
ds_read_b128 v[72:75], v21 offset:26624
v_mfma_f32_16x16x32_bf16 v[148:151], a[68:71], v[80:83], v[148:151]
v_mfma_f32_16x16x32_bf16 v[156:159], a[68:71], v[84:87], v[156:159]
buffer_store_dwordx4 v[52:55], v20, s[24:27], s70 offen offset:3072 sc1
ds_read_b128 v[76:79], v21 offset:27648
v_mfma_f32_16x16x32_bf16 v[152:155], a[64:67], v[84:87], v[152:155]
v_mfma_f32_16x16x32_bf16 v[144:147], a[72:75], v[88:91], v[144:147]
ds_read_b128 v[80:83], v21 offset:28672
v_mfma_f32_16x16x32_bf16 v[148:151], a[76:79], v[88:91], v[148:151]
v_mfma_f32_16x16x32_bf16 v[156:159], a[76:79], v[92:95], v[156:159]
ds_read_b128 v[84:87], v21 offset:29696
v_mfma_f32_16x16x32_bf16 v[152:155], a[72:75], v[92:95], v[152:155]
v_mfma_f32_16x16x32_bf16 v[144:147], a[80:83], v[96:99], v[144:147]
buffer_store_dwordx2 v[8:9], v63, s[24:27], s70 offen offset:1536 sc1
ds_read_b128 v[88:91], v21 offset:30720
v_mfma_f32_16x16x32_bf16 v[148:151], a[84:87], v[96:99], v[148:151]
s_waitcnt lgkmcnt(3)
v_mfma_f32_16x16x32_bf16 v[156:159], a[84:87], v[100:103], v[156:159]
ds_read_b128 v[92:95], v21 offset:31744
v_mfma_f32_16x16x32_bf16 v[152:155], a[80:83], v[100:103], v[152:155]
v_mfma_f32_16x16x32_bf16 v[144:147], a[88:91], v[104:107], v[144:147]
v_mfma_f32_16x16x32_bf16 v[148:151], a[92:95], v[104:107], v[148:151]
v_mfma_f32_16x16x32_bf16 v[156:159], a[92:95], v[108:111], v[156:159]
v_mfma_f32_16x16x32_bf16 v[152:155], a[88:91], v[108:111], v[152:155]
v_mfma_f32_16x16x32_bf16 v[144:147], a[96:99], v[64:67], v[144:147]
v_mfma_f32_16x16x32_bf16 v[148:151], a[100:103], v[64:67], v[148:151]
v_mfma_f32_16x16x32_bf16 v[156:159], a[100:103], v[68:71], v[156:159]
s_waitcnt vmcnt(28) lgkmcnt(0)
s_barrier
ds_read_b128 v[96:99], v21 offset:32768
v_mfma_f32_16x16x32_bf16 v[152:155], a[96:99], v[68:71], v[152:155]
ds_read_b128 v[100:103], v21 offset:33792
v_mfma_f32_16x16x32_bf16 v[144:147], a[104:107], v[72:75], v[144:147]
ds_read_b128 v[104:107], v21 offset:34816
v_mfma_f32_16x16x32_bf16 v[148:151], a[108:111], v[72:75], v[148:151]
ds_read_b128 v[108:111], v21 offset:35840
v_mfma_f32_16x16x32_bf16 v[156:159], a[108:111], v[76:79], v[156:159]
ds_read_b128 v[64:67], v21 offset:36864
v_mfma_f32_16x16x32_bf16 v[152:155], a[104:107], v[76:79], v[152:155]
ds_read_b128 v[68:71], v21 offset:37888
v_mfma_f32_16x16x32_bf16 v[144:147], a[112:115], v[80:83], v[144:147]
ds_read_b128 v[72:75], v21 offset:38912
v_mfma_f32_16x16x32_bf16 v[148:151], a[116:119], v[80:83], v[148:151]
v_mfma_f32_16x16x32_bf16 v[156:159], a[116:119], v[84:87], v[156:159]
ds_read_b128 v[76:79], v21 offset:39936
v_mfma_f32_16x16x32_bf16 v[152:155], a[112:115], v[84:87], v[152:155]
v_mfma_f32_16x16x32_bf16 v[144:147], a[120:123], v[88:91], v[144:147]
ds_read_b128 v[80:83], v21 offset:40960
v_mfma_f32_16x16x32_bf16 v[148:151], a[124:127], v[88:91], v[148:151]
v_mfma_f32_16x16x32_bf16 v[156:159], a[124:127], v[92:95], v[156:159]
ds_read_b128 v[84:87], v21 offset:41984
v_mfma_f32_16x16x32_bf16 v[152:155], a[120:123], v[92:95], v[152:155]
s_waitcnt lgkmcnt(3)
v_mfma_f32_16x16x32_bf16 v[144:147], a[128:131], v[96:99], v[144:147]
ds_read_b128 v[88:91], v21 offset:43008
v_mfma_f32_16x16x32_bf16 v[148:151], a[132:135], v[96:99], v[148:151]
v_mfma_f32_16x16x32_bf16 v[156:159], a[132:135], v[100:103], v[156:159]
ds_read_b128 v[92:95], v21 offset:44032
v_mfma_f32_16x16x32_bf16 v[152:155], a[128:131], v[100:103], v[152:155]
v_mfma_f32_16x16x32_bf16 v[144:147], a[136:139], v[104:107], v[144:147]
ds_read_b128 v[96:99], v21 offset:45056
v_mfma_f32_16x16x32_bf16 v[148:151], a[140:143], v[104:107], v[148:151]
v_mfma_f32_16x16x32_bf16 v[156:159], a[140:143], v[108:111], v[156:159]
ds_read_b128 v[100:103], v21 offset:46080
v_mfma_f32_16x16x32_bf16 v[152:155], a[136:139], v[108:111], v[152:155]
v_mfma_f32_16x16x32_bf16 v[144:147], a[144:147], v[64:67], v[144:147]
buffer_load_dwordx4 v[10:13], v20, s[24:27], s46 offen offset:2048 sc1
ds_read_b128 v[104:107], v21 offset:47104
v_mfma_f32_16x16x32_bf16 v[148:151], a[148:151], v[64:67], v[148:151]
v_mfma_f32_16x16x32_bf16 v[156:159], a[148:151], v[68:71], v[156:159]
buffer_load_dwordx4 v[14:17], v20, s[24:27], s46 offen offset:3072 sc1
ds_read_b128 v[108:111], v21 offset:48128
v_mfma_f32_16x16x32_bf16 v[152:155], a[144:147], v[68:71], v[152:155]
v_mfma_f32_16x16x32_bf16 v[144:147], a[152:155], v[72:75], v[144:147]
buffer_load_dwordx2 v[18:19], v63, s[24:27], s62 offen offset:0 sc1
ds_read_b128 v[64:67], v21 offset:49152
v_mfma_f32_16x16x32_bf16 v[148:151], a[156:159], v[72:75], v[148:151]
s_waitcnt lgkmcnt(3)
v_mfma_f32_16x16x32_bf16 v[156:159], a[156:159], v[76:79], v[156:159]
ds_read_b128 v[68:71], v21 offset:50176
s_waitcnt vmcnt(16)
v_cmp_ne_u32 vcc, s53, v3
s_cbranch_vccnz L_spin17
L_back17:
v_mfma_f32_16x16x32_bf16 v[152:155], a[152:155], v[76:79], v[152:155]
v_mfma_f32_16x16x32_bf16 v[144:147], a[160:163], v[80:83], v[144:147]
ds_read_b128 v[72:75], v21 offset:51200
s_add_u32 m0, s47, 147456
v_mfma_f32_16x16x32_bf16 v[148:151], a[164:167], v[80:83], v[148:151]
buffer_load_dwordx4 v22, s[24:27], s77 offen offset:0 sc1 lds
s_add_u32 s77, s77, 64512
v_mfma_f32_16x16x32_bf16 v[156:159], a[164:167], v[84:87], v[156:159]
buffer_load_dwordx4 v22, s[24:27], s77 offen offset:1024 sc1 lds
ds_read_b128 v[76:79], v21 offset:52224
s_add_u32 s77, s77, 982016
v_mfma_f32_16x16x32_bf16 v[152:155], a[160:163], v[84:87], v[152:155]
s_waitcnt vmcnt(13)
v_xor_b32 v44, s53, v191
v_xor_b32_e64 v45, s53, v127
v_mfma_f32_16x16x32_bf16 v[144:147], a[168:171], v[88:91], v[144:147]
buffer_load_dwordx4 v22, s[24:27], s77 offen offset:2048 sc1 lds
ds_read_b128 v[80:83], v21 offset:53248
v_mfma_f32_16x16x32_bf16 v[148:151], a[172:175], v[88:91], v[148:151]
s_add_u32 s77, s77, 64512
v_xor_b32_e64 v46, s53, v123
v_or3_b32 v44, v44, v45, v46
v_mfma_f32_16x16x32_bf16 v[156:159], a[172:175], v[92:95], v[156:159]
buffer_load_dwordx4 v22, s[24:27], s77 offen offset:3072 sc1 lds
ds_read_b128 v[84:87], v21 offset:54272
v_xor_b32_e64 v45, s53, v119
v_mfma_f32_16x16x32_bf16 v[152:155], a[168:171], v[92:95], v[152:155]
v_xor_b32_e64 v46, s53, v115
v_or3_b32 v44, v44, v45, v46
v_mfma_f32_16x16x32_bf16 v[144:147], a[176:179], v[96:99], v[144:147]
ds_read_b128 v[88:91], v21 offset:55296
v_cmp_lt_u32 vcc, s72, v44
s_cbranch_vccnz L_spin18
L_back18:
v_mfma_f32_16x16x32_bf16 v[148:151], a[180:183], v[96:99], v[148:151]
v_lshlrev_b32_e64 v44, 16, v112
v_and_b32 v45, 0xffff0000, v112
v_mfma_f32_16x16x32_bf16 v[156:159], a[180:183], v[100:103], v[156:159]
ds_read_b128 v[92:95], v21 offset:56320
v_add_f32 v192, v192, v44
v_add_f32 v193, v193, v45
v_mfma_f32_16x16x32_bf16 v[152:155], a[176:179], v[100:103], v[152:155]
v_lshlrev_b32 v46, 16, v113
v_and_b32 v47, 0xffff0000, v113
s_waitcnt lgkmcnt(3)
v_mfma_f32_16x16x32_bf16 v[144:147], a[184:187], v[104:107], v[144:147]
v_add_f32 v194, v194, v46
v_add_f32 v195, v195, v47
v_lshlrev_b32_e64 v44, 16, v114
v_mfma_f32_16x16x32_bf16 v[148:151], a[188:191], v[104:107], v[148:151]
v_and_b32 v45, 0xffff0000, v114
v_add_f32 v196, v196, v44
v_add_f32 v197, v197, v45
v_mfma_f32_16x16x32_bf16 v[156:159], a[188:191], v[108:111], v[156:159]
v_lshlrev_b32 v46, 16, v115
v_lshlrev_b32 v47, 16, v188
v_add_f32 v198, v198, v46
v_add_f32 v199, v199, v47
v_mfma_f32_16x16x32_bf16 v[152:155], a[184:187], v[108:111], v[152:155]
v_lshlrev_b32_e64 v44, 16, v116
v_and_b32 v45, 0xffff0000, v116
v_add_f32_e64 v200, v200, v44
v_mfma_f32_16x16x32_bf16 v[144:147], a[192:195], v[64:67], v[144:147]
v_add_f32 v201, v201, v45
v_lshlrev_b32 v46, 16, v117
v_and_b32 v47, 0xffff0000, v117
v_mfma_f32_16x16x32_bf16 v[148:151], a[196:199], v[64:67], v[148:151]
v_add_f32 v202, v202, v46
v_add_f32 v203, v203, v47
v_lshlrev_b32_e64 v44, 16, v118
v_mfma_f32_16x16x32_bf16 v[156:159], a[196:199], v[68:71], v[156:159]
s_waitcnt lgkmcnt(0)
s_barrier
ds_read_b128 v[96:99], v20 offset:0
v_and_b32 v45, 0xffff0000, v118
v_mfma_f32_16x16x32_bf16 v[152:155], a[192:195], v[68:71], v[152:155]
ds_read_b128 v[100:103], v20 offset:1024
v_add_f32 v204, v204, v44
v_add_f32 v205, v205, v45
v_mfma_f32_16x16x32_bf16 v[144:147], a[200:203], v[72:75], v[144:147]
ds_read_b128 v[104:107], v20 offset:2048
v_lshlrev_b32_e64 v46, 16, v119
v_and_b32 v47, 0xffff0000, v188
v_mfma_f32_16x16x32_bf16 v[148:151], a[204:207], v[72:75], v[148:151]
ds_read_b128 v[108:111], v20 offset:3072
v_add_f32 v206, v206, v46
v_add_f32 v207, v207, v47
v_mfma_f32_16x16x32_bf16 v[156:159], a[204:207], v[76:79], v[156:159]
ds_read_b128 v[64:67], v20 offset:4096
v_lshlrev_b32_e64 v44, 16, v120
v_and_b32 v45, 0xffff0000, v120
v_add_f32_e64 v208, v208, v44
v_mfma_f32_16x16x32_bf16 v[152:155], a[200:203], v[76:79], v[152:155]
ds_read_b128 v[68:71], v20 offset:5120
v_add_f32 v209, v209, v45
v_lshlrev_b32 v46, 16, v121
v_mfma_f32_16x16x32_bf16 v[144:147], a[208:211], v[80:83], v[144:147]
ds_read_b128 v[72:75], v20 offset:6144
v_and_b32 v47, 0xffff0000, v121
v_add_f32_e64 v210, v210, v46
v_mfma_f32_16x16x32_bf16 v[148:151], a[212:215], v[80:83], v[148:151]
v_add_f32 v211, v211, v47
v_lshlrev_b32 v44, 16, v122
v_and_b32 v45, 0xffff0000, v122
v_mfma_f32_16x16x32_bf16 v[156:159], a[212:215], v[84:87], v[156:159]
ds_read_b128 v[76:79], v20 offset:7168
v_add_f32 v212, v212, v44
v_add_f32 v213, v213, v45
v_lshlrev_b32_e64 v46, 16, v123
v_mfma_f32_16x16x32_bf16 v[152:155], a[208:211], v[84:87], v[152:155]
v_lshlrev_b32 v47, 16, v189
v_add_f32 v214, v214, v46
v_add_f32_e64 v215, v215, v47
v_mfma_f32_16x16x32_bf16 v[144:147], a[216:219], v[88:91], v[144:147]
ds_read_b128 v[80:83], v20 offset:8192
v_lshlrev_b32_e64 v44, 16, v124
v_and_b32 v45, 0xffff0000, v124
v_mfma_f32_16x16x32_bf16 v[148:151], a[220:223], v[88:91], v[148:151]
v_add_f32 v216, v216, v44
v_add_f32 v217, v217, v45
v_lshlrev_b32_e64 v46, 16, v125
v_mfma_f32_16x16x32_bf16 v[156:159], a[220:223], v[92:95], v[156:159]
ds_read_b128 v[84:87], v20 offset:9216
v_and_b32 v47, 0xffff0000, v125
v_add_f32 v218, v218, v46
v_add_f32 v219, v219, v47
v_mfma_f32_16x16x32_bf16 v[152:155], a[216:219], v[92:95], v[152:155]
v_lshlrev_b32 v44, 16, v126
v_and_b32 v45, 0xffff0000, v126
s_waitcnt lgkmcnt(3)
v_mfma_f32_16x16x32_bf16 v[160:163], a[0:3], v[96:99], 0
ds_read_b128 v[88:91], v20 offset:10240
v_add_f32 v220, v220, v44
v_add_f32 v221, v221, v45
v_mfma_f32_16x16x32_bf16 v[164:167], a[4:7], v[96:99], 0
v_lshlrev_b32_e64 v46, 16, v127
v_and_b32 v47, 0xffff0000, v189
v_add_f32_e64 v222, v222, v46
v_mfma_f32_16x16x32_bf16 v[172:175], a[4:7], v[100:103], 0
ds_read_b128 v[92:95], v20 offset:11264
v_add_f32 v223, v223, v47
s_waitcnt vmcnt(10)
v_xor_b32_e64 v44, s53, v43
v_mfma_f32_16x16x32_bf16 v[168:171], a[0:3], v[100:103], 0
v_xor_b32 v45, s53, v39
v_xor_b32 v46, s53, v35
v_or3_b32 v44, v44, v45, v46
v_mfma_f32_16x16x32_bf16 v[160:163], a[8:11], v[104:107], v[160:163]
ds_read_b128 v[96:99], v20 offset:12288
v_xor_b32 v45, s53, v31
v_xor_b32 v46, s53, v27
v_mfma_f32_16x16x32_bf16 v[164:167], a[12:15], v[104:107], v[164:167]
v_or3_b32 v44, v44, v45, v46
v_cmp_lt_u32 vcc, s72, v44
s_cbranch_vccnz L_spin19
L_back19:
v_mfma_f32_16x16x32_bf16 v[172:175], a[12:15], v[108:111], v[172:175]
buffer_load_dwordx4 v[176:179], v20, s[24:27], s62 offen offset:1024 sc1
v_mfma_f32_16x16x32_bf16 v[168:171], a[8:11], v[108:111], v[168:171]
ds_read_b128 v[100:103], v20 offset:13312
v_lshlrev_b32_e64 v44, 16, v24
v_and_b32 v45, 0xffff0000, v24
v_mfma_f32_16x16x32_bf16 v[160:163], a[16:19], v[64:67], v[160:163]
buffer_load_dwordx4 v[180:183], v20, s[24:27], s62 offen offset:2048 sc1
ds_read_b128 v[104:107], v20 offset:14336
v_mfma_f32_16x16x32_bf16 v[164:167], a[20:23], v[64:67], v[164:167]
v_add_f32 v192, v192, v44
v_add_f32 v193, v193, v45
v_lshlrev_b32_e64 v46, 16, v25
v_mfma_f32_16x16x32_bf16 v[172:175], a[20:23], v[68:71], v[172:175]
buffer_load_dwordx2 v[184:185], v63, s[24:27], s62 offen offset:512 sc1
ds_read_b128 v[108:111], v20 offset:15360
v_and_b32 v47, 0xffff0000, v25
v_mfma_f32_16x16x32_bf16 v[168:171], a[16:19], v[68:71], v[168:171]
v_add_f32 v194, v194, v46
v_add_f32 v195, v195, v47
v_lshlrev_b32_e64 v44, 16, v26
v_mfma_f32_16x16x32_bf16 v[160:163], a[24:27], v[72:75], v[160:163]
ds_read_b128 v[64:67], v20 offset:16384
v_and_b32 v45, 0xffff0000, v26
v_add_f32_e64 v196, v196, v44
v_mfma_f32_16x16x32_bf16 v[164:167], a[28:31], v[72:75], v[164:167]
v_add_f32_e64 v197, v197, v45
v_lshlrev_b32 v46, 16, v27
s_waitcnt lgkmcnt(3)
v_mfma_f32_16x16x32_bf16 v[172:175], a[28:31], v[76:79], v[172:175]
ds_read_b128 v[68:71], v20 offset:17408
v_lshlrev_b32 v47, 16, v40
v_add_f32 v198, v198, v46
v_add_f32_e64 v199, v199, v47
v_mfma_f32_16x16x32_bf16 v[168:171], a[24:27], v[76:79], v[168:171]
v_lshlrev_b32_e64 v44, 16, v28
v_and_b32 v45, 0xffff0000, v28
v_add_f32_e64 v200, v200, v44
v_mfma_f32_16x16x32_bf16 v[160:163], a[32:35], v[80:83], v[160:163]
ds_read_b128 v[72:75], v20 offset:18432
v_add_f32 v201, v201, v45
v_lshlrev_b32 v46, 16, v29
v_mfma_f32_16x16x32_bf16 v[164:167], a[36:39], v[80:83], v[164:167]
v_and_b32 v47, 0xffff0000, v29
v_add_f32 v202, v202, v46
v_add_f32 v203, v203, v47
v_mfma_f32_16x16x32_bf16 v[172:175], a[36:39], v[84:87], v[172:175]
ds_read_b128 v[76:79], v20 offset:19456
v_lshlrev_b32_e64 v44, 16, v30
v_and_b32 v45, 0xffff0000, v30
v_add_f32_e64 v204, v204, v44
v_mfma_f32_16x16x32_bf16 v[168:171], a[32:35], v[84:87], v[168:171]
v_add_f32 v205, v205, v45
v_lshlrev_b32 v46, 16, v31
v_and_b32 v47, 0xffff0000, v40
v_mfma_f32_16x16x32_bf16 v[160:163], a[40:43], v[88:91], v[160:163]
ds_read_b128 v[80:83], v20 offset:20480
v_add_f32 v206, v206, v46
v_add_f32 v207, v207, v47
v_mfma_f32_16x16x32_bf16 v[164:167], a[44:47], v[88:91], v[164:167]
v_lshlrev_b32_e64 v44, 16, v32
v_and_b32 v45, 0xffff0000, v32
v_add_f32_e64 v208, v208, v44
v_mfma_f32_16x16x32_bf16 v[172:175], a[44:47], v[92:95], v[172:175]
ds_read_b128 v[84:87], v20 offset:21504
v_add_f32 v209, v209, v45
v_lshlrev_b32 v46, 16, v33
v_and_b32 v47, 0xffff0000, v33
v_mfma_f32_16x16x32_bf16 v[168:171], a[40:43], v[92:95], v[168:171]
v_add_f32 v210, v210, v46
v_add_f32 v211, v211, v47
v_lshlrev_b32_e64 v44, 16, v34
v_mfma_f32_16x16x32_bf16 v[160:163], a[48:51], v[96:99], v[160:163]
ds_read_b128 v[88:91], v20 offset:22528
v_and_b32 v45, 0xffff0000, v34
v_add_f32_e64 v212, v212, v44
v_mfma_f32_16x16x32_bf16 v[164:167], a[52:55], v[96:99], v[164:167]
v_add_f32 v213, v213, v45
v_lshlrev_b32 v46, 16, v35
v_lshlrev_b32_e64 v47, 16, v41
v_mfma_f32_16x16x32_bf16 v[172:175], a[52:55], v[100:103], v[172:175]
ds_read_b128 v[92:95], v20 offset:23552
v_add_f32 v214, v214, v46
v_add_f32 v215, v215, v47
v_lshlrev_b32_e64 v44, 16, v36
v_mfma_f32_16x16x32_bf16 v[168:171], a[48:51], v[100:103], v[168:171]
v_and_b32 v45, 0xffff0000, v36
v_add_f32 v216, v216, v44
s_waitcnt lgkmcnt(3)
v_mfma_f32_16x16x32_bf16 v[160:163], a[56:59], v[104:107], v[160:163]
ds_read_b128 v[96:99], v20 offset:24576
v_add_f32 v217, v217, v45
v_lshlrev_b32 v46, 16, v37
v_mfma_f32_16x16x32_bf16 v[164:167], a[60:63], v[104:107], v[164:167]
v_and_b32 v47, 0xffff0000, v37
v_add_f32 v218, v218, v46
v_add_f32 v219, v219, v47
v_mfma_f32_16x16x32_bf16 v[172:175], a[60:63], v[108:111], v[172:175]
ds_read_b128 v[100:103], v20 offset:25600
v_lshlrev_b32_e64 v44, 16, v38
v_and_b32 v45, 0xffff0000, v38
v_add_f32_e64 v220, v220, v44
v_mfma_f32_16x16x32_bf16 v[168:171], a[56:59], v[108:111], v[168:171]
v_add_f32 v221, v221, v45
v_lshlrev_b32 v46, 16, v39
v_and_b32 v47, 0xffff0000, v41
v_mfma_f32_16x16x32_bf16 v[160:163], a[64:67], v[64:67], v[160:163]
ds_read_b128 v[104:107], v20 offset:26624
v_add_f32 v222, v222, v46
v_add_f32 v223, v223, v47
v_mfma_f32_16x16x32_bf16 v[164:167], a[68:71], v[64:67], v[164:167]
v_mfma_f32_16x16x32_bf16 v[172:175], a[68:71], v[68:71], v[172:175]
ds_read_b128 v[108:111], v20 offset:27648
s_waitcnt vmcnt(7)
v_xor_b32 v44, s53, v19
v_xor_b32_e64 v45, s53, v17
v_mfma_f32_16x16x32_bf16 v[168:171], a[64:67], v[68:71], v[168:171]
v_xor_b32_e64 v46, s53, v13
v_or3_b32 v44, v44, v45, v46
v_mfma_f32_16x16x32_bf16 v[160:163], a[72:75], v[72:75], v[160:163]
ds_read_b128 v[64:67], v20 offset:28672
v_cmp_lt_u32 vcc, s72, v44
s_cbranch_vccnz L_spin20
L_back20:
v_mfma_f32_16x16x32_bf16 v[164:167], a[76:79], v[72:75], v[164:167]
v_lshlrev_b32_e64 v44, 16, v10
v_and_b32 v45, 0xffff0000, v10
v_mfma_f32_16x16x32_bf16 v[172:175], a[76:79], v[76:79], v[172:175]
ds_read_b128 v[68:71], v20 offset:29696
v_add_f32 v192, v192, v44
v_add_f32 v193, v193, v45
v_mfma_f32_16x16x32_bf16 v[168:171], a[72:75], v[76:79], v[168:171]
v_lshlrev_b32_e64 v46, 16, v11
v_and_b32 v47, 0xffff0000, v11
v_add_f32_e64 v194, v194, v46
v_mfma_f32_16x16x32_bf16 v[160:163], a[80:83], v[80:83], v[160:163]
ds_read_b128 v[72:75], v20 offset:30720
v_add_f32 v195, v195, v47
v_lshlrev_b32 v44, 16, v12
v_mfma_f32_16x16x32_bf16 v[164:167], a[84:87], v[80:83], v[164:167]
v_and_b32 v45, 0xffff0000, v12
v_add_f32 v196, v196, v44
s_waitcnt lgkmcnt(3)
v_mfma_f32_16x16x32_bf16 v[172:175], a[84:87], v[84:87], v[172:175]
ds_read_b128 v[76:79], v20 offset:31744
v_add_f32 v197, v197, v45
v_lshlrev_b32 v46, 16, v13
v_lshlrev_b32_e64 v47, 16, v18
v_mfma_f32_16x16x32_bf16 v[168:171], a[80:83], v[84:87], v[168:171]
v_add_f32 v198, v198, v46
v_add_f32 v199, v199, v47
v_lshlrev_b32_e64 v44, 16, v14
v_mfma_f32_16x16x32_bf16 v[160:163], a[88:91], v[88:91], v[160:163]
v_and_b32 v45, 0xffff0000, v14
v_add_f32 v200, v200, v44
v_add_f32 v201, v201, v45
v_mfma_f32_16x16x32_bf16 v[164:167], a[92:95], v[88:91], v[164:167]
v_lshlrev_b32_e64 v46, 16, v15
v_and_b32 v47, 0xffff0000, v15
v_add_f32_e64 v202, v202, v46
v_mfma_f32_16x16x32_bf16 v[172:175], a[92:95], v[92:95], v[172:175]
v_add_f32 v203, v203, v47
v_lshlrev_b32 v44, 16, v16
v_and_b32 v45, 0xffff0000, v16
v_add_f32_e64 v204, v204, v44
v_mfma_f32_16x16x32_bf16 v[168:171], a[88:91], v[92:95], v[168:171]
v_add_f32 v205, v205, v45
v_lshlrev_b32 v46, 16, v17
v_and_b32 v47, 0xffff0000, v18
v_mfma_f32_16x16x32_bf16 v[160:163], a[96:99], v[96:99], v[160:163]
v_add_f32 v206, v206, v46
v_add_f32 v207, v207, v47
v_mfma_f32_16x16x32_bf16 v[164:167], a[100:103], v[96:99], v[164:167]
v_mfma_f32_16x16x32_bf16 v[172:175], a[100:103], v[100:103], v[172:175]
s_waitcnt vmcnt(3) lgkmcnt(0)
s_barrier
ds_read_b128 v[80:83], v20 offset:32768
v_mfma_f32_16x16x32_bf16 v[168:171], a[96:99], v[100:103], v[168:171]
ds_read_b128 v[84:87], v20 offset:33792
v_mfma_f32_16x16x32_bf16 v[160:163], a[104:107], v[104:107], v[160:163]
ds_read_b128 v[88:91], v20 offset:34816
ds_read_b128 v[224:227], v60 offset:16384
ds_read_b128 v[228:231], v60 offset:17408
v_mfma_f32_16x16x32_bf16 v[164:167], a[108:111], v[104:107], v[164:167]
ds_read_b128 v[92:95], v20 offset:35840
ds_read_b128 v[232:235], v60 offset:18432
ds_read_b128 v[236:239], v60 offset:19456
v_mfma_f32_16x16x32_bf16 v[172:175], a[108:111], v[108:111], v[172:175]
ds_read_b128 v[96:99], v20 offset:36864
v_mfma_f32_16x16x32_bf16 v[168:171], a[104:107], v[108:111], v[168:171]
ds_read_b128 v[100:103], v20 offset:37888
v_mfma_f32_16x16x32_bf16 v[160:163], a[112:115], v[64:67], v[160:163]
ds_read_b128 v[104:107], v20 offset:38912
v_mfma_f32_16x16x32_bf16 v[164:167], a[116:119], v[64:67], v[164:167]
v_mfma_f32_16x16x32_bf16 v[172:175], a[116:119], v[68:71], v[172:175]
ds_read_b128 v[108:111], v20 offset:39936
v_mfma_f32_16x16x32_bf16 v[168:171], a[112:115], v[68:71], v[168:171]
v_mfma_f32_16x16x32_bf16 v[160:163], a[120:123], v[72:75], v[160:163]
ds_read_b128 v[64:67], v20 offset:40960
s_waitcnt lgkmcnt(9)
v_permlane32_swap_b32 v224, v226
v_mfma_f32_16x16x32_bf16 v[164:167], a[124:127], v[72:75], v[164:167]
v_permlane32_swap_b32 v225, v227
s_waitcnt lgkmcnt(8)
v_permlane32_swap_b32_e64 v228, v230
v_mfma_f32_16x16x32_bf16 v[172:175], a[124:127], v[76:79], v[172:175]
ds_read_b128 v[68:71], v20 offset:41984
v_permlane32_swap_b32 v229, v231
s_waitcnt lgkmcnt(7)
v_permlane32_swap_b32_e64 v232, v234
v_mfma_f32_16x16x32_bf16 v[168:171], a[120:123], v[76:79], v[168:171]
v_permlane32_swap_b32 v233, v235
s_waitcnt lgkmcnt(6)
v_permlane32_swap_b32_e64 v236, v238
v_mfma_f32_16x16x32_bf16 v[160:163], a[128:131], v[80:83], v[160:163]
ds_read_b128 v[72:75], v20 offset:43008
v_permlane32_swap_b32 v237, v239
v_lshlrev_b32 v44, 16, v224
v_mfma_f32_16x16x32_bf16 v[164:167], a[132:135], v[80:83], v[164:167]
v_and_b32 v45, 0xffff0000, v224
v_fmac_f32 v192, 0x35800000, v44
v_fmac_f32 v193, 0x35800000, v45
v_mfma_f32_16x16x32_bf16 v[172:175], a[132:135], v[84:87], v[172:175]
ds_read_b128 v[76:79], v20 offset:44032
v_lshlrev_b32_e64 v46, 16, v225
v_and_b32 v47, 0xffff0000, v225
v_fmac_f32 v194, 0x35800000, v46
v_mfma_f32_16x16x32_bf16 v[168:171], a[128:131], v[84:87], v[168:171]
v_fmac_f32 v195, 0x35800000, v47
v_lshlrev_b32_e64 v44, 16, v226
v_and_b32 v45, 0xffff0000, v226
v_mfma_f32_16x16x32_bf16 v[160:163], a[136:139], v[88:91], v[160:163]
ds_read_b128 v[80:83], v20 offset:45056
v_fmac_f32 v196, 0x35800000, v44
v_fmac_f32 v197, 0x35800000, v45
v_mfma_f32_16x16x32_bf16 v[164:167], a[140:143], v[88:91], v[164:167]
v_lshlrev_b32_e64 v46, 16, v227
v_and_b32 v47, 0xffff0000, v227
v_fmac_f32 v198, 0x35800000, v46
v_mfma_f32_16x16x32_bf16 v[172:175], a[140:143], v[92:95], v[172:175]
ds_read_b128 v[84:87], v20 offset:46080
v_fmac_f32 v199, 0x35800000, v47
v_lshlrev_b32_e64 v44, 16, v228
v_and_b32 v45, 0xffff0000, v228
v_mfma_f32_16x16x32_bf16 v[168:171], a[136:139], v[92:95], v[168:171]
v_fmac_f32 v200, 0x35800000, v44
v_fmac_f32 v201, 0x35800000, v45
s_waitcnt lgkmcnt(3)
v_mfma_f32_16x16x32_bf16 v[160:163], a[144:147], v[96:99], v[160:163]
ds_read_b128 v[88:91], v20 offset:47104
v_lshlrev_b32 v46, 16, v229
v_and_b32 v47, 0xffff0000, v229
v_mfma_f32_16x16x32_bf16 v[164:167], a[148:151], v[96:99], v[164:167]
v_fmac_f32 v202, 0x35800000, v46
v_fmac_f32 v203, 0x35800000, v47
v_lshlrev_b32_e64 v44, 16, v230
v_mfma_f32_16x16x32_bf16 v[172:175], a[148:151], v[100:103], v[172:175]
ds_read_b128 v[92:95], v20 offset:48128
v_and_b32 v45, 0xffff0000, v230
v_fmac_f32 v204, 0x35800000, v44
v_fmac_f32 v205, 0x35800000, v45
v_mfma_f32_16x16x32_bf16 v[168:171], a[144:147], v[100:103], v[168:171]
v_lshlrev_b32_e64 v46, 16, v231
v_and_b32 v47, 0xffff0000, v231
v_fmac_f32 v206, 0x35800000, v46
v_mfma_f32_16x16x32_bf16 v[160:163], a[152:155], v[104:107], v[160:163]
ds_read_b128 v[96:99], v20 offset:49152
v_fmac_f32 v207, 0x35800000, v47
v_lshlrev_b32_e64 v44, 16, v232
v_mfma_f32_16x16x32_bf16 v[164:167], a[156:159], v[104:107], v[164:167]
v_and_b32 v45, 0xffff0000, v232
v_fmac_f32 v208, 0x35800000, v44
v_fmac_f32 v209, 0x35800000, v45
v_mfma_f32_16x16x32_bf16 v[172:175], a[156:159], v[108:111], v[172:175]
ds_read_b128 v[100:103], v20 offset:50176
v_lshlrev_b32_e64 v46, 16, v233
v_and_b32 v47, 0xffff0000, v233
v_fmac_f32 v210, 0x35800000, v46
v_mfma_f32_16x16x32_bf16 v[168:171], a[152:155], v[108:111], v[168:171]
v_fmac_f32 v211, 0x35800000, v47
v_lshlrev_b32_e64 v44, 16, v234
v_and_b32 v45, 0xffff0000, v234
v_mfma_f32_16x16x32_bf16 v[160:163], a[160:163], v[64:67], v[160:163]
ds_read_b128 v[104:107], v20 offset:51200
v_fmac_f32 v212, 0x35800000, v44
v_fmac_f32 v213, 0x35800000, v45
v_mfma_f32_16x16x32_bf16 v[164:167], a[164:167], v[64:67], v[164:167]
v_lshlrev_b32_e64 v46, 16, v235
v_and_b32 v47, 0xffff0000, v235
v_fmac_f32 v214, 0x35800000, v46
v_mfma_f32_16x16x32_bf16 v[172:175], a[164:167], v[68:71], v[172:175]
ds_read_b128 v[108:111], v20 offset:52224
v_fmac_f32 v215, 0x35800000, v47
v_lshlrev_b32_e64 v44, 16, v236
v_and_b32 v45, 0xffff0000, v236
v_mfma_f32_16x16x32_bf16 v[168:171], a[160:163], v[68:71], v[168:171]
v_fmac_f32 v216, 0x35800000, v44
v_fmac_f32 v217, 0x35800000, v45
v_lshlrev_b32_e64 v46, 16, v237
v_mfma_f32_16x16x32_bf16 v[160:163], a[168:171], v[72:75], v[160:163]
ds_read_b128 v[64:67], v20 offset:53248
v_and_b32 v47, 0xffff0000, v237
v_fmac_f32 v218, 0x35800000, v46
v_mfma_f32_16x16x32_bf16 v[164:167], a[172:175], v[72:75], v[164:167]
v_fmac_f32 v219, 0x35800000, v47
v_lshlrev_b32 v44, 16, v238
s_waitcnt lgkmcnt(3)
v_mfma_f32_16x16x32_bf16 v[172:175], a[172:175], v[76:79], v[172:175]
ds_read_b128 v[68:71], v20 offset:54272
v_and_b32 v45, 0xffff0000, v238
v_fmac_f32 v220, 0x35800000, v44
v_fmac_f32 v221, 0x35800000, v45
v_mfma_f32_16x16x32_bf16 v[168:171], a[168:171], v[76:79], v[168:171]
v_lshlrev_b32_e64 v46, 16, v239
v_and_b32 v47, 0xffff0000, v239
v_fmac_f32 v222, 0x35800000, v46
v_mfma_f32_16x16x32_bf16 v[160:163], a[176:179], v[80:83], v[160:163]
ds_read_b128 v[72:75], v20 offset:55296
v_fmac_f32 v223, 0x35800000, v47
v_mfma_f32_16x16x32_bf16 v[164:167], a[180:183], v[80:83], v[164:167]
s_waitcnt vmcnt(0)
v_xor_b32 v44, s53, v185
v_xor_b32_e64 v45, s53, v183
v_mfma_f32_16x16x32_bf16 v[172:175], a[180:183], v[84:87], v[172:175]
ds_read_b128 v[76:79], v20 offset:56320
v_xor_b32_e64 v46, s53, v179
v_or3_b32 v44, v44, v45, v46
v_mfma_f32_16x16x32_bf16 v[168:171], a[176:179], v[84:87], v[168:171]
v_cmp_lt_u32 vcc, s72, v44
s_cbranch_vccnz L_spin21
L_back21:
v_mfma_f32_16x16x32_bf16 v[160:163], a[184:187], v[88:91], v[160:163]
v_lshlrev_b32_e64 v44, 16, v176
v_and_b32 v45, 0xffff0000, v176
v_mfma_f32_16x16x32_bf16 v[164:167], a[188:191], v[88:91], v[164:167]
v_add_f32 v208, v208, v44
v_add_f32 v209, v209, v45
v_lshlrev_b32_e64 v46, 16, v177
v_mfma_f32_16x16x32_bf16 v[172:175], a[188:191], v[92:95], v[172:175]
v_and_b32 v47, 0xffff0000, v177
v_add_f32 v210, v210, v46
v_add_f32 v211, v211, v47
v_lshlrev_b32_e64 v44, 16, v178
v_mfma_f32_16x16x32_bf16 v[168:171], a[184:187], v[92:95], v[168:171]
v_and_b32 v45, 0xffff0000, v178
v_add_f32 v212, v212, v44
v_add_f32 v213, v213, v45
v_mfma_f32_16x16x32_bf16 v[160:163], a[192:195], v[96:99], v[160:163]
v_lshlrev_b32 v46, 16, v179
v_lshlrev_b32 v47, 16, v184
v_add_f32_e64 v214, v214, v46
v_mfma_f32_16x16x32_bf16 v[164:167], a[196:199], v[96:99], v[164:167]
v_add_f32 v215, v215, v47
v_lshlrev_b32 v44, 16, v180
v_and_b32 v45, 0xffff0000, v180
v_mfma_f32_16x16x32_bf16 v[172:175], a[196:199], v[100:103], v[172:175]
v_add_f32 v216, v216, v44
v_add_f32 v217, v217, v45
v_lshlrev_b32_e64 v46, 16, v181
v_and_b32 v47, 0xffff0000, v181
v_mfma_f32_16x16x32_bf16 v[168:171], a[192:195], v[100:103], v[168:171]
v_add_f32_e64 v218, v218, v46
v_add_f32 v219, v219, v47
s_waitcnt lgkmcnt(0)
v_mfma_f32_16x16x32_bf16 v[160:163], a[200:203], v[104:107], v[160:163]
v_lshlrev_b32_e64 v44, 16, v182
v_and_b32 v45, 0xffff0000, v182
v_add_f32_e64 v220, v220, v44
v_mfma_f32_16x16x32_bf16 v[164:167], a[204:207], v[104:107], v[164:167]
v_add_f32 v221, v221, v45
v_lshlrev_b32 v46, 16, v183
v_and_b32 v47, 0xffff0000, v184
v_mfma_f32_16x16x32_bf16 v[172:175], a[204:207], v[108:111], v[172:175]
v_add_f32 v222, v222, v46
v_add_f32 v223, v223, v47
v_add_f32 v192, v192, v144
v_add_f32 v193, v193, v145
v_mfma_f32_16x16x32_bf16 v[168:171], a[200:203], v[108:111], v[168:171]
v_add_f32 v194, v194, v146
v_add_f32 v195, v195, v147
v_add_f32_e64 v196, v196, v148
v_mfma_f32_16x16x32_bf16 v[160:163], a[208:211], v[64:67], v[160:163]
v_add_f32 v197, v197, v149
v_add_f32 v198, v198, v150
v_add_f32_e64 v199, v199, v151
v_mfma_f32_16x16x32_bf16 v[164:167], a[212:215], v[64:67], v[164:167]
v_cvt_pk_bf16_f32 v48, v192, v193
v_cvt_pk_bf16_f32 v50, v196, v197
v_cvt_pk_bf16_f32 v49, v194, v195
v_mfma_f32_16x16x32_bf16 v[172:175], a[212:215], v[68:71], v[172:175]
v_cvt_pk_bf16_f32 v51, v198, v199
v_add_f32 v200, v200, v152
v_add_f32 v201, v201, v153
v_permlane32_swap_b32_e64 v48, v50
v_mfma_f32_16x16x32_bf16 v[168:171], a[208:211], v[68:71], v[168:171]
v_permlane32_swap_b32_e64 v49, v51
buffer_store_dwordx4 v[48:51], v2, s[32:35], s76 offen
s_add_u32 s76, s76, 0x8000
v_mfma_f32_16x16x32_bf16 v[160:163], a[216:219], v[72:75], v[160:163]
v_add_f32 v202, v202, v154
v_add_f32 v203, v203, v155
v_add_f32_e64 v204, v204, v156
v_mfma_f32_16x16x32_bf16 v[164:167], a[220:223], v[72:75], v[164:167]
v_add_f32 v205, v205, v157
v_add_f32 v206, v206, v158
v_add_f32_e64 v207, v207, v159
v_mfma_f32_16x16x32_bf16 v[172:175], a[220:223], v[76:79], v[172:175]
v_cvt_pk_bf16_f32 v52, v200, v201
v_cvt_pk_bf16_f32 v54, v204, v205
v_cvt_pk_bf16_f32 v53, v202, v203
v_cvt_pk_bf16_f32 v55, v206, v207
v_mfma_f32_16x16x32_bf16 v[168:171], a[216:219], v[76:79], v[168:171]
v_permlane32_swap_b32 v52, v54
v_permlane32_swap_b32 v53, v55
buffer_store_dwordx4 v[52:55], v2, s[32:35], s76 offen
s_add_u32 s76, s76, 0x8000
v_add_f32 v208, v208, v160
v_add_f32 v209, v209, v161
v_add_f32 v210, v210, v162
v_add_f32 v211, v211, v163
v_add_f32 v212, v212, v164
v_add_f32 v213, v213, v165
v_add_f32 v214, v214, v166
v_add_f32 v215, v215, v167
v_cvt_pk_bf16_f32 v48, v208, v209
v_cvt_pk_bf16_f32 v50, v212, v213
v_cvt_pk_bf16_f32 v49, v210, v211
v_cvt_pk_bf16_f32 v51, v214, v215
v_add_f32 v216, v216, v168
v_add_f32 v217, v217, v169
v_permlane32_swap_b32 v48, v50
v_permlane32_swap_b32 v49, v51
buffer_store_dwordx4 v[48:51], v2, s[32:35], s76 offen
s_add_u32 s76, s76, 0x8000
v_add_f32 v218, v218, v170
v_add_f32 v219, v219, v171
v_add_f32 v220, v220, v172
v_add_f32 v221, v221, v173
v_add_f32 v222, v222, v174
v_add_f32 v223, v223, v175
v_cvt_pk_bf16_f32 v52, v216, v217
v_cvt_pk_bf16_f32 v54, v220, v221
v_cvt_pk_bf16_f32 v53, v218, v219
v_cvt_pk_bf16_f32 v55, v222, v223
v_permlane32_swap_b32 v52, v54
s_nop 0
v_permlane32_swap_b32_e64 v53, v55
buffer_store_dwordx4 v[52:55], v2, s[32:35], s76 offen
s_add_u32 s76, s76, 0x8000
s_branch L_noep
L_spin0:
s_cmp_eq_u32 s3, 0
s_cbranch_scc1 L_back0
s_sub_u32 s3, s3, 1
s_sleep 1
s_mov_b32 s60, m0
s_lshl_b32 m0, s36, 11
s_add_u32 m0, m0, 131072
s_nop 0
buffer_load_dwordx4 v20, s[24:27], s62 offen offset:0 sc1 lds
buffer_load_dwordx4 v20, s[24:27], s62 offen offset:1024 sc1 lds
s_waitcnt vmcnt(0)
ds_read2st64_b32 v[240:241], v242 offset0:0 offset1:4
s_mov_b32 m0, s60
s_waitcnt lgkmcnt(0)
s_waitcnt vmcnt(0)
v_xor_b32 v241, s61, v241
v_xor_b32 v240, s61, v240
v_or_b32 v241, v241, v240
v_cmp_ne_u32 vcc, 0, v241
s_cbranch_vccnz L_spin0
s_branch L_back0
L_spin1:
s_cmp_eq_u32 s3, 0
s_cbranch_scc1 L_back1
s_sub_u32 s3, s3, 1
s_sleep 1
buffer_load_dword v23, v1, s[24:27], s59 offen offset:0 sc1
s_waitcnt vmcnt(0)
v_cmp_ne_u32 vcc, s53, v23
s_cbranch_vccnz L_spin1
s_branch L_back1
L_spin2:
s_cmp_eq_u32 s3, 0
s_cbranch_scc1 L_back2
s_sub_u32 s3, s3, 1
s_sleep 1
buffer_load_dword v23, v1, s[24:27], s59 offen offset:128 sc1
s_waitcnt vmcnt(0)
v_cmp_ne_u32 vcc, s53, v23
s_cbranch_vccnz L_spin2
s_branch L_back2
L_spin3:
s_cmp_eq_u32 s3, 0
s_cbranch_scc1 L_back3
s_sub_u32 s3, s3, 1
s_sleep 1
buffer_load_dword v5, v4, s[24:27], s80 offen sc1
s_waitcnt vmcnt(0)
v_cmp_ne_u32 vcc, s53, v5
s_cbranch_vccnz L_spin3
s_branch L_back3
L_spin4:
s_cmp_eq_u32 s3, 0
s_cbranch_scc1 L_back4
s_sub_u32 s3, s3, 1
s_sleep 1
buffer_load_dword v23, v1, s[24:27], s59 offen offset:256 sc1
s_waitcnt vmcnt(0)
v_cmp_ne_u32 vcc, s53, v23
s_cbranch_vccnz L_spin4
s_branch L_back4
L_spin5:
s_cmp_eq_u32 s3, 0
s_cbranch_scc1 L_back5
s_sub_u32 s3, s3, 1
s_sleep 1
buffer_load_dword v23, v1, s[24:27], s59 offen offset:384 sc1
s_waitcnt vmcnt(0)
v_cmp_ne_u32 vcc, s53, v23
s_cbranch_vccnz L_spin5
s_branch L_back5
L_spin6:
s_cmp_eq_u32 s3, 0
s_cbranch_scc1 L_back6
s_sub_u32 s3, s3, 1
s_sleep 2
buffer_load_dwordx4 v[160:163], v20, s[24:27], s71 offen offset:0 sc1
buffer_load_dwordx4 v[164:167], v20, s[24:27], s71 offen offset:1024 sc1
buffer_load_dwordx4 v[168:171], v20, s[24:27], s71 offen offset:2048 sc1
buffer_load_dwordx4 v[172:175], v20, s[24:27], s71 offen offset:3072 sc1
buffer_load_dwordx4 v[40:43], v20, s[24:27], s45 offen offset:0 sc1
s_waitcnt vmcnt(0)
v_xor_b32 v44, s53, v43
v_xor_b32 v45, s53, v175
v_xor_b32 v46, s53, v171
v_or3_b32 v44, v44, v45, v46
v_xor_b32 v45, s53, v167
v_xor_b32 v46, s53, v163
v_or3_b32 v44, v44, v45, v46
v_cmp_lt_u32 vcc, s72, v44
s_cbranch_vccnz L_spin6
s_branch L_back6
s_nop 0
L_spin7:
s_cmp_eq_u32 s3, 0
s_cbranch_scc1 L_back7
s_sub_u32 s3, s3, 1
s_sleep 1
buffer_load_dword v23, v1, s[24:27], s59 offen offset:512 sc1
s_waitcnt vmcnt(0)
v_cmp_ne_u32 vcc, s53, v23
s_cbranch_vccnz L_spin7
s_branch L_back7
L_spin8:
s_cmp_eq_u32 s3, 0
s_cbranch_scc1 L_back8
s_sub_u32 s3, s3, 1
s_sleep 2
buffer_load_dwordx4 v[176:179], v20, s[24:27], s45 offen offset:1024 sc1
buffer_load_dwordx4 v[180:183], v20, s[24:27], s45 offen offset:2048 sc1
buffer_load_dwordx4 v[184:187], v20, s[24:27], s45 offen offset:3072 sc1
buffer_load_dwordx4 v[188:191], v20, s[24:27], s46 offen offset:0 sc1
buffer_load_dwordx4 v[24:27], v20, s[24:27], s46 offen offset:1024 sc1
s_waitcnt vmcnt(0)
v_xor_b32 v44, s53, v27
v_xor_b32 v45, s53, v191
v_xor_b32 v46, s53, v187
v_or3_b32 v44, v44, v45, v46
v_xor_b32 v45, s53, v183
v_xor_b32 v46, s53, v179
v_or3_b32 v44, v44, v45, v46
v_cmp_lt_u32 vcc, s72, v44
s_cbranch_vccnz L_spin8
s_branch L_back8
s_nop 0
L_spin9:
s_cmp_eq_u32 s3, 0
s_cbranch_scc1 L_back9
s_sub_u32 s3, s3, 1
s_sleep 2
buffer_load_dwordx4 v[240:243], v20, s[24:27], s46 offen offset:2048 sc1
buffer_load_dwordx4 v[244:247], v20, s[24:27], s46 offen offset:3072 sc1
buffer_load_dwordx2 v[248:249], v63, s[24:27], s62 offen offset:0 sc1
s_waitcnt vmcnt(0)
v_xor_b32 v44, s53, v249
v_xor_b32 v45, s53, v247
v_xor_b32 v46, s53, v243
v_or3_b32 v44, v44, v45, v46
v_cmp_lt_u32 vcc, s72, v44
s_cbranch_vccnz L_spin9
s_branch L_back9
s_nop 0
L_spin10:
s_cmp_eq_u32 s3, 0
s_cbranch_scc1 L_back10
s_sub_u32 s3, s3, 1
s_sleep 1
buffer_load_dword v3, v62, s[24:27], s79 offen sc1
s_waitcnt vmcnt(0)
v_cmp_ne_u32 vcc, s53, v3
s_cbranch_vccnz L_spin10
s_branch L_back10
L_spin11:
s_cmp_eq_u32 s3, 0
s_cbranch_scc1 L_back11
s_sub_u32 s3, s3, 1
s_sleep 2
buffer_load_dwordx4 v[112:115], v20, s[24:27], s62 offen offset:1024 sc1
buffer_load_dwordx4 v[116:119], v20, s[24:27], s62 offen offset:2048 sc1
buffer_load_dwordx2 v[120:121], v63, s[24:27], s62 offen offset:512 sc1
s_waitcnt vmcnt(0)
v_xor_b32 v44, s53, v121
v_xor_b32 v45, s53, v119
v_xor_b32 v46, s53, v115
v_or3_b32 v44, v44, v45, v46
v_cmp_lt_u32 vcc, s72, v44
s_cbranch_vccnz L_spin11
s_branch L_back11
s_nop 0
L_spin12:
s_cmp_eq_u32 s3, 0
s_cbranch_scc1 L_back12
s_sub_u32 s3, s3, 1
s_sleep 1
buffer_load_dword v23, v1, s[24:27], s62 offen sc1
s_waitcnt vmcnt(0)
v_cmp_ne_u32 vcc, s53, v23
s_cbranch_vccnz L_spin12
s_branch L_back12
L_spin13:
s_cmp_eq_u32 s3, 0
s_cbranch_scc1 L_back13
s_sub_u32 s3, s3, 1
s_sleep 1
buffer_load_dword v23, v1, s[24:27], s59 offen offset:128 sc1
s_waitcnt vmcnt(0)
buffer_store_dword v56, v57, s[24:27], s63 offen offset:384 sc1
v_cmp_ne_u32 vcc, s53, v23
s_cbranch_vccnz L_spin13
s_branch L_back13
L_spin14:
s_cmp_eq_u32 s3, 0
s_cbranch_scc1 L_back14
s_sub_u32 s3, s3, 1
s_sleep 1
buffer_load_dword v5, v4, s[24:27], s80 offen sc1
s_waitcnt vmcnt(0)
v_cmp_ne_u32 vcc, s53, v5
s_cbranch_vccnz L_spin14
s_branch L_back14
L_spin15:
s_cmp_eq_u32 s3, 0
s_cbranch_scc1 L_back15
s_sub_u32 s3, s3, 1
s_sleep 1
buffer_load_dword v23, v1, s[24:27], s59 offen offset:256 sc1
s_waitcnt vmcnt(0)
v_cmp_ne_u32 vcc, s53, v23
s_cbranch_vccnz L_spin15
s_branch L_back15
L_spin16:
s_cmp_eq_u32 s3, 0
s_cbranch_scc1 L_back16
s_sub_u32 s3, s3, 1
s_sleep 1
buffer_load_dword v23, v1, s[24:27], s59 offen offset:512 sc1
s_waitcnt vmcnt(0)
v_cmp_ne_u32 vcc, s53, v23
s_cbranch_vccnz L_spin16
s_branch L_back16
L_spin17:
s_cmp_eq_u32 s3, 0
s_cbranch_scc1 L_back17
s_sub_u32 s3, s3, 1
s_sleep 1
buffer_load_dword v3, v62, s[24:27], s79 offen sc1
s_waitcnt vmcnt(0)
v_cmp_ne_u32 vcc, s53, v3
s_cbranch_vccnz L_spin17
s_branch L_back17
L_spin18:
s_cmp_eq_u32 s3, 0
s_cbranch_scc1 L_back18
s_sub_u32 s3, s3, 1
s_sleep 2
buffer_load_dwordx4 v[112:115], v20, s[24:27], s71 offen offset:0 sc1
buffer_load_dwordx4 v[116:119], v20, s[24:27], s71 offen offset:1024 sc1
buffer_load_dwordx4 v[120:123], v20, s[24:27], s71 offen offset:2048 sc1
buffer_load_dwordx4 v[124:127], v20, s[24:27], s71 offen offset:3072 sc1
buffer_load_dwordx4 v[188:191], v20, s[24:27], s45 offen offset:0 sc1
s_waitcnt vmcnt(0)
v_xor_b32 v44, s53, v191
v_xor_b32 v45, s53, v127
v_xor_b32 v46, s53, v123
v_or3_b32 v44, v44, v45, v46
v_xor_b32 v45, s53, v119
v_xor_b32 v46, s53, v115
v_or3_b32 v44, v44, v45, v46
v_cmp_lt_u32 vcc, s72, v44
s_cbranch_vccnz L_spin18
s_branch L_back18
s_nop 0
L_spin19:
s_cmp_eq_u32 s3, 0
s_cbranch_scc1 L_back19
s_sub_u32 s3, s3, 1
s_sleep 2
buffer_load_dwordx4 v[24:27], v20, s[24:27], s45 offen offset:1024 sc1
buffer_load_dwordx4 v[28:31], v20, s[24:27], s45 offen offset:2048 sc1
buffer_load_dwordx4 v[32:35], v20, s[24:27], s45 offen offset:3072 sc1
buffer_load_dwordx4 v[36:39], v20, s[24:27], s46 offen offset:0 sc1
buffer_load_dwordx4 v[40:43], v20, s[24:27], s46 offen offset:1024 sc1
s_waitcnt vmcnt(0)
v_xor_b32 v44, s53, v43
v_xor_b32 v45, s53, v39
v_xor_b32 v46, s53, v35
v_or3_b32 v44, v44, v45, v46
v_xor_b32 v45, s53, v31
v_xor_b32 v46, s53, v27
v_or3_b32 v44, v44, v45, v46
v_cmp_lt_u32 vcc, s72, v44
s_cbranch_vccnz L_spin19
s_branch L_back19
s_nop 0
L_spin20:
s_cmp_eq_u32 s3, 0
s_cbranch_scc1 L_back20
s_sub_u32 s3, s3, 1
s_sleep 2
buffer_load_dwordx4 v[10:13], v20, s[24:27], s46 offen offset:2048 sc1
buffer_load_dwordx4 v[14:17], v20, s[24:27], s46 offen offset:3072 sc1
buffer_load_dwordx2 v[18:19], v63, s[24:27], s62 offen offset:0 sc1
s_waitcnt vmcnt(0)
v_xor_b32 v44, s53, v19
v_xor_b32 v45, s53, v17
v_xor_b32 v46, s53, v13
v_or3_b32 v44, v44, v45, v46
v_cmp_lt_u32 vcc, s72, v44
s_cbranch_vccnz L_spin20
s_branch L_back20
s_nop 0
L_spin21:
s_cmp_eq_u32 s3, 0
s_cbranch_scc1 L_back21
s_sub_u32 s3, s3, 1
s_sleep 2
buffer_load_dwordx4 v[176:179], v20, s[24:27], s62 offen offset:1024 sc1
buffer_load_dwordx4 v[180:183], v20, s[24:27], s62 offen offset:2048 sc1
buffer_load_dwordx2 v[184:185], v63, s[24:27], s62 offen offset:512 sc1
s_waitcnt vmcnt(0)
v_xor_b32 v44, s53, v185
v_xor_b32 v45, s53, v183
v_xor_b32 v46, s53, v179
v_or3_b32 v44, v44, v45, v46
v_cmp_lt_u32 vcc, s72, v44
s_cbranch_vccnz L_spin21
s_branch L_back21
L_code_end:

.section .rodata,"a"
.p2align 6
.amdhsa_kernel parallel_sum__spectral_gfnet__dense_activation_gelu__prompt_kernel
  .amdhsa_next_free_vgpr 512
  .amdhsa_next_free_sgpr 102
  .amdhsa_accum_offset 256
  .amdhsa_group_segment_fixed_size 0
  .amdhsa_kernarg_size 88
  .amdhsa_user_sgpr_count 2
  .amdhsa_user_sgpr_kernarg_segment_ptr 1
  .amdhsa_system_sgpr_workgroup_id_x 1
.end_amdhsa_kernel
```
